```python
import torch

def _softmax(x, axis=-1):
    return torch.softmax(x, dim=axis)

def _gelu(x):
    return torch.nn.functional.gelu(x, approximate='tanh')

def _silu(x):
    return torch.nn.functional.silu(x)

def _sigmoid(x):
    return torch.sigmoid(x)

def _layernorm(x, axis=-1, eps=1e-05):
    m = x.mean(dim=axis, keepdim=True)
    v = x.var(dim=axis, keepdim=True, unbiased=False)
    return (x - m) / torch.sqrt(v + eps)

def _scatter_add(tgt, idx, src, axis=0):
    return tgt.clone().index_add_(axis, idx, src)

def _segment_sum(src, seg, n):
    out = torch.zeros((n,) + src.shape[1:], dtype=src.dtype)
    return out.index_add_(0, seg, src)

def _pad(x, pw):
    flat = tuple((v for pair in reversed(pw) for v in pair))
    return torch.nn.functional.pad(x, flat)
kernel_name = 'parallel_sum__compressed_kv_cla__mixer_gmlp__prompt'

def setup_inputs():

    _w = lambda a: (lambda t: t.to(torch.bfloat16) if t.is_floating_point() else t)(torch.as_tensor(a))

    def _A_setup():
        B, H, Sq, Sk, D, M = (1, 32, 2048, 2048, 128, 512)
        Dc = 4 * D
        return {'x': _w((lambda *s: torch.randn(*s, dtype=torch.bfloat16) * 0.05)(B, Sq, M)), 'c_kv': _w((lambda *s: torch.randn(*s, dtype=torch.bfloat16) * 1.6)(B, Sk, Dc)), 'w_q': _w((lambda *s: torch.randn(*s, dtype=torch.bfloat16) * 1.6)(M, H, D) * M ** (-0.5)), 'w_uk': _w((lambda *s: torch.randn(*s, dtype=torch.bfloat16) * 1.6)(Dc, H, D) * Dc ** (-0.5)), 'w_uv': _w((lambda *s: torch.randn(*s, dtype=torch.bfloat16) * 1.6)(Dc, H, D) * Dc ** (-0.5)), 'w_o': _w((lambda *s: torch.randn(*s, dtype=torch.bfloat16) * 1.6)(H, D, M) * (H * D) ** (-0.5))}
    _A_in = _A_setup()

    def _B_setup():
        B, S, D, F = (1, 2048, 512, 1792)
        Fh = F // 2
        return {'x': _w((lambda *s: torch.randn(*s, dtype=torch.bfloat16) * 0.05)(B, S, D)), 'w_in': _w((lambda *s: torch.randn(*s, dtype=torch.bfloat16) * 0.4)(D, 2 * Fh)), 'w_sp': _w(0.01 * (lambda *s: torch.randn(*s, dtype=torch.bfloat16) * 0.4)(S, S)), 'b_sp': _w(1.0 + 0.01 * (lambda *s: torch.randn(*s, dtype=torch.bfloat16) * 0.05)(S)), 'w_out': _w((lambda *s: torch.randn(*s, dtype=torch.bfloat16) * 0.05)(Fh, D))}
    _B_in = _B_setup()
    return {'A_x': _A_in['x'], 'A_c_kv': _A_in['c_kv'], 'A_w_q': _A_in['w_q'], 'A_w_uk': _A_in['w_uk'], 'A_w_uv': _A_in['w_uv'], 'A_w_o': _A_in['w_o'], 'B_x': _B_in['x'], 'B_w_in': _B_in['w_in'], 'B_w_sp': _B_in['w_sp'], 'B_b_sp': _B_in['b_sp'], 'B_w_out': _B_in['w_out']}

def reference(A_x, A_c_kv, A_w_q, A_w_uk, A_w_uv, A_w_o, B_x, B_w_in, B_w_sp, B_b_sp, B_w_out):

    def _A_ref(x, c_kv, w_q, w_uk, w_uv, w_o):
        B, Sq, M = (x.shape[0], x.shape[1], x.shape[2])
        Sk = c_kv.shape[1]
        H, D = (w_q.shape[1], w_q.shape[2])
        q = torch.einsum('bqm,mhd->bhqd', x, w_q)
        k = torch.einsum('bkc,chd->bhkd', c_kv, w_uk)
        v = torch.einsum('bkc,chd->bhkd', c_kv, w_uv)
        scores = torch.einsum('bhqd,bhkd->bhqk', q, k) * D ** (-0.5)
        off = Sk - Sq
        qi = torch.arange(Sq)[:, None]
        kj = torch.arange(Sk)[None, :]
        cmask = kj <= qi + off
        scores = torch.where(cmask[None, None], scores, -1000000000.0)
        p = _softmax(scores, axis=-1)
        ctx = torch.einsum('bhqk,bhkd->bhqd', p, v)
        return torch.einsum('bhqd,hdm->bqm', ctx, w_o)

    def _B_ref(x, w_in, w_sp, b_sp, w_out):
        B, S, D = x.shape
        F = w_in.shape[-1]
        Fh = F // 2
        z = _gelu(torch.einsum('bsd,df->bsf', x, w_in))
        z1 = z[..., :Fh].clone()
        z2 = _layernorm(z[..., Fh:], axis=-1)
        g = torch.einsum('ts,bsf->btf', w_sp, z2) + b_sp[None, :, None]
        return torch.einsum('bsf,fd->bsd', z1 * g, w_out)
    x = A_x
    xn = _layernorm(x, axis=-1)
    return x + _A_ref(xn, A_c_kv, A_w_q, A_w_uk, A_w_uv, A_w_o) + _B_ref(xn, B_w_in, B_w_sp, B_b_sp, B_w_out)
```

```asm
; @launch grid=(256,1,1) block=(512,1,1) lds=163840
.amdgcn_target "amdgcn-amd-amdhsa--gfx950"
.text
.globl parallel_sum__compressed_kv_cla__mixer_gmlp__prompt_kernel
.p2align 8
.type parallel_sum__compressed_kv_cla__mixer_gmlp__prompt_kernel,@function
parallel_sum__compressed_kv_cla__mixer_gmlp__prompt_kernel:
    s_cmp_ge_u32 s2, 256
    s_cbranch_scc1 L_k1_exit
    s_load_dwordx4 s[4:7], s[0:1], 0
    s_load_dwordx4 s[12:15], s[0:1], 24
    s_load_dwordx2 s[24:25], s[0:1], 16
    s_load_dwordx2 s[96:97], s[0:1], 56
    s_load_dwordx4 s[16:19], s[0:1], 96
    v_lshrrev_b32 v84, 6, v0
    v_and_b32 v1, 63, v0
    v_readfirstlane_b32 s32, v84
    s_and_b32 s34, s2, 7
    s_lshl_b32 s34, s34, 1
    s_bfe_u32 s39, s2, 0x10003
    s_add_u32 s34, s34, s39
    s_and_b32 s39, s2, 16
    s_add_u32 s34, s34, s39
    s_lshr_b32 s33, s2, 5
    s_lshl_b32 s38, s33, 3
    s_add_u32 s38, s38, s32
    s_lshl_b32 s36, s32, 12
    s_lshl_b32 s46, s32, 11
    s_lshl_b32 s42, s38, 15
    s_and_b32 s43, s34, 15
    s_lshl_b32 s43, s43, 9
    s_lshr_b32 s39, s32, 2
    s_lshl_b32 s39, s39, 7
    s_add_u32 s47, s43, s39
    s_and_b32 s39, s32, 3
    s_lshl_b32 s39, s39, 17
    s_add_u32 s47, s47, s39
    v_lshrrev_b32 v84, 4, v1
    v_and_b32 v85, 7, v1
    v_xor_b32 v84, v84, v85
    v_lshrrev_b32 v86, 3, v1
    v_lshlrev_b32 v87, 10, v86
    v_lshl_add_u32 v236, v84, 4, v87
    v_xor_b32 v237, 64, v236
    v_add_u32 v237, 7168, v237
    v_add_u32 v238, 14336, v236
    v_add_u32 v239, 14336, v237
    v_lshlrev_b32 v100, 10, v85
    v_lshl_add_u32 v100, v86, 4, v100
    s_lshl_b32 s41, s2, 13
    s_lshl_b32 s39, s32, 7
    s_add_u32 s41, s41, s39
    v_bfe_u32 v87, v1, 4, 1
    v_lshlrev_b32 v87, 2, v87
    v_xor_b32 v87, v87, v85
    v_lshlrev_b32 v88, 13, v86
    v_lshl_add_u32 v248, v87, 4, v88
    v_xor_b32 v249, 16, v248
    v_add_u32 v249, 64512, v249
    s_waitcnt lgkmcnt(0)
    s_mov_b32 s28, s4
    s_mov_b32 s29, s5
    s_mov_b32 s30, 2097152
    s_mov_b32 s31, 0x20000
    s_mov_b32 s20, s6
    s_mov_b32 s21, s7
    s_mov_b32 s22, 2097152
    s_mov_b32 s23, 0x20000
    s_cmp_lt_u32 s34, 16
    s_cselect_b32 s8, s12, s14
    s_cselect_b32 s9, s13, s15
    s_mov_b32 s10, 4194304
    s_mov_b32 s11, 0x20000
    buffer_load_dwordx4 v[96:99], v100, s[28:31], s41 offen
    s_add_u32 m0, s46, 98304
    s_add_u32 s35, s47, 0
    buffer_load_dwordx4 v248, s[8:11], s35 offen offset:0 lds
    buffer_load_dwordx4 v249, s[8:11], s35 offen offset:1024 lds
    s_add_u32 m0, s36, 0
    s_add_u32 s35, s42, 0
    buffer_load_dwordx4 v236, s[20:23], s35 offen offset:0 lds
    buffer_load_dwordx4 v237, s[20:23], s35 offen offset:1024 lds
    buffer_load_dwordx4 v238, s[20:23], s35 offen offset:2048 lds
    buffer_load_dwordx4 v239, s[20:23], s35 offen offset:3072 lds
    s_add_u32 m0, s46, 114688
    s_add_u32 s35, s47, 524288
    buffer_load_dwordx4 v248, s[8:11], s35 offen offset:0 lds
    buffer_load_dwordx4 v249, s[8:11], s35 offen offset:1024 lds
    s_add_u32 m0, s36, 32768
    s_add_u32 s35, s42, 128
    buffer_load_dwordx4 v236, s[20:23], s35 offen offset:0 lds
    buffer_load_dwordx4 v237, s[20:23], s35 offen offset:1024 lds
    buffer_load_dwordx4 v238, s[20:23], s35 offen offset:2048 lds
    buffer_load_dwordx4 v239, s[20:23], s35 offen offset:3072 lds
    s_add_u32 m0, s46, 131072
    s_add_u32 s35, s47, 1048576
    buffer_load_dwordx4 v248, s[8:11], s35 offen offset:0 lds
    buffer_load_dwordx4 v249, s[8:11], s35 offen offset:1024 lds
    s_add_u32 m0, s36, 65536
    s_add_u32 s35, s42, 256
    buffer_load_dwordx4 v236, s[20:23], s35 offen offset:0 lds
    buffer_load_dwordx4 v237, s[20:23], s35 offen offset:1024 lds
    buffer_load_dwordx4 v238, s[20:23], s35 offen offset:2048 lds
    buffer_load_dwordx4 v239, s[20:23], s35 offen offset:3072 lds
    s_lshl_b32 s39, s32, 5
    v_add_u32 v86, s39, v86
    v_mul_u32_u24 v88, 8192, v86
    v_lshl_add_u32 v228, v87, 4, v88
    v_xor_b32 v229, 16, v228
    v_add_u32 v229, 64512, v229
    v_add_u32 v230, 129024, v228
    v_add_u32 v231, 129024, v229
    s_mov_b32 s26, 4194304
    s_mov_b32 s27, 0x20000
    s_mov_b32 s98, 1835008
    s_mov_b32 s99, 0x20000
    s_mov_b32 s52, s16
    s_mov_b32 s53, s17
    s_mov_b32 s54, 256
    s_mov_b32 s55, 0x20000
    s_mov_b32 s56, s18
    s_mov_b32 s57, s19
    s_mov_b32 s58, 2097152
    s_mov_b32 s59, 0x20000
    s_and_b32 s44, s2, 7
    s_lshl_b32 s44, s44, 2
    s_bfe_u32 s39, s2, 0x20003
    s_add_u32 s44, s44, s39
    s_lshl_b32 s45, s44, 7
    s_cmp_lt_u32 s44, 28
    s_cselect_b32 s45, s45, 0x40000000
    s_lshl_b32 s44, s44, 8
    s_cmp_lg_u32 s2, 0
    s_cbranch_scc1 L_k1_nozero
    s_add_u32 s28, s18, 92274688
    s_addc_u32 s29, s19, 0
    s_mov_b32 s30, 24576
    s_mov_b32 s31, 0x20000
    v_lshlrev_b32 v84, 7, v0
    v_mov_b32 v85, 0
    buffer_store_dword v85, v84, s[28:31], 0 offen sc1
L_k1_nozero:
    s_lshr_b32 s39, s34, 4
    s_lshl_b32 s39, s39, 24
    s_add_u32 s39, s39, 16777216
    s_add_u32 s28, s18, s39
    s_addc_u32 s29, s19, 0
    s_mov_b32 s30, 16777216
    s_and_b32 s37, s34, 15
    s_lshl_b32 s37, s37, 20
    s_lshl_b32 s39, s38, 13
    s_add_u32 s37, s37, s39
    v_and_b32 v84, 15, v1
    v_bfe_u32 v85, v1, 1, 3
    v_lshrrev_b32 v86, 4, v1
    v_xor_b32 v85, v85, v86
    v_lshlrev_b32 v84, 7, v84
    v_lshl_add_u32 v84, v85, 4, v84
    v_add_u32 v240, s36, v84
    v_xor_b32 v241, 64, v240
    v_add_u32 v242, 65536, v240
    v_add_u32 v243, 65536, v241
    v_bfe_u32 v85, v1, 2, 2
    v_lshl_add_u32 v86, v86, 3, v85
    v_lshlrev_b32 v86, 7, v86
    v_and_b32 v87, 1, v1
    v_lshl_add_u32 v86, v87, 3, v86
    v_bfe_u32 v87, v1, 3, 1
    v_lshl_add_u32 v86, v87, 6, v86
    v_bfe_u32 v87, v1, 1, 1
    v_bfe_u32 v88, v1, 4, 1
    v_lshl_add_u32 v86, v87, 5, v86
    v_lshl_add_u32 v232, v88, 4, v86
    v_xor_b32 v233, 16, v232
    v_xor_b32 v234, 64, v232
    v_xor_b32 v235, 80, v232
    v_add_u32 v244, 98304, v232
    v_add_u32 v245, 98304, v233
    v_add_u32 v246, 98304, v234
    v_add_u32 v247, 98304, v235
    v_lshlrev_b32 v2, 4, v1
    v_mov_b32 v86, 0x3f803f80
    v_mov_b32 v84, 0
    v_mov_b32 v85, 0
    v_and_b32 v89, 7, v1
    v_lshlrev_b32 v89, 6, v89
    v_add_u32 v89, 147456, v89
    s_lshl_b32 s39, s32, 3
    v_add_u32 v90, s39, v89
    s_waitcnt vmcnt(18)
    v_dot2_f32_bf16 v84, v96, v86, v84
    v_dot2_f32_bf16 v85, v96, v96, v85
    v_dot2_f32_bf16 v84, v97, v86, v84
    v_dot2_f32_bf16 v85, v97, v97, v85
    v_dot2_f32_bf16 v84, v98, v86, v84
    v_dot2_f32_bf16 v85, v98, v98, v85
    v_dot2_f32_bf16 v84, v99, v86, v84
    v_dot2_f32_bf16 v85, v99, v99, v85
    s_nop 2
    v_add_f32_dpp v84, v84, v84 row_ror:8 row_mask:0xf bank_mask:0xf
    v_add_f32_dpp v85, v85, v85 row_ror:8 row_mask:0xf bank_mask:0xf
    v_mov_b32 v87, v84
    v_mov_b32 v88, v85
    s_nop 1
    v_permlane16_swap_b32 v84, v87
    v_permlane16_swap_b32 v85, v88
    s_nop 1
    v_add_f32 v84, v84, v87
    v_add_f32 v85, v85, v88
    v_mov_b32 v87, v84
    v_mov_b32 v88, v85
    s_nop 1
    v_permlane32_swap_b32 v84, v87
    v_permlane32_swap_b32 v85, v88
    s_nop 1
    v_add_f32 v84, v84, v87
    v_add_f32 v85, v85, v88
    ds_write_b64 v90, v[84:85]
    s_lshr_b32 s41, s2, 2
    s_lshl_b32 s41, s41, 15
    s_add_u32 s41, s41, s36
    s_bfe_u32 s39, s2, 0x10001
    s_lshl_b32 s39, s39, 10
    s_add_u32 s41, s41, s39
    s_and_b32 s39, s2, 1
    s_lshl_b32 s39, s39, 7
    s_add_u32 s41, s41, s39
    s_mov_b32 s48, s41
    s_lshl_b32 s49, s2, 3
    s_add_u32 s49, s49, s32
    s_lshl_b32 s50, s49, 10
    s_lshl_b32 s49, s49, 11
    v_and_b32 v254, 3, v1
    v_lshlrev_b32 v254, 7, v254
    s_waitcnt vmcnt(12) lgkmcnt(0)
    s_barrier
    ds_read_b128 v[104:107], v89 offset:0
    ds_read_b128 v[108:111], v89 offset:16
    ds_read_b128 v[112:115], v89 offset:32
    ds_read_b128 v[116:119], v89 offset:48
    s_cmp_lt_u32 s34, 16
    s_cbranch_scc0 L_k1_V
L_k1_K:
    s_waitcnt vmcnt(12)
    ds_read_b128 v[4:7], v240 offset:0
    ds_read_b128 v[8:11], v240 offset:2048
    ds_read_b128 v[12:15], v241 offset:0
    ds_read_b128 v[16:19], v241 offset:2048
    ds_read_b64_tr_b16 v[196:197], v244 offset:0
    ds_read_b64_tr_b16 v[198:199], v244 offset:512
    ds_read_b64_tr_b16 v[200:201], v245 offset:0
    ds_read_b64_tr_b16 v[202:203], v245 offset:512
    ds_read_b64_tr_b16 v[204:205], v246 offset:0
    ds_read_b64_tr_b16 v[206:207], v246 offset:512
    ds_read_b64_tr_b16 v[208:209], v247 offset:0
    ds_read_b64_tr_b16 v[210:211], v247 offset:512
    ds_read_b64_tr_b16 v[212:213], v244 offset:8192
    ds_read_b64_tr_b16 v[214:215], v244 offset:8704
    ds_read_b64_tr_b16 v[216:217], v245 offset:8192
    ds_read_b64_tr_b16 v[218:219], v245 offset:8704
    s_waitcnt vmcnt(10) lgkmcnt(12)
    s_barrier
    s_waitcnt lgkmcnt(8)
    v_mfma_f32_16x16x32_bf16 v[132:135], v[196:199], v[4:7], 0
    ds_read_b64_tr_b16 v[220:221], v246 offset:8192
    v_mfma_f32_16x16x32_bf16 v[140:143], v[196:199], v[8:11], 0
    ds_read_b64_tr_b16 v[222:223], v246 offset:8704
    s_add_u32 m0, s46, 147456
    s_add_u32 s35, s47, 1572864
    buffer_load_dwordx4 v248, s[8:11], s35 offen offset:0 lds
    v_mfma_f32_16x16x32_bf16 v[136:139], v[200:203], v[4:7], 0
    ds_read_b64_tr_b16 v[224:225], v247 offset:8192
    v_mfma_f32_16x16x32_bf16 v[144:147], v[200:203], v[8:11], 0
    ds_read_b64_tr_b16 v[226:227], v247 offset:8704
    buffer_load_dwordx4 v249, s[8:11], s35 offen offset:1024 lds
    s_waitcnt lgkmcnt(8)
    v_mfma_f32_16x16x32_bf16 v[148:151], v[204:207], v[4:7], 0
    ds_read_b64_tr_b16 v[196:197], v244 offset:4096
    v_mfma_f32_16x16x32_bf16 v[156:159], v[204:207], v[8:11], 0
    ds_read_b64_tr_b16 v[198:199], v244 offset:4608
    s_add_u32 m0, s36, 0
    s_add_u32 s35, s42, 384
    buffer_load_dwordx4 v236, s[20:23], s35 offen offset:0 lds
    v_mfma_f32_16x16x32_bf16 v[152:155], v[208:211], v[4:7], 0
    ds_read_b64_tr_b16 v[200:201], v245 offset:4096
    v_mfma_f32_16x16x32_bf16 v[160:163], v[208:211], v[8:11], 0
    ds_read_b64_tr_b16 v[202:203], v245 offset:4608
    buffer_load_dwordx4 v237, s[20:23], s35 offen offset:1024 lds
    s_waitcnt lgkmcnt(8)
    v_mfma_f32_16x16x32_bf16 v[164:167], v[212:215], v[4:7], 0
    ds_read_b64_tr_b16 v[204:205], v246 offset:4096
    v_lshrrev_b32 v100, 5, v1
    v_mfma_f32_16x16x32_bf16 v[172:175], v[212:215], v[8:11], 0
    ds_read_b64_tr_b16 v[206:207], v246 offset:4608
    buffer_load_dwordx4 v238, s[20:23], s35 offen offset:2048 lds
    v_lshlrev_b32 v100, 11, v100
    v_mfma_f32_16x16x32_bf16 v[168:171], v[216:219], v[4:7], 0
    ds_read_b64_tr_b16 v[208:209], v247 offset:4096
    v_bfe_u32 v87, v1, 3, 2
    v_mfma_f32_16x16x32_bf16 v[176:179], v[216:219], v[8:11], 0
    ds_read_b64_tr_b16 v[210:211], v247 offset:4608
    buffer_load_dwordx4 v239, s[20:23], s35 offen offset:3072 lds
    v_lshl_add_u32 v100, v87, 8, v100
    s_waitcnt vmcnt(12)
    ds_read_b128 v[20:23], v240 offset:32768
    ds_read_b128 v[24:27], v240 offset:34816
    ds_read_b128 v[28:31], v241 offset:32768
    ds_read_b128 v[32:35], v241 offset:34816
    s_waitcnt lgkmcnt(8)
    v_mfma_f32_16x16x32_bf16 v[180:183], v[220:223], v[4:7], 0
    ds_read_b64_tr_b16 v[212:213], v244 offset:12288
    v_and_b32 v87, 7, v1
    v_mfma_f32_16x16x32_bf16 v[188:191], v[220:223], v[8:11], 0
    ds_read_b64_tr_b16 v[214:215], v244 offset:12800
    v_lshl_add_u32 v100, v87, 4, v100
    v_mfma_f32_16x16x32_bf16 v[184:187], v[224:227], v[4:7], 0
    ds_read_b64_tr_b16 v[216:217], v245 offset:12288
    v_add_f32 v104, v104, v106
    v_mfma_f32_16x16x32_bf16 v[192:195], v[224:227], v[8:11], 0
    ds_read_b64_tr_b16 v[218:219], v245 offset:12800
    v_add_f32 v105, v105, v107
    s_waitcnt lgkmcnt(8)
    v_mfma_f32_16x16x32_bf16 v[132:135], v[196:199], v[12:15], v[132:135]
    ds_read_b64_tr_b16 v[220:221], v246 offset:12288
    v_add_f32 v104, v104, v108
    v_mfma_f32_16x16x32_bf16 v[140:143], v[196:199], v[16:19], v[140:143]
    ds_read_b64_tr_b16 v[222:223], v246 offset:12800
    v_add_f32 v105, v105, v109
    v_mfma_f32_16x16x32_bf16 v[136:139], v[200:203], v[12:15], v[136:139]
    ds_read_b64_tr_b16 v[224:225], v247 offset:12288
    v_add_f32 v104, v104, v110
    v_mfma_f32_16x16x32_bf16 v[144:147], v[200:203], v[16:19], v[144:147]
    ds_read_b64_tr_b16 v[226:227], v247 offset:12800
    v_add_f32 v105, v105, v111
    s_waitcnt lgkmcnt(8)
    v_mfma_f32_16x16x32_bf16 v[148:151], v[204:207], v[12:15], v[148:151]
    ds_read_b64_tr_b16 v[196:197], v244 offset:16384
    v_add_f32 v104, v104, v112
    v_mfma_f32_16x16x32_bf16 v[156:159], v[204:207], v[16:19], v[156:159]
    ds_read_b64_tr_b16 v[198:199], v244 offset:16896
    v_add_f32 v105, v105, v113
    v_mfma_f32_16x16x32_bf16 v[152:155], v[208:211], v[12:15], v[152:155]
    ds_read_b64_tr_b16 v[200:201], v245 offset:16384
    v_add_f32 v104, v104, v114
    v_mfma_f32_16x16x32_bf16 v[160:163], v[208:211], v[16:19], v[160:163]
    ds_read_b64_tr_b16 v[202:203], v245 offset:16896
    v_add_f32 v105, v105, v115
    s_waitcnt lgkmcnt(8)
    v_mfma_f32_16x16x32_bf16 v[164:167], v[212:215], v[12:15], v[164:167]
    ds_read_b64_tr_b16 v[204:205], v246 offset:16384
    v_add_f32 v104, v104, v116
    v_mfma_f32_16x16x32_bf16 v[172:175], v[212:215], v[16:19], v[172:175]
    ds_read_b64_tr_b16 v[206:207], v246 offset:16896
    s_add_u32 m0, s36, 32768
    s_add_u32 s35, s42, 512
    buffer_load_dwordx4 v236, s[20:23], s35 offen offset:0 lds
    v_add_f32 v105, v105, v117
    v_mfma_f32_16x16x32_bf16 v[168:171], v[216:219], v[12:15], v[168:171]
    ds_read_b64_tr_b16 v[208:209], v247 offset:16384
    v_add_f32 v104, v104, v118
    v_mfma_f32_16x16x32_bf16 v[176:179], v[216:219], v[16:19], v[176:179]
    ds_read_b64_tr_b16 v[210:211], v247 offset:16896
    buffer_load_dwordx4 v237, s[20:23], s35 offen offset:1024 lds
    v_add_f32 v105, v105, v119
    s_waitcnt lgkmcnt(8)
    v_mfma_f32_16x16x32_bf16 v[180:183], v[220:223], v[12:15], v[180:183]
    ds_read_b64_tr_b16 v[212:213], v244 offset:24576
    v_mul_f32 v84, 0x3b000000, v104
    v_mfma_f32_16x16x32_bf16 v[188:191], v[220:223], v[16:19], v[188:191]
    ds_read_b64_tr_b16 v[214:215], v244 offset:25088
    buffer_load_dwordx4 v238, s[20:23], s35 offen offset:2048 lds
    v_mul_f32 v85, 0x3b000000, v105
    v_mfma_f32_16x16x32_bf16 v[184:187], v[224:227], v[12:15], v[184:187]
    ds_read_b64_tr_b16 v[216:217], v245 offset:24576
    v_fma_f32 v85, -v84, v84, v85
    v_mfma_f32_16x16x32_bf16 v[192:195], v[224:227], v[16:19], v[192:195]
    ds_read_b64_tr_b16 v[218:219], v245 offset:25088
    buffer_load_dwordx4 v239, s[20:23], s35 offen offset:3072 lds
    v_max_f32 v85, 0, v85
    s_waitcnt vmcnt(14)
    s_barrier
    s_waitcnt lgkmcnt(8)
    v_mfma_f32_16x16x32_bf16 v[132:135], v[196:199], v[20:23], v[132:135]
    ds_read_b64_tr_b16 v[220:221], v246 offset:24576
    v_mfma_f32_16x16x32_bf16 v[140:143], v[196:199], v[24:27], v[140:143]
    ds_read_b64_tr_b16 v[222:223], v246 offset:25088
    s_add_u32 m0, s46, 98304
    s_add_u32 s35, s47, 2097152
    buffer_load_dwordx4 v248, s[8:11], s35 offen offset:0 lds
    v_mfma_f32_16x16x32_bf16 v[136:139], v[200:203], v[20:23], v[136:139]
    ds_read_b64_tr_b16 v[224:225], v247 offset:24576
    v_mfma_f32_16x16x32_bf16 v[144:147], v[200:203], v[24:27], v[144:147]
    ds_read_b64_tr_b16 v[226:227], v247 offset:25088
    buffer_load_dwordx4 v249, s[8:11], s35 offen offset:1024 lds
    s_waitcnt lgkmcnt(8)
    v_mfma_f32_16x16x32_bf16 v[148:151], v[204:207], v[20:23], v[148:151]
    ds_read_b64_tr_b16 v[196:197], v244 offset:20480
    v_mfma_f32_16x16x32_bf16 v[156:159], v[204:207], v[24:27], v[156:159]
    ds_read_b64_tr_b16 v[198:199], v244 offset:20992
    v_mfma_f32_16x16x32_bf16 v[152:155], v[208:211], v[20:23], v[152:155]
    ds_read_b64_tr_b16 v[200:201], v245 offset:20480
    v_mfma_f32_16x16x32_bf16 v[160:163], v[208:211], v[24:27], v[160:163]
    ds_read_b64_tr_b16 v[202:203], v245 offset:20992
    s_waitcnt lgkmcnt(8)
    v_mfma_f32_16x16x32_bf16 v[164:167], v[212:215], v[20:23], v[164:167]
    ds_read_b64_tr_b16 v[204:205], v246 offset:20480
    v_cvt_pk_bf16_f32 v87, v84, v85
    v_mfma_f32_16x16x32_bf16 v[172:175], v[212:215], v[24:27], v[172:175]
    ds_read_b64_tr_b16 v[206:207], v246 offset:20992
    v_lshlrev_b32 v84, 16, v87
    v_mfma_f32_16x16x32_bf16 v[168:171], v[216:219], v[20:23], v[168:171]
    ds_read_b64_tr_b16 v[208:209], v247 offset:20480
    v_and_b32 v85, 0xffff0000, v87
    v_mfma_f32_16x16x32_bf16 v[176:179], v[216:219], v[24:27], v[176:179]
    ds_read_b64_tr_b16 v[210:211], v247 offset:20992
    v_add_f32 v85, 0x3727c5ac, v85
    s_waitcnt vmcnt(12)
    ds_read_b128 v[36:39], v242 offset:0
    ds_read_b128 v[40:43], v242 offset:2048
    ds_read_b128 v[44:47], v243 offset:0
    ds_read_b128 v[48:51], v243 offset:2048
    s_waitcnt lgkmcnt(8)
    v_mfma_f32_16x16x32_bf16 v[180:183], v[220:223], v[20:23], v[180:183]
    ds_read_b64_tr_b16 v[212:213], v244 offset:28672
    v_cvt_pk_bf16_f32 v85, v85, v85
    v_mfma_f32_16x16x32_bf16 v[188:191], v[220:223], v[24:27], v[188:191]
    ds_read_b64_tr_b16 v[214:215], v244 offset:29184
    v_and_b32 v85, 0xffff0000, v85
    v_mfma_f32_16x16x32_bf16 v[184:187], v[224:227], v[20:23], v[184:187]
    ds_read_b64_tr_b16 v[216:217], v245 offset:28672
    v_sqrt_f32 v85, v85
    s_nop 0
    v_mfma_f32_16x16x32_bf16 v[192:195], v[224:227], v[24:27], v[192:195]
    ds_read_b64_tr_b16 v[218:219], v245 offset:29184
    v_cvt_pk_bf16_f32 v85, v85, v85
    s_waitcnt lgkmcnt(8)
    v_mfma_f32_16x16x32_bf16 v[132:135], v[196:199], v[28:31], v[132:135]
    ds_read_b64_tr_b16 v[220:221], v246 offset:28672
    v_and_b32 v85, 0xffff0000, v85
    v_mfma_f32_16x16x32_bf16 v[140:143], v[196:199], v[32:35], v[140:143]
    ds_read_b64_tr_b16 v[222:223], v246 offset:29184
    v_rcp_f32 v85, v85
    v_mfma_f32_16x16x32_bf16 v[136:139], v[200:203], v[28:31], v[136:139]
    ds_read_b64_tr_b16 v[224:225], v247 offset:28672
    v_lshlrev_b32 v87, 16, v96
    v_mfma_f32_16x16x32_bf16 v[144:147], v[200:203], v[32:35], v[144:147]
    ds_read_b64_tr_b16 v[226:227], v247 offset:29184
    v_and_b32 v88, 0xffff0000, v96
    s_waitcnt lgkmcnt(8)
    v_mfma_f32_16x16x32_bf16 v[148:151], v[204:207], v[28:31], v[148:151]
    ds_read_b64_tr_b16 v[196:197], v244 offset:32768
    v_sub_f32 v87, v87, v84
    v_mfma_f32_16x16x32_bf16 v[156:159], v[204:207], v[32:35], v[156:159]
    ds_read_b64_tr_b16 v[198:199], v244 offset:33280
    v_sub_f32 v88, v88, v84
    v_mfma_f32_16x16x32_bf16 v[152:155], v[208:211], v[28:31], v[152:155]
    ds_read_b64_tr_b16 v[200:201], v245 offset:32768
    v_cvt_pk_bf16_f32 v88, v87, v88
    v_mfma_f32_16x16x32_bf16 v[160:163], v[208:211], v[32:35], v[160:163]
    ds_read_b64_tr_b16 v[202:203], v245 offset:33280
    v_lshlrev_b32 v87, 16, v88
    s_waitcnt lgkmcnt(8)
    v_mfma_f32_16x16x32_bf16 v[164:167], v[212:215], v[28:31], v[164:167]
    ds_read_b64_tr_b16 v[204:205], v246 offset:32768
    v_and_b32 v88, 0xffff0000, v88
    v_mfma_f32_16x16x32_bf16 v[172:175], v[212:215], v[32:35], v[172:175]
    ds_read_b64_tr_b16 v[206:207], v246 offset:33280
    s_add_u32 m0, s36, 65536
    s_add_u32 s35, s42, 640
    buffer_load_dwordx4 v236, s[20:23], s35 offen offset:0 lds
    v_mul_f32 v87, v87, v85
    v_mfma_f32_16x16x32_bf16 v[168:171], v[216:219], v[28:31], v[168:171]
    ds_read_b64_tr_b16 v[208:209], v247 offset:32768
    v_mul_f32 v88, v88, v85
    v_mfma_f32_16x16x32_bf16 v[176:179], v[216:219], v[32:35], v[176:179]
    ds_read_b64_tr_b16 v[210:211], v247 offset:33280
    buffer_load_dwordx4 v237, s[20:23], s35 offen offset:1024 lds
    v_cvt_pk_bf16_f32 v96, v87, v88
    s_waitcnt lgkmcnt(8)
    v_mfma_f32_16x16x32_bf16 v[180:183], v[220:223], v[28:31], v[180:183]
    ds_read_b64_tr_b16 v[212:213], v244 offset:40960
    v_lshlrev_b32 v87, 16, v97
    v_mfma_f32_16x16x32_bf16 v[188:191], v[220:223], v[32:35], v[188:191]
    ds_read_b64_tr_b16 v[214:215], v244 offset:41472
    buffer_load_dwordx4 v238, s[20:23], s35 offen offset:2048 lds
    v_and_b32 v88, 0xffff0000, v97
    v_mfma_f32_16x16x32_bf16 v[184:187], v[224:227], v[28:31], v[184:187]
    ds_read_b64_tr_b16 v[216:217], v245 offset:40960
    v_sub_f32 v87, v87, v84
    v_mfma_f32_16x16x32_bf16 v[192:195], v[224:227], v[32:35], v[192:195]
    ds_read_b64_tr_b16 v[218:219], v245 offset:41472
    buffer_load_dwordx4 v239, s[20:23], s35 offen offset:3072 lds
    v_sub_f32 v88, v88, v84
    s_waitcnt vmcnt(14)
    s_barrier
    s_waitcnt lgkmcnt(8)
    v_mfma_f32_16x16x32_bf16 v[132:135], v[196:199], v[36:39], v[132:135]
    ds_read_b64_tr_b16 v[220:221], v246 offset:40960
    v_mfma_f32_16x16x32_bf16 v[140:143], v[196:199], v[40:43], v[140:143]
    ds_read_b64_tr_b16 v[222:223], v246 offset:41472
    s_add_u32 m0, s46, 114688
    s_add_u32 s35, s47, 2621440
    buffer_load_dwordx4 v248, s[8:11], s35 offen offset:0 lds
    v_mfma_f32_16x16x32_bf16 v[136:139], v[200:203], v[36:39], v[136:139]
    ds_read_b64_tr_b16 v[224:225], v247 offset:40960
    v_mfma_f32_16x16x32_bf16 v[144:147], v[200:203], v[40:43], v[144:147]
    ds_read_b64_tr_b16 v[226:227], v247 offset:41472
    buffer_load_dwordx4 v249, s[8:11], s35 offen offset:1024 lds
    s_waitcnt lgkmcnt(8)
    v_mfma_f32_16x16x32_bf16 v[148:151], v[204:207], v[36:39], v[148:151]
    ds_read_b64_tr_b16 v[196:197], v244 offset:36864
    v_mfma_f32_16x16x32_bf16 v[156:159], v[204:207], v[40:43], v[156:159]
    ds_read_b64_tr_b16 v[198:199], v244 offset:37376
    buffer_load_dword v255, v254, s[24:27], s49 offen offset:0
    v_mfma_f32_16x16x32_bf16 v[152:155], v[208:211], v[36:39], v[152:155]
    ds_read_b64_tr_b16 v[200:201], v245 offset:36864
    v_mfma_f32_16x16x32_bf16 v[160:163], v[208:211], v[40:43], v[160:163]
    ds_read_b64_tr_b16 v[202:203], v245 offset:37376
    s_waitcnt lgkmcnt(8)
    v_mfma_f32_16x16x32_bf16 v[164:167], v[212:215], v[36:39], v[164:167]
    ds_read_b64_tr_b16 v[204:205], v246 offset:36864
    v_cvt_pk_bf16_f32 v88, v87, v88
    v_mfma_f32_16x16x32_bf16 v[172:175], v[212:215], v[40:43], v[172:175]
    ds_read_b64_tr_b16 v[206:207], v246 offset:37376
    v_lshlrev_b32 v87, 16, v88
    v_mfma_f32_16x16x32_bf16 v[168:171], v[216:219], v[36:39], v[168:171]
    ds_read_b64_tr_b16 v[208:209], v247 offset:36864
    v_and_b32 v88, 0xffff0000, v88
    v_mfma_f32_16x16x32_bf16 v[176:179], v[216:219], v[40:43], v[176:179]
    ds_read_b64_tr_b16 v[210:211], v247 offset:37376
    v_mul_f32 v87, v87, v85
    s_waitcnt vmcnt(13)
    ds_read_b128 v[52:55], v240 offset:0
    ds_read_b128 v[56:59], v240 offset:2048
    ds_read_b128 v[60:63], v241 offset:0
    ds_read_b128 v[64:67], v241 offset:2048
    s_waitcnt lgkmcnt(8)
    v_mfma_f32_16x16x32_bf16 v[180:183], v[220:223], v[36:39], v[180:183]
    ds_read_b64_tr_b16 v[212:213], v244 offset:45056
    v_mul_f32 v88, v88, v85
    v_mfma_f32_16x16x32_bf16 v[188:191], v[220:223], v[40:43], v[188:191]
    ds_read_b64_tr_b16 v[214:215], v244 offset:45568
    v_cvt_pk_bf16_f32 v97, v87, v88
    v_mfma_f32_16x16x32_bf16 v[184:187], v[224:227], v[36:39], v[184:187]
    ds_read_b64_tr_b16 v[216:217], v245 offset:45056
    v_lshlrev_b32 v87, 16, v98
    v_mfma_f32_16x16x32_bf16 v[192:195], v[224:227], v[40:43], v[192:195]
    ds_read_b64_tr_b16 v[218:219], v245 offset:45568
    v_and_b32 v88, 0xffff0000, v98
    s_waitcnt lgkmcnt(8)
    v_mfma_f32_16x16x32_bf16 v[132:135], v[196:199], v[44:47], v[132:135]
    ds_read_b64_tr_b16 v[220:221], v246 offset:45056
    v_sub_f32 v87, v87, v84
    v_mfma_f32_16x16x32_bf16 v[140:143], v[196:199], v[48:51], v[140:143]
    ds_read_b64_tr_b16 v[222:223], v246 offset:45568
    v_sub_f32 v88, v88, v84
    v_mfma_f32_16x16x32_bf16 v[136:139], v[200:203], v[44:47], v[136:139]
    ds_read_b64_tr_b16 v[224:225], v247 offset:45056
    v_cvt_pk_bf16_f32 v88, v87, v88
    v_mfma_f32_16x16x32_bf16 v[144:147], v[200:203], v[48:51], v[144:147]
    ds_read_b64_tr_b16 v[226:227], v247 offset:45568
    v_lshlrev_b32 v87, 16, v88
    s_waitcnt lgkmcnt(8)
    v_mfma_f32_16x16x32_bf16 v[148:151], v[204:207], v[44:47], v[148:151]
    ds_read_b64_tr_b16 v[196:197], v244 offset:49152
    v_and_b32 v88, 0xffff0000, v88
    v_mfma_f32_16x16x32_bf16 v[156:159], v[204:207], v[48:51], v[156:159]
    ds_read_b64_tr_b16 v[198:199], v244 offset:49664
    v_mul_f32 v87, v87, v85
    v_mfma_f32_16x16x32_bf16 v[152:155], v[208:211], v[44:47], v[152:155]
    ds_read_b64_tr_b16 v[200:201], v245 offset:49152
    v_mfma_f32_16x16x32_bf16 v[160:163], v[208:211], v[48:51], v[160:163]
    ds_read_b64_tr_b16 v[202:203], v245 offset:49664
    s_waitcnt lgkmcnt(8)
    v_mfma_f32_16x16x32_bf16 v[164:167], v[212:215], v[44:47], v[164:167]
    ds_read_b64_tr_b16 v[204:205], v246 offset:49152
    v_mfma_f32_16x16x32_bf16 v[172:175], v[212:215], v[48:51], v[172:175]
    ds_read_b64_tr_b16 v[206:207], v246 offset:49664
    s_add_u32 m0, s36, 0
    s_add_u32 s35, s42, 768
    buffer_load_dwordx4 v236, s[20:23], s35 offen offset:0 lds
    v_mfma_f32_16x16x32_bf16 v[168:171], v[216:219], v[44:47], v[168:171]
    ds_read_b64_tr_b16 v[208:209], v247 offset:49152
    v_mfma_f32_16x16x32_bf16 v[176:179], v[216:219], v[48:51], v[176:179]
    ds_read_b64_tr_b16 v[210:211], v247 offset:49664
    buffer_load_dwordx4 v237, s[20:23], s35 offen offset:1024 lds
    s_waitcnt lgkmcnt(8)
    v_mfma_f32_16x16x32_bf16 v[180:183], v[220:223], v[44:47], v[180:183]
    ds_read_b64_tr_b16 v[212:213], v244 offset:57344
    v_mfma_f32_16x16x32_bf16 v[188:191], v[220:223], v[48:51], v[188:191]
    ds_read_b64_tr_b16 v[214:215], v244 offset:57856
    buffer_load_dwordx4 v238, s[20:23], s35 offen offset:2048 lds
    v_mfma_f32_16x16x32_bf16 v[184:187], v[224:227], v[44:47], v[184:187]
    ds_read_b64_tr_b16 v[216:217], v245 offset:57344
    v_mfma_f32_16x16x32_bf16 v[192:195], v[224:227], v[48:51], v[192:195]
    ds_read_b64_tr_b16 v[218:219], v245 offset:57856
    buffer_load_dwordx4 v239, s[20:23], s35 offen offset:3072 lds
    s_waitcnt vmcnt(11)
    s_barrier
    s_waitcnt lgkmcnt(8)
    v_mfma_f32_16x16x32_bf16 v[132:135], v[196:199], v[52:55], v[132:135]
    ds_read_b64_tr_b16 v[220:221], v246 offset:57344
    v_mfma_f32_16x16x32_bf16 v[140:143], v[196:199], v[56:59], v[140:143]
    ds_read_b64_tr_b16 v[222:223], v246 offset:57856
    s_add_u32 m0, s46, 131072
    s_add_u32 s35, s47, 3145728
    buffer_load_dwordx4 v248, s[8:11], s35 offen offset:0 lds
    v_mfma_f32_16x16x32_bf16 v[136:139], v[200:203], v[52:55], v[136:139]
    ds_read_b64_tr_b16 v[224:225], v247 offset:57344
    v_mfma_f32_16x16x32_bf16 v[144:147], v[200:203], v[56:59], v[144:147]
    ds_read_b64_tr_b16 v[226:227], v247 offset:57856
    buffer_load_dwordx4 v249, s[8:11], s35 offen offset:1024 lds
    s_waitcnt lgkmcnt(8)
    v_mfma_f32_16x16x32_bf16 v[148:151], v[204:207], v[52:55], v[148:151]
    ds_read_b64_tr_b16 v[196:197], v244 offset:53248
    v_mfma_f32_16x16x32_bf16 v[156:159], v[204:207], v[56:59], v[156:159]
    ds_read_b64_tr_b16 v[198:199], v244 offset:53760
    buffer_load_dword v255, v254, s[24:27], s49 offen offset:512
    v_mfma_f32_16x16x32_bf16 v[152:155], v[208:211], v[52:55], v[152:155]
    ds_read_b64_tr_b16 v[200:201], v245 offset:53248
    v_mfma_f32_16x16x32_bf16 v[160:163], v[208:211], v[56:59], v[160:163]
    ds_read_b64_tr_b16 v[202:203], v245 offset:53760
    s_waitcnt lgkmcnt(8)
    v_mfma_f32_16x16x32_bf16 v[164:167], v[212:215], v[52:55], v[164:167]
    ds_read_b64_tr_b16 v[204:205], v246 offset:53248
    v_mul_f32 v88, v88, v85
    v_mfma_f32_16x16x32_bf16 v[172:175], v[212:215], v[56:59], v[172:175]
    ds_read_b64_tr_b16 v[206:207], v246 offset:53760
    v_cvt_pk_bf16_f32 v98, v87, v88
    v_mfma_f32_16x16x32_bf16 v[168:171], v[216:219], v[52:55], v[168:171]
    ds_read_b64_tr_b16 v[208:209], v247 offset:53248
    v_lshlrev_b32 v87, 16, v99
    v_mfma_f32_16x16x32_bf16 v[176:179], v[216:219], v[56:59], v[176:179]
    ds_read_b64_tr_b16 v[210:211], v247 offset:53760
    v_and_b32 v88, 0xffff0000, v99
    s_waitcnt vmcnt(16)
    ds_read_b128 v[68:71], v240 offset:32768
    ds_read_b128 v[72:75], v240 offset:34816
    ds_read_b128 v[76:79], v241 offset:32768
    ds_read_b128 v[80:83], v241 offset:34816
    s_waitcnt lgkmcnt(8)
    v_mfma_f32_16x16x32_bf16 v[180:183], v[220:223], v[52:55], v[180:183]
    ds_read_b64_tr_b16 v[212:213], v244 offset:61440
    v_sub_f32 v87, v87, v84
    v_mfma_f32_16x16x32_bf16 v[188:191], v[220:223], v[56:59], v[188:191]
    ds_read_b64_tr_b16 v[214:215], v244 offset:61952
    v_sub_f32 v88, v88, v84
    v_mfma_f32_16x16x32_bf16 v[184:187], v[224:227], v[52:55], v[184:187]
    ds_read_b64_tr_b16 v[216:217], v245 offset:61440
    v_cvt_pk_bf16_f32 v88, v87, v88
    v_mfma_f32_16x16x32_bf16 v[192:195], v[224:227], v[56:59], v[192:195]
    ds_read_b64_tr_b16 v[218:219], v245 offset:61952
    v_lshlrev_b32 v87, 16, v88
    s_waitcnt lgkmcnt(8)
    v_mfma_f32_16x16x32_bf16 v[132:135], v[196:199], v[60:63], v[132:135]
    ds_read_b64_tr_b16 v[220:221], v246 offset:61440
    v_and_b32 v88, 0xffff0000, v88
    v_mfma_f32_16x16x32_bf16 v[140:143], v[196:199], v[64:67], v[140:143]
    ds_read_b64_tr_b16 v[222:223], v246 offset:61952
    v_mul_f32 v87, v87, v85
    v_mfma_f32_16x16x32_bf16 v[136:139], v[200:203], v[60:63], v[136:139]
    ds_read_b64_tr_b16 v[224:225], v247 offset:61440
    v_mul_f32 v88, v88, v85
    v_mfma_f32_16x16x32_bf16 v[144:147], v[200:203], v[64:67], v[144:147]
    ds_read_b64_tr_b16 v[226:227], v247 offset:61952
    v_cvt_pk_bf16_f32 v99, v87, v88
    s_waitcnt lgkmcnt(8)
    v_mfma_f32_16x16x32_bf16 v[148:151], v[204:207], v[60:63], v[148:151]
    ds_read_b64_tr_b16 v[196:197], v244 offset:0
    v_mov_b32 v250, v96
    v_mfma_f32_16x16x32_bf16 v[156:159], v[204:207], v[64:67], v[156:159]
    ds_read_b64_tr_b16 v[198:199], v244 offset:512
    v_mov_b32 v251, v97
    v_mfma_f32_16x16x32_bf16 v[152:155], v[208:211], v[60:63], v[152:155]
    ds_read_b64_tr_b16 v[200:201], v245 offset:0
    v_mov_b32 v252, v98
    v_mfma_f32_16x16x32_bf16 v[160:163], v[208:211], v[64:67], v[160:163]
    ds_read_b64_tr_b16 v[202:203], v245 offset:512
    v_mov_b32 v253, v99
    s_waitcnt lgkmcnt(8)
    v_mfma_f32_16x16x32_bf16 v[164:167], v[212:215], v[60:63], v[164:167]
    ds_read_b64_tr_b16 v[204:205], v246 offset:0
    v_mov_b32 v3, v100
    v_mfma_f32_16x16x32_bf16 v[172:175], v[212:215], v[64:67], v[172:175]
    ds_read_b64_tr_b16 v[206:207], v246 offset:512
    s_add_u32 m0, s36, 32768
    s_add_u32 s35, s42, 896
    buffer_load_dwordx4 v236, s[20:23], s35 offen offset:0 lds
    v_mfma_f32_16x16x32_bf16 v[168:171], v[216:219], v[60:63], v[168:171]
    ds_read_b64_tr_b16 v[208:209], v247 offset:0
    v_mfma_f32_16x16x32_bf16 v[176:179], v[216:219], v[64:67], v[176:179]
    ds_read_b64_tr_b16 v[210:211], v247 offset:512
    buffer_load_dwordx4 v237, s[20:23], s35 offen offset:1024 lds
    s_waitcnt lgkmcnt(8)
    v_mfma_f32_16x16x32_bf16 v[180:183], v[220:223], v[60:63], v[180:183]
    ds_read_b64_tr_b16 v[212:213], v244 offset:8192
    v_mfma_f32_16x16x32_bf16 v[188:191], v[220:223], v[64:67], v[188:191]
    ds_read_b64_tr_b16 v[214:215], v244 offset:8704
    buffer_load_dwordx4 v238, s[20:23], s35 offen offset:2048 lds
    v_mfma_f32_16x16x32_bf16 v[184:187], v[224:227], v[60:63], v[184:187]
    ds_read_b64_tr_b16 v[216:217], v245 offset:8192
    v_mfma_f32_16x16x32_bf16 v[192:195], v[224:227], v[64:67], v[192:195]
    ds_read_b64_tr_b16 v[218:219], v245 offset:8704
    buffer_load_dwordx4 v239, s[20:23], s35 offen offset:3072 lds
    s_waitcnt vmcnt(12)
    s_barrier
    s_waitcnt lgkmcnt(8)
    v_mfma_f32_16x16x32_bf16 v[132:135], v[196:199], v[68:71], v[132:135]
    ds_read_b64_tr_b16 v[220:221], v246 offset:8192
    v_mfma_f32_16x16x32_bf16 v[140:143], v[196:199], v[72:75], v[140:143]
    ds_read_b64_tr_b16 v[222:223], v246 offset:8704
    s_add_u32 m0, s46, 147456
    s_add_u32 s35, s47, 3670016
    buffer_load_dwordx4 v248, s[8:11], s35 offen offset:0 lds
    v_mfma_f32_16x16x32_bf16 v[136:139], v[200:203], v[68:71], v[136:139]
    ds_read_b64_tr_b16 v[224:225], v247 offset:8192
    v_mfma_f32_16x16x32_bf16 v[144:147], v[200:203], v[72:75], v[144:147]
    ds_read_b64_tr_b16 v[226:227], v247 offset:8704
    buffer_load_dwordx4 v249, s[8:11], s35 offen offset:1024 lds
    s_waitcnt lgkmcnt(8)
    v_mfma_f32_16x16x32_bf16 v[148:151], v[204:207], v[68:71], v[148:151]
    ds_read_b64_tr_b16 v[196:197], v244 offset:4096
    v_mfma_f32_16x16x32_bf16 v[156:159], v[204:207], v[72:75], v[156:159]
    ds_read_b64_tr_b16 v[198:199], v244 offset:4608
    buffer_load_dword v255, v254, s[24:27], s49 offen offset:1024
    v_mfma_f32_16x16x32_bf16 v[152:155], v[208:211], v[68:71], v[152:155]
    ds_read_b64_tr_b16 v[200:201], v245 offset:4096
    v_mfma_f32_16x16x32_bf16 v[160:163], v[208:211], v[72:75], v[160:163]
    ds_read_b64_tr_b16 v[202:203], v245 offset:4608
    s_waitcnt lgkmcnt(8)
    v_mfma_f32_16x16x32_bf16 v[164:167], v[212:215], v[68:71], v[164:167]
    ds_read_b64_tr_b16 v[204:205], v246 offset:4096
    v_mfma_f32_16x16x32_bf16 v[172:175], v[212:215], v[72:75], v[172:175]
    ds_read_b64_tr_b16 v[206:207], v246 offset:4608
    v_mfma_f32_16x16x32_bf16 v[168:171], v[216:219], v[68:71], v[168:171]
    ds_read_b64_tr_b16 v[208:209], v247 offset:4096
    v_mfma_f32_16x16x32_bf16 v[176:179], v[216:219], v[72:75], v[176:179]
    ds_read_b64_tr_b16 v[210:211], v247 offset:4608
    s_waitcnt vmcnt(17)
    ds_read_b128 v[84:87], v242 offset:0
    ds_read_b128 v[88:91], v242 offset:2048
    ds_read_b128 v[92:95], v243 offset:0
    ds_read_b128 v[96:99], v243 offset:2048
    s_waitcnt lgkmcnt(8)
    v_mfma_f32_16x16x32_bf16 v[180:183], v[220:223], v[68:71], v[180:183]
    ds_read_b64_tr_b16 v[212:213], v244 offset:12288
    v_mfma_f32_16x16x32_bf16 v[188:191], v[220:223], v[72:75], v[188:191]
    ds_read_b64_tr_b16 v[214:215], v244 offset:12800
    v_mfma_f32_16x16x32_bf16 v[184:187], v[224:227], v[68:71], v[184:187]
    ds_read_b64_tr_b16 v[216:217], v245 offset:12288
    v_mfma_f32_16x16x32_bf16 v[192:195], v[224:227], v[72:75], v[192:195]
    ds_read_b64_tr_b16 v[218:219], v245 offset:12800
    s_waitcnt lgkmcnt(8)
    v_mfma_f32_16x16x32_bf16 v[132:135], v[196:199], v[76:79], v[132:135]
    ds_read_b64_tr_b16 v[220:221], v246 offset:12288
    v_mfma_f32_16x16x32_bf16 v[140:143], v[196:199], v[80:83], v[140:143]
    ds_read_b64_tr_b16 v[222:223], v246 offset:12800
    v_mfma_f32_16x16x32_bf16 v[136:139], v[200:203], v[76:79], v[136:139]
    ds_read_b64_tr_b16 v[224:225], v247 offset:12288
    v_mfma_f32_16x16x32_bf16 v[144:147], v[200:203], v[80:83], v[144:147]
    ds_read_b64_tr_b16 v[226:227], v247 offset:12800
    s_waitcnt lgkmcnt(8)
    v_mfma_f32_16x16x32_bf16 v[148:151], v[204:207], v[76:79], v[148:151]
    ds_read_b64_tr_b16 v[196:197], v244 offset:16384
    v_mfma_f32_16x16x32_bf16 v[156:159], v[204:207], v[80:83], v[156:159]
    ds_read_b64_tr_b16 v[198:199], v244 offset:16896
    v_mfma_f32_16x16x32_bf16 v[152:155], v[208:211], v[76:79], v[152:155]
    ds_read_b64_tr_b16 v[200:201], v245 offset:16384
    v_mfma_f32_16x16x32_bf16 v[160:163], v[208:211], v[80:83], v[160:163]
    ds_read_b64_tr_b16 v[202:203], v245 offset:16896
    s_waitcnt lgkmcnt(8)
    v_mfma_f32_16x16x32_bf16 v[164:167], v[212:215], v[76:79], v[164:167]
    ds_read_b64_tr_b16 v[204:205], v246 offset:16384
    v_mfma_f32_16x16x32_bf16 v[172:175], v[212:215], v[80:83], v[172:175]
    ds_read_b64_tr_b16 v[206:207], v246 offset:16896
    s_add_u32 m0, s36, 65536
    s_add_u32 s35, s43, 256
    buffer_load_dwordx4 v228, s[8:11], s35 offen offset:0 lds
    v_mfma_f32_16x16x32_bf16 v[168:171], v[216:219], v[76:79], v[168:171]
    ds_read_b64_tr_b16 v[208:209], v247 offset:16384
    v_mfma_f32_16x16x32_bf16 v[176:179], v[216:219], v[80:83], v[176:179]
    ds_read_b64_tr_b16 v[210:211], v247 offset:16896
    buffer_load_dwordx4 v229, s[8:11], s35 offen offset:1024 lds
    s_waitcnt lgkmcnt(8)
    v_mfma_f32_16x16x32_bf16 v[180:183], v[220:223], v[76:79], v[180:183]
    ds_read_b64_tr_b16 v[212:213], v244 offset:24576
    v_mfma_f32_16x16x32_bf16 v[188:191], v[220:223], v[80:83], v[188:191]
    ds_read_b64_tr_b16 v[214:215], v244 offset:25088
    buffer_load_dwordx4 v230, s[8:11], s35 offen offset:2048 lds
    v_mfma_f32_16x16x32_bf16 v[184:187], v[224:227], v[76:79], v[184:187]
    ds_read_b64_tr_b16 v[216:217], v245 offset:24576
    v_mfma_f32_16x16x32_bf16 v[192:195], v[224:227], v[80:83], v[192:195]
    ds_read_b64_tr_b16 v[218:219], v245 offset:25088
    buffer_load_dwordx4 v231, s[8:11], s35 offen offset:3072 lds
    s_waitcnt vmcnt(12)
    s_barrier
    s_waitcnt lgkmcnt(8)
    v_mfma_f32_16x16x32_bf16 v[132:135], v[196:199], v[84:87], v[132:135]
    ds_read_b64_tr_b16 v[220:221], v246 offset:24576
    v_mfma_f32_16x16x32_bf16 v[140:143], v[196:199], v[88:91], v[140:143]
    ds_read_b64_tr_b16 v[222:223], v246 offset:25088
    buffer_load_dword v255, v254, s[24:27], s49 offen offset:1536
    v_mfma_f32_16x16x32_bf16 v[136:139], v[200:203], v[84:87], v[136:139]
    ds_read_b64_tr_b16 v[224:225], v247 offset:24576
    v_mfma_f32_16x16x32_bf16 v[144:147], v[200:203], v[88:91], v[144:147]
    ds_read_b64_tr_b16 v[226:227], v247 offset:25088
    s_waitcnt lgkmcnt(8)
    v_mfma_f32_16x16x32_bf16 v[148:151], v[204:207], v[84:87], v[148:151]
    ds_read_b64_tr_b16 v[196:197], v244 offset:20480
    v_mfma_f32_16x16x32_bf16 v[156:159], v[204:207], v[88:91], v[156:159]
    ds_read_b64_tr_b16 v[198:199], v244 offset:20992
    v_mfma_f32_16x16x32_bf16 v[152:155], v[208:211], v[84:87], v[152:155]
    ds_read_b64_tr_b16 v[200:201], v245 offset:20480
    v_mfma_f32_16x16x32_bf16 v[160:163], v[208:211], v[88:91], v[160:163]
    ds_read_b64_tr_b16 v[202:203], v245 offset:20992
    s_waitcnt lgkmcnt(8)
    v_mfma_f32_16x16x32_bf16 v[164:167], v[212:215], v[84:87], v[164:167]
    ds_read_b64_tr_b16 v[204:205], v246 offset:20480
    v_lshrrev_b32 v237, 13, v228
    v_mfma_f32_16x16x32_bf16 v[172:175], v[212:215], v[88:91], v[172:175]
    ds_read_b64_tr_b16 v[206:207], v246 offset:20992
    v_mul_u32_u24 v237, 3584, v237
    v_mfma_f32_16x16x32_bf16 v[168:171], v[216:219], v[84:87], v[168:171]
    ds_read_b64_tr_b16 v[208:209], v247 offset:20480
    v_and_b32 v236, 0x7f, v228
    v_mfma_f32_16x16x32_bf16 v[176:179], v[216:219], v[88:91], v[176:179]
    ds_read_b64_tr_b16 v[210:211], v247 offset:20992
    v_add_u32 v236, v236, v237
    s_waitcnt vmcnt(15)
    ds_read_b128 v[100:103], v240 offset:0
    ds_read_b128 v[104:107], v240 offset:2048
    ds_read_b128 v[108:111], v241 offset:0
    ds_read_b128 v[112:115], v241 offset:2048
    s_waitcnt lgkmcnt(8)
    v_mfma_f32_16x16x32_bf16 v[180:183], v[220:223], v[84:87], v[180:183]
    ds_read_b64_tr_b16 v[212:213], v244 offset:28672
    v_xor_b32 v237, 16, v236
    v_mfma_f32_16x16x32_bf16 v[188:191], v[220:223], v[88:91], v[188:191]
    ds_read_b64_tr_b16 v[214:215], v244 offset:29184
    v_add_u32 v237, 27648, v237
    v_mfma_f32_16x16x32_bf16 v[184:187], v[224:227], v[84:87], v[184:187]
    ds_read_b64_tr_b16 v[216:217], v245 offset:28672
    v_add_u32 v238, 55296, v236
    v_mfma_f32_16x16x32_bf16 v[192:195], v[224:227], v[88:91], v[192:195]
    ds_read_b64_tr_b16 v[218:219], v245 offset:29184
    v_add_u32 v239, 55296, v237
    s_waitcnt lgkmcnt(8)
    v_mfma_f32_16x16x32_bf16 v[132:135], v[196:199], v[92:95], v[132:135]
    ds_read_b64_tr_b16 v[220:221], v246 offset:28672
    buffer_store_dwordx4 v[250:253], v3, s[56:59], s48 offen sc1
    v_mfma_f32_16x16x32_bf16 v[140:143], v[196:199], v[96:99], v[140:143]
    ds_read_b64_tr_b16 v[222:223], v246 offset:29184
    v_mfma_f32_16x16x32_bf16 v[136:139], v[200:203], v[92:95], v[136:139]
    ds_read_b64_tr_b16 v[224:225], v247 offset:28672
    v_mfma_f32_16x16x32_bf16 v[144:147], v[200:203], v[96:99], v[144:147]
    ds_read_b64_tr_b16 v[226:227], v247 offset:29184
    s_waitcnt lgkmcnt(8)
    v_mfma_f32_16x16x32_bf16 v[148:151], v[204:207], v[92:95], v[148:151]
    ds_read_b64_tr_b16 v[196:197], v244 offset:32768
    v_mfma_f32_16x16x32_bf16 v[156:159], v[204:207], v[96:99], v[156:159]
    ds_read_b64_tr_b16 v[198:199], v244 offset:33280
    v_mfma_f32_16x16x32_bf16 v[152:155], v[208:211], v[92:95], v[152:155]
    ds_read_b64_tr_b16 v[200:201], v245 offset:32768
    v_mfma_f32_16x16x32_bf16 v[160:163], v[208:211], v[96:99], v[160:163]
    ds_read_b64_tr_b16 v[202:203], v245 offset:33280
    s_waitcnt lgkmcnt(8)
    v_mfma_f32_16x16x32_bf16 v[164:167], v[212:215], v[92:95], v[164:167]
    ds_read_b64_tr_b16 v[204:205], v246 offset:32768
    v_mfma_f32_16x16x32_bf16 v[172:175], v[212:215], v[96:99], v[172:175]
    ds_read_b64_tr_b16 v[206:207], v246 offset:33280
    s_add_u32 m0, s36, 0
    s_add_u32 s35, s43, 2097408
    buffer_load_dwordx4 v228, s[8:11], s35 offen offset:0 lds
    v_mfma_f32_16x16x32_bf16 v[168:171], v[216:219], v[92:95], v[168:171]
    ds_read_b64_tr_b16 v[208:209], v247 offset:32768
    v_mfma_f32_16x16x32_bf16 v[176:179], v[216:219], v[96:99], v[176:179]
    ds_read_b64_tr_b16 v[210:211], v247 offset:33280
    buffer_load_dwordx4 v229, s[8:11], s35 offen offset:1024 lds
    s_waitcnt lgkmcnt(8)
    v_mfma_f32_16x16x32_bf16 v[180:183], v[220:223], v[92:95], v[180:183]
    ds_read_b64_tr_b16 v[212:213], v244 offset:40960
    v_mfma_f32_16x16x32_bf16 v[188:191], v[220:223], v[96:99], v[188:191]
    ds_read_b64_tr_b16 v[214:215], v244 offset:41472
    buffer_load_dwordx4 v230, s[8:11], s35 offen offset:2048 lds
    v_mfma_f32_16x16x32_bf16 v[184:187], v[224:227], v[92:95], v[184:187]
    ds_read_b64_tr_b16 v[216:217], v245 offset:40960
    v_mfma_f32_16x16x32_bf16 v[192:195], v[224:227], v[96:99], v[192:195]
    ds_read_b64_tr_b16 v[218:219], v245 offset:41472
    buffer_load_dwordx4 v231, s[8:11], s35 offen offset:3072 lds
    s_waitcnt vmcnt(11)
    s_barrier
    s_waitcnt lgkmcnt(8)
    v_mfma_f32_16x16x32_bf16 v[132:135], v[196:199], v[100:103], v[132:135]
    ds_read_b64_tr_b16 v[220:221], v246 offset:40960
    v_mfma_f32_16x16x32_bf16 v[140:143], v[196:199], v[104:107], v[140:143]
    ds_read_b64_tr_b16 v[222:223], v246 offset:41472
    buffer_load_dword v255, v254, s[96:99], s50 offen offset:0
    v_mfma_f32_16x16x32_bf16 v[136:139], v[200:203], v[100:103], v[136:139]
    ds_read_b64_tr_b16 v[224:225], v247 offset:40960
    v_mfma_f32_16x16x32_bf16 v[144:147], v[200:203], v[104:107], v[144:147]
    ds_read_b64_tr_b16 v[226:227], v247 offset:41472
    s_waitcnt lgkmcnt(8)
    v_mfma_f32_16x16x32_bf16 v[148:151], v[204:207], v[100:103], v[148:151]
    ds_read_b64_tr_b16 v[196:197], v244 offset:36864
    v_mfma_f32_16x16x32_bf16 v[156:159], v[204:207], v[104:107], v[156:159]
    ds_read_b64_tr_b16 v[198:199], v244 offset:37376
    v_mfma_f32_16x16x32_bf16 v[152:155], v[208:211], v[100:103], v[152:155]
    ds_read_b64_tr_b16 v[200:201], v245 offset:36864
    v_mfma_f32_16x16x32_bf16 v[160:163], v[208:211], v[104:107], v[160:163]
    ds_read_b64_tr_b16 v[202:203], v245 offset:37376
    s_waitcnt lgkmcnt(8)
    v_mfma_f32_16x16x32_bf16 v[164:167], v[212:215], v[100:103], v[164:167]
    ds_read_b64_tr_b16 v[204:205], v246 offset:36864
    v_mfma_f32_16x16x32_bf16 v[172:175], v[212:215], v[104:107], v[172:175]
    ds_read_b64_tr_b16 v[206:207], v246 offset:37376
    v_mfma_f32_16x16x32_bf16 v[168:171], v[216:219], v[100:103], v[168:171]
    ds_read_b64_tr_b16 v[208:209], v247 offset:36864
    v_mfma_f32_16x16x32_bf16 v[176:179], v[216:219], v[104:107], v[176:179]
    ds_read_b64_tr_b16 v[210:211], v247 offset:37376
    s_waitcnt vmcnt(14)
    ds_read_b128 v[116:119], v240 offset:32768
    ds_read_b128 v[120:123], v240 offset:34816
    ds_read_b128 v[124:127], v241 offset:32768
    ds_read_b128 v[128:131], v241 offset:34816
    s_waitcnt lgkmcnt(8)
    v_mfma_f32_16x16x32_bf16 v[180:183], v[220:223], v[100:103], v[180:183]
    ds_read_b64_tr_b16 v[212:213], v244 offset:45056
    v_mfma_f32_16x16x32_bf16 v[188:191], v[220:223], v[104:107], v[188:191]
    ds_read_b64_tr_b16 v[214:215], v244 offset:45568
    v_mfma_f32_16x16x32_bf16 v[184:187], v[224:227], v[100:103], v[184:187]
    ds_read_b64_tr_b16 v[216:217], v245 offset:45056
    v_mfma_f32_16x16x32_bf16 v[192:195], v[224:227], v[104:107], v[192:195]
    ds_read_b64_tr_b16 v[218:219], v245 offset:45568
    s_waitcnt lgkmcnt(8)
    v_mfma_f32_16x16x32_bf16 v[132:135], v[196:199], v[108:111], v[132:135]
    ds_read_b64_tr_b16 v[220:221], v246 offset:45056
    v_mfma_f32_16x16x32_bf16 v[140:143], v[196:199], v[112:115], v[140:143]
    ds_read_b64_tr_b16 v[222:223], v246 offset:45568
    v_mfma_f32_16x16x32_bf16 v[136:139], v[200:203], v[108:111], v[136:139]
    ds_read_b64_tr_b16 v[224:225], v247 offset:45056
    v_mfma_f32_16x16x32_bf16 v[144:147], v[200:203], v[112:115], v[144:147]
    ds_read_b64_tr_b16 v[226:227], v247 offset:45568
    s_waitcnt lgkmcnt(8)
    v_mfma_f32_16x16x32_bf16 v[148:151], v[204:207], v[108:111], v[148:151]
    ds_read_b64_tr_b16 v[196:197], v244 offset:49152
    v_mfma_f32_16x16x32_bf16 v[156:159], v[204:207], v[112:115], v[156:159]
    ds_read_b64_tr_b16 v[198:199], v244 offset:49664
    v_mfma_f32_16x16x32_bf16 v[152:155], v[208:211], v[108:111], v[152:155]
    ds_read_b64_tr_b16 v[200:201], v245 offset:49152
    v_mfma_f32_16x16x32_bf16 v[160:163], v[208:211], v[112:115], v[160:163]
    ds_read_b64_tr_b16 v[202:203], v245 offset:49664
    s_waitcnt lgkmcnt(8)
    v_mfma_f32_16x16x32_bf16 v[164:167], v[212:215], v[108:111], v[164:167]
    ds_read_b64_tr_b16 v[204:205], v246 offset:49152
    v_mfma_f32_16x16x32_bf16 v[172:175], v[212:215], v[112:115], v[172:175]
    ds_read_b64_tr_b16 v[206:207], v246 offset:49664
    s_add_u32 m0, s36, 32768
    s_add_u32 s35, s43, 384
    buffer_load_dwordx4 v228, s[8:11], s35 offen offset:0 lds
    v_mfma_f32_16x16x32_bf16 v[168:171], v[216:219], v[108:111], v[168:171]
    ds_read_b64_tr_b16 v[208:209], v247 offset:49152
    v_mfma_f32_16x16x32_bf16 v[176:179], v[216:219], v[112:115], v[176:179]
    ds_read_b64_tr_b16 v[210:211], v247 offset:49664
    buffer_load_dwordx4 v229, s[8:11], s35 offen offset:1024 lds
    s_waitcnt lgkmcnt(8)
    v_mfma_f32_16x16x32_bf16 v[180:183], v[220:223], v[108:111], v[180:183]
    ds_read_b64_tr_b16 v[212:213], v244 offset:57344
    v_mfma_f32_16x16x32_bf16 v[188:191], v[220:223], v[112:115], v[188:191]
    ds_read_b64_tr_b16 v[214:215], v244 offset:57856
    buffer_load_dwordx4 v230, s[8:11], s35 offen offset:2048 lds
    v_mfma_f32_16x16x32_bf16 v[184:187], v[224:227], v[108:111], v[184:187]
    ds_read_b64_tr_b16 v[216:217], v245 offset:57344
    v_mfma_f32_16x16x32_bf16 v[192:195], v[224:227], v[112:115], v[192:195]
    ds_read_b64_tr_b16 v[218:219], v245 offset:57856
    buffer_load_dwordx4 v231, s[8:11], s35 offen offset:3072 lds
    s_waitcnt vmcnt(9)
    s_barrier
    s_cmp_lg_u32 s32, 0
    s_cbranch_scc1 L_k1ns_1
    s_and_b32 s39, s2, 0xfc
    v_mov_b32 v252, 0
    v_mov_b32 v253, 1
    s_mov_b64 exec, 1
    buffer_atomic_add v253, v252, s[52:55], s39 offen sc1
    s_mov_b64 exec, -1
L_k1ns_1:
    s_waitcnt lgkmcnt(8)
    v_mfma_f32_16x16x32_bf16 v[132:135], v[196:199], v[116:119], v[132:135]
    ds_read_b64_tr_b16 v[220:221], v246 offset:57344
    v_mfma_f32_16x16x32_bf16 v[140:143], v[196:199], v[120:123], v[140:143]
    ds_read_b64_tr_b16 v[222:223], v246 offset:57856
    s_add_u32 m0, s36, 98304
    s_add_u32 s35, s43, 2097536
    buffer_load_dwordx4 v228, s[8:11], s35 offen offset:0 lds
    v_mfma_f32_16x16x32_bf16 v[136:139], v[200:203], v[116:119], v[136:139]
    ds_read_b64_tr_b16 v[224:225], v247 offset:57344
    v_mfma_f32_16x16x32_bf16 v[144:147], v[200:203], v[120:123], v[144:147]
    ds_read_b64_tr_b16 v[226:227], v247 offset:57856
    buffer_load_dwordx4 v229, s[8:11], s35 offen offset:1024 lds
    s_waitcnt lgkmcnt(8)
    v_mfma_f32_16x16x32_bf16 v[148:151], v[204:207], v[116:119], v[148:151]
    ds_read_b64_tr_b16 v[196:197], v244 offset:53248
    v_mfma_f32_16x16x32_bf16 v[156:159], v[204:207], v[120:123], v[156:159]
    ds_read_b64_tr_b16 v[198:199], v244 offset:53760
    buffer_load_dwordx4 v230, s[8:11], s35 offen offset:2048 lds
    v_mfma_f32_16x16x32_bf16 v[152:155], v[208:211], v[116:119], v[152:155]
    ds_read_b64_tr_b16 v[200:201], v245 offset:53248
    v_mfma_f32_16x16x32_bf16 v[160:163], v[208:211], v[120:123], v[160:163]
    ds_read_b64_tr_b16 v[202:203], v245 offset:53760
    buffer_load_dwordx4 v231, s[8:11], s35 offen offset:3072 lds
    s_waitcnt lgkmcnt(8)
    v_mfma_f32_16x16x32_bf16 v[164:167], v[212:215], v[116:119], v[164:167]
    ds_read_b64_tr_b16 v[204:205], v246 offset:53248
    v_add_u32 v240, 0x10000, v232
    v_mfma_f32_16x16x32_bf16 v[172:175], v[212:215], v[120:123], v[172:175]
    ds_read_b64_tr_b16 v[206:207], v246 offset:53760
    buffer_load_dword v255, v254, s[96:99], s50 offen offset:512
    v_add_u32 v241, 0x10000, v233
    v_mfma_f32_16x16x32_bf16 v[168:171], v[216:219], v[116:119], v[168:171]
    ds_read_b64_tr_b16 v[208:209], v247 offset:53248
    v_add_u32 v242, 0x10000, v234
    v_mfma_f32_16x16x32_bf16 v[176:179], v[216:219], v[120:123], v[176:179]
    ds_read_b64_tr_b16 v[210:211], v247 offset:53760
    v_add_u32 v243, 0x10000, v235
    s_waitcnt lgkmcnt(8)
    v_mfma_f32_16x16x32_bf16 v[180:183], v[220:223], v[116:119], v[180:183]
    ds_read_b64_tr_b16 v[212:213], v244 offset:61440
    v_mfma_f32_16x16x32_bf16 v[188:191], v[220:223], v[120:123], v[188:191]
    ds_read_b64_tr_b16 v[214:215], v244 offset:61952
    v_mfma_f32_16x16x32_bf16 v[184:187], v[224:227], v[116:119], v[184:187]
    ds_read_b64_tr_b16 v[216:217], v245 offset:61440
    v_mfma_f32_16x16x32_bf16 v[192:195], v[224:227], v[120:123], v[192:195]
    ds_read_b64_tr_b16 v[218:219], v245 offset:61952
    s_waitcnt lgkmcnt(8)
    v_mfma_f32_16x16x32_bf16 v[132:135], v[196:199], v[124:127], v[132:135]
    ds_read_b64_tr_b16 v[220:221], v246 offset:61440
    v_mfma_f32_16x16x32_bf16 v[140:143], v[196:199], v[128:131], v[140:143]
    ds_read_b64_tr_b16 v[222:223], v246 offset:61952
    v_mfma_f32_16x16x32_bf16 v[136:139], v[200:203], v[124:127], v[136:139]
    ds_read_b64_tr_b16 v[224:225], v247 offset:61440
    v_mfma_f32_16x16x32_bf16 v[144:147], v[200:203], v[128:131], v[144:147]
    ds_read_b64_tr_b16 v[226:227], v247 offset:61952
    s_waitcnt lgkmcnt(8)
    v_mfma_f32_16x16x32_bf16 v[148:151], v[204:207], v[124:127], v[148:151]
    ds_read_b64_tr_b16 v[196:197], v240 offset:0
    v_mfma_f32_16x16x32_bf16 v[156:159], v[204:207], v[128:131], v[156:159]
    ds_read_b64_tr_b16 v[198:199], v240 offset:512
    v_mfma_f32_16x16x32_bf16 v[152:155], v[208:211], v[124:127], v[152:155]
    ds_read_b64_tr_b16 v[200:201], v241 offset:0
    v_mfma_f32_16x16x32_bf16 v[160:163], v[208:211], v[128:131], v[160:163]
    ds_read_b64_tr_b16 v[202:203], v241 offset:512
    s_waitcnt lgkmcnt(8)
    v_mfma_f32_16x16x32_bf16 v[164:167], v[212:215], v[124:127], v[164:167]
    ds_read_b64_tr_b16 v[204:205], v242 offset:0
    v_mfma_f32_16x16x32_bf16 v[172:175], v[212:215], v[128:131], v[172:175]
    ds_read_b64_tr_b16 v[206:207], v242 offset:512
    v_mfma_f32_16x16x32_bf16 v[168:171], v[216:219], v[124:127], v[168:171]
    ds_read_b64_tr_b16 v[208:209], v243 offset:0
    v_mfma_f32_16x16x32_bf16 v[176:179], v[216:219], v[128:131], v[176:179]
    ds_read_b64_tr_b16 v[210:211], v243 offset:512
    s_waitcnt lgkmcnt(8)
    v_mfma_f32_16x16x32_bf16 v[180:183], v[220:223], v[124:127], v[180:183]
    ds_read_b64_tr_b16 v[212:213], v240 offset:4096
    v_mfma_f32_16x16x32_bf16 v[188:191], v[220:223], v[128:131], v[188:191]
    ds_read_b64_tr_b16 v[214:215], v240 offset:4608
    v_mfma_f32_16x16x32_bf16 v[184:187], v[224:227], v[124:127], v[184:187]
    ds_read_b64_tr_b16 v[216:217], v241 offset:4096
    v_mfma_f32_16x16x32_bf16 v[192:195], v[224:227], v[128:131], v[192:195]
    ds_read_b64_tr_b16 v[218:219], v241 offset:4608
    s_waitcnt vmcnt(10)
    s_nop 3
    v_cvt_pk_bf16_f32 v164, v164, v165
    v_cvt_pk_bf16_f32 v165, v166, v167
    v_cvt_pk_bf16_f32 v166, v168, v169
    v_cvt_pk_bf16_f32 v167, v170, v171
    v_cvt_pk_bf16_f32 v168, v172, v173
    v_cvt_pk_bf16_f32 v169, v174, v175
    v_cvt_pk_bf16_f32 v170, v176, v177
    v_cvt_pk_bf16_f32 v171, v178, v179
    v_cvt_pk_bf16_f32 v172, v180, v181
    v_cvt_pk_bf16_f32 v173, v182, v183
    v_cvt_pk_bf16_f32 v174, v184, v185
    v_cvt_pk_bf16_f32 v175, v186, v187
    v_cvt_pk_bf16_f32 v176, v188, v189
    v_cvt_pk_bf16_f32 v177, v190, v191
    v_cvt_pk_bf16_f32 v178, v192, v193
    v_cvt_pk_bf16_f32 v179, v194, v195
    v_cvt_pk_bf16_f32 v180, v132, v133
    v_cvt_pk_bf16_f32 v181, v134, v135
    v_cvt_pk_bf16_f32 v182, v136, v137
    v_cvt_pk_bf16_f32 v183, v138, v139
    v_cvt_pk_bf16_f32 v184, v140, v141
    v_cvt_pk_bf16_f32 v185, v142, v143
    v_cvt_pk_bf16_f32 v186, v144, v145
    v_cvt_pk_bf16_f32 v187, v146, v147
    v_cvt_pk_bf16_f32 v188, v148, v149
    v_cvt_pk_bf16_f32 v189, v150, v151
    v_cvt_pk_bf16_f32 v190, v152, v153
    v_cvt_pk_bf16_f32 v191, v154, v155
    v_cvt_pk_bf16_f32 v192, v156, v157
    v_cvt_pk_bf16_f32 v193, v158, v159
    v_cvt_pk_bf16_f32 v194, v160, v161
    v_cvt_pk_bf16_f32 v195, v162, v163
    s_barrier
    s_waitcnt lgkmcnt(8)
    v_mfma_f32_16x16x32_bf16 v[132:135], v[196:199], v[4:7], 0
    ds_read_b64_tr_b16 v[220:221], v242 offset:4096
    v_mfma_f32_16x16x32_bf16 v[140:143], v[196:199], v[8:11], 0
    ds_read_b64_tr_b16 v[222:223], v242 offset:4608
    s_add_u32 m0, s36, 131072
    s_add_u32 s35, s45, 917504
    buffer_load_dwordx4 v236, s[96:99], s35 offen offset:0 lds
    v_mfma_f32_16x16x32_bf16 v[136:139], v[200:203], v[4:7], 0
    ds_read_b64_tr_b16 v[224:225], v243 offset:4096
    v_mfma_f32_16x16x32_bf16 v[144:147], v[200:203], v[8:11], 0
    ds_read_b64_tr_b16 v[226:227], v243 offset:4608
    buffer_load_dwordx4 v237, s[96:99], s35 offen offset:1024 lds
    s_waitcnt lgkmcnt(8)
    v_mfma_f32_16x16x32_bf16 v[148:151], v[204:207], v[4:7], 0
    ds_read_b64_tr_b16 v[196:197], v240 offset:8192
    v_mfma_f32_16x16x32_bf16 v[156:159], v[204:207], v[8:11], 0
    ds_read_b64_tr_b16 v[198:199], v240 offset:8704
    buffer_load_dwordx4 v238, s[96:99], s35 offen offset:2048 lds
    v_mfma_f32_16x16x32_bf16 v[152:155], v[208:211], v[4:7], 0
    ds_read_b64_tr_b16 v[200:201], v241 offset:8192
    v_mfma_f32_16x16x32_bf16 v[160:163], v[208:211], v[8:11], 0
    ds_read_b64_tr_b16 v[202:203], v241 offset:8704
    buffer_load_dwordx4 v239, s[96:99], s35 offen offset:3072 lds
    s_waitcnt lgkmcnt(8)
    v_mfma_f32_16x16x32_bf16 v[132:135], v[212:215], v[12:15], v[132:135]
    ds_read_b64_tr_b16 v[204:205], v242 offset:8192
    v_mfma_f32_16x16x32_bf16 v[140:143], v[212:215], v[16:19], v[140:143]
    ds_read_b64_tr_b16 v[206:207], v242 offset:8704
    v_mfma_f32_16x16x32_bf16 v[136:139], v[216:219], v[12:15], v[136:139]
    ds_read_b64_tr_b16 v[208:209], v243 offset:8192
    v_mfma_f32_16x16x32_bf16 v[144:147], v[216:219], v[16:19], v[144:147]
    ds_read_b64_tr_b16 v[210:211], v243 offset:8704
    s_waitcnt lgkmcnt(8)
    v_mfma_f32_16x16x32_bf16 v[148:151], v[220:223], v[12:15], v[148:151]
    ds_read_b64_tr_b16 v[212:213], v240 offset:12288
    v_mfma_f32_16x16x32_bf16 v[156:159], v[220:223], v[16:19], v[156:159]
    ds_read_b64_tr_b16 v[214:215], v240 offset:12800
    v_mfma_f32_16x16x32_bf16 v[152:155], v[224:227], v[12:15], v[152:155]
    ds_read_b64_tr_b16 v[216:217], v241 offset:12288
    v_mfma_f32_16x16x32_bf16 v[160:163], v[224:227], v[16:19], v[160:163]
    ds_read_b64_tr_b16 v[218:219], v241 offset:12800
    s_waitcnt lgkmcnt(8)
    v_mfma_f32_16x16x32_bf16 v[132:135], v[196:199], v[20:23], v[132:135]
    ds_read_b64_tr_b16 v[220:221], v242 offset:12288
    v_mfma_f32_16x16x32_bf16 v[140:143], v[196:199], v[24:27], v[140:143]
    ds_read_b64_tr_b16 v[222:223], v242 offset:12800
    v_mfma_f32_16x16x32_bf16 v[136:139], v[200:203], v[20:23], v[136:139]
    ds_read_b64_tr_b16 v[224:225], v243 offset:12288
    v_mfma_f32_16x16x32_bf16 v[144:147], v[200:203], v[24:27], v[144:147]
    ds_read_b64_tr_b16 v[226:227], v243 offset:12800
    s_waitcnt lgkmcnt(8)
    v_mfma_f32_16x16x32_bf16 v[148:151], v[204:207], v[20:23], v[148:151]
    ds_read_b64_tr_b16 v[196:197], v240 offset:16384
    v_mfma_f32_16x16x32_bf16 v[156:159], v[204:207], v[24:27], v[156:159]
    ds_read_b64_tr_b16 v[198:199], v240 offset:16896
    s_add_u32 s41, s37, 0
    buffer_store_dwordx4 v[180:183], v2, s[28:31], s41 offen offset:0 sc1
    v_mfma_f32_16x16x32_bf16 v[152:155], v[208:211], v[20:23], v[152:155]
    ds_read_b64_tr_b16 v[200:201], v241 offset:16384
    v_mfma_f32_16x16x32_bf16 v[160:163], v[208:211], v[24:27], v[160:163]
    ds_read_b64_tr_b16 v[202:203], v241 offset:16896
    s_waitcnt lgkmcnt(8)
    v_mfma_f32_16x16x32_bf16 v[132:135], v[212:215], v[28:31], v[132:135]
    ds_read_b64_tr_b16 v[204:205], v242 offset:16384
    v_mfma_f32_16x16x32_bf16 v[140:143], v[212:215], v[32:35], v[140:143]
    ds_read_b64_tr_b16 v[206:207], v242 offset:16896
    v_mfma_f32_16x16x32_bf16 v[136:139], v[216:219], v[28:31], v[136:139]
    ds_read_b64_tr_b16 v[208:209], v243 offset:16384
    v_mfma_f32_16x16x32_bf16 v[144:147], v[216:219], v[32:35], v[144:147]
    ds_read_b64_tr_b16 v[210:211], v243 offset:16896
    s_waitcnt lgkmcnt(8)
    v_mfma_f32_16x16x32_bf16 v[148:151], v[220:223], v[28:31], v[148:151]
    ds_read_b64_tr_b16 v[212:213], v240 offset:20480
    v_mfma_f32_16x16x32_bf16 v[156:159], v[220:223], v[32:35], v[156:159]
    ds_read_b64_tr_b16 v[214:215], v240 offset:20992
    v_mfma_f32_16x16x32_bf16 v[152:155], v[224:227], v[28:31], v[152:155]
    ds_read_b64_tr_b16 v[216:217], v241 offset:20480
    v_mfma_f32_16x16x32_bf16 v[160:163], v[224:227], v[32:35], v[160:163]
    ds_read_b64_tr_b16 v[218:219], v241 offset:20992
    s_waitcnt lgkmcnt(8)
    v_mfma_f32_16x16x32_bf16 v[132:135], v[196:199], v[36:39], v[132:135]
    ds_read_b64_tr_b16 v[220:221], v242 offset:20480
    v_mfma_f32_16x16x32_bf16 v[140:143], v[196:199], v[40:43], v[140:143]
    ds_read_b64_tr_b16 v[222:223], v242 offset:20992
    v_mfma_f32_16x16x32_bf16 v[136:139], v[200:203], v[36:39], v[136:139]
    ds_read_b64_tr_b16 v[224:225], v243 offset:20480
    v_mfma_f32_16x16x32_bf16 v[144:147], v[200:203], v[40:43], v[144:147]
    ds_read_b64_tr_b16 v[226:227], v243 offset:20992
    s_waitcnt lgkmcnt(8)
    v_mfma_f32_16x16x32_bf16 v[148:151], v[204:207], v[36:39], v[148:151]
    ds_read_b64_tr_b16 v[196:197], v240 offset:24576
    v_mfma_f32_16x16x32_bf16 v[156:159], v[204:207], v[40:43], v[156:159]
    ds_read_b64_tr_b16 v[198:199], v240 offset:25088
    v_mfma_f32_16x16x32_bf16 v[152:155], v[208:211], v[36:39], v[152:155]
    ds_read_b64_tr_b16 v[200:201], v241 offset:24576
    v_mfma_f32_16x16x32_bf16 v[160:163], v[208:211], v[40:43], v[160:163]
    ds_read_b64_tr_b16 v[202:203], v241 offset:25088
    s_waitcnt lgkmcnt(8)
    v_mfma_f32_16x16x32_bf16 v[132:135], v[212:215], v[44:47], v[132:135]
    ds_read_b64_tr_b16 v[204:205], v242 offset:24576
    v_mfma_f32_16x16x32_bf16 v[140:143], v[212:215], v[48:51], v[140:143]
    ds_read_b64_tr_b16 v[206:207], v242 offset:25088
    v_mfma_f32_16x16x32_bf16 v[136:139], v[216:219], v[44:47], v[136:139]
    ds_read_b64_tr_b16 v[208:209], v243 offset:24576
    v_mfma_f32_16x16x32_bf16 v[144:147], v[216:219], v[48:51], v[144:147]
    ds_read_b64_tr_b16 v[210:211], v243 offset:25088
    s_waitcnt lgkmcnt(8)
    v_mfma_f32_16x16x32_bf16 v[148:151], v[220:223], v[44:47], v[148:151]
    ds_read_b64_tr_b16 v[212:213], v240 offset:28672
    v_mfma_f32_16x16x32_bf16 v[156:159], v[220:223], v[48:51], v[156:159]
    ds_read_b64_tr_b16 v[214:215], v240 offset:29184
    v_mfma_f32_16x16x32_bf16 v[152:155], v[224:227], v[44:47], v[152:155]
    ds_read_b64_tr_b16 v[216:217], v241 offset:28672
    v_mfma_f32_16x16x32_bf16 v[160:163], v[224:227], v[48:51], v[160:163]
    ds_read_b64_tr_b16 v[218:219], v241 offset:29184
    s_waitcnt lgkmcnt(8)
    v_mfma_f32_16x16x32_bf16 v[132:135], v[196:199], v[52:55], v[132:135]
    ds_read_b64_tr_b16 v[220:221], v242 offset:28672
    v_mfma_f32_16x16x32_bf16 v[140:143], v[196:199], v[56:59], v[140:143]
    ds_read_b64_tr_b16 v[222:223], v242 offset:29184
    s_add_u32 s41, s37, 0
    buffer_store_dwordx4 v[184:187], v2, s[28:31], s41 offen offset:1024 sc1
    v_mfma_f32_16x16x32_bf16 v[136:139], v[200:203], v[52:55], v[136:139]
    ds_read_b64_tr_b16 v[224:225], v243 offset:28672
    v_mfma_f32_16x16x32_bf16 v[144:147], v[200:203], v[56:59], v[144:147]
    ds_read_b64_tr_b16 v[226:227], v243 offset:29184
    s_waitcnt lgkmcnt(8)
    v_mfma_f32_16x16x32_bf16 v[148:151], v[204:207], v[52:55], v[148:151]
    ds_read_b64_tr_b16 v[196:197], v232 offset:0
    v_mfma_f32_16x16x32_bf16 v[156:159], v[204:207], v[56:59], v[156:159]
    ds_read_b64_tr_b16 v[198:199], v232 offset:512
    v_mfma_f32_16x16x32_bf16 v[152:155], v[208:211], v[52:55], v[152:155]
    ds_read_b64_tr_b16 v[200:201], v233 offset:0
    v_mfma_f32_16x16x32_bf16 v[160:163], v[208:211], v[56:59], v[160:163]
    ds_read_b64_tr_b16 v[202:203], v233 offset:512
    s_waitcnt lgkmcnt(8)
    v_mfma_f32_16x16x32_bf16 v[132:135], v[212:215], v[60:63], v[132:135]
    ds_read_b64_tr_b16 v[204:205], v234 offset:0
    v_mfma_f32_16x16x32_bf16 v[140:143], v[212:215], v[64:67], v[140:143]
    ds_read_b64_tr_b16 v[206:207], v234 offset:512
    v_mfma_f32_16x16x32_bf16 v[136:139], v[216:219], v[60:63], v[136:139]
    ds_read_b64_tr_b16 v[208:209], v235 offset:0
    v_mfma_f32_16x16x32_bf16 v[144:147], v[216:219], v[64:67], v[144:147]
    ds_read_b64_tr_b16 v[210:211], v235 offset:512
    s_waitcnt lgkmcnt(8)
    v_mfma_f32_16x16x32_bf16 v[148:151], v[220:223], v[60:63], v[148:151]
    ds_read_b64_tr_b16 v[212:213], v232 offset:4096
    v_mfma_f32_16x16x32_bf16 v[156:159], v[220:223], v[64:67], v[156:159]
    ds_read_b64_tr_b16 v[214:215], v232 offset:4608
    v_mfma_f32_16x16x32_bf16 v[152:155], v[224:227], v[60:63], v[152:155]
    ds_read_b64_tr_b16 v[216:217], v233 offset:4096
    v_mfma_f32_16x16x32_bf16 v[160:163], v[224:227], v[64:67], v[160:163]
    ds_read_b64_tr_b16 v[218:219], v233 offset:4608
    s_waitcnt vmcnt(11)
    s_barrier
    s_waitcnt lgkmcnt(8)
    v_mfma_f32_16x16x32_bf16 v[132:135], v[196:199], v[68:71], v[132:135]
    ds_read_b64_tr_b16 v[220:221], v234 offset:4096
    v_mfma_f32_16x16x32_bf16 v[140:143], v[196:199], v[72:75], v[140:143]
    ds_read_b64_tr_b16 v[222:223], v234 offset:4608
    s_add_u32 m0, s36, 65536
    s_add_u32 s35, s45, 0
    buffer_load_dwordx4 v236, s[96:99], s35 offen offset:0 lds
    v_mfma_f32_16x16x32_bf16 v[136:139], v[200:203], v[68:71], v[136:139]
    ds_read_b64_tr_b16 v[224:225], v235 offset:4096
    v_mfma_f32_16x16x32_bf16 v[144:147], v[200:203], v[72:75], v[144:147]
    ds_read_b64_tr_b16 v[226:227], v235 offset:4608
    buffer_load_dwordx4 v237, s[96:99], s35 offen offset:1024 lds
    s_waitcnt lgkmcnt(8)
    v_mfma_f32_16x16x32_bf16 v[148:151], v[204:207], v[68:71], v[148:151]
    ds_read_b64_tr_b16 v[196:197], v232 offset:8192
    v_mfma_f32_16x16x32_bf16 v[156:159], v[204:207], v[72:75], v[156:159]
    ds_read_b64_tr_b16 v[198:199], v232 offset:8704
    buffer_load_dwordx4 v238, s[96:99], s35 offen offset:2048 lds
    v_mfma_f32_16x16x32_bf16 v[152:155], v[208:211], v[68:71], v[152:155]
    ds_read_b64_tr_b16 v[200:201], v233 offset:8192
    v_mfma_f32_16x16x32_bf16 v[160:163], v[208:211], v[72:75], v[160:163]
    ds_read_b64_tr_b16 v[202:203], v233 offset:8704
    buffer_load_dwordx4 v239, s[96:99], s35 offen offset:3072 lds
    s_waitcnt lgkmcnt(8)
    v_mfma_f32_16x16x32_bf16 v[132:135], v[212:215], v[76:79], v[132:135]
    ds_read_b64_tr_b16 v[204:205], v234 offset:8192
    v_mfma_f32_16x16x32_bf16 v[140:143], v[212:215], v[80:83], v[140:143]
    ds_read_b64_tr_b16 v[206:207], v234 offset:8704
    v_mfma_f32_16x16x32_bf16 v[136:139], v[216:219], v[76:79], v[136:139]
    ds_read_b64_tr_b16 v[208:209], v235 offset:8192
    v_mfma_f32_16x16x32_bf16 v[144:147], v[216:219], v[80:83], v[144:147]
    ds_read_b64_tr_b16 v[210:211], v235 offset:8704
    s_waitcnt lgkmcnt(8)
    v_mfma_f32_16x16x32_bf16 v[148:151], v[220:223], v[76:79], v[148:151]
    ds_read_b64_tr_b16 v[212:213], v232 offset:12288
    v_mfma_f32_16x16x32_bf16 v[156:159], v[220:223], v[80:83], v[156:159]
    ds_read_b64_tr_b16 v[214:215], v232 offset:12800
    v_mfma_f32_16x16x32_bf16 v[152:155], v[224:227], v[76:79], v[152:155]
    ds_read_b64_tr_b16 v[216:217], v233 offset:12288
    v_mfma_f32_16x16x32_bf16 v[160:163], v[224:227], v[80:83], v[160:163]
    ds_read_b64_tr_b16 v[218:219], v233 offset:12800
    s_waitcnt lgkmcnt(8)
    v_mfma_f32_16x16x32_bf16 v[132:135], v[196:199], v[84:87], v[132:135]
    ds_read_b64_tr_b16 v[220:221], v234 offset:12288
    v_mfma_f32_16x16x32_bf16 v[140:143], v[196:199], v[88:91], v[140:143]
    ds_read_b64_tr_b16 v[222:223], v234 offset:12800
    v_mfma_f32_16x16x32_bf16 v[136:139], v[200:203], v[84:87], v[136:139]
    ds_read_b64_tr_b16 v[224:225], v235 offset:12288
    v_mfma_f32_16x16x32_bf16 v[144:147], v[200:203], v[88:91], v[144:147]
    ds_read_b64_tr_b16 v[226:227], v235 offset:12800
    s_waitcnt lgkmcnt(8)
    v_mfma_f32_16x16x32_bf16 v[148:151], v[204:207], v[84:87], v[148:151]
    ds_read_b64_tr_b16 v[196:197], v232 offset:16384
    v_mfma_f32_16x16x32_bf16 v[156:159], v[204:207], v[88:91], v[156:159]
    ds_read_b64_tr_b16 v[198:199], v232 offset:16896
    s_add_u32 s41, s37, 0
    buffer_store_dwordx4 v[188:191], v2, s[28:31], s41 offen offset:2048 sc1
    v_mfma_f32_16x16x32_bf16 v[152:155], v[208:211], v[84:87], v[152:155]
    ds_read_b64_tr_b16 v[200:201], v233 offset:16384
    v_mfma_f32_16x16x32_bf16 v[160:163], v[208:211], v[88:91], v[160:163]
    ds_read_b64_tr_b16 v[202:203], v233 offset:16896
    s_waitcnt lgkmcnt(8)
    v_mfma_f32_16x16x32_bf16 v[132:135], v[212:215], v[92:95], v[132:135]
    ds_read_b64_tr_b16 v[204:205], v234 offset:16384
    v_mfma_f32_16x16x32_bf16 v[140:143], v[212:215], v[96:99], v[140:143]
    ds_read_b64_tr_b16 v[206:207], v234 offset:16896
    v_mfma_f32_16x16x32_bf16 v[136:139], v[216:219], v[92:95], v[136:139]
    ds_read_b64_tr_b16 v[208:209], v235 offset:16384
    v_mfma_f32_16x16x32_bf16 v[144:147], v[216:219], v[96:99], v[144:147]
    ds_read_b64_tr_b16 v[210:211], v235 offset:16896
    s_waitcnt lgkmcnt(8)
    v_mfma_f32_16x16x32_bf16 v[148:151], v[220:223], v[92:95], v[148:151]
    ds_read_b64_tr_b16 v[212:213], v232 offset:20480
    v_mfma_f32_16x16x32_bf16 v[156:159], v[220:223], v[96:99], v[156:159]
    ds_read_b64_tr_b16 v[214:215], v232 offset:20992
    v_mfma_f32_16x16x32_bf16 v[152:155], v[224:227], v[92:95], v[152:155]
    ds_read_b64_tr_b16 v[216:217], v233 offset:20480
    v_mfma_f32_16x16x32_bf16 v[160:163], v[224:227], v[96:99], v[160:163]
    ds_read_b64_tr_b16 v[218:219], v233 offset:20992
    s_waitcnt lgkmcnt(8)
    v_mfma_f32_16x16x32_bf16 v[132:135], v[196:199], v[100:103], v[132:135]
    ds_read_b64_tr_b16 v[220:221], v234 offset:20480
    v_mfma_f32_16x16x32_bf16 v[140:143], v[196:199], v[104:107], v[140:143]
    ds_read_b64_tr_b16 v[222:223], v234 offset:20992
    v_mfma_f32_16x16x32_bf16 v[136:139], v[200:203], v[100:103], v[136:139]
    ds_read_b64_tr_b16 v[224:225], v235 offset:20480
    v_mfma_f32_16x16x32_bf16 v[144:147], v[200:203], v[104:107], v[144:147]
    ds_read_b64_tr_b16 v[226:227], v235 offset:20992
    s_waitcnt lgkmcnt(8)
    v_mfma_f32_16x16x32_bf16 v[148:151], v[204:207], v[100:103], v[148:151]
    ds_read_b64_tr_b16 v[196:197], v232 offset:24576
    v_mfma_f32_16x16x32_bf16 v[156:159], v[204:207], v[104:107], v[156:159]
    ds_read_b64_tr_b16 v[198:199], v232 offset:25088
    v_mfma_f32_16x16x32_bf16 v[152:155], v[208:211], v[100:103], v[152:155]
    ds_read_b64_tr_b16 v[200:201], v233 offset:24576
    v_mfma_f32_16x16x32_bf16 v[160:163], v[208:211], v[104:107], v[160:163]
    ds_read_b64_tr_b16 v[202:203], v233 offset:25088
    s_waitcnt lgkmcnt(8)
    v_mfma_f32_16x16x32_bf16 v[132:135], v[212:215], v[108:111], v[132:135]
    ds_read_b64_tr_b16 v[204:205], v234 offset:24576
    v_mfma_f32_16x16x32_bf16 v[140:143], v[212:215], v[112:115], v[140:143]
    ds_read_b64_tr_b16 v[206:207], v234 offset:25088
    v_mfma_f32_16x16x32_bf16 v[136:139], v[216:219], v[108:111], v[136:139]
    ds_read_b64_tr_b16 v[208:209], v235 offset:24576
    v_mfma_f32_16x16x32_bf16 v[144:147], v[216:219], v[112:115], v[144:147]
    ds_read_b64_tr_b16 v[210:211], v235 offset:25088
    s_waitcnt lgkmcnt(8)
    v_mfma_f32_16x16x32_bf16 v[148:151], v[220:223], v[108:111], v[148:151]
    ds_read_b64_tr_b16 v[212:213], v232 offset:28672
    v_mfma_f32_16x16x32_bf16 v[156:159], v[220:223], v[112:115], v[156:159]
    ds_read_b64_tr_b16 v[214:215], v232 offset:29184
    v_mfma_f32_16x16x32_bf16 v[152:155], v[224:227], v[108:111], v[152:155]
    ds_read_b64_tr_b16 v[216:217], v233 offset:28672
    v_mfma_f32_16x16x32_bf16 v[160:163], v[224:227], v[112:115], v[160:163]
    ds_read_b64_tr_b16 v[218:219], v233 offset:29184
    s_waitcnt lgkmcnt(8)
    v_mfma_f32_16x16x32_bf16 v[132:135], v[196:199], v[116:119], v[132:135]
    ds_read_b64_tr_b16 v[220:221], v234 offset:28672
    v_mfma_f32_16x16x32_bf16 v[140:143], v[196:199], v[120:123], v[140:143]
    ds_read_b64_tr_b16 v[222:223], v234 offset:29184
    s_add_u32 s41, s37, 0
    buffer_store_dwordx4 v[192:195], v2, s[28:31], s41 offen offset:3072 sc1
    v_mfma_f32_16x16x32_bf16 v[136:139], v[200:203], v[116:119], v[136:139]
    ds_read_b64_tr_b16 v[224:225], v235 offset:28672
    v_mfma_f32_16x16x32_bf16 v[144:147], v[200:203], v[120:123], v[144:147]
    ds_read_b64_tr_b16 v[226:227], v235 offset:29184
    s_waitcnt lgkmcnt(8)
    v_mfma_f32_16x16x32_bf16 v[148:151], v[204:207], v[116:119], v[148:151]
    ds_read_b64_tr_b16 v[196:197], v232 offset:32768
    v_mfma_f32_16x16x32_bf16 v[156:159], v[204:207], v[120:123], v[156:159]
    ds_read_b64_tr_b16 v[198:199], v232 offset:33280
    v_mfma_f32_16x16x32_bf16 v[152:155], v[208:211], v[116:119], v[152:155]
    ds_read_b64_tr_b16 v[200:201], v233 offset:32768
    v_mfma_f32_16x16x32_bf16 v[160:163], v[208:211], v[120:123], v[160:163]
    ds_read_b64_tr_b16 v[202:203], v233 offset:33280
    s_waitcnt lgkmcnt(8)
    v_mfma_f32_16x16x32_bf16 v[132:135], v[212:215], v[124:127], v[132:135]
    ds_read_b64_tr_b16 v[204:205], v234 offset:32768
    v_mfma_f32_16x16x32_bf16 v[140:143], v[212:215], v[128:131], v[140:143]
    ds_read_b64_tr_b16 v[206:207], v234 offset:33280
    v_mfma_f32_16x16x32_bf16 v[136:139], v[216:219], v[124:127], v[136:139]
    ds_read_b64_tr_b16 v[208:209], v235 offset:32768
    v_mfma_f32_16x16x32_bf16 v[144:147], v[216:219], v[128:131], v[144:147]
    ds_read_b64_tr_b16 v[210:211], v235 offset:33280
    s_waitcnt lgkmcnt(8)
    v_mfma_f32_16x16x32_bf16 v[148:151], v[220:223], v[124:127], v[148:151]
    ds_read_b64_tr_b16 v[212:213], v232 offset:36864
    v_mfma_f32_16x16x32_bf16 v[156:159], v[220:223], v[128:131], v[156:159]
    ds_read_b64_tr_b16 v[214:215], v232 offset:37376
    v_mfma_f32_16x16x32_bf16 v[152:155], v[224:227], v[124:127], v[152:155]
    ds_read_b64_tr_b16 v[216:217], v233 offset:36864
    v_mfma_f32_16x16x32_bf16 v[160:163], v[224:227], v[128:131], v[160:163]
    ds_read_b64_tr_b16 v[218:219], v233 offset:37376
    s_waitcnt vmcnt(13)
    s_nop 3
    v_cvt_pk_bf16_f32 v180, v132, v133
    v_cvt_pk_bf16_f32 v181, v134, v135
    v_cvt_pk_bf16_f32 v182, v136, v137
    v_cvt_pk_bf16_f32 v183, v138, v139
    v_cvt_pk_bf16_f32 v184, v140, v141
    v_cvt_pk_bf16_f32 v185, v142, v143
    v_cvt_pk_bf16_f32 v186, v144, v145
    v_cvt_pk_bf16_f32 v187, v146, v147
    v_cvt_pk_bf16_f32 v188, v148, v149
    v_cvt_pk_bf16_f32 v189, v150, v151
    v_cvt_pk_bf16_f32 v190, v152, v153
    v_cvt_pk_bf16_f32 v191, v154, v155
    v_cvt_pk_bf16_f32 v192, v156, v157
    v_cvt_pk_bf16_f32 v193, v158, v159
    v_cvt_pk_bf16_f32 v194, v160, v161
    v_cvt_pk_bf16_f32 v195, v162, v163
    s_barrier
    s_waitcnt lgkmcnt(8)
    v_mfma_f32_16x16x32_bf16 v[132:135], v[196:199], v[4:7], 0
    ds_read_b64_tr_b16 v[220:221], v234 offset:36864
    v_mfma_f32_16x16x32_bf16 v[140:143], v[196:199], v[8:11], 0
    ds_read_b64_tr_b16 v[222:223], v234 offset:37376
    s_add_u32 m0, s36, 0
    s_add_u32 s35, s44, 0
    buffer_load_dwordx4 v228, s[24:27], s35 offen offset:0 lds
    v_mfma_f32_16x16x32_bf16 v[136:139], v[200:203], v[4:7], 0
    ds_read_b64_tr_b16 v[224:225], v235 offset:36864
    v_mfma_f32_16x16x32_bf16 v[144:147], v[200:203], v[8:11], 0
    ds_read_b64_tr_b16 v[226:227], v235 offset:37376
    buffer_load_dwordx4 v229, s[24:27], s35 offen offset:1024 lds
    s_waitcnt lgkmcnt(8)
    v_mfma_f32_16x16x32_bf16 v[148:151], v[204:207], v[4:7], 0
    ds_read_b64_tr_b16 v[196:197], v232 offset:40960
    v_mfma_f32_16x16x32_bf16 v[156:159], v[204:207], v[8:11], 0
    ds_read_b64_tr_b16 v[198:199], v232 offset:41472
    buffer_load_dwordx4 v230, s[24:27], s35 offen offset:2048 lds
    v_mfma_f32_16x16x32_bf16 v[152:155], v[208:211], v[4:7], 0
    ds_read_b64_tr_b16 v[200:201], v233 offset:40960
    v_mfma_f32_16x16x32_bf16 v[160:163], v[208:211], v[8:11], 0
    ds_read_b64_tr_b16 v[202:203], v233 offset:41472
    buffer_load_dwordx4 v231, s[24:27], s35 offen offset:3072 lds
    s_waitcnt lgkmcnt(8)
    v_mfma_f32_16x16x32_bf16 v[132:135], v[212:215], v[12:15], v[132:135]
    ds_read_b64_tr_b16 v[204:205], v234 offset:40960
    s_lshr_b32 s39, s2, 5
    v_mfma_f32_16x16x32_bf16 v[140:143], v[212:215], v[16:19], v[140:143]
    ds_read_b64_tr_b16 v[206:207], v234 offset:41472
    s_sub_u32 s40, 15, s39
    v_mfma_f32_16x16x32_bf16 v[136:139], v[216:219], v[12:15], v[136:139]
    ds_read_b64_tr_b16 v[208:209], v235 offset:40960
    s_cmp_lt_u32 s32, 4
    s_cselect_b32 s39, s40, s39
    v_mfma_f32_16x16x32_bf16 v[144:147], v[216:219], v[16:19], v[144:147]
    ds_read_b64_tr_b16 v[210:211], v235 offset:41472
    s_lshl_b32 s39, s39, 2
    s_waitcnt lgkmcnt(8)
    v_mfma_f32_16x16x32_bf16 v[148:151], v[220:223], v[12:15], v[148:151]
    ds_read_b64_tr_b16 v[212:213], v232 offset:45056
    s_and_b32 s40, s32, 3
    v_mfma_f32_16x16x32_bf16 v[156:159], v[220:223], v[16:19], v[156:159]
    ds_read_b64_tr_b16 v[214:215], v232 offset:45568
    s_add_u32 s43, s39, s40
    v_mfma_f32_16x16x32_bf16 v[152:155], v[224:227], v[12:15], v[152:155]
    ds_read_b64_tr_b16 v[216:217], v233 offset:45056
    v_and_b32 v252, 1, v1
    v_mfma_f32_16x16x32_bf16 v[160:163], v[224:227], v[16:19], v[160:163]
    ds_read_b64_tr_b16 v[218:219], v233 offset:45568
    s_lshl_b32 s39, s43, 2
    v_mul_u32_u24 v252, s39, v252
    s_waitcnt lgkmcnt(8)
    v_mfma_f32_16x16x32_bf16 v[132:135], v[196:199], v[20:23], v[132:135]
    ds_read_b64_tr_b16 v[220:221], v234 offset:45056
    s_lshl_b32 s43, s43, 15
    v_mfma_f32_16x16x32_bf16 v[140:143], v[196:199], v[24:27], v[140:143]
    ds_read_b64_tr_b16 v[222:223], v234 offset:45568
    buffer_load_dword v254, v252, s[52:55], 0 offen sc0 sc1
    v_mfma_f32_16x16x32_bf16 v[136:139], v[200:203], v[20:23], v[136:139]
    ds_read_b64_tr_b16 v[224:225], v235 offset:45056
    v_mfma_f32_16x16x32_bf16 v[144:147], v[200:203], v[24:27], v[144:147]
    ds_read_b64_tr_b16 v[226:227], v235 offset:45568
    s_waitcnt lgkmcnt(8)
    v_mfma_f32_16x16x32_bf16 v[148:151], v[204:207], v[20:23], v[148:151]
    ds_read_b64_tr_b16 v[196:197], v232 offset:49152
    v_mfma_f32_16x16x32_bf16 v[156:159], v[204:207], v[24:27], v[156:159]
    ds_read_b64_tr_b16 v[198:199], v232 offset:49664
    s_add_u32 s41, s37, 4096
    buffer_store_dwordx4 v[164:167], v2, s[28:31], s41 offen offset:0 sc1
    v_mfma_f32_16x16x32_bf16 v[152:155], v[208:211], v[20:23], v[152:155]
    ds_read_b64_tr_b16 v[200:201], v233 offset:49152
    v_mfma_f32_16x16x32_bf16 v[160:163], v[208:211], v[24:27], v[160:163]
    ds_read_b64_tr_b16 v[202:203], v233 offset:49664
    s_waitcnt lgkmcnt(8)
    v_mfma_f32_16x16x32_bf16 v[132:135], v[212:215], v[28:31], v[132:135]
    ds_read_b64_tr_b16 v[204:205], v234 offset:49152
    v_mfma_f32_16x16x32_bf16 v[140:143], v[212:215], v[32:35], v[140:143]
    ds_read_b64_tr_b16 v[206:207], v234 offset:49664
    v_mfma_f32_16x16x32_bf16 v[136:139], v[216:219], v[28:31], v[136:139]
    ds_read_b64_tr_b16 v[208:209], v235 offset:49152
    v_mfma_f32_16x16x32_bf16 v[144:147], v[216:219], v[32:35], v[144:147]
    ds_read_b64_tr_b16 v[210:211], v235 offset:49664
    s_waitcnt lgkmcnt(8)
    v_mfma_f32_16x16x32_bf16 v[148:151], v[220:223], v[28:31], v[148:151]
    ds_read_b64_tr_b16 v[212:213], v232 offset:53248
    v_mfma_f32_16x16x32_bf16 v[156:159], v[220:223], v[32:35], v[156:159]
    ds_read_b64_tr_b16 v[214:215], v232 offset:53760
    v_mfma_f32_16x16x32_bf16 v[152:155], v[224:227], v[28:31], v[152:155]
    ds_read_b64_tr_b16 v[216:217], v233 offset:53248
    v_mfma_f32_16x16x32_bf16 v[160:163], v[224:227], v[32:35], v[160:163]
    ds_read_b64_tr_b16 v[218:219], v233 offset:53760
    s_waitcnt lgkmcnt(8)
    v_mfma_f32_16x16x32_bf16 v[132:135], v[196:199], v[36:39], v[132:135]
    ds_read_b64_tr_b16 v[220:221], v234 offset:53248
    v_mfma_f32_16x16x32_bf16 v[140:143], v[196:199], v[40:43], v[140:143]
    ds_read_b64_tr_b16 v[222:223], v234 offset:53760
    v_mfma_f32_16x16x32_bf16 v[136:139], v[200:203], v[36:39], v[136:139]
    ds_read_b64_tr_b16 v[224:225], v235 offset:53248
    v_mfma_f32_16x16x32_bf16 v[144:147], v[200:203], v[40:43], v[144:147]
    ds_read_b64_tr_b16 v[226:227], v235 offset:53760
    s_waitcnt lgkmcnt(8)
    v_mfma_f32_16x16x32_bf16 v[148:151], v[204:207], v[36:39], v[148:151]
    ds_read_b64_tr_b16 v[196:197], v232 offset:57344
    v_mfma_f32_16x16x32_bf16 v[156:159], v[204:207], v[40:43], v[156:159]
    ds_read_b64_tr_b16 v[198:199], v232 offset:57856
    v_mfma_f32_16x16x32_bf16 v[152:155], v[208:211], v[36:39], v[152:155]
    ds_read_b64_tr_b16 v[200:201], v233 offset:57344
    v_mfma_f32_16x16x32_bf16 v[160:163], v[208:211], v[40:43], v[160:163]
    ds_read_b64_tr_b16 v[202:203], v233 offset:57856
    s_waitcnt lgkmcnt(8)
    v_mfma_f32_16x16x32_bf16 v[132:135], v[212:215], v[44:47], v[132:135]
    ds_read_b64_tr_b16 v[204:205], v234 offset:57344
    v_mfma_f32_16x16x32_bf16 v[140:143], v[212:215], v[48:51], v[140:143]
    ds_read_b64_tr_b16 v[206:207], v234 offset:57856
    v_mfma_f32_16x16x32_bf16 v[136:139], v[216:219], v[44:47], v[136:139]
    ds_read_b64_tr_b16 v[208:209], v235 offset:57344
    v_mfma_f32_16x16x32_bf16 v[144:147], v[216:219], v[48:51], v[144:147]
    ds_read_b64_tr_b16 v[210:211], v235 offset:57856
    s_waitcnt lgkmcnt(8)
    v_mfma_f32_16x16x32_bf16 v[148:151], v[220:223], v[44:47], v[148:151]
    ds_read_b64_tr_b16 v[212:213], v232 offset:61440
    v_mfma_f32_16x16x32_bf16 v[156:159], v[220:223], v[48:51], v[156:159]
    ds_read_b64_tr_b16 v[214:215], v232 offset:61952
    v_mfma_f32_16x16x32_bf16 v[152:155], v[224:227], v[44:47], v[152:155]
    ds_read_b64_tr_b16 v[216:217], v233 offset:61440
    v_mfma_f32_16x16x32_bf16 v[160:163], v[224:227], v[48:51], v[160:163]
    ds_read_b64_tr_b16 v[218:219], v233 offset:61952
    s_waitcnt lgkmcnt(8)
    v_mfma_f32_16x16x32_bf16 v[132:135], v[196:199], v[52:55], v[132:135]
    ds_read_b64_tr_b16 v[220:221], v234 offset:61440
    v_mfma_f32_16x16x32_bf16 v[140:143], v[196:199], v[56:59], v[140:143]
    ds_read_b64_tr_b16 v[222:223], v234 offset:61952
    s_add_u32 s41, s37, 4096
    buffer_store_dwordx4 v[168:171], v2, s[28:31], s41 offen offset:1024 sc1
    v_mfma_f32_16x16x32_bf16 v[136:139], v[200:203], v[52:55], v[136:139]
    ds_read_b64_tr_b16 v[224:225], v235 offset:61440
    v_mfma_f32_16x16x32_bf16 v[144:147], v[200:203], v[56:59], v[144:147]
    ds_read_b64_tr_b16 v[226:227], v235 offset:61952
    s_waitcnt lgkmcnt(8)
    v_mfma_f32_16x16x32_bf16 v[148:151], v[204:207], v[52:55], v[148:151]
    ds_read_b64_tr_b16 v[196:197], v244 offset:0
    v_mfma_f32_16x16x32_bf16 v[156:159], v[204:207], v[56:59], v[156:159]
    ds_read_b64_tr_b16 v[198:199], v244 offset:512
    v_mfma_f32_16x16x32_bf16 v[152:155], v[208:211], v[52:55], v[152:155]
    ds_read_b64_tr_b16 v[200:201], v245 offset:0
    v_mfma_f32_16x16x32_bf16 v[160:163], v[208:211], v[56:59], v[160:163]
    ds_read_b64_tr_b16 v[202:203], v245 offset:512
    s_waitcnt lgkmcnt(8)
    v_mfma_f32_16x16x32_bf16 v[132:135], v[212:215], v[60:63], v[132:135]
    ds_read_b64_tr_b16 v[204:205], v246 offset:0
    v_mfma_f32_16x16x32_bf16 v[140:143], v[212:215], v[64:67], v[140:143]
    ds_read_b64_tr_b16 v[206:207], v246 offset:512
    v_mfma_f32_16x16x32_bf16 v[136:139], v[216:219], v[60:63], v[136:139]
    ds_read_b64_tr_b16 v[208:209], v247 offset:0
    v_mfma_f32_16x16x32_bf16 v[144:147], v[216:219], v[64:67], v[144:147]
    ds_read_b64_tr_b16 v[210:211], v247 offset:512
    s_waitcnt lgkmcnt(8)
    v_mfma_f32_16x16x32_bf16 v[148:151], v[220:223], v[60:63], v[148:151]
    ds_read_b64_tr_b16 v[212:213], v244 offset:4096
    v_mfma_f32_16x16x32_bf16 v[156:159], v[220:223], v[64:67], v[156:159]
    ds_read_b64_tr_b16 v[214:215], v244 offset:4608
    v_mfma_f32_16x16x32_bf16 v[152:155], v[224:227], v[60:63], v[152:155]
    ds_read_b64_tr_b16 v[216:217], v245 offset:4096
    v_mfma_f32_16x16x32_bf16 v[160:163], v[224:227], v[64:67], v[160:163]
    ds_read_b64_tr_b16 v[218:219], v245 offset:4608
    s_barrier
    s_waitcnt lgkmcnt(8)
    v_mfma_f32_16x16x32_bf16 v[132:135], v[196:199], v[68:71], v[132:135]
    ds_read_b64_tr_b16 v[220:221], v246 offset:4096
    v_mfma_f32_16x16x32_bf16 v[140:143], v[196:199], v[72:75], v[140:143]
    ds_read_b64_tr_b16 v[222:223], v246 offset:4608
    s_add_u32 m0, s36, 32768
    s_add_u32 s35, s44, 128
    buffer_load_dwordx4 v228, s[24:27], s35 offen offset:0 lds
    v_mfma_f32_16x16x32_bf16 v[136:139], v[200:203], v[68:71], v[136:139]
    ds_read_b64_tr_b16 v[224:225], v247 offset:4096
    v_mfma_f32_16x16x32_bf16 v[144:147], v[200:203], v[72:75], v[144:147]
    ds_read_b64_tr_b16 v[226:227], v247 offset:4608
    buffer_load_dwordx4 v229, s[24:27], s35 offen offset:1024 lds
    s_waitcnt lgkmcnt(8)
    v_mfma_f32_16x16x32_bf16 v[148:151], v[204:207], v[68:71], v[148:151]
    ds_read_b64_tr_b16 v[196:197], v244 offset:8192
    v_mfma_f32_16x16x32_bf16 v[156:159], v[204:207], v[72:75], v[156:159]
    ds_read_b64_tr_b16 v[198:199], v244 offset:8704
    buffer_load_dwordx4 v230, s[24:27], s35 offen offset:2048 lds
    v_mfma_f32_16x16x32_bf16 v[152:155], v[208:211], v[68:71], v[152:155]
    ds_read_b64_tr_b16 v[200:201], v245 offset:8192
    v_mfma_f32_16x16x32_bf16 v[160:163], v[208:211], v[72:75], v[160:163]
    ds_read_b64_tr_b16 v[202:203], v245 offset:8704
    buffer_load_dwordx4 v231, s[24:27], s35 offen offset:3072 lds
    s_waitcnt lgkmcnt(8)
    v_mfma_f32_16x16x32_bf16 v[132:135], v[212:215], v[76:79], v[132:135]
    ds_read_b64_tr_b16 v[204:205], v246 offset:8192
    v_mfma_f32_16x16x32_bf16 v[140:143], v[212:215], v[80:83], v[140:143]
    ds_read_b64_tr_b16 v[206:207], v246 offset:8704
    v_mfma_f32_16x16x32_bf16 v[136:139], v[216:219], v[76:79], v[136:139]
    ds_read_b64_tr_b16 v[208:209], v247 offset:8192
    v_mfma_f32_16x16x32_bf16 v[144:147], v[216:219], v[80:83], v[144:147]
    ds_read_b64_tr_b16 v[210:211], v247 offset:8704
    s_waitcnt lgkmcnt(8)
    v_mfma_f32_16x16x32_bf16 v[148:151], v[220:223], v[76:79], v[148:151]
    ds_read_b64_tr_b16 v[212:213], v244 offset:12288
    v_mfma_f32_16x16x32_bf16 v[156:159], v[220:223], v[80:83], v[156:159]
    ds_read_b64_tr_b16 v[214:215], v244 offset:12800
    v_mfma_f32_16x16x32_bf16 v[152:155], v[224:227], v[76:79], v[152:155]
    ds_read_b64_tr_b16 v[216:217], v245 offset:12288
    v_mfma_f32_16x16x32_bf16 v[160:163], v[224:227], v[80:83], v[160:163]
    ds_read_b64_tr_b16 v[218:219], v245 offset:12800
    s_waitcnt lgkmcnt(8)
    v_mfma_f32_16x16x32_bf16 v[132:135], v[196:199], v[84:87], v[132:135]
    ds_read_b64_tr_b16 v[220:221], v246 offset:12288
    v_mfma_f32_16x16x32_bf16 v[140:143], v[196:199], v[88:91], v[140:143]
    ds_read_b64_tr_b16 v[222:223], v246 offset:12800
    v_mfma_f32_16x16x32_bf16 v[136:139], v[200:203], v[84:87], v[136:139]
    ds_read_b64_tr_b16 v[224:225], v247 offset:12288
    v_mfma_f32_16x16x32_bf16 v[144:147], v[200:203], v[88:91], v[144:147]
    ds_read_b64_tr_b16 v[226:227], v247 offset:12800
    s_waitcnt lgkmcnt(8)
    v_mfma_f32_16x16x32_bf16 v[148:151], v[204:207], v[84:87], v[148:151]
    ds_read_b64_tr_b16 v[196:197], v244 offset:16384
    v_mfma_f32_16x16x32_bf16 v[156:159], v[204:207], v[88:91], v[156:159]
    ds_read_b64_tr_b16 v[198:199], v244 offset:16896
    s_add_u32 s41, s37, 4096
    buffer_store_dwordx4 v[172:175], v2, s[28:31], s41 offen offset:2048 sc1
    v_mfma_f32_16x16x32_bf16 v[152:155], v[208:211], v[84:87], v[152:155]
    ds_read_b64_tr_b16 v[200:201], v245 offset:16384
    v_mfma_f32_16x16x32_bf16 v[160:163], v[208:211], v[88:91], v[160:163]
    ds_read_b64_tr_b16 v[202:203], v245 offset:16896
    s_waitcnt lgkmcnt(8)
    v_mfma_f32_16x16x32_bf16 v[132:135], v[212:215], v[92:95], v[132:135]
    ds_read_b64_tr_b16 v[204:205], v246 offset:16384
    v_mfma_f32_16x16x32_bf16 v[140:143], v[212:215], v[96:99], v[140:143]
    ds_read_b64_tr_b16 v[206:207], v246 offset:16896
    v_mfma_f32_16x16x32_bf16 v[136:139], v[216:219], v[92:95], v[136:139]
    ds_read_b64_tr_b16 v[208:209], v247 offset:16384
    v_mfma_f32_16x16x32_bf16 v[144:147], v[216:219], v[96:99], v[144:147]
    ds_read_b64_tr_b16 v[210:211], v247 offset:16896
    s_waitcnt vmcnt(7)
    s_mov_b32 s40, 0x200000
L_k1xn_2:
    v_cmp_gt_u32 vcc, 4, v254
    s_cbranch_vccz L_k1xnok_3
    s_sleep 8
    buffer_load_dword v254, v252, s[52:55], 0 offen sc0 sc1
    s_waitcnt vmcnt(0)
    s_sub_u32 s40, s40, 1
    s_cmp_lg_u32 s40, 0
    s_cbranch_scc1 L_k1xn_2
L_k1xnok_3:
    s_add_u32 s40, s43, 4096
    buffer_load_dwordx4 v[4:7], v2, s[56:59], s43 offen offset:0 sc1
    buffer_load_dwordx4 v[8:11], v2, s[56:59], s43 offen offset:1024 sc1
    buffer_load_dwordx4 v[12:15], v2, s[56:59], s43 offen offset:2048 sc1
    buffer_load_dwordx4 v[16:19], v2, s[56:59], s43 offen offset:3072 sc1
    buffer_load_dwordx4 v[20:23], v2, s[56:59], s40 offen offset:0 sc1
    buffer_load_dwordx4 v[24:27], v2, s[56:59], s40 offen offset:1024 sc1
    s_waitcnt lgkmcnt(8)
    v_mfma_f32_16x16x32_bf16 v[148:151], v[220:223], v[92:95], v[148:151]
    ds_read_b64_tr_b16 v[212:213], v244 offset:20480
    v_mfma_f32_16x16x32_bf16 v[156:159], v[220:223], v[96:99], v[156:159]
    ds_read_b64_tr_b16 v[214:215], v244 offset:20992
    v_mfma_f32_16x16x32_bf16 v[152:155], v[224:227], v[92:95], v[152:155]
    ds_read_b64_tr_b16 v[216:217], v245 offset:20480
    v_mfma_f32_16x16x32_bf16 v[160:163], v[224:227], v[96:99], v[160:163]
    ds_read_b64_tr_b16 v[218:219], v245 offset:20992
    s_waitcnt lgkmcnt(8)
    v_mfma_f32_16x16x32_bf16 v[132:135], v[196:199], v[100:103], v[132:135]
    ds_read_b64_tr_b16 v[220:221], v246 offset:20480
    v_mfma_f32_16x16x32_bf16 v[140:143], v[196:199], v[104:107], v[140:143]
    ds_read_b64_tr_b16 v[222:223], v246 offset:20992
    v_mfma_f32_16x16x32_bf16 v[136:139], v[200:203], v[100:103], v[136:139]
    ds_read_b64_tr_b16 v[224:225], v247 offset:20480
    v_mfma_f32_16x16x32_bf16 v[144:147], v[200:203], v[104:107], v[144:147]
    ds_read_b64_tr_b16 v[226:227], v247 offset:20992
    s_waitcnt lgkmcnt(8)
    v_mfma_f32_16x16x32_bf16 v[148:151], v[204:207], v[100:103], v[148:151]
    ds_read_b64_tr_b16 v[196:197], v244 offset:24576
    v_mfma_f32_16x16x32_bf16 v[156:159], v[204:207], v[104:107], v[156:159]
    ds_read_b64_tr_b16 v[198:199], v244 offset:25088
    v_mfma_f32_16x16x32_bf16 v[152:155], v[208:211], v[100:103], v[152:155]
    ds_read_b64_tr_b16 v[200:201], v245 offset:24576
    v_mfma_f32_16x16x32_bf16 v[160:163], v[208:211], v[104:107], v[160:163]
    ds_read_b64_tr_b16 v[202:203], v245 offset:25088
    s_waitcnt lgkmcnt(8)
    v_mfma_f32_16x16x32_bf16 v[132:135], v[212:215], v[108:111], v[132:135]
    ds_read_b64_tr_b16 v[204:205], v246 offset:24576
    v_mfma_f32_16x16x32_bf16 v[140:143], v[212:215], v[112:115], v[140:143]
    ds_read_b64_tr_b16 v[206:207], v246 offset:25088
    v_mfma_f32_16x16x32_bf16 v[136:139], v[216:219], v[108:111], v[136:139]
    ds_read_b64_tr_b16 v[208:209], v247 offset:24576
    v_mfma_f32_16x16x32_bf16 v[144:147], v[216:219], v[112:115], v[144:147]
    ds_read_b64_tr_b16 v[210:211], v247 offset:25088
    s_waitcnt lgkmcnt(8)
    v_mfma_f32_16x16x32_bf16 v[148:151], v[220:223], v[108:111], v[148:151]
    ds_read_b64_tr_b16 v[212:213], v244 offset:28672
    v_mfma_f32_16x16x32_bf16 v[156:159], v[220:223], v[112:115], v[156:159]
    ds_read_b64_tr_b16 v[214:215], v244 offset:29184
    v_mfma_f32_16x16x32_bf16 v[152:155], v[224:227], v[108:111], v[152:155]
    ds_read_b64_tr_b16 v[216:217], v245 offset:28672
    v_mfma_f32_16x16x32_bf16 v[160:163], v[224:227], v[112:115], v[160:163]
    ds_read_b64_tr_b16 v[218:219], v245 offset:29184
    s_waitcnt lgkmcnt(8)
    v_mfma_f32_16x16x32_bf16 v[132:135], v[196:199], v[116:119], v[132:135]
    ds_read_b64_tr_b16 v[220:221], v246 offset:28672
    v_mfma_f32_16x16x32_bf16 v[140:143], v[196:199], v[120:123], v[140:143]
    ds_read_b64_tr_b16 v[222:223], v246 offset:29184
    s_add_u32 s41, s37, 4096
    buffer_store_dwordx4 v[176:179], v2, s[28:31], s41 offen offset:3072 sc1
    v_mfma_f32_16x16x32_bf16 v[136:139], v[200:203], v[116:119], v[136:139]
    ds_read_b64_tr_b16 v[224:225], v247 offset:28672
    v_mfma_f32_16x16x32_bf16 v[144:147], v[200:203], v[120:123], v[144:147]
    ds_read_b64_tr_b16 v[226:227], v247 offset:29184
    s_waitcnt lgkmcnt(8)
    v_mfma_f32_16x16x32_bf16 v[148:151], v[204:207], v[116:119], v[148:151]
    v_mfma_f32_16x16x32_bf16 v[156:159], v[204:207], v[120:123], v[156:159]
    v_mfma_f32_16x16x32_bf16 v[152:155], v[208:211], v[116:119], v[152:155]
    v_mfma_f32_16x16x32_bf16 v[160:163], v[208:211], v[120:123], v[160:163]
    s_waitcnt lgkmcnt(4)
    v_mfma_f32_16x16x32_bf16 v[132:135], v[212:215], v[124:127], v[132:135]
    v_mfma_f32_16x16x32_bf16 v[140:143], v[212:215], v[128:131], v[140:143]
    v_mfma_f32_16x16x32_bf16 v[136:139], v[216:219], v[124:127], v[136:139]
    v_mfma_f32_16x16x32_bf16 v[144:147], v[216:219], v[128:131], v[144:147]
    s_waitcnt lgkmcnt(0)
    v_mfma_f32_16x16x32_bf16 v[148:151], v[220:223], v[124:127], v[148:151]
    v_mfma_f32_16x16x32_bf16 v[156:159], v[220:223], v[128:131], v[156:159]
    v_mfma_f32_16x16x32_bf16 v[152:155], v[224:227], v[124:127], v[152:155]
    v_mfma_f32_16x16x32_bf16 v[160:163], v[224:227], v[128:131], v[160:163]
    s_bfe_u32 s52, s34, 0x30001
    s_mov_b32 s53, s45
    s_add_u32 s57, s37, 0
    v_cvt_pk_bf16_f32 v132, v132, v133
    v_cvt_pk_bf16_f32 v133, v134, v135
    v_cvt_pk_bf16_f32 v134, v136, v137
    v_cvt_pk_bf16_f32 v135, v138, v139
    v_cvt_pk_bf16_f32 v136, v140, v141
    v_cvt_pk_bf16_f32 v137, v142, v143
    v_cvt_pk_bf16_f32 v138, v144, v145
    v_cvt_pk_bf16_f32 v139, v146, v147
    v_cvt_pk_bf16_f32 v140, v148, v149
    v_cvt_pk_bf16_f32 v141, v150, v151
    v_cvt_pk_bf16_f32 v142, v152, v153
    v_cvt_pk_bf16_f32 v143, v154, v155
    v_cvt_pk_bf16_f32 v144, v156, v157
    v_cvt_pk_bf16_f32 v145, v158, v159
    v_cvt_pk_bf16_f32 v146, v160, v161
    v_cvt_pk_bf16_f32 v147, v162, v163
    v_mov_b32 v148, v180
    v_mov_b32 v149, v181
    v_mov_b32 v150, v182
    v_mov_b32 v151, v183
    v_mov_b32 v152, v184
    v_mov_b32 v153, v185
    v_mov_b32 v154, v186
    v_mov_b32 v155, v187
    v_mov_b32 v156, v188
    v_mov_b32 v157, v189
    v_mov_b32 v158, v190
    v_mov_b32 v159, v191
    v_mov_b32 v160, v192
    v_mov_b32 v161, v193
    v_mov_b32 v162, v194
    v_mov_b32 v163, v195
    s_branch L_k2_entry
L_k1_V:
    s_waitcnt vmcnt(12)
    ds_read_b128 v[4:7], v240 offset:0
    ds_read_b128 v[8:11], v240 offset:2048
    ds_read_b128 v[12:15], v241 offset:0
    ds_read_b128 v[16:19], v241 offset:2048
    ds_read_b64_tr_b16 v[196:197], v244 offset:0
    ds_read_b64_tr_b16 v[198:199], v244 offset:512
    ds_read_b64_tr_b16 v[200:201], v245 offset:0
    ds_read_b64_tr_b16 v[202:203], v245 offset:512
    ds_read_b64_tr_b16 v[204:205], v246 offset:0
    ds_read_b64_tr_b16 v[206:207], v246 offset:512
    ds_read_b64_tr_b16 v[208:209], v247 offset:0
    ds_read_b64_tr_b16 v[210:211], v247 offset:512
    ds_read_b64_tr_b16 v[212:213], v244 offset:8192
    ds_read_b64_tr_b16 v[214:215], v244 offset:8704
    ds_read_b64_tr_b16 v[216:217], v245 offset:8192
    ds_read_b64_tr_b16 v[218:219], v245 offset:8704
    s_waitcnt vmcnt(10) lgkmcnt(12)
    s_barrier
    s_waitcnt lgkmcnt(8)
    v_mfma_f32_16x16x32_bf16 v[132:135], v[4:7], v[196:199], 0
    ds_read_b64_tr_b16 v[220:221], v246 offset:8192
    v_mfma_f32_16x16x32_bf16 v[136:139], v[8:11], v[196:199], 0
    ds_read_b64_tr_b16 v[222:223], v246 offset:8704
    s_add_u32 m0, s46, 147456
    s_add_u32 s35, s47, 1572864
    buffer_load_dwordx4 v248, s[8:11], s35 offen offset:0 lds
    v_mfma_f32_16x16x32_bf16 v[140:143], v[4:7], v[200:203], 0
    ds_read_b64_tr_b16 v[224:225], v247 offset:8192
    v_mfma_f32_16x16x32_bf16 v[144:147], v[8:11], v[200:203], 0
    ds_read_b64_tr_b16 v[226:227], v247 offset:8704
    buffer_load_dwordx4 v249, s[8:11], s35 offen offset:1024 lds
    s_waitcnt lgkmcnt(8)
    v_mfma_f32_16x16x32_bf16 v[148:151], v[4:7], v[204:207], 0
    ds_read_b64_tr_b16 v[196:197], v244 offset:4096
    v_mfma_f32_16x16x32_bf16 v[152:155], v[8:11], v[204:207], 0
    ds_read_b64_tr_b16 v[198:199], v244 offset:4608
    s_add_u32 m0, s36, 0
    s_add_u32 s35, s42, 384
    buffer_load_dwordx4 v236, s[20:23], s35 offen offset:0 lds
    v_mfma_f32_16x16x32_bf16 v[156:159], v[4:7], v[208:211], 0
    ds_read_b64_tr_b16 v[200:201], v245 offset:4096
    v_mfma_f32_16x16x32_bf16 v[160:163], v[8:11], v[208:211], 0
    ds_read_b64_tr_b16 v[202:203], v245 offset:4608
    buffer_load_dwordx4 v237, s[20:23], s35 offen offset:1024 lds
    s_waitcnt lgkmcnt(8)
    v_mfma_f32_16x16x32_bf16 v[164:167], v[4:7], v[212:215], 0
    ds_read_b64_tr_b16 v[204:205], v246 offset:4096
    v_lshrrev_b32 v100, 5, v1
    v_mfma_f32_16x16x32_bf16 v[168:171], v[8:11], v[212:215], 0
    ds_read_b64_tr_b16 v[206:207], v246 offset:4608
    buffer_load_dwordx4 v238, s[20:23], s35 offen offset:2048 lds
    v_lshlrev_b32 v100, 11, v100
    v_mfma_f32_16x16x32_bf16 v[172:175], v[4:7], v[216:219], 0
    ds_read_b64_tr_b16 v[208:209], v247 offset:4096
    v_bfe_u32 v87, v1, 3, 2
    v_mfma_f32_16x16x32_bf16 v[176:179], v[8:11], v[216:219], 0
    ds_read_b64_tr_b16 v[210:211], v247 offset:4608
    buffer_load_dwordx4 v239, s[20:23], s35 offen offset:3072 lds
    v_lshl_add_u32 v100, v87, 8, v100
    s_waitcnt vmcnt(12)
    ds_read_b128 v[20:23], v240 offset:32768
    ds_read_b128 v[24:27], v240 offset:34816
    ds_read_b128 v[28:31], v241 offset:32768
    ds_read_b128 v[32:35], v241 offset:34816
    s_waitcnt lgkmcnt(8)
    v_mfma_f32_16x16x32_bf16 v[180:183], v[4:7], v[220:223], 0
    ds_read_b64_tr_b16 v[212:213], v244 offset:12288
    v_and_b32 v87, 7, v1
    v_mfma_f32_16x16x32_bf16 v[184:187], v[8:11], v[220:223], 0
    ds_read_b64_tr_b16 v[214:215], v244 offset:12800
    v_lshl_add_u32 v100, v87, 4, v100
    v_mfma_f32_16x16x32_bf16 v[188:191], v[4:7], v[224:227], 0
    ds_read_b64_tr_b16 v[216:217], v245 offset:12288
    v_add_f32 v104, v104, v106
    v_mfma_f32_16x16x32_bf16 v[192:195], v[8:11], v[224:227], 0
    ds_read_b64_tr_b16 v[218:219], v245 offset:12800
    v_add_f32 v105, v105, v107
    s_waitcnt lgkmcnt(8)
    v_mfma_f32_16x16x32_bf16 v[132:135], v[12:15], v[196:199], v[132:135]
    ds_read_b64_tr_b16 v[220:221], v246 offset:12288
    v_add_f32 v104, v104, v108
    v_mfma_f32_16x16x32_bf16 v[136:139], v[16:19], v[196:199], v[136:139]
    ds_read_b64_tr_b16 v[222:223], v246 offset:12800
    v_add_f32 v105, v105, v109
    v_mfma_f32_16x16x32_bf16 v[140:143], v[12:15], v[200:203], v[140:143]
    ds_read_b64_tr_b16 v[224:225], v247 offset:12288
    v_add_f32 v104, v104, v110
    v_mfma_f32_16x16x32_bf16 v[144:147], v[16:19], v[200:203], v[144:147]
    ds_read_b64_tr_b16 v[226:227], v247 offset:12800
    v_add_f32 v105, v105, v111
    s_waitcnt lgkmcnt(8)
    v_mfma_f32_16x16x32_bf16 v[148:151], v[12:15], v[204:207], v[148:151]
    ds_read_b64_tr_b16 v[196:197], v244 offset:16384
    v_add_f32 v104, v104, v112
    v_mfma_f32_16x16x32_bf16 v[152:155], v[16:19], v[204:207], v[152:155]
    ds_read_b64_tr_b16 v[198:199], v244 offset:16896
    v_add_f32 v105, v105, v113
    v_mfma_f32_16x16x32_bf16 v[156:159], v[12:15], v[208:211], v[156:159]
    ds_read_b64_tr_b16 v[200:201], v245 offset:16384
    v_add_f32 v104, v104, v114
    v_mfma_f32_16x16x32_bf16 v[160:163], v[16:19], v[208:211], v[160:163]
    ds_read_b64_tr_b16 v[202:203], v245 offset:16896
    v_add_f32 v105, v105, v115
    s_waitcnt lgkmcnt(8)
    v_mfma_f32_16x16x32_bf16 v[164:167], v[12:15], v[212:215], v[164:167]
    ds_read_b64_tr_b16 v[204:205], v246 offset:16384
    v_add_f32 v104, v104, v116
    v_mfma_f32_16x16x32_bf16 v[168:171], v[16:19], v[212:215], v[168:171]
    ds_read_b64_tr_b16 v[206:207], v246 offset:16896
    s_add_u32 m0, s36, 32768
    s_add_u32 s35, s42, 512
    buffer_load_dwordx4 v236, s[20:23], s35 offen offset:0 lds
    v_add_f32 v105, v105, v117
    v_mfma_f32_16x16x32_bf16 v[172:175], v[12:15], v[216:219], v[172:175]
    ds_read_b64_tr_b16 v[208:209], v247 offset:16384
    v_add_f32 v104, v104, v118
    v_mfma_f32_16x16x32_bf16 v[176:179], v[16:19], v[216:219], v[176:179]
    ds_read_b64_tr_b16 v[210:211], v247 offset:16896
    buffer_load_dwordx4 v237, s[20:23], s35 offen offset:1024 lds
    v_add_f32 v105, v105, v119
    s_waitcnt lgkmcnt(8)
    v_mfma_f32_16x16x32_bf16 v[180:183], v[12:15], v[220:223], v[180:183]
    ds_read_b64_tr_b16 v[212:213], v244 offset:24576
    v_mul_f32 v84, 0x3b000000, v104
    v_mfma_f32_16x16x32_bf16 v[184:187], v[16:19], v[220:223], v[184:187]
    ds_read_b64_tr_b16 v[214:215], v244 offset:25088
    buffer_load_dwordx4 v238, s[20:23], s35 offen offset:2048 lds
    v_mul_f32 v85, 0x3b000000, v105
    v_mfma_f32_16x16x32_bf16 v[188:191], v[12:15], v[224:227], v[188:191]
    ds_read_b64_tr_b16 v[216:217], v245 offset:24576
    v_fma_f32 v85, -v84, v84, v85
    v_mfma_f32_16x16x32_bf16 v[192:195], v[16:19], v[224:227], v[192:195]
    ds_read_b64_tr_b16 v[218:219], v245 offset:25088
    buffer_load_dwordx4 v239, s[20:23], s35 offen offset:3072 lds
    v_max_f32 v85, 0, v85
    s_waitcnt vmcnt(14)
    s_barrier
    s_waitcnt lgkmcnt(8)
    v_mfma_f32_16x16x32_bf16 v[132:135], v[20:23], v[196:199], v[132:135]
    ds_read_b64_tr_b16 v[220:221], v246 offset:24576
    v_mfma_f32_16x16x32_bf16 v[136:139], v[24:27], v[196:199], v[136:139]
    ds_read_b64_tr_b16 v[222:223], v246 offset:25088
    s_add_u32 m0, s46, 98304
    s_add_u32 s35, s47, 2097152
    buffer_load_dwordx4 v248, s[8:11], s35 offen offset:0 lds
    v_mfma_f32_16x16x32_bf16 v[140:143], v[20:23], v[200:203], v[140:143]
    ds_read_b64_tr_b16 v[224:225], v247 offset:24576
    v_mfma_f32_16x16x32_bf16 v[144:147], v[24:27], v[200:203], v[144:147]
    ds_read_b64_tr_b16 v[226:227], v247 offset:25088
    buffer_load_dwordx4 v249, s[8:11], s35 offen offset:1024 lds
    s_waitcnt lgkmcnt(8)
    v_mfma_f32_16x16x32_bf16 v[148:151], v[20:23], v[204:207], v[148:151]
    ds_read_b64_tr_b16 v[196:197], v244 offset:20480
    v_mfma_f32_16x16x32_bf16 v[152:155], v[24:27], v[204:207], v[152:155]
    ds_read_b64_tr_b16 v[198:199], v244 offset:20992
    v_mfma_f32_16x16x32_bf16 v[156:159], v[20:23], v[208:211], v[156:159]
    ds_read_b64_tr_b16 v[200:201], v245 offset:20480
    v_mfma_f32_16x16x32_bf16 v[160:163], v[24:27], v[208:211], v[160:163]
    ds_read_b64_tr_b16 v[202:203], v245 offset:20992
    s_waitcnt lgkmcnt(8)
    v_mfma_f32_16x16x32_bf16 v[164:167], v[20:23], v[212:215], v[164:167]
    ds_read_b64_tr_b16 v[204:205], v246 offset:20480
    v_cvt_pk_bf16_f32 v87, v84, v85
    v_mfma_f32_16x16x32_bf16 v[168:171], v[24:27], v[212:215], v[168:171]
    ds_read_b64_tr_b16 v[206:207], v246 offset:20992
    v_lshlrev_b32 v84, 16, v87
    v_mfma_f32_16x16x32_bf16 v[172:175], v[20:23], v[216:219], v[172:175]
    ds_read_b64_tr_b16 v[208:209], v247 offset:20480
    v_and_b32 v85, 0xffff0000, v87
    v_mfma_f32_16x16x32_bf16 v[176:179], v[24:27], v[216:219], v[176:179]
    ds_read_b64_tr_b16 v[210:211], v247 offset:20992
    v_add_f32 v85, 0x3727c5ac, v85
    s_waitcnt vmcnt(12)
    ds_read_b128 v[36:39], v242 offset:0
    ds_read_b128 v[40:43], v242 offset:2048
    ds_read_b128 v[44:47], v243 offset:0
    ds_read_b128 v[48:51], v243 offset:2048
    s_waitcnt lgkmcnt(8)
    v_mfma_f32_16x16x32_bf16 v[180:183], v[20:23], v[220:223], v[180:183]
    ds_read_b64_tr_b16 v[212:213], v244 offset:28672
    v_cvt_pk_bf16_f32 v85, v85, v85
    v_mfma_f32_16x16x32_bf16 v[184:187], v[24:27], v[220:223], v[184:187]
    ds_read_b64_tr_b16 v[214:215], v244 offset:29184
    v_and_b32 v85, 0xffff0000, v85
    v_mfma_f32_16x16x32_bf16 v[188:191], v[20:23], v[224:227], v[188:191]
    ds_read_b64_tr_b16 v[216:217], v245 offset:28672
    v_sqrt_f32 v85, v85
    s_nop 0
    v_mfma_f32_16x16x32_bf16 v[192:195], v[24:27], v[224:227], v[192:195]
    ds_read_b64_tr_b16 v[218:219], v245 offset:29184
    v_cvt_pk_bf16_f32 v85, v85, v85
    s_waitcnt lgkmcnt(8)
    v_mfma_f32_16x16x32_bf16 v[132:135], v[28:31], v[196:199], v[132:135]
    ds_read_b64_tr_b16 v[220:221], v246 offset:28672
    v_and_b32 v85, 0xffff0000, v85
    v_mfma_f32_16x16x32_bf16 v[136:139], v[32:35], v[196:199], v[136:139]
    ds_read_b64_tr_b16 v[222:223], v246 offset:29184
    v_rcp_f32 v85, v85
    v_mfma_f32_16x16x32_bf16 v[140:143], v[28:31], v[200:203], v[140:143]
    ds_read_b64_tr_b16 v[224:225], v247 offset:28672
    v_lshlrev_b32 v87, 16, v96
    v_mfma_f32_16x16x32_bf16 v[144:147], v[32:35], v[200:203], v[144:147]
    ds_read_b64_tr_b16 v[226:227], v247 offset:29184
    v_and_b32 v88, 0xffff0000, v96
    s_waitcnt lgkmcnt(8)
    v_mfma_f32_16x16x32_bf16 v[148:151], v[28:31], v[204:207], v[148:151]
    ds_read_b64_tr_b16 v[196:197], v244 offset:32768
    v_sub_f32 v87, v87, v84
    v_mfma_f32_16x16x32_bf16 v[152:155], v[32:35], v[204:207], v[152:155]
    ds_read_b64_tr_b16 v[198:199], v244 offset:33280
    v_sub_f32 v88, v88, v84
    v_mfma_f32_16x16x32_bf16 v[156:159], v[28:31], v[208:211], v[156:159]
    ds_read_b64_tr_b16 v[200:201], v245 offset:32768
    v_cvt_pk_bf16_f32 v88, v87, v88
    v_mfma_f32_16x16x32_bf16 v[160:163], v[32:35], v[208:211], v[160:163]
    ds_read_b64_tr_b16 v[202:203], v245 offset:33280
    v_lshlrev_b32 v87, 16, v88
    s_waitcnt lgkmcnt(8)
    v_mfma_f32_16x16x32_bf16 v[164:167], v[28:31], v[212:215], v[164:167]
    ds_read_b64_tr_b16 v[204:205], v246 offset:32768
    v_and_b32 v88, 0xffff0000, v88
    v_mfma_f32_16x16x32_bf16 v[168:171], v[32:35], v[212:215], v[168:171]
    ds_read_b64_tr_b16 v[206:207], v246 offset:33280
    s_add_u32 m0, s36, 65536
    s_add_u32 s35, s42, 640
    buffer_load_dwordx4 v236, s[20:23], s35 offen offset:0 lds
    v_mul_f32 v87, v87, v85
    v_mfma_f32_16x16x32_bf16 v[172:175], v[28:31], v[216:219], v[172:175]
    ds_read_b64_tr_b16 v[208:209], v247 offset:32768
    v_mul_f32 v88, v88, v85
    v_mfma_f32_16x16x32_bf16 v[176:179], v[32:35], v[216:219], v[176:179]
    ds_read_b64_tr_b16 v[210:211], v247 offset:33280
    buffer_load_dwordx4 v237, s[20:23], s35 offen offset:1024 lds
    v_cvt_pk_bf16_f32 v96, v87, v88
    s_waitcnt lgkmcnt(8)
    v_mfma_f32_16x16x32_bf16 v[180:183], v[28:31], v[220:223], v[180:183]
    ds_read_b64_tr_b16 v[212:213], v244 offset:40960
    v_lshlrev_b32 v87, 16, v97
    v_mfma_f32_16x16x32_bf16 v[184:187], v[32:35], v[220:223], v[184:187]
    ds_read_b64_tr_b16 v[214:215], v244 offset:41472
    buffer_load_dwordx4 v238, s[20:23], s35 offen offset:2048 lds
    v_and_b32 v88, 0xffff0000, v97
    v_mfma_f32_16x16x32_bf16 v[188:191], v[28:31], v[224:227], v[188:191]
    ds_read_b64_tr_b16 v[216:217], v245 offset:40960
    v_sub_f32 v87, v87, v84
    v_mfma_f32_16x16x32_bf16 v[192:195], v[32:35], v[224:227], v[192:195]
    ds_read_b64_tr_b16 v[218:219], v245 offset:41472
    buffer_load_dwordx4 v239, s[20:23], s35 offen offset:3072 lds
    v_sub_f32 v88, v88, v84
    s_waitcnt vmcnt(14)
    s_barrier
    s_waitcnt lgkmcnt(8)
    v_mfma_f32_16x16x32_bf16 v[132:135], v[36:39], v[196:199], v[132:135]
    ds_read_b64_tr_b16 v[220:221], v246 offset:40960
    v_mfma_f32_16x16x32_bf16 v[136:139], v[40:43], v[196:199], v[136:139]
    ds_read_b64_tr_b16 v[222:223], v246 offset:41472
    s_add_u32 m0, s46, 114688
    s_add_u32 s35, s47, 2621440
    buffer_load_dwordx4 v248, s[8:11], s35 offen offset:0 lds
    v_mfma_f32_16x16x32_bf16 v[140:143], v[36:39], v[200:203], v[140:143]
    ds_read_b64_tr_b16 v[224:225], v247 offset:40960
    v_mfma_f32_16x16x32_bf16 v[144:147], v[40:43], v[200:203], v[144:147]
    ds_read_b64_tr_b16 v[226:227], v247 offset:41472
    buffer_load_dwordx4 v249, s[8:11], s35 offen offset:1024 lds
    s_waitcnt lgkmcnt(8)
    v_mfma_f32_16x16x32_bf16 v[148:151], v[36:39], v[204:207], v[148:151]
    ds_read_b64_tr_b16 v[196:197], v244 offset:36864
    v_mfma_f32_16x16x32_bf16 v[152:155], v[40:43], v[204:207], v[152:155]
    ds_read_b64_tr_b16 v[198:199], v244 offset:37376
    buffer_load_dword v255, v254, s[24:27], s49 offen offset:0
    v_mfma_f32_16x16x32_bf16 v[156:159], v[36:39], v[208:211], v[156:159]
    ds_read_b64_tr_b16 v[200:201], v245 offset:36864
    v_mfma_f32_16x16x32_bf16 v[160:163], v[40:43], v[208:211], v[160:163]
    ds_read_b64_tr_b16 v[202:203], v245 offset:37376
    s_waitcnt lgkmcnt(8)
    v_mfma_f32_16x16x32_bf16 v[164:167], v[36:39], v[212:215], v[164:167]
    ds_read_b64_tr_b16 v[204:205], v246 offset:36864
    v_cvt_pk_bf16_f32 v88, v87, v88
    v_mfma_f32_16x16x32_bf16 v[168:171], v[40:43], v[212:215], v[168:171]
    ds_read_b64_tr_b16 v[206:207], v246 offset:37376
    v_lshlrev_b32 v87, 16, v88
    v_mfma_f32_16x16x32_bf16 v[172:175], v[36:39], v[216:219], v[172:175]
    ds_read_b64_tr_b16 v[208:209], v247 offset:36864
    v_and_b32 v88, 0xffff0000, v88
    v_mfma_f32_16x16x32_bf16 v[176:179], v[40:43], v[216:219], v[176:179]
    ds_read_b64_tr_b16 v[210:211], v247 offset:37376
    v_mul_f32 v87, v87, v85
    s_waitcnt vmcnt(13)
    ds_read_b128 v[52:55], v240 offset:0
    ds_read_b128 v[56:59], v240 offset:2048
    ds_read_b128 v[60:63], v241 offset:0
    ds_read_b128 v[64:67], v241 offset:2048
    s_waitcnt lgkmcnt(8)
    v_mfma_f32_16x16x32_bf16 v[180:183], v[36:39], v[220:223], v[180:183]
    ds_read_b64_tr_b16 v[212:213], v244 offset:45056
    v_mul_f32 v88, v88, v85
    v_mfma_f32_16x16x32_bf16 v[184:187], v[40:43], v[220:223], v[184:187]
    ds_read_b64_tr_b16 v[214:215], v244 offset:45568
    v_cvt_pk_bf16_f32 v97, v87, v88
    v_mfma_f32_16x16x32_bf16 v[188:191], v[36:39], v[224:227], v[188:191]
    ds_read_b64_tr_b16 v[216:217], v245 offset:45056
    v_lshlrev_b32 v87, 16, v98
    v_mfma_f32_16x16x32_bf16 v[192:195], v[40:43], v[224:227], v[192:195]
    ds_read_b64_tr_b16 v[218:219], v245 offset:45568
    v_and_b32 v88, 0xffff0000, v98
    s_waitcnt lgkmcnt(8)
    v_mfma_f32_16x16x32_bf16 v[132:135], v[44:47], v[196:199], v[132:135]
    ds_read_b64_tr_b16 v[220:221], v246 offset:45056
    v_sub_f32 v87, v87, v84
    v_mfma_f32_16x16x32_bf16 v[136:139], v[48:51], v[196:199], v[136:139]
    ds_read_b64_tr_b16 v[222:223], v246 offset:45568
    v_sub_f32 v88, v88, v84
    v_mfma_f32_16x16x32_bf16 v[140:143], v[44:47], v[200:203], v[140:143]
    ds_read_b64_tr_b16 v[224:225], v247 offset:45056
    v_cvt_pk_bf16_f32 v88, v87, v88
    v_mfma_f32_16x16x32_bf16 v[144:147], v[48:51], v[200:203], v[144:147]
    ds_read_b64_tr_b16 v[226:227], v247 offset:45568
    v_lshlrev_b32 v87, 16, v88
    s_waitcnt lgkmcnt(8)
    v_mfma_f32_16x16x32_bf16 v[148:151], v[44:47], v[204:207], v[148:151]
    ds_read_b64_tr_b16 v[196:197], v244 offset:49152
    v_and_b32 v88, 0xffff0000, v88
    v_mfma_f32_16x16x32_bf16 v[152:155], v[48:51], v[204:207], v[152:155]
    ds_read_b64_tr_b16 v[198:199], v244 offset:49664
    v_mul_f32 v87, v87, v85
    v_mfma_f32_16x16x32_bf16 v[156:159], v[44:47], v[208:211], v[156:159]
    ds_read_b64_tr_b16 v[200:201], v245 offset:49152
    v_mfma_f32_16x16x32_bf16 v[160:163], v[48:51], v[208:211], v[160:163]
    ds_read_b64_tr_b16 v[202:203], v245 offset:49664
    s_waitcnt lgkmcnt(8)
    v_mfma_f32_16x16x32_bf16 v[164:167], v[44:47], v[212:215], v[164:167]
    ds_read_b64_tr_b16 v[204:205], v246 offset:49152
    v_mfma_f32_16x16x32_bf16 v[168:171], v[48:51], v[212:215], v[168:171]
    ds_read_b64_tr_b16 v[206:207], v246 offset:49664
    s_add_u32 m0, s36, 0
    s_add_u32 s35, s42, 768
    buffer_load_dwordx4 v236, s[20:23], s35 offen offset:0 lds
    v_mfma_f32_16x16x32_bf16 v[172:175], v[44:47], v[216:219], v[172:175]
    ds_read_b64_tr_b16 v[208:209], v247 offset:49152
    v_mfma_f32_16x16x32_bf16 v[176:179], v[48:51], v[216:219], v[176:179]
    ds_read_b64_tr_b16 v[210:211], v247 offset:49664
    buffer_load_dwordx4 v237, s[20:23], s35 offen offset:1024 lds
    s_waitcnt lgkmcnt(8)
    v_mfma_f32_16x16x32_bf16 v[180:183], v[44:47], v[220:223], v[180:183]
    ds_read_b64_tr_b16 v[212:213], v244 offset:57344
    v_mfma_f32_16x16x32_bf16 v[184:187], v[48:51], v[220:223], v[184:187]
    ds_read_b64_tr_b16 v[214:215], v244 offset:57856
    buffer_load_dwordx4 v238, s[20:23], s35 offen offset:2048 lds
    v_mfma_f32_16x16x32_bf16 v[188:191], v[44:47], v[224:227], v[188:191]
    ds_read_b64_tr_b16 v[216:217], v245 offset:57344
    v_mfma_f32_16x16x32_bf16 v[192:195], v[48:51], v[224:227], v[192:195]
    ds_read_b64_tr_b16 v[218:219], v245 offset:57856
    buffer_load_dwordx4 v239, s[20:23], s35 offen offset:3072 lds
    s_waitcnt vmcnt(11)
    s_barrier
    s_waitcnt lgkmcnt(8)
    v_mfma_f32_16x16x32_bf16 v[132:135], v[52:55], v[196:199], v[132:135]
    ds_read_b64_tr_b16 v[220:221], v246 offset:57344
    v_mfma_f32_16x16x32_bf16 v[136:139], v[56:59], v[196:199], v[136:139]
    ds_read_b64_tr_b16 v[222:223], v246 offset:57856
    s_add_u32 m0, s46, 131072
    s_add_u32 s35, s47, 3145728
    buffer_load_dwordx4 v248, s[8:11], s35 offen offset:0 lds
    v_mfma_f32_16x16x32_bf16 v[140:143], v[52:55], v[200:203], v[140:143]
    ds_read_b64_tr_b16 v[224:225], v247 offset:57344
    v_mfma_f32_16x16x32_bf16 v[144:147], v[56:59], v[200:203], v[144:147]
    ds_read_b64_tr_b16 v[226:227], v247 offset:57856
    buffer_load_dwordx4 v249, s[8:11], s35 offen offset:1024 lds
    s_waitcnt lgkmcnt(8)
    v_mfma_f32_16x16x32_bf16 v[148:151], v[52:55], v[204:207], v[148:151]
    ds_read_b64_tr_b16 v[196:197], v244 offset:53248
    v_mfma_f32_16x16x32_bf16 v[152:155], v[56:59], v[204:207], v[152:155]
    ds_read_b64_tr_b16 v[198:199], v244 offset:53760
    buffer_load_dword v255, v254, s[24:27], s49 offen offset:512
    v_mfma_f32_16x16x32_bf16 v[156:159], v[52:55], v[208:211], v[156:159]
    ds_read_b64_tr_b16 v[200:201], v245 offset:53248
    v_mfma_f32_16x16x32_bf16 v[160:163], v[56:59], v[208:211], v[160:163]
    ds_read_b64_tr_b16 v[202:203], v245 offset:53760
    s_waitcnt lgkmcnt(8)
    v_mfma_f32_16x16x32_bf16 v[164:167], v[52:55], v[212:215], v[164:167]
    ds_read_b64_tr_b16 v[204:205], v246 offset:53248
    v_mul_f32 v88, v88, v85
    v_mfma_f32_16x16x32_bf16 v[168:171], v[56:59], v[212:215], v[168:171]
    ds_read_b64_tr_b16 v[206:207], v246 offset:53760
    v_cvt_pk_bf16_f32 v98, v87, v88
    v_mfma_f32_16x16x32_bf16 v[172:175], v[52:55], v[216:219], v[172:175]
    ds_read_b64_tr_b16 v[208:209], v247 offset:53248
    v_lshlrev_b32 v87, 16, v99
    v_mfma_f32_16x16x32_bf16 v[176:179], v[56:59], v[216:219], v[176:179]
    ds_read_b64_tr_b16 v[210:211], v247 offset:53760
    v_and_b32 v88, 0xffff0000, v99
    s_waitcnt vmcnt(16)
    ds_read_b128 v[68:71], v240 offset:32768
    ds_read_b128 v[72:75], v240 offset:34816
    ds_read_b128 v[76:79], v241 offset:32768
    ds_read_b128 v[80:83], v241 offset:34816
    s_waitcnt lgkmcnt(8)
    v_mfma_f32_16x16x32_bf16 v[180:183], v[52:55], v[220:223], v[180:183]
    ds_read_b64_tr_b16 v[212:213], v244 offset:61440
    v_sub_f32 v87, v87, v84
    v_mfma_f32_16x16x32_bf16 v[184:187], v[56:59], v[220:223], v[184:187]
    ds_read_b64_tr_b16 v[214:215], v244 offset:61952
    v_sub_f32 v88, v88, v84
    v_mfma_f32_16x16x32_bf16 v[188:191], v[52:55], v[224:227], v[188:191]
    ds_read_b64_tr_b16 v[216:217], v245 offset:61440
    v_cvt_pk_bf16_f32 v88, v87, v88
    v_mfma_f32_16x16x32_bf16 v[192:195], v[56:59], v[224:227], v[192:195]
    ds_read_b64_tr_b16 v[218:219], v245 offset:61952
    v_lshlrev_b32 v87, 16, v88
    s_waitcnt lgkmcnt(8)
    v_mfma_f32_16x16x32_bf16 v[132:135], v[60:63], v[196:199], v[132:135]
    ds_read_b64_tr_b16 v[220:221], v246 offset:61440
    v_and_b32 v88, 0xffff0000, v88
    v_mfma_f32_16x16x32_bf16 v[136:139], v[64:67], v[196:199], v[136:139]
    ds_read_b64_tr_b16 v[222:223], v246 offset:61952
    v_mul_f32 v87, v87, v85
    v_mfma_f32_16x16x32_bf16 v[140:143], v[60:63], v[200:203], v[140:143]
    ds_read_b64_tr_b16 v[224:225], v247 offset:61440
    v_mul_f32 v88, v88, v85
    v_mfma_f32_16x16x32_bf16 v[144:147], v[64:67], v[200:203], v[144:147]
    ds_read_b64_tr_b16 v[226:227], v247 offset:61952
    v_cvt_pk_bf16_f32 v99, v87, v88
    s_waitcnt lgkmcnt(8)
    v_mfma_f32_16x16x32_bf16 v[148:151], v[60:63], v[204:207], v[148:151]
    ds_read_b64_tr_b16 v[196:197], v244 offset:0
    v_mov_b32 v250, v96
    v_mfma_f32_16x16x32_bf16 v[152:155], v[64:67], v[204:207], v[152:155]
    ds_read_b64_tr_b16 v[198:199], v244 offset:512
    v_mov_b32 v251, v97
    v_mfma_f32_16x16x32_bf16 v[156:159], v[60:63], v[208:211], v[156:159]
    ds_read_b64_tr_b16 v[200:201], v245 offset:0
    v_mov_b32 v252, v98
    v_mfma_f32_16x16x32_bf16 v[160:163], v[64:67], v[208:211], v[160:163]
    ds_read_b64_tr_b16 v[202:203], v245 offset:512
    v_mov_b32 v253, v99
    s_waitcnt lgkmcnt(8)
    v_mfma_f32_16x16x32_bf16 v[164:167], v[60:63], v[212:215], v[164:167]
    ds_read_b64_tr_b16 v[204:205], v246 offset:0
    v_mov_b32 v3, v100
    v_mfma_f32_16x16x32_bf16 v[168:171], v[64:67], v[212:215], v[168:171]
    ds_read_b64_tr_b16 v[206:207], v246 offset:512
    s_add_u32 m0, s36, 32768
    s_add_u32 s35, s42, 896
    buffer_load_dwordx4 v236, s[20:23], s35 offen offset:0 lds
    v_mfma_f32_16x16x32_bf16 v[172:175], v[60:63], v[216:219], v[172:175]
    ds_read_b64_tr_b16 v[208:209], v247 offset:0
    v_mfma_f32_16x16x32_bf16 v[176:179], v[64:67], v[216:219], v[176:179]
    ds_read_b64_tr_b16 v[210:211], v247 offset:512
    buffer_load_dwordx4 v237, s[20:23], s35 offen offset:1024 lds
    s_waitcnt lgkmcnt(8)
    v_mfma_f32_16x16x32_bf16 v[180:183], v[60:63], v[220:223], v[180:183]
    ds_read_b64_tr_b16 v[212:213], v244 offset:8192
    v_mfma_f32_16x16x32_bf16 v[184:187], v[64:67], v[220:223], v[184:187]
    ds_read_b64_tr_b16 v[214:215], v244 offset:8704
    buffer_load_dwordx4 v238, s[20:23], s35 offen offset:2048 lds
    v_mfma_f32_16x16x32_bf16 v[188:191], v[60:63], v[224:227], v[188:191]
    ds_read_b64_tr_b16 v[216:217], v245 offset:8192
    v_mfma_f32_16x16x32_bf16 v[192:195], v[64:67], v[224:227], v[192:195]
    ds_read_b64_tr_b16 v[218:219], v245 offset:8704
    buffer_load_dwordx4 v239, s[20:23], s35 offen offset:3072 lds
    s_waitcnt vmcnt(12)
    s_barrier
    s_waitcnt lgkmcnt(8)
    v_mfma_f32_16x16x32_bf16 v[132:135], v[68:71], v[196:199], v[132:135]
    ds_read_b64_tr_b16 v[220:221], v246 offset:8192
    v_mfma_f32_16x16x32_bf16 v[136:139], v[72:75], v[196:199], v[136:139]
    ds_read_b64_tr_b16 v[222:223], v246 offset:8704
    s_add_u32 m0, s46, 147456
    s_add_u32 s35, s47, 3670016
    buffer_load_dwordx4 v248, s[8:11], s35 offen offset:0 lds
    v_mfma_f32_16x16x32_bf16 v[140:143], v[68:71], v[200:203], v[140:143]
    ds_read_b64_tr_b16 v[224:225], v247 offset:8192
    v_mfma_f32_16x16x32_bf16 v[144:147], v[72:75], v[200:203], v[144:147]
    ds_read_b64_tr_b16 v[226:227], v247 offset:8704
    buffer_load_dwordx4 v249, s[8:11], s35 offen offset:1024 lds
    s_waitcnt lgkmcnt(8)
    v_mfma_f32_16x16x32_bf16 v[148:151], v[68:71], v[204:207], v[148:151]
    ds_read_b64_tr_b16 v[196:197], v244 offset:4096
    v_mfma_f32_16x16x32_bf16 v[152:155], v[72:75], v[204:207], v[152:155]
    ds_read_b64_tr_b16 v[198:199], v244 offset:4608
    buffer_load_dword v255, v254, s[24:27], s49 offen offset:1024
    v_mfma_f32_16x16x32_bf16 v[156:159], v[68:71], v[208:211], v[156:159]
    ds_read_b64_tr_b16 v[200:201], v245 offset:4096
    v_mfma_f32_16x16x32_bf16 v[160:163], v[72:75], v[208:211], v[160:163]
    ds_read_b64_tr_b16 v[202:203], v245 offset:4608
    s_waitcnt lgkmcnt(8)
    v_mfma_f32_16x16x32_bf16 v[164:167], v[68:71], v[212:215], v[164:167]
    ds_read_b64_tr_b16 v[204:205], v246 offset:4096
    v_mfma_f32_16x16x32_bf16 v[168:171], v[72:75], v[212:215], v[168:171]
    ds_read_b64_tr_b16 v[206:207], v246 offset:4608
    v_mfma_f32_16x16x32_bf16 v[172:175], v[68:71], v[216:219], v[172:175]
    ds_read_b64_tr_b16 v[208:209], v247 offset:4096
    v_mfma_f32_16x16x32_bf16 v[176:179], v[72:75], v[216:219], v[176:179]
    ds_read_b64_tr_b16 v[210:211], v247 offset:4608
    s_waitcnt vmcnt(17)
    ds_read_b128 v[84:87], v242 offset:0
    ds_read_b128 v[88:91], v242 offset:2048
    ds_read_b128 v[92:95], v243 offset:0
    ds_read_b128 v[96:99], v243 offset:2048
    s_waitcnt lgkmcnt(8)
    v_mfma_f32_16x16x32_bf16 v[180:183], v[68:71], v[220:223], v[180:183]
    ds_read_b64_tr_b16 v[212:213], v244 offset:12288
    v_mfma_f32_16x16x32_bf16 v[184:187], v[72:75], v[220:223], v[184:187]
    ds_read_b64_tr_b16 v[214:215], v244 offset:12800
    v_mfma_f32_16x16x32_bf16 v[188:191], v[68:71], v[224:227], v[188:191]
    ds_read_b64_tr_b16 v[216:217], v245 offset:12288
    v_mfma_f32_16x16x32_bf16 v[192:195], v[72:75], v[224:227], v[192:195]
    ds_read_b64_tr_b16 v[218:219], v245 offset:12800
    s_waitcnt lgkmcnt(8)
    v_mfma_f32_16x16x32_bf16 v[132:135], v[76:79], v[196:199], v[132:135]
    ds_read_b64_tr_b16 v[220:221], v246 offset:12288
    v_mfma_f32_16x16x32_bf16 v[136:139], v[80:83], v[196:199], v[136:139]
    ds_read_b64_tr_b16 v[222:223], v246 offset:12800
    v_mfma_f32_16x16x32_bf16 v[140:143], v[76:79], v[200:203], v[140:143]
    ds_read_b64_tr_b16 v[224:225], v247 offset:12288
    v_mfma_f32_16x16x32_bf16 v[144:147], v[80:83], v[200:203], v[144:147]
    ds_read_b64_tr_b16 v[226:227], v247 offset:12800
    s_waitcnt lgkmcnt(8)
    v_mfma_f32_16x16x32_bf16 v[148:151], v[76:79], v[204:207], v[148:151]
    ds_read_b64_tr_b16 v[196:197], v244 offset:16384
    v_mfma_f32_16x16x32_bf16 v[152:155], v[80:83], v[204:207], v[152:155]
    ds_read_b64_tr_b16 v[198:199], v244 offset:16896
    v_mfma_f32_16x16x32_bf16 v[156:159], v[76:79], v[208:211], v[156:159]
    ds_read_b64_tr_b16 v[200:201], v245 offset:16384
    v_mfma_f32_16x16x32_bf16 v[160:163], v[80:83], v[208:211], v[160:163]
    ds_read_b64_tr_b16 v[202:203], v245 offset:16896
    s_waitcnt lgkmcnt(8)
    v_mfma_f32_16x16x32_bf16 v[164:167], v[76:79], v[212:215], v[164:167]
    ds_read_b64_tr_b16 v[204:205], v246 offset:16384
    v_mfma_f32_16x16x32_bf16 v[168:171], v[80:83], v[212:215], v[168:171]
    ds_read_b64_tr_b16 v[206:207], v246 offset:16896
    s_add_u32 m0, s36, 65536
    s_add_u32 s35, s43, 256
    buffer_load_dwordx4 v228, s[8:11], s35 offen offset:0 lds
    v_mfma_f32_16x16x32_bf16 v[172:175], v[76:79], v[216:219], v[172:175]
    ds_read_b64_tr_b16 v[208:209], v247 offset:16384
    v_mfma_f32_16x16x32_bf16 v[176:179], v[80:83], v[216:219], v[176:179]
    ds_read_b64_tr_b16 v[210:211], v247 offset:16896
    buffer_load_dwordx4 v229, s[8:11], s35 offen offset:1024 lds
    s_waitcnt lgkmcnt(8)
    v_mfma_f32_16x16x32_bf16 v[180:183], v[76:79], v[220:223], v[180:183]
    ds_read_b64_tr_b16 v[212:213], v244 offset:24576
    v_mfma_f32_16x16x32_bf16 v[184:187], v[80:83], v[220:223], v[184:187]
    ds_read_b64_tr_b16 v[214:215], v244 offset:25088
    buffer_load_dwordx4 v230, s[8:11], s35 offen offset:2048 lds
    v_mfma_f32_16x16x32_bf16 v[188:191], v[76:79], v[224:227], v[188:191]
    ds_read_b64_tr_b16 v[216:217], v245 offset:24576
    v_mfma_f32_16x16x32_bf16 v[192:195], v[80:83], v[224:227], v[192:195]
    ds_read_b64_tr_b16 v[218:219], v245 offset:25088
    buffer_load_dwordx4 v231, s[8:11], s35 offen offset:3072 lds
    s_waitcnt vmcnt(12)
    s_barrier
    s_waitcnt lgkmcnt(8)
    v_mfma_f32_16x16x32_bf16 v[132:135], v[84:87], v[196:199], v[132:135]
    ds_read_b64_tr_b16 v[220:221], v246 offset:24576
    v_mfma_f32_16x16x32_bf16 v[136:139], v[88:91], v[196:199], v[136:139]
    ds_read_b64_tr_b16 v[222:223], v246 offset:25088
    buffer_load_dword v255, v254, s[24:27], s49 offen offset:1536
    v_mfma_f32_16x16x32_bf16 v[140:143], v[84:87], v[200:203], v[140:143]
    ds_read_b64_tr_b16 v[224:225], v247 offset:24576
    v_mfma_f32_16x16x32_bf16 v[144:147], v[88:91], v[200:203], v[144:147]
    ds_read_b64_tr_b16 v[226:227], v247 offset:25088
    s_waitcnt lgkmcnt(8)
    v_mfma_f32_16x16x32_bf16 v[148:151], v[84:87], v[204:207], v[148:151]
    ds_read_b64_tr_b16 v[196:197], v244 offset:20480
    v_mfma_f32_16x16x32_bf16 v[152:155], v[88:91], v[204:207], v[152:155]
    ds_read_b64_tr_b16 v[198:199], v244 offset:20992
    v_mfma_f32_16x16x32_bf16 v[156:159], v[84:87], v[208:211], v[156:159]
    ds_read_b64_tr_b16 v[200:201], v245 offset:20480
    v_mfma_f32_16x16x32_bf16 v[160:163], v[88:91], v[208:211], v[160:163]
    ds_read_b64_tr_b16 v[202:203], v245 offset:20992
    s_waitcnt lgkmcnt(8)
    v_mfma_f32_16x16x32_bf16 v[164:167], v[84:87], v[212:215], v[164:167]
    ds_read_b64_tr_b16 v[204:205], v246 offset:20480
    v_lshrrev_b32 v237, 13, v228
    v_mfma_f32_16x16x32_bf16 v[168:171], v[88:91], v[212:215], v[168:171]
    ds_read_b64_tr_b16 v[206:207], v246 offset:20992
    v_mul_u32_u24 v237, 3584, v237
    v_mfma_f32_16x16x32_bf16 v[172:175], v[84:87], v[216:219], v[172:175]
    ds_read_b64_tr_b16 v[208:209], v247 offset:20480
    v_and_b32 v236, 0x7f, v228
    v_mfma_f32_16x16x32_bf16 v[176:179], v[88:91], v[216:219], v[176:179]
    ds_read_b64_tr_b16 v[210:211], v247 offset:20992
    v_add_u32 v236, v236, v237
    s_waitcnt vmcnt(15)
    ds_read_b128 v[100:103], v240 offset:0
    ds_read_b128 v[104:107], v240 offset:2048
    ds_read_b128 v[108:111], v241 offset:0
    ds_read_b128 v[112:115], v241 offset:2048
    s_waitcnt lgkmcnt(8)
    v_mfma_f32_16x16x32_bf16 v[180:183], v[84:87], v[220:223], v[180:183]
    ds_read_b64_tr_b16 v[212:213], v244 offset:28672
    v_xor_b32 v237, 16, v236
    v_mfma_f32_16x16x32_bf16 v[184:187], v[88:91], v[220:223], v[184:187]
    ds_read_b64_tr_b16 v[214:215], v244 offset:29184
    v_add_u32 v237, 27648, v237
    v_mfma_f32_16x16x32_bf16 v[188:191], v[84:87], v[224:227], v[188:191]
    ds_read_b64_tr_b16 v[216:217], v245 offset:28672
    v_add_u32 v238, 55296, v236
    v_mfma_f32_16x16x32_bf16 v[192:195], v[88:91], v[224:227], v[192:195]
    ds_read_b64_tr_b16 v[218:219], v245 offset:29184
    v_add_u32 v239, 55296, v237
    s_waitcnt lgkmcnt(8)
    v_mfma_f32_16x16x32_bf16 v[132:135], v[92:95], v[196:199], v[132:135]
    ds_read_b64_tr_b16 v[220:221], v246 offset:28672
    buffer_store_dwordx4 v[250:253], v3, s[56:59], s48 offen sc1
    v_mfma_f32_16x16x32_bf16 v[136:139], v[96:99], v[196:199], v[136:139]
    ds_read_b64_tr_b16 v[222:223], v246 offset:29184
    v_mfma_f32_16x16x32_bf16 v[140:143], v[92:95], v[200:203], v[140:143]
    ds_read_b64_tr_b16 v[224:225], v247 offset:28672
    v_mfma_f32_16x16x32_bf16 v[144:147], v[96:99], v[200:203], v[144:147]
    ds_read_b64_tr_b16 v[226:227], v247 offset:29184
    s_waitcnt lgkmcnt(8)
    v_mfma_f32_16x16x32_bf16 v[148:151], v[92:95], v[204:207], v[148:151]
    ds_read_b64_tr_b16 v[196:197], v244 offset:32768
    v_mfma_f32_16x16x32_bf16 v[152:155], v[96:99], v[204:207], v[152:155]
    ds_read_b64_tr_b16 v[198:199], v244 offset:33280
    v_mfma_f32_16x16x32_bf16 v[156:159], v[92:95], v[208:211], v[156:159]
    ds_read_b64_tr_b16 v[200:201], v245 offset:32768
    v_mfma_f32_16x16x32_bf16 v[160:163], v[96:99], v[208:211], v[160:163]
    ds_read_b64_tr_b16 v[202:203], v245 offset:33280
    s_waitcnt lgkmcnt(8)
    v_mfma_f32_16x16x32_bf16 v[164:167], v[92:95], v[212:215], v[164:167]
    ds_read_b64_tr_b16 v[204:205], v246 offset:32768
    v_mfma_f32_16x16x32_bf16 v[168:171], v[96:99], v[212:215], v[168:171]
    ds_read_b64_tr_b16 v[206:207], v246 offset:33280
    s_add_u32 m0, s36, 0
    s_add_u32 s35, s43, 2097408
    buffer_load_dwordx4 v228, s[8:11], s35 offen offset:0 lds
    v_mfma_f32_16x16x32_bf16 v[172:175], v[92:95], v[216:219], v[172:175]
    ds_read_b64_tr_b16 v[208:209], v247 offset:32768
    v_mfma_f32_16x16x32_bf16 v[176:179], v[96:99], v[216:219], v[176:179]
    ds_read_b64_tr_b16 v[210:211], v247 offset:33280
    buffer_load_dwordx4 v229, s[8:11], s35 offen offset:1024 lds
    s_waitcnt lgkmcnt(8)
    v_mfma_f32_16x16x32_bf16 v[180:183], v[92:95], v[220:223], v[180:183]
    ds_read_b64_tr_b16 v[212:213], v244 offset:40960
    v_mfma_f32_16x16x32_bf16 v[184:187], v[96:99], v[220:223], v[184:187]
    ds_read_b64_tr_b16 v[214:215], v244 offset:41472
    buffer_load_dwordx4 v230, s[8:11], s35 offen offset:2048 lds
    v_mfma_f32_16x16x32_bf16 v[188:191], v[92:95], v[224:227], v[188:191]
    ds_read_b64_tr_b16 v[216:217], v245 offset:40960
    v_mfma_f32_16x16x32_bf16 v[192:195], v[96:99], v[224:227], v[192:195]
    ds_read_b64_tr_b16 v[218:219], v245 offset:41472
    buffer_load_dwordx4 v231, s[8:11], s35 offen offset:3072 lds
    s_waitcnt vmcnt(11)
    s_barrier
    s_waitcnt lgkmcnt(8)
    v_mfma_f32_16x16x32_bf16 v[132:135], v[100:103], v[196:199], v[132:135]
    ds_read_b64_tr_b16 v[220:221], v246 offset:40960
    v_mfma_f32_16x16x32_bf16 v[136:139], v[104:107], v[196:199], v[136:139]
    ds_read_b64_tr_b16 v[222:223], v246 offset:41472
    buffer_load_dword v255, v254, s[96:99], s50 offen offset:0
    v_mfma_f32_16x16x32_bf16 v[140:143], v[100:103], v[200:203], v[140:143]
    ds_read_b64_tr_b16 v[224:225], v247 offset:40960
    v_mfma_f32_16x16x32_bf16 v[144:147], v[104:107], v[200:203], v[144:147]
    ds_read_b64_tr_b16 v[226:227], v247 offset:41472
    s_waitcnt lgkmcnt(8)
    v_mfma_f32_16x16x32_bf16 v[148:151], v[100:103], v[204:207], v[148:151]
    ds_read_b64_tr_b16 v[196:197], v244 offset:36864
    v_mfma_f32_16x16x32_bf16 v[152:155], v[104:107], v[204:207], v[152:155]
    ds_read_b64_tr_b16 v[198:199], v244 offset:37376
    v_mfma_f32_16x16x32_bf16 v[156:159], v[100:103], v[208:211], v[156:159]
    ds_read_b64_tr_b16 v[200:201], v245 offset:36864
    v_mfma_f32_16x16x32_bf16 v[160:163], v[104:107], v[208:211], v[160:163]
    ds_read_b64_tr_b16 v[202:203], v245 offset:37376
    s_waitcnt lgkmcnt(8)
    v_mfma_f32_16x16x32_bf16 v[164:167], v[100:103], v[212:215], v[164:167]
    ds_read_b64_tr_b16 v[204:205], v246 offset:36864
    v_mfma_f32_16x16x32_bf16 v[168:171], v[104:107], v[212:215], v[168:171]
    ds_read_b64_tr_b16 v[206:207], v246 offset:37376
    v_mfma_f32_16x16x32_bf16 v[172:175], v[100:103], v[216:219], v[172:175]
    ds_read_b64_tr_b16 v[208:209], v247 offset:36864
    v_mfma_f32_16x16x32_bf16 v[176:179], v[104:107], v[216:219], v[176:179]
    ds_read_b64_tr_b16 v[210:211], v247 offset:37376
    s_waitcnt vmcnt(14)
    ds_read_b128 v[116:119], v240 offset:32768
    ds_read_b128 v[120:123], v240 offset:34816
    ds_read_b128 v[124:127], v241 offset:32768
    ds_read_b128 v[128:131], v241 offset:34816
    s_waitcnt lgkmcnt(8)
    v_mfma_f32_16x16x32_bf16 v[180:183], v[100:103], v[220:223], v[180:183]
    ds_read_b64_tr_b16 v[212:213], v244 offset:45056
    v_mfma_f32_16x16x32_bf16 v[184:187], v[104:107], v[220:223], v[184:187]
    ds_read_b64_tr_b16 v[214:215], v244 offset:45568
    v_mfma_f32_16x16x32_bf16 v[188:191], v[100:103], v[224:227], v[188:191]
    ds_read_b64_tr_b16 v[216:217], v245 offset:45056
    v_mfma_f32_16x16x32_bf16 v[192:195], v[104:107], v[224:227], v[192:195]
    ds_read_b64_tr_b16 v[218:219], v245 offset:45568
    s_waitcnt lgkmcnt(8)
    v_mfma_f32_16x16x32_bf16 v[132:135], v[108:111], v[196:199], v[132:135]
    ds_read_b64_tr_b16 v[220:221], v246 offset:45056
    v_mfma_f32_16x16x32_bf16 v[136:139], v[112:115], v[196:199], v[136:139]
    ds_read_b64_tr_b16 v[222:223], v246 offset:45568
    v_mfma_f32_16x16x32_bf16 v[140:143], v[108:111], v[200:203], v[140:143]
    ds_read_b64_tr_b16 v[224:225], v247 offset:45056
    v_mfma_f32_16x16x32_bf16 v[144:147], v[112:115], v[200:203], v[144:147]
    ds_read_b64_tr_b16 v[226:227], v247 offset:45568
    s_waitcnt lgkmcnt(8)
    v_mfma_f32_16x16x32_bf16 v[148:151], v[108:111], v[204:207], v[148:151]
    ds_read_b64_tr_b16 v[196:197], v244 offset:49152
    v_mfma_f32_16x16x32_bf16 v[152:155], v[112:115], v[204:207], v[152:155]
    ds_read_b64_tr_b16 v[198:199], v244 offset:49664
    v_mfma_f32_16x16x32_bf16 v[156:159], v[108:111], v[208:211], v[156:159]
    ds_read_b64_tr_b16 v[200:201], v245 offset:49152
    v_mfma_f32_16x16x32_bf16 v[160:163], v[112:115], v[208:211], v[160:163]
    ds_read_b64_tr_b16 v[202:203], v245 offset:49664
    s_waitcnt lgkmcnt(8)
    v_mfma_f32_16x16x32_bf16 v[164:167], v[108:111], v[212:215], v[164:167]
    ds_read_b64_tr_b16 v[204:205], v246 offset:49152
    v_mfma_f32_16x16x32_bf16 v[168:171], v[112:115], v[212:215], v[168:171]
    ds_read_b64_tr_b16 v[206:207], v246 offset:49664
    s_add_u32 m0, s36, 32768
    s_add_u32 s35, s43, 384
    buffer_load_dwordx4 v228, s[8:11], s35 offen offset:0 lds
    v_mfma_f32_16x16x32_bf16 v[172:175], v[108:111], v[216:219], v[172:175]
    ds_read_b64_tr_b16 v[208:209], v247 offset:49152
    v_mfma_f32_16x16x32_bf16 v[176:179], v[112:115], v[216:219], v[176:179]
    ds_read_b64_tr_b16 v[210:211], v247 offset:49664
    buffer_load_dwordx4 v229, s[8:11], s35 offen offset:1024 lds
    s_waitcnt lgkmcnt(8)
    v_mfma_f32_16x16x32_bf16 v[180:183], v[108:111], v[220:223], v[180:183]
    ds_read_b64_tr_b16 v[212:213], v244 offset:57344
    v_mfma_f32_16x16x32_bf16 v[184:187], v[112:115], v[220:223], v[184:187]
    ds_read_b64_tr_b16 v[214:215], v244 offset:57856
    buffer_load_dwordx4 v230, s[8:11], s35 offen offset:2048 lds
    v_mfma_f32_16x16x32_bf16 v[188:191], v[108:111], v[224:227], v[188:191]
    ds_read_b64_tr_b16 v[216:217], v245 offset:57344
    v_mfma_f32_16x16x32_bf16 v[192:195], v[112:115], v[224:227], v[192:195]
    ds_read_b64_tr_b16 v[218:219], v245 offset:57856
    buffer_load_dwordx4 v231, s[8:11], s35 offen offset:3072 lds
    s_waitcnt vmcnt(9)
    s_barrier
    s_cmp_lg_u32 s32, 0
    s_cbranch_scc1 L_k1ns_4
    s_and_b32 s39, s2, 0xfc
    v_mov_b32 v252, 0
    v_mov_b32 v253, 1
    s_mov_b64 exec, 1
    buffer_atomic_add v253, v252, s[52:55], s39 offen sc1
    s_mov_b64 exec, -1
L_k1ns_4:
    s_waitcnt lgkmcnt(8)
    v_mfma_f32_16x16x32_bf16 v[132:135], v[116:119], v[196:199], v[132:135]
    ds_read_b64_tr_b16 v[220:221], v246 offset:57344
    v_mfma_f32_16x16x32_bf16 v[136:139], v[120:123], v[196:199], v[136:139]
    ds_read_b64_tr_b16 v[222:223], v246 offset:57856
    s_add_u32 m0, s36, 98304
    s_add_u32 s35, s43, 2097536
    buffer_load_dwordx4 v228, s[8:11], s35 offen offset:0 lds
    v_mfma_f32_16x16x32_bf16 v[140:143], v[116:119], v[200:203], v[140:143]
    ds_read_b64_tr_b16 v[224:225], v247 offset:57344
    v_mfma_f32_16x16x32_bf16 v[144:147], v[120:123], v[200:203], v[144:147]
    ds_read_b64_tr_b16 v[226:227], v247 offset:57856
    buffer_load_dwordx4 v229, s[8:11], s35 offen offset:1024 lds
    s_waitcnt lgkmcnt(8)
    v_mfma_f32_16x16x32_bf16 v[148:151], v[116:119], v[204:207], v[148:151]
    ds_read_b64_tr_b16 v[196:197], v244 offset:53248
    v_mfma_f32_16x16x32_bf16 v[152:155], v[120:123], v[204:207], v[152:155]
    ds_read_b64_tr_b16 v[198:199], v244 offset:53760
    buffer_load_dwordx4 v230, s[8:11], s35 offen offset:2048 lds
    v_mfma_f32_16x16x32_bf16 v[156:159], v[116:119], v[208:211], v[156:159]
    ds_read_b64_tr_b16 v[200:201], v245 offset:53248
    v_mfma_f32_16x16x32_bf16 v[160:163], v[120:123], v[208:211], v[160:163]
    ds_read_b64_tr_b16 v[202:203], v245 offset:53760
    buffer_load_dwordx4 v231, s[8:11], s35 offen offset:3072 lds
    s_waitcnt lgkmcnt(8)
    v_mfma_f32_16x16x32_bf16 v[164:167], v[116:119], v[212:215], v[164:167]
    ds_read_b64_tr_b16 v[204:205], v246 offset:53248
    v_add_u32 v240, 0x10000, v232
    v_mfma_f32_16x16x32_bf16 v[168:171], v[120:123], v[212:215], v[168:171]
    ds_read_b64_tr_b16 v[206:207], v246 offset:53760
    buffer_load_dword v255, v254, s[96:99], s50 offen offset:512
    v_add_u32 v241, 0x10000, v233
    v_mfma_f32_16x16x32_bf16 v[172:175], v[116:119], v[216:219], v[172:175]
    ds_read_b64_tr_b16 v[208:209], v247 offset:53248
    v_add_u32 v242, 0x10000, v234
    v_mfma_f32_16x16x32_bf16 v[176:179], v[120:123], v[216:219], v[176:179]
    ds_read_b64_tr_b16 v[210:211], v247 offset:53760
    v_add_u32 v243, 0x10000, v235
    s_waitcnt lgkmcnt(8)
    v_mfma_f32_16x16x32_bf16 v[180:183], v[116:119], v[220:223], v[180:183]
    ds_read_b64_tr_b16 v[212:213], v244 offset:61440
    v_mfma_f32_16x16x32_bf16 v[184:187], v[120:123], v[220:223], v[184:187]
    ds_read_b64_tr_b16 v[214:215], v244 offset:61952
    v_mfma_f32_16x16x32_bf16 v[188:191], v[116:119], v[224:227], v[188:191]
    ds_read_b64_tr_b16 v[216:217], v245 offset:61440
    v_mfma_f32_16x16x32_bf16 v[192:195], v[120:123], v[224:227], v[192:195]
    ds_read_b64_tr_b16 v[218:219], v245 offset:61952
    s_waitcnt lgkmcnt(8)
    v_mfma_f32_16x16x32_bf16 v[132:135], v[124:127], v[196:199], v[132:135]
    ds_read_b64_tr_b16 v[220:221], v246 offset:61440
    v_mfma_f32_16x16x32_bf16 v[136:139], v[128:131], v[196:199], v[136:139]
    ds_read_b64_tr_b16 v[222:223], v246 offset:61952
    v_mfma_f32_16x16x32_bf16 v[140:143], v[124:127], v[200:203], v[140:143]
    ds_read_b64_tr_b16 v[224:225], v247 offset:61440
    v_mfma_f32_16x16x32_bf16 v[144:147], v[128:131], v[200:203], v[144:147]
    ds_read_b64_tr_b16 v[226:227], v247 offset:61952
    s_waitcnt lgkmcnt(8)
    v_mfma_f32_16x16x32_bf16 v[148:151], v[124:127], v[204:207], v[148:151]
    ds_read_b64_tr_b16 v[196:197], v240 offset:0
    v_mfma_f32_16x16x32_bf16 v[152:155], v[128:131], v[204:207], v[152:155]
    ds_read_b64_tr_b16 v[198:199], v240 offset:512
    v_mfma_f32_16x16x32_bf16 v[156:159], v[124:127], v[208:211], v[156:159]
    ds_read_b64_tr_b16 v[200:201], v241 offset:0
    v_mfma_f32_16x16x32_bf16 v[160:163], v[128:131], v[208:211], v[160:163]
    ds_read_b64_tr_b16 v[202:203], v241 offset:512
    s_waitcnt lgkmcnt(8)
    v_mfma_f32_16x16x32_bf16 v[164:167], v[124:127], v[212:215], v[164:167]
    ds_read_b64_tr_b16 v[204:205], v242 offset:0
    v_mfma_f32_16x16x32_bf16 v[168:171], v[128:131], v[212:215], v[168:171]
    ds_read_b64_tr_b16 v[206:207], v242 offset:512
    v_mfma_f32_16x16x32_bf16 v[172:175], v[124:127], v[216:219], v[172:175]
    ds_read_b64_tr_b16 v[208:209], v243 offset:0
    v_mfma_f32_16x16x32_bf16 v[176:179], v[128:131], v[216:219], v[176:179]
    ds_read_b64_tr_b16 v[210:211], v243 offset:512
    s_waitcnt lgkmcnt(8)
    v_mfma_f32_16x16x32_bf16 v[180:183], v[124:127], v[220:223], v[180:183]
    ds_read_b64_tr_b16 v[212:213], v240 offset:4096
    v_mfma_f32_16x16x32_bf16 v[184:187], v[128:131], v[220:223], v[184:187]
    ds_read_b64_tr_b16 v[214:215], v240 offset:4608
    v_mfma_f32_16x16x32_bf16 v[188:191], v[124:127], v[224:227], v[188:191]
    ds_read_b64_tr_b16 v[216:217], v241 offset:4096
    v_mfma_f32_16x16x32_bf16 v[192:195], v[128:131], v[224:227], v[192:195]
    ds_read_b64_tr_b16 v[218:219], v241 offset:4608
    s_waitcnt vmcnt(10)
    s_nop 3
    v_cvt_pk_bf16_f32 v164, v164, v165
    v_cvt_pk_bf16_f32 v165, v166, v167
    v_cvt_pk_bf16_f32 v166, v168, v169
    v_cvt_pk_bf16_f32 v167, v170, v171
    v_cvt_pk_bf16_f32 v168, v172, v173
    v_cvt_pk_bf16_f32 v169, v174, v175
    v_cvt_pk_bf16_f32 v170, v176, v177
    v_cvt_pk_bf16_f32 v171, v178, v179
    v_cvt_pk_bf16_f32 v172, v180, v181
    v_cvt_pk_bf16_f32 v173, v182, v183
    v_cvt_pk_bf16_f32 v174, v184, v185
    v_cvt_pk_bf16_f32 v175, v186, v187
    v_cvt_pk_bf16_f32 v176, v188, v189
    v_cvt_pk_bf16_f32 v177, v190, v191
    v_cvt_pk_bf16_f32 v178, v192, v193
    v_cvt_pk_bf16_f32 v179, v194, v195
    v_cvt_pk_bf16_f32 v180, v132, v133
    v_cvt_pk_bf16_f32 v181, v134, v135
    v_cvt_pk_bf16_f32 v182, v136, v137
    v_cvt_pk_bf16_f32 v183, v138, v139
    v_cvt_pk_bf16_f32 v184, v140, v141
    v_cvt_pk_bf16_f32 v185, v142, v143
    v_cvt_pk_bf16_f32 v186, v144, v145
    v_cvt_pk_bf16_f32 v187, v146, v147
    v_cvt_pk_bf16_f32 v188, v148, v149
    v_cvt_pk_bf16_f32 v189, v150, v151
    v_cvt_pk_bf16_f32 v190, v152, v153
    v_cvt_pk_bf16_f32 v191, v154, v155
    v_cvt_pk_bf16_f32 v192, v156, v157
    v_cvt_pk_bf16_f32 v193, v158, v159
    v_cvt_pk_bf16_f32 v194, v160, v161
    v_cvt_pk_bf16_f32 v195, v162, v163
    s_barrier
    s_waitcnt lgkmcnt(8)
    v_mfma_f32_16x16x32_bf16 v[132:135], v[4:7], v[196:199], 0
    ds_read_b64_tr_b16 v[220:221], v242 offset:4096
    v_mfma_f32_16x16x32_bf16 v[136:139], v[8:11], v[196:199], 0
    ds_read_b64_tr_b16 v[222:223], v242 offset:4608
    s_add_u32 m0, s36, 131072
    s_add_u32 s35, s45, 917504
    buffer_load_dwordx4 v236, s[96:99], s35 offen offset:0 lds
    v_mfma_f32_16x16x32_bf16 v[140:143], v[4:7], v[200:203], 0
    ds_read_b64_tr_b16 v[224:225], v243 offset:4096
    v_mfma_f32_16x16x32_bf16 v[144:147], v[8:11], v[200:203], 0
    ds_read_b64_tr_b16 v[226:227], v243 offset:4608
    buffer_load_dwordx4 v237, s[96:99], s35 offen offset:1024 lds
    s_waitcnt lgkmcnt(8)
    v_mfma_f32_16x16x32_bf16 v[148:151], v[4:7], v[204:207], 0
    ds_read_b64_tr_b16 v[196:197], v240 offset:8192
    v_mfma_f32_16x16x32_bf16 v[152:155], v[8:11], v[204:207], 0
    ds_read_b64_tr_b16 v[198:199], v240 offset:8704
    buffer_load_dwordx4 v238, s[96:99], s35 offen offset:2048 lds
    v_mfma_f32_16x16x32_bf16 v[156:159], v[4:7], v[208:211], 0
    ds_read_b64_tr_b16 v[200:201], v241 offset:8192
    v_mfma_f32_16x16x32_bf16 v[160:163], v[8:11], v[208:211], 0
    ds_read_b64_tr_b16 v[202:203], v241 offset:8704
    buffer_load_dwordx4 v239, s[96:99], s35 offen offset:3072 lds
    s_waitcnt lgkmcnt(8)
    v_mfma_f32_16x16x32_bf16 v[132:135], v[12:15], v[212:215], v[132:135]
    ds_read_b64_tr_b16 v[204:205], v242 offset:8192
    v_mfma_f32_16x16x32_bf16 v[136:139], v[16:19], v[212:215], v[136:139]
    ds_read_b64_tr_b16 v[206:207], v242 offset:8704
    v_mfma_f32_16x16x32_bf16 v[140:143], v[12:15], v[216:219], v[140:143]
    ds_read_b64_tr_b16 v[208:209], v243 offset:8192
    v_mfma_f32_16x16x32_bf16 v[144:147], v[16:19], v[216:219], v[144:147]
    ds_read_b64_tr_b16 v[210:211], v243 offset:8704
    s_waitcnt lgkmcnt(8)
    v_mfma_f32_16x16x32_bf16 v[148:151], v[12:15], v[220:223], v[148:151]
    ds_read_b64_tr_b16 v[212:213], v240 offset:12288
    v_mfma_f32_16x16x32_bf16 v[152:155], v[16:19], v[220:223], v[152:155]
    ds_read_b64_tr_b16 v[214:215], v240 offset:12800
    v_mfma_f32_16x16x32_bf16 v[156:159], v[12:15], v[224:227], v[156:159]
    ds_read_b64_tr_b16 v[216:217], v241 offset:12288
    v_mfma_f32_16x16x32_bf16 v[160:163], v[16:19], v[224:227], v[160:163]
    ds_read_b64_tr_b16 v[218:219], v241 offset:12800
    s_waitcnt lgkmcnt(8)
    v_mfma_f32_16x16x32_bf16 v[132:135], v[20:23], v[196:199], v[132:135]
    ds_read_b64_tr_b16 v[220:221], v242 offset:12288
    v_mfma_f32_16x16x32_bf16 v[136:139], v[24:27], v[196:199], v[136:139]
    ds_read_b64_tr_b16 v[222:223], v242 offset:12800
    v_mfma_f32_16x16x32_bf16 v[140:143], v[20:23], v[200:203], v[140:143]
    ds_read_b64_tr_b16 v[224:225], v243 offset:12288
    v_mfma_f32_16x16x32_bf16 v[144:147], v[24:27], v[200:203], v[144:147]
    ds_read_b64_tr_b16 v[226:227], v243 offset:12800
    s_waitcnt lgkmcnt(8)
    v_mfma_f32_16x16x32_bf16 v[148:151], v[20:23], v[204:207], v[148:151]
    ds_read_b64_tr_b16 v[196:197], v240 offset:16384
    v_mfma_f32_16x16x32_bf16 v[152:155], v[24:27], v[204:207], v[152:155]
    ds_read_b64_tr_b16 v[198:199], v240 offset:16896
    s_add_u32 s41, s37, 0
    buffer_store_dwordx4 v[180:183], v2, s[28:31], s41 offen offset:0 sc1
    v_mfma_f32_16x16x32_bf16 v[156:159], v[20:23], v[208:211], v[156:159]
    ds_read_b64_tr_b16 v[200:201], v241 offset:16384
    v_mfma_f32_16x16x32_bf16 v[160:163], v[24:27], v[208:211], v[160:163]
    ds_read_b64_tr_b16 v[202:203], v241 offset:16896
    s_waitcnt lgkmcnt(8)
    v_mfma_f32_16x16x32_bf16 v[132:135], v[28:31], v[212:215], v[132:135]
    ds_read_b64_tr_b16 v[204:205], v242 offset:16384
    v_mfma_f32_16x16x32_bf16 v[136:139], v[32:35], v[212:215], v[136:139]
    ds_read_b64_tr_b16 v[206:207], v242 offset:16896
    v_mfma_f32_16x16x32_bf16 v[140:143], v[28:31], v[216:219], v[140:143]
    ds_read_b64_tr_b16 v[208:209], v243 offset:16384
    v_mfma_f32_16x16x32_bf16 v[144:147], v[32:35], v[216:219], v[144:147]
    ds_read_b64_tr_b16 v[210:211], v243 offset:16896
    s_waitcnt lgkmcnt(8)
    v_mfma_f32_16x16x32_bf16 v[148:151], v[28:31], v[220:223], v[148:151]
    ds_read_b64_tr_b16 v[212:213], v240 offset:20480
    v_mfma_f32_16x16x32_bf16 v[152:155], v[32:35], v[220:223], v[152:155]
    ds_read_b64_tr_b16 v[214:215], v240 offset:20992
    v_mfma_f32_16x16x32_bf16 v[156:159], v[28:31], v[224:227], v[156:159]
    ds_read_b64_tr_b16 v[216:217], v241 offset:20480
    v_mfma_f32_16x16x32_bf16 v[160:163], v[32:35], v[224:227], v[160:163]
    ds_read_b64_tr_b16 v[218:219], v241 offset:20992
    s_waitcnt lgkmcnt(8)
    v_mfma_f32_16x16x32_bf16 v[132:135], v[36:39], v[196:199], v[132:135]
    ds_read_b64_tr_b16 v[220:221], v242 offset:20480
    v_mfma_f32_16x16x32_bf16 v[136:139], v[40:43], v[196:199], v[136:139]
    ds_read_b64_tr_b16 v[222:223], v242 offset:20992
    v_mfma_f32_16x16x32_bf16 v[140:143], v[36:39], v[200:203], v[140:143]
    ds_read_b64_tr_b16 v[224:225], v243 offset:20480
    v_mfma_f32_16x16x32_bf16 v[144:147], v[40:43], v[200:203], v[144:147]
    ds_read_b64_tr_b16 v[226:227], v243 offset:20992
    s_waitcnt lgkmcnt(8)
    v_mfma_f32_16x16x32_bf16 v[148:151], v[36:39], v[204:207], v[148:151]
    ds_read_b64_tr_b16 v[196:197], v240 offset:24576
    v_mfma_f32_16x16x32_bf16 v[152:155], v[40:43], v[204:207], v[152:155]
    ds_read_b64_tr_b16 v[198:199], v240 offset:25088
    v_mfma_f32_16x16x32_bf16 v[156:159], v[36:39], v[208:211], v[156:159]
    ds_read_b64_tr_b16 v[200:201], v241 offset:24576
    v_mfma_f32_16x16x32_bf16 v[160:163], v[40:43], v[208:211], v[160:163]
    ds_read_b64_tr_b16 v[202:203], v241 offset:25088
    s_waitcnt lgkmcnt(8)
    v_mfma_f32_16x16x32_bf16 v[132:135], v[44:47], v[212:215], v[132:135]
    ds_read_b64_tr_b16 v[204:205], v242 offset:24576
    v_mfma_f32_16x16x32_bf16 v[136:139], v[48:51], v[212:215], v[136:139]
    ds_read_b64_tr_b16 v[206:207], v242 offset:25088
    v_mfma_f32_16x16x32_bf16 v[140:143], v[44:47], v[216:219], v[140:143]
    ds_read_b64_tr_b16 v[208:209], v243 offset:24576
    v_mfma_f32_16x16x32_bf16 v[144:147], v[48:51], v[216:219], v[144:147]
    ds_read_b64_tr_b16 v[210:211], v243 offset:25088
    s_waitcnt lgkmcnt(8)
    v_mfma_f32_16x16x32_bf16 v[148:151], v[44:47], v[220:223], v[148:151]
    ds_read_b64_tr_b16 v[212:213], v240 offset:28672
    v_mfma_f32_16x16x32_bf16 v[152:155], v[48:51], v[220:223], v[152:155]
    ds_read_b64_tr_b16 v[214:215], v240 offset:29184
    v_mfma_f32_16x16x32_bf16 v[156:159], v[44:47], v[224:227], v[156:159]
    ds_read_b64_tr_b16 v[216:217], v241 offset:28672
    v_mfma_f32_16x16x32_bf16 v[160:163], v[48:51], v[224:227], v[160:163]
    ds_read_b64_tr_b16 v[218:219], v241 offset:29184
    s_waitcnt lgkmcnt(8)
    v_mfma_f32_16x16x32_bf16 v[132:135], v[52:55], v[196:199], v[132:135]
    ds_read_b64_tr_b16 v[220:221], v242 offset:28672
    v_mfma_f32_16x16x32_bf16 v[136:139], v[56:59], v[196:199], v[136:139]
    ds_read_b64_tr_b16 v[222:223], v242 offset:29184
    s_add_u32 s41, s37, 0
    buffer_store_dwordx4 v[184:187], v2, s[28:31], s41 offen offset:1024 sc1
    v_mfma_f32_16x16x32_bf16 v[140:143], v[52:55], v[200:203], v[140:143]
    ds_read_b64_tr_b16 v[224:225], v243 offset:28672
    v_mfma_f32_16x16x32_bf16 v[144:147], v[56:59], v[200:203], v[144:147]
    ds_read_b64_tr_b16 v[226:227], v243 offset:29184
    s_waitcnt lgkmcnt(8)
    v_mfma_f32_16x16x32_bf16 v[148:151], v[52:55], v[204:207], v[148:151]
    ds_read_b64_tr_b16 v[196:197], v232 offset:0
    v_mfma_f32_16x16x32_bf16 v[152:155], v[56:59], v[204:207], v[152:155]
    ds_read_b64_tr_b16 v[198:199], v232 offset:512
    v_mfma_f32_16x16x32_bf16 v[156:159], v[52:55], v[208:211], v[156:159]
    ds_read_b64_tr_b16 v[200:201], v233 offset:0
    v_mfma_f32_16x16x32_bf16 v[160:163], v[56:59], v[208:211], v[160:163]
    ds_read_b64_tr_b16 v[202:203], v233 offset:512
    s_waitcnt lgkmcnt(8)
    v_mfma_f32_16x16x32_bf16 v[132:135], v[60:63], v[212:215], v[132:135]
    ds_read_b64_tr_b16 v[204:205], v234 offset:0
    v_mfma_f32_16x16x32_bf16 v[136:139], v[64:67], v[212:215], v[136:139]
    ds_read_b64_tr_b16 v[206:207], v234 offset:512
    v_mfma_f32_16x16x32_bf16 v[140:143], v[60:63], v[216:219], v[140:143]
    ds_read_b64_tr_b16 v[208:209], v235 offset:0
    v_mfma_f32_16x16x32_bf16 v[144:147], v[64:67], v[216:219], v[144:147]
    ds_read_b64_tr_b16 v[210:211], v235 offset:512
    s_waitcnt lgkmcnt(8)
    v_mfma_f32_16x16x32_bf16 v[148:151], v[60:63], v[220:223], v[148:151]
    ds_read_b64_tr_b16 v[212:213], v232 offset:4096
    v_mfma_f32_16x16x32_bf16 v[152:155], v[64:67], v[220:223], v[152:155]
    ds_read_b64_tr_b16 v[214:215], v232 offset:4608
    v_mfma_f32_16x16x32_bf16 v[156:159], v[60:63], v[224:227], v[156:159]
    ds_read_b64_tr_b16 v[216:217], v233 offset:4096
    v_mfma_f32_16x16x32_bf16 v[160:163], v[64:67], v[224:227], v[160:163]
    ds_read_b64_tr_b16 v[218:219], v233 offset:4608
    s_waitcnt vmcnt(11)
    s_barrier
    s_waitcnt lgkmcnt(8)
    v_mfma_f32_16x16x32_bf16 v[132:135], v[68:71], v[196:199], v[132:135]
    ds_read_b64_tr_b16 v[220:221], v234 offset:4096
    v_mfma_f32_16x16x32_bf16 v[136:139], v[72:75], v[196:199], v[136:139]
    ds_read_b64_tr_b16 v[222:223], v234 offset:4608
    s_add_u32 m0, s36, 65536
    s_add_u32 s35, s45, 0
    buffer_load_dwordx4 v236, s[96:99], s35 offen offset:0 lds
    v_mfma_f32_16x16x32_bf16 v[140:143], v[68:71], v[200:203], v[140:143]
    ds_read_b64_tr_b16 v[224:225], v235 offset:4096
    v_mfma_f32_16x16x32_bf16 v[144:147], v[72:75], v[200:203], v[144:147]
    ds_read_b64_tr_b16 v[226:227], v235 offset:4608
    buffer_load_dwordx4 v237, s[96:99], s35 offen offset:1024 lds
    s_waitcnt lgkmcnt(8)
    v_mfma_f32_16x16x32_bf16 v[148:151], v[68:71], v[204:207], v[148:151]
    ds_read_b64_tr_b16 v[196:197], v232 offset:8192
    v_mfma_f32_16x16x32_bf16 v[152:155], v[72:75], v[204:207], v[152:155]
    ds_read_b64_tr_b16 v[198:199], v232 offset:8704
    buffer_load_dwordx4 v238, s[96:99], s35 offen offset:2048 lds
    v_mfma_f32_16x16x32_bf16 v[156:159], v[68:71], v[208:211], v[156:159]
    ds_read_b64_tr_b16 v[200:201], v233 offset:8192
    v_mfma_f32_16x16x32_bf16 v[160:163], v[72:75], v[208:211], v[160:163]
    ds_read_b64_tr_b16 v[202:203], v233 offset:8704
    buffer_load_dwordx4 v239, s[96:99], s35 offen offset:3072 lds
    s_waitcnt lgkmcnt(8)
    v_mfma_f32_16x16x32_bf16 v[132:135], v[76:79], v[212:215], v[132:135]
    ds_read_b64_tr_b16 v[204:205], v234 offset:8192
    v_mfma_f32_16x16x32_bf16 v[136:139], v[80:83], v[212:215], v[136:139]
    ds_read_b64_tr_b16 v[206:207], v234 offset:8704
    v_mfma_f32_16x16x32_bf16 v[140:143], v[76:79], v[216:219], v[140:143]
    ds_read_b64_tr_b16 v[208:209], v235 offset:8192
    v_mfma_f32_16x16x32_bf16 v[144:147], v[80:83], v[216:219], v[144:147]
    ds_read_b64_tr_b16 v[210:211], v235 offset:8704
    s_waitcnt lgkmcnt(8)
    v_mfma_f32_16x16x32_bf16 v[148:151], v[76:79], v[220:223], v[148:151]
    ds_read_b64_tr_b16 v[212:213], v232 offset:12288
    v_mfma_f32_16x16x32_bf16 v[152:155], v[80:83], v[220:223], v[152:155]
    ds_read_b64_tr_b16 v[214:215], v232 offset:12800
    v_mfma_f32_16x16x32_bf16 v[156:159], v[76:79], v[224:227], v[156:159]
    ds_read_b64_tr_b16 v[216:217], v233 offset:12288
    v_mfma_f32_16x16x32_bf16 v[160:163], v[80:83], v[224:227], v[160:163]
    ds_read_b64_tr_b16 v[218:219], v233 offset:12800
    s_waitcnt lgkmcnt(8)
    v_mfma_f32_16x16x32_bf16 v[132:135], v[84:87], v[196:199], v[132:135]
    ds_read_b64_tr_b16 v[220:221], v234 offset:12288
    v_mfma_f32_16x16x32_bf16 v[136:139], v[88:91], v[196:199], v[136:139]
    ds_read_b64_tr_b16 v[222:223], v234 offset:12800
    v_mfma_f32_16x16x32_bf16 v[140:143], v[84:87], v[200:203], v[140:143]
    ds_read_b64_tr_b16 v[224:225], v235 offset:12288
    v_mfma_f32_16x16x32_bf16 v[144:147], v[88:91], v[200:203], v[144:147]
    ds_read_b64_tr_b16 v[226:227], v235 offset:12800
    s_waitcnt lgkmcnt(8)
    v_mfma_f32_16x16x32_bf16 v[148:151], v[84:87], v[204:207], v[148:151]
    ds_read_b64_tr_b16 v[196:197], v232 offset:16384
    v_mfma_f32_16x16x32_bf16 v[152:155], v[88:91], v[204:207], v[152:155]
    ds_read_b64_tr_b16 v[198:199], v232 offset:16896
    s_add_u32 s41, s37, 0
    buffer_store_dwordx4 v[188:191], v2, s[28:31], s41 offen offset:2048 sc1
    v_mfma_f32_16x16x32_bf16 v[156:159], v[84:87], v[208:211], v[156:159]
    ds_read_b64_tr_b16 v[200:201], v233 offset:16384
    v_mfma_f32_16x16x32_bf16 v[160:163], v[88:91], v[208:211], v[160:163]
    ds_read_b64_tr_b16 v[202:203], v233 offset:16896
    s_waitcnt lgkmcnt(8)
    v_mfma_f32_16x16x32_bf16 v[132:135], v[92:95], v[212:215], v[132:135]
    ds_read_b64_tr_b16 v[204:205], v234 offset:16384
    v_mfma_f32_16x16x32_bf16 v[136:139], v[96:99], v[212:215], v[136:139]
    ds_read_b64_tr_b16 v[206:207], v234 offset:16896
    v_mfma_f32_16x16x32_bf16 v[140:143], v[92:95], v[216:219], v[140:143]
    ds_read_b64_tr_b16 v[208:209], v235 offset:16384
    v_mfma_f32_16x16x32_bf16 v[144:147], v[96:99], v[216:219], v[144:147]
    ds_read_b64_tr_b16 v[210:211], v235 offset:16896
    s_waitcnt lgkmcnt(8)
    v_mfma_f32_16x16x32_bf16 v[148:151], v[92:95], v[220:223], v[148:151]
    ds_read_b64_tr_b16 v[212:213], v232 offset:20480
    v_mfma_f32_16x16x32_bf16 v[152:155], v[96:99], v[220:223], v[152:155]
    ds_read_b64_tr_b16 v[214:215], v232 offset:20992
    v_mfma_f32_16x16x32_bf16 v[156:159], v[92:95], v[224:227], v[156:159]
    ds_read_b64_tr_b16 v[216:217], v233 offset:20480
    v_mfma_f32_16x16x32_bf16 v[160:163], v[96:99], v[224:227], v[160:163]
    ds_read_b64_tr_b16 v[218:219], v233 offset:20992
    s_waitcnt lgkmcnt(8)
    v_mfma_f32_16x16x32_bf16 v[132:135], v[100:103], v[196:199], v[132:135]
    ds_read_b64_tr_b16 v[220:221], v234 offset:20480
    v_mfma_f32_16x16x32_bf16 v[136:139], v[104:107], v[196:199], v[136:139]
    ds_read_b64_tr_b16 v[222:223], v234 offset:20992
    v_mfma_f32_16x16x32_bf16 v[140:143], v[100:103], v[200:203], v[140:143]
    ds_read_b64_tr_b16 v[224:225], v235 offset:20480
    v_mfma_f32_16x16x32_bf16 v[144:147], v[104:107], v[200:203], v[144:147]
    ds_read_b64_tr_b16 v[226:227], v235 offset:20992
    s_waitcnt lgkmcnt(8)
    v_mfma_f32_16x16x32_bf16 v[148:151], v[100:103], v[204:207], v[148:151]
    ds_read_b64_tr_b16 v[196:197], v232 offset:24576
    v_mfma_f32_16x16x32_bf16 v[152:155], v[104:107], v[204:207], v[152:155]
    ds_read_b64_tr_b16 v[198:199], v232 offset:25088
    v_mfma_f32_16x16x32_bf16 v[156:159], v[100:103], v[208:211], v[156:159]
    ds_read_b64_tr_b16 v[200:201], v233 offset:24576
    v_mfma_f32_16x16x32_bf16 v[160:163], v[104:107], v[208:211], v[160:163]
    ds_read_b64_tr_b16 v[202:203], v233 offset:25088
    s_waitcnt lgkmcnt(8)
    v_mfma_f32_16x16x32_bf16 v[132:135], v[108:111], v[212:215], v[132:135]
    ds_read_b64_tr_b16 v[204:205], v234 offset:24576
    v_mfma_f32_16x16x32_bf16 v[136:139], v[112:115], v[212:215], v[136:139]
    ds_read_b64_tr_b16 v[206:207], v234 offset:25088
    v_mfma_f32_16x16x32_bf16 v[140:143], v[108:111], v[216:219], v[140:143]
    ds_read_b64_tr_b16 v[208:209], v235 offset:24576
    v_mfma_f32_16x16x32_bf16 v[144:147], v[112:115], v[216:219], v[144:147]
    ds_read_b64_tr_b16 v[210:211], v235 offset:25088
    s_waitcnt lgkmcnt(8)
    v_mfma_f32_16x16x32_bf16 v[148:151], v[108:111], v[220:223], v[148:151]
    ds_read_b64_tr_b16 v[212:213], v232 offset:28672
    v_mfma_f32_16x16x32_bf16 v[152:155], v[112:115], v[220:223], v[152:155]
    ds_read_b64_tr_b16 v[214:215], v232 offset:29184
    v_mfma_f32_16x16x32_bf16 v[156:159], v[108:111], v[224:227], v[156:159]
    ds_read_b64_tr_b16 v[216:217], v233 offset:28672
    v_mfma_f32_16x16x32_bf16 v[160:163], v[112:115], v[224:227], v[160:163]
    ds_read_b64_tr_b16 v[218:219], v233 offset:29184
    s_waitcnt lgkmcnt(8)
    v_mfma_f32_16x16x32_bf16 v[132:135], v[116:119], v[196:199], v[132:135]
    ds_read_b64_tr_b16 v[220:221], v234 offset:28672
    v_mfma_f32_16x16x32_bf16 v[136:139], v[120:123], v[196:199], v[136:139]
    ds_read_b64_tr_b16 v[222:223], v234 offset:29184
    s_add_u32 s41, s37, 0
    buffer_store_dwordx4 v[192:195], v2, s[28:31], s41 offen offset:3072 sc1
    v_mfma_f32_16x16x32_bf16 v[140:143], v[116:119], v[200:203], v[140:143]
    ds_read_b64_tr_b16 v[224:225], v235 offset:28672
    v_mfma_f32_16x16x32_bf16 v[144:147], v[120:123], v[200:203], v[144:147]
    ds_read_b64_tr_b16 v[226:227], v235 offset:29184
    s_waitcnt lgkmcnt(8)
    v_mfma_f32_16x16x32_bf16 v[148:151], v[116:119], v[204:207], v[148:151]
    ds_read_b64_tr_b16 v[196:197], v232 offset:32768
    v_mfma_f32_16x16x32_bf16 v[152:155], v[120:123], v[204:207], v[152:155]
    ds_read_b64_tr_b16 v[198:199], v232 offset:33280
    v_mfma_f32_16x16x32_bf16 v[156:159], v[116:119], v[208:211], v[156:159]
    ds_read_b64_tr_b16 v[200:201], v233 offset:32768
    v_mfma_f32_16x16x32_bf16 v[160:163], v[120:123], v[208:211], v[160:163]
    ds_read_b64_tr_b16 v[202:203], v233 offset:33280
    s_waitcnt lgkmcnt(8)
    v_mfma_f32_16x16x32_bf16 v[132:135], v[124:127], v[212:215], v[132:135]
    ds_read_b64_tr_b16 v[204:205], v234 offset:32768
    v_mfma_f32_16x16x32_bf16 v[136:139], v[128:131], v[212:215], v[136:139]
    ds_read_b64_tr_b16 v[206:207], v234 offset:33280
    v_mfma_f32_16x16x32_bf16 v[140:143], v[124:127], v[216:219], v[140:143]
    ds_read_b64_tr_b16 v[208:209], v235 offset:32768
    v_mfma_f32_16x16x32_bf16 v[144:147], v[128:131], v[216:219], v[144:147]
    ds_read_b64_tr_b16 v[210:211], v235 offset:33280
    s_waitcnt lgkmcnt(8)
    v_mfma_f32_16x16x32_bf16 v[148:151], v[124:127], v[220:223], v[148:151]
    ds_read_b64_tr_b16 v[212:213], v232 offset:36864
    v_mfma_f32_16x16x32_bf16 v[152:155], v[128:131], v[220:223], v[152:155]
    ds_read_b64_tr_b16 v[214:215], v232 offset:37376
    v_mfma_f32_16x16x32_bf16 v[156:159], v[124:127], v[224:227], v[156:159]
    ds_read_b64_tr_b16 v[216:217], v233 offset:36864
    v_mfma_f32_16x16x32_bf16 v[160:163], v[128:131], v[224:227], v[160:163]
    ds_read_b64_tr_b16 v[218:219], v233 offset:37376
    s_waitcnt vmcnt(13)
    s_nop 3
    v_cvt_pk_bf16_f32 v180, v132, v133
    v_cvt_pk_bf16_f32 v181, v134, v135
    v_cvt_pk_bf16_f32 v182, v136, v137
    v_cvt_pk_bf16_f32 v183, v138, v139
    v_cvt_pk_bf16_f32 v184, v140, v141
    v_cvt_pk_bf16_f32 v185, v142, v143
    v_cvt_pk_bf16_f32 v186, v144, v145
    v_cvt_pk_bf16_f32 v187, v146, v147
    v_cvt_pk_bf16_f32 v188, v148, v149
    v_cvt_pk_bf16_f32 v189, v150, v151
    v_cvt_pk_bf16_f32 v190, v152, v153
    v_cvt_pk_bf16_f32 v191, v154, v155
    v_cvt_pk_bf16_f32 v192, v156, v157
    v_cvt_pk_bf16_f32 v193, v158, v159
    v_cvt_pk_bf16_f32 v194, v160, v161
    v_cvt_pk_bf16_f32 v195, v162, v163
    s_barrier
    s_waitcnt lgkmcnt(8)
    v_mfma_f32_16x16x32_bf16 v[132:135], v[4:7], v[196:199], 0
    ds_read_b64_tr_b16 v[220:221], v234 offset:36864
    v_mfma_f32_16x16x32_bf16 v[136:139], v[8:11], v[196:199], 0
    ds_read_b64_tr_b16 v[222:223], v234 offset:37376
    s_add_u32 m0, s36, 0
    s_add_u32 s35, s44, 0
    buffer_load_dwordx4 v228, s[24:27], s35 offen offset:0 lds
    v_mfma_f32_16x16x32_bf16 v[140:143], v[4:7], v[200:203], 0
    ds_read_b64_tr_b16 v[224:225], v235 offset:36864
    v_mfma_f32_16x16x32_bf16 v[144:147], v[8:11], v[200:203], 0
    ds_read_b64_tr_b16 v[226:227], v235 offset:37376
    buffer_load_dwordx4 v229, s[24:27], s35 offen offset:1024 lds
    s_waitcnt lgkmcnt(8)
    v_mfma_f32_16x16x32_bf16 v[148:151], v[4:7], v[204:207], 0
    ds_read_b64_tr_b16 v[196:197], v232 offset:40960
    v_mfma_f32_16x16x32_bf16 v[152:155], v[8:11], v[204:207], 0
    ds_read_b64_tr_b16 v[198:199], v232 offset:41472
    buffer_load_dwordx4 v230, s[24:27], s35 offen offset:2048 lds
    v_mfma_f32_16x16x32_bf16 v[156:159], v[4:7], v[208:211], 0
    ds_read_b64_tr_b16 v[200:201], v233 offset:40960
    v_mfma_f32_16x16x32_bf16 v[160:163], v[8:11], v[208:211], 0
    ds_read_b64_tr_b16 v[202:203], v233 offset:41472
    buffer_load_dwordx4 v231, s[24:27], s35 offen offset:3072 lds
    s_waitcnt lgkmcnt(8)
    v_mfma_f32_16x16x32_bf16 v[132:135], v[12:15], v[212:215], v[132:135]
    ds_read_b64_tr_b16 v[204:205], v234 offset:40960
    s_lshr_b32 s39, s2, 5
    v_mfma_f32_16x16x32_bf16 v[136:139], v[16:19], v[212:215], v[136:139]
    ds_read_b64_tr_b16 v[206:207], v234 offset:41472
    s_sub_u32 s40, 15, s39
    v_mfma_f32_16x16x32_bf16 v[140:143], v[12:15], v[216:219], v[140:143]
    ds_read_b64_tr_b16 v[208:209], v235 offset:40960
    s_cmp_lt_u32 s32, 4
    s_cselect_b32 s39, s40, s39
    v_mfma_f32_16x16x32_bf16 v[144:147], v[16:19], v[216:219], v[144:147]
    ds_read_b64_tr_b16 v[210:211], v235 offset:41472
    s_lshl_b32 s39, s39, 2
    s_waitcnt lgkmcnt(8)
    v_mfma_f32_16x16x32_bf16 v[148:151], v[12:15], v[220:223], v[148:151]
    ds_read_b64_tr_b16 v[212:213], v232 offset:45056
    s_and_b32 s40, s32, 3
    v_mfma_f32_16x16x32_bf16 v[152:155], v[16:19], v[220:223], v[152:155]
    ds_read_b64_tr_b16 v[214:215], v232 offset:45568
    s_add_u32 s43, s39, s40
    v_mfma_f32_16x16x32_bf16 v[156:159], v[12:15], v[224:227], v[156:159]
    ds_read_b64_tr_b16 v[216:217], v233 offset:45056
    v_and_b32 v252, 1, v1
    v_mfma_f32_16x16x32_bf16 v[160:163], v[16:19], v[224:227], v[160:163]
    ds_read_b64_tr_b16 v[218:219], v233 offset:45568
    s_lshl_b32 s39, s43, 2
    v_mul_u32_u24 v252, s39, v252
    s_waitcnt lgkmcnt(8)
    v_mfma_f32_16x16x32_bf16 v[132:135], v[20:23], v[196:199], v[132:135]
    ds_read_b64_tr_b16 v[220:221], v234 offset:45056
    s_lshl_b32 s43, s43, 15
    v_mfma_f32_16x16x32_bf16 v[136:139], v[24:27], v[196:199], v[136:139]
    ds_read_b64_tr_b16 v[222:223], v234 offset:45568
    buffer_load_dword v254, v252, s[52:55], 0 offen sc0 sc1
    v_mfma_f32_16x16x32_bf16 v[140:143], v[20:23], v[200:203], v[140:143]
    ds_read_b64_tr_b16 v[224:225], v235 offset:45056
    v_mfma_f32_16x16x32_bf16 v[144:147], v[24:27], v[200:203], v[144:147]
    ds_read_b64_tr_b16 v[226:227], v235 offset:45568
    s_waitcnt lgkmcnt(8)
    v_mfma_f32_16x16x32_bf16 v[148:151], v[20:23], v[204:207], v[148:151]
    ds_read_b64_tr_b16 v[196:197], v232 offset:49152
    v_mfma_f32_16x16x32_bf16 v[152:155], v[24:27], v[204:207], v[152:155]
    ds_read_b64_tr_b16 v[198:199], v232 offset:49664
    s_add_u32 s41, s37, 4096
    buffer_store_dwordx4 v[164:167], v2, s[28:31], s41 offen offset:0 sc1
    v_mfma_f32_16x16x32_bf16 v[156:159], v[20:23], v[208:211], v[156:159]
    ds_read_b64_tr_b16 v[200:201], v233 offset:49152
    v_mfma_f32_16x16x32_bf16 v[160:163], v[24:27], v[208:211], v[160:163]
    ds_read_b64_tr_b16 v[202:203], v233 offset:49664
    s_waitcnt lgkmcnt(8)
    v_mfma_f32_16x16x32_bf16 v[132:135], v[28:31], v[212:215], v[132:135]
    ds_read_b64_tr_b16 v[204:205], v234 offset:49152
    v_mfma_f32_16x16x32_bf16 v[136:139], v[32:35], v[212:215], v[136:139]
    ds_read_b64_tr_b16 v[206:207], v234 offset:49664
    v_mfma_f32_16x16x32_bf16 v[140:143], v[28:31], v[216:219], v[140:143]
    ds_read_b64_tr_b16 v[208:209], v235 offset:49152
    v_mfma_f32_16x16x32_bf16 v[144:147], v[32:35], v[216:219], v[144:147]
    ds_read_b64_tr_b16 v[210:211], v235 offset:49664
    s_waitcnt lgkmcnt(8)
    v_mfma_f32_16x16x32_bf16 v[148:151], v[28:31], v[220:223], v[148:151]
    ds_read_b64_tr_b16 v[212:213], v232 offset:53248
    v_mfma_f32_16x16x32_bf16 v[152:155], v[32:35], v[220:223], v[152:155]
    ds_read_b64_tr_b16 v[214:215], v232 offset:53760
    v_mfma_f32_16x16x32_bf16 v[156:159], v[28:31], v[224:227], v[156:159]
    ds_read_b64_tr_b16 v[216:217], v233 offset:53248
    v_mfma_f32_16x16x32_bf16 v[160:163], v[32:35], v[224:227], v[160:163]
    ds_read_b64_tr_b16 v[218:219], v233 offset:53760
    s_waitcnt lgkmcnt(8)
    v_mfma_f32_16x16x32_bf16 v[132:135], v[36:39], v[196:199], v[132:135]
    ds_read_b64_tr_b16 v[220:221], v234 offset:53248
    v_mfma_f32_16x16x32_bf16 v[136:139], v[40:43], v[196:199], v[136:139]
    ds_read_b64_tr_b16 v[222:223], v234 offset:53760
    v_mfma_f32_16x16x32_bf16 v[140:143], v[36:39], v[200:203], v[140:143]
    ds_read_b64_tr_b16 v[224:225], v235 offset:53248
    v_mfma_f32_16x16x32_bf16 v[144:147], v[40:43], v[200:203], v[144:147]
    ds_read_b64_tr_b16 v[226:227], v235 offset:53760
    s_waitcnt lgkmcnt(8)
    v_mfma_f32_16x16x32_bf16 v[148:151], v[36:39], v[204:207], v[148:151]
    ds_read_b64_tr_b16 v[196:197], v232 offset:57344
    v_mfma_f32_16x16x32_bf16 v[152:155], v[40:43], v[204:207], v[152:155]
    ds_read_b64_tr_b16 v[198:199], v232 offset:57856
    v_mfma_f32_16x16x32_bf16 v[156:159], v[36:39], v[208:211], v[156:159]
    ds_read_b64_tr_b16 v[200:201], v233 offset:57344
    v_mfma_f32_16x16x32_bf16 v[160:163], v[40:43], v[208:211], v[160:163]
    ds_read_b64_tr_b16 v[202:203], v233 offset:57856
    s_waitcnt lgkmcnt(8)
    v_mfma_f32_16x16x32_bf16 v[132:135], v[44:47], v[212:215], v[132:135]
    ds_read_b64_tr_b16 v[204:205], v234 offset:57344
    v_mfma_f32_16x16x32_bf16 v[136:139], v[48:51], v[212:215], v[136:139]
    ds_read_b64_tr_b16 v[206:207], v234 offset:57856
    v_mfma_f32_16x16x32_bf16 v[140:143], v[44:47], v[216:219], v[140:143]
    ds_read_b64_tr_b16 v[208:209], v235 offset:57344
    v_mfma_f32_16x16x32_bf16 v[144:147], v[48:51], v[216:219], v[144:147]
    ds_read_b64_tr_b16 v[210:211], v235 offset:57856
    s_waitcnt lgkmcnt(8)
    v_mfma_f32_16x16x32_bf16 v[148:151], v[44:47], v[220:223], v[148:151]
    ds_read_b64_tr_b16 v[212:213], v232 offset:61440
    v_mfma_f32_16x16x32_bf16 v[152:155], v[48:51], v[220:223], v[152:155]
    ds_read_b64_tr_b16 v[214:215], v232 offset:61952
    v_mfma_f32_16x16x32_bf16 v[156:159], v[44:47], v[224:227], v[156:159]
    ds_read_b64_tr_b16 v[216:217], v233 offset:61440
    v_mfma_f32_16x16x32_bf16 v[160:163], v[48:51], v[224:227], v[160:163]
    ds_read_b64_tr_b16 v[218:219], v233 offset:61952
    s_waitcnt lgkmcnt(8)
    v_mfma_f32_16x16x32_bf16 v[132:135], v[52:55], v[196:199], v[132:135]
    ds_read_b64_tr_b16 v[220:221], v234 offset:61440
    v_mfma_f32_16x16x32_bf16 v[136:139], v[56:59], v[196:199], v[136:139]
    ds_read_b64_tr_b16 v[222:223], v234 offset:61952
    s_add_u32 s41, s37, 4096
    buffer_store_dwordx4 v[168:171], v2, s[28:31], s41 offen offset:1024 sc1
    v_mfma_f32_16x16x32_bf16 v[140:143], v[52:55], v[200:203], v[140:143]
    ds_read_b64_tr_b16 v[224:225], v235 offset:61440
    v_mfma_f32_16x16x32_bf16 v[144:147], v[56:59], v[200:203], v[144:147]
    ds_read_b64_tr_b16 v[226:227], v235 offset:61952
    s_waitcnt lgkmcnt(8)
    v_mfma_f32_16x16x32_bf16 v[148:151], v[52:55], v[204:207], v[148:151]
    ds_read_b64_tr_b16 v[196:197], v244 offset:0
    v_mfma_f32_16x16x32_bf16 v[152:155], v[56:59], v[204:207], v[152:155]
    ds_read_b64_tr_b16 v[198:199], v244 offset:512
    v_mfma_f32_16x16x32_bf16 v[156:159], v[52:55], v[208:211], v[156:159]
    ds_read_b64_tr_b16 v[200:201], v245 offset:0
    v_mfma_f32_16x16x32_bf16 v[160:163], v[56:59], v[208:211], v[160:163]
    ds_read_b64_tr_b16 v[202:203], v245 offset:512
    s_waitcnt lgkmcnt(8)
    v_mfma_f32_16x16x32_bf16 v[132:135], v[60:63], v[212:215], v[132:135]
    ds_read_b64_tr_b16 v[204:205], v246 offset:0
    v_mfma_f32_16x16x32_bf16 v[136:139], v[64:67], v[212:215], v[136:139]
    ds_read_b64_tr_b16 v[206:207], v246 offset:512
    v_mfma_f32_16x16x32_bf16 v[140:143], v[60:63], v[216:219], v[140:143]
    ds_read_b64_tr_b16 v[208:209], v247 offset:0
    v_mfma_f32_16x16x32_bf16 v[144:147], v[64:67], v[216:219], v[144:147]
    ds_read_b64_tr_b16 v[210:211], v247 offset:512
    s_waitcnt lgkmcnt(8)
    v_mfma_f32_16x16x32_bf16 v[148:151], v[60:63], v[220:223], v[148:151]
    ds_read_b64_tr_b16 v[212:213], v244 offset:4096
    v_mfma_f32_16x16x32_bf16 v[152:155], v[64:67], v[220:223], v[152:155]
    ds_read_b64_tr_b16 v[214:215], v244 offset:4608
    v_mfma_f32_16x16x32_bf16 v[156:159], v[60:63], v[224:227], v[156:159]
    ds_read_b64_tr_b16 v[216:217], v245 offset:4096
    v_mfma_f32_16x16x32_bf16 v[160:163], v[64:67], v[224:227], v[160:163]
    ds_read_b64_tr_b16 v[218:219], v245 offset:4608
    s_barrier
    s_waitcnt lgkmcnt(8)
    v_mfma_f32_16x16x32_bf16 v[132:135], v[68:71], v[196:199], v[132:135]
    ds_read_b64_tr_b16 v[220:221], v246 offset:4096
    v_mfma_f32_16x16x32_bf16 v[136:139], v[72:75], v[196:199], v[136:139]
    ds_read_b64_tr_b16 v[222:223], v246 offset:4608
    s_add_u32 m0, s36, 32768
    s_add_u32 s35, s44, 128
    buffer_load_dwordx4 v228, s[24:27], s35 offen offset:0 lds
    v_mfma_f32_16x16x32_bf16 v[140:143], v[68:71], v[200:203], v[140:143]
    ds_read_b64_tr_b16 v[224:225], v247 offset:4096
    v_mfma_f32_16x16x32_bf16 v[144:147], v[72:75], v[200:203], v[144:147]
    ds_read_b64_tr_b16 v[226:227], v247 offset:4608
    buffer_load_dwordx4 v229, s[24:27], s35 offen offset:1024 lds
    s_waitcnt lgkmcnt(8)
    v_mfma_f32_16x16x32_bf16 v[148:151], v[68:71], v[204:207], v[148:151]
    ds_read_b64_tr_b16 v[196:197], v244 offset:8192
    v_mfma_f32_16x16x32_bf16 v[152:155], v[72:75], v[204:207], v[152:155]
    ds_read_b64_tr_b16 v[198:199], v244 offset:8704
    buffer_load_dwordx4 v230, s[24:27], s35 offen offset:2048 lds
    v_mfma_f32_16x16x32_bf16 v[156:159], v[68:71], v[208:211], v[156:159]
    ds_read_b64_tr_b16 v[200:201], v245 offset:8192
    v_mfma_f32_16x16x32_bf16 v[160:163], v[72:75], v[208:211], v[160:163]
    ds_read_b64_tr_b16 v[202:203], v245 offset:8704
    buffer_load_dwordx4 v231, s[24:27], s35 offen offset:3072 lds
    s_waitcnt lgkmcnt(8)
    v_mfma_f32_16x16x32_bf16 v[132:135], v[76:79], v[212:215], v[132:135]
    ds_read_b64_tr_b16 v[204:205], v246 offset:8192
    v_mfma_f32_16x16x32_bf16 v[136:139], v[80:83], v[212:215], v[136:139]
    ds_read_b64_tr_b16 v[206:207], v246 offset:8704
    v_mfma_f32_16x16x32_bf16 v[140:143], v[76:79], v[216:219], v[140:143]
    ds_read_b64_tr_b16 v[208:209], v247 offset:8192
    v_mfma_f32_16x16x32_bf16 v[144:147], v[80:83], v[216:219], v[144:147]
    ds_read_b64_tr_b16 v[210:211], v247 offset:8704
    s_waitcnt lgkmcnt(8)
    v_mfma_f32_16x16x32_bf16 v[148:151], v[76:79], v[220:223], v[148:151]
    ds_read_b64_tr_b16 v[212:213], v244 offset:12288
    v_mfma_f32_16x16x32_bf16 v[152:155], v[80:83], v[220:223], v[152:155]
    ds_read_b64_tr_b16 v[214:215], v244 offset:12800
    v_mfma_f32_16x16x32_bf16 v[156:159], v[76:79], v[224:227], v[156:159]
    ds_read_b64_tr_b16 v[216:217], v245 offset:12288
    v_mfma_f32_16x16x32_bf16 v[160:163], v[80:83], v[224:227], v[160:163]
    ds_read_b64_tr_b16 v[218:219], v245 offset:12800
    s_waitcnt lgkmcnt(8)
    v_mfma_f32_16x16x32_bf16 v[132:135], v[84:87], v[196:199], v[132:135]
    ds_read_b64_tr_b16 v[220:221], v246 offset:12288
    v_mfma_f32_16x16x32_bf16 v[136:139], v[88:91], v[196:199], v[136:139]
    ds_read_b64_tr_b16 v[222:223], v246 offset:12800
    v_mfma_f32_16x16x32_bf16 v[140:143], v[84:87], v[200:203], v[140:143]
    ds_read_b64_tr_b16 v[224:225], v247 offset:12288
    v_mfma_f32_16x16x32_bf16 v[144:147], v[88:91], v[200:203], v[144:147]
    ds_read_b64_tr_b16 v[226:227], v247 offset:12800
    s_waitcnt lgkmcnt(8)
    v_mfma_f32_16x16x32_bf16 v[148:151], v[84:87], v[204:207], v[148:151]
    ds_read_b64_tr_b16 v[196:197], v244 offset:16384
    v_mfma_f32_16x16x32_bf16 v[152:155], v[88:91], v[204:207], v[152:155]
    ds_read_b64_tr_b16 v[198:199], v244 offset:16896
    s_add_u32 s41, s37, 4096
    buffer_store_dwordx4 v[172:175], v2, s[28:31], s41 offen offset:2048 sc1
    v_mfma_f32_16x16x32_bf16 v[156:159], v[84:87], v[208:211], v[156:159]
    ds_read_b64_tr_b16 v[200:201], v245 offset:16384
    v_mfma_f32_16x16x32_bf16 v[160:163], v[88:91], v[208:211], v[160:163]
    ds_read_b64_tr_b16 v[202:203], v245 offset:16896
    s_waitcnt lgkmcnt(8)
    v_mfma_f32_16x16x32_bf16 v[132:135], v[92:95], v[212:215], v[132:135]
    ds_read_b64_tr_b16 v[204:205], v246 offset:16384
    v_mfma_f32_16x16x32_bf16 v[136:139], v[96:99], v[212:215], v[136:139]
    ds_read_b64_tr_b16 v[206:207], v246 offset:16896
    v_mfma_f32_16x16x32_bf16 v[140:143], v[92:95], v[216:219], v[140:143]
    ds_read_b64_tr_b16 v[208:209], v247 offset:16384
    v_mfma_f32_16x16x32_bf16 v[144:147], v[96:99], v[216:219], v[144:147]
    ds_read_b64_tr_b16 v[210:211], v247 offset:16896
    s_waitcnt vmcnt(7)
    s_mov_b32 s40, 0x200000
L_k1xn_5:
    v_cmp_gt_u32 vcc, 4, v254
    s_cbranch_vccz L_k1xnok_6
    s_sleep 8
    buffer_load_dword v254, v252, s[52:55], 0 offen sc0 sc1
    s_waitcnt vmcnt(0)
    s_sub_u32 s40, s40, 1
    s_cmp_lg_u32 s40, 0
    s_cbranch_scc1 L_k1xn_5
L_k1xnok_6:
    s_add_u32 s40, s43, 4096
    buffer_load_dwordx4 v[4:7], v2, s[56:59], s43 offen offset:0 sc1
    buffer_load_dwordx4 v[8:11], v2, s[56:59], s43 offen offset:1024 sc1
    buffer_load_dwordx4 v[12:15], v2, s[56:59], s43 offen offset:2048 sc1
    buffer_load_dwordx4 v[16:19], v2, s[56:59], s43 offen offset:3072 sc1
    buffer_load_dwordx4 v[20:23], v2, s[56:59], s40 offen offset:0 sc1
    buffer_load_dwordx4 v[24:27], v2, s[56:59], s40 offen offset:1024 sc1
    s_waitcnt lgkmcnt(8)
    v_mfma_f32_16x16x32_bf16 v[148:151], v[92:95], v[220:223], v[148:151]
    ds_read_b64_tr_b16 v[212:213], v244 offset:20480
    v_mfma_f32_16x16x32_bf16 v[152:155], v[96:99], v[220:223], v[152:155]
    ds_read_b64_tr_b16 v[214:215], v244 offset:20992
    v_mfma_f32_16x16x32_bf16 v[156:159], v[92:95], v[224:227], v[156:159]
    ds_read_b64_tr_b16 v[216:217], v245 offset:20480
    v_mfma_f32_16x16x32_bf16 v[160:163], v[96:99], v[224:227], v[160:163]
    ds_read_b64_tr_b16 v[218:219], v245 offset:20992
    s_waitcnt lgkmcnt(8)
    v_mfma_f32_16x16x32_bf16 v[132:135], v[100:103], v[196:199], v[132:135]
    ds_read_b64_tr_b16 v[220:221], v246 offset:20480
    v_mfma_f32_16x16x32_bf16 v[136:139], v[104:107], v[196:199], v[136:139]
    ds_read_b64_tr_b16 v[222:223], v246 offset:20992
    v_mfma_f32_16x16x32_bf16 v[140:143], v[100:103], v[200:203], v[140:143]
    ds_read_b64_tr_b16 v[224:225], v247 offset:20480
    v_mfma_f32_16x16x32_bf16 v[144:147], v[104:107], v[200:203], v[144:147]
    ds_read_b64_tr_b16 v[226:227], v247 offset:20992
    s_waitcnt lgkmcnt(8)
    v_mfma_f32_16x16x32_bf16 v[148:151], v[100:103], v[204:207], v[148:151]
    ds_read_b64_tr_b16 v[196:197], v244 offset:24576
    v_mfma_f32_16x16x32_bf16 v[152:155], v[104:107], v[204:207], v[152:155]
    ds_read_b64_tr_b16 v[198:199], v244 offset:25088
    v_mfma_f32_16x16x32_bf16 v[156:159], v[100:103], v[208:211], v[156:159]
    ds_read_b64_tr_b16 v[200:201], v245 offset:24576
    v_mfma_f32_16x16x32_bf16 v[160:163], v[104:107], v[208:211], v[160:163]
    ds_read_b64_tr_b16 v[202:203], v245 offset:25088
    s_waitcnt lgkmcnt(8)
    v_mfma_f32_16x16x32_bf16 v[132:135], v[108:111], v[212:215], v[132:135]
    ds_read_b64_tr_b16 v[204:205], v246 offset:24576
    v_mfma_f32_16x16x32_bf16 v[136:139], v[112:115], v[212:215], v[136:139]
    ds_read_b64_tr_b16 v[206:207], v246 offset:25088
    v_mfma_f32_16x16x32_bf16 v[140:143], v[108:111], v[216:219], v[140:143]
    ds_read_b64_tr_b16 v[208:209], v247 offset:24576
    v_mfma_f32_16x16x32_bf16 v[144:147], v[112:115], v[216:219], v[144:147]
    ds_read_b64_tr_b16 v[210:211], v247 offset:25088
    s_waitcnt lgkmcnt(8)
    v_mfma_f32_16x16x32_bf16 v[148:151], v[108:111], v[220:223], v[148:151]
    ds_read_b64_tr_b16 v[212:213], v244 offset:28672
    v_mfma_f32_16x16x32_bf16 v[152:155], v[112:115], v[220:223], v[152:155]
    ds_read_b64_tr_b16 v[214:215], v244 offset:29184
    v_mfma_f32_16x16x32_bf16 v[156:159], v[108:111], v[224:227], v[156:159]
    ds_read_b64_tr_b16 v[216:217], v245 offset:28672
    v_mfma_f32_16x16x32_bf16 v[160:163], v[112:115], v[224:227], v[160:163]
    ds_read_b64_tr_b16 v[218:219], v245 offset:29184
    s_waitcnt lgkmcnt(8)
    v_mfma_f32_16x16x32_bf16 v[132:135], v[116:119], v[196:199], v[132:135]
    ds_read_b64_tr_b16 v[220:221], v246 offset:28672
    v_mfma_f32_16x16x32_bf16 v[136:139], v[120:123], v[196:199], v[136:139]
    ds_read_b64_tr_b16 v[222:223], v246 offset:29184
    s_add_u32 s41, s37, 4096
    buffer_store_dwordx4 v[176:179], v2, s[28:31], s41 offen offset:3072 sc1
    v_mfma_f32_16x16x32_bf16 v[140:143], v[116:119], v[200:203], v[140:143]
    ds_read_b64_tr_b16 v[224:225], v247 offset:28672
    v_mfma_f32_16x16x32_bf16 v[144:147], v[120:123], v[200:203], v[144:147]
    ds_read_b64_tr_b16 v[226:227], v247 offset:29184
    s_waitcnt lgkmcnt(8)
    v_mfma_f32_16x16x32_bf16 v[148:151], v[116:119], v[204:207], v[148:151]
    v_mfma_f32_16x16x32_bf16 v[152:155], v[120:123], v[204:207], v[152:155]
    v_mfma_f32_16x16x32_bf16 v[156:159], v[116:119], v[208:211], v[156:159]
    v_mfma_f32_16x16x32_bf16 v[160:163], v[120:123], v[208:211], v[160:163]
    s_waitcnt lgkmcnt(4)
    v_mfma_f32_16x16x32_bf16 v[132:135], v[124:127], v[212:215], v[132:135]
    v_mfma_f32_16x16x32_bf16 v[136:139], v[128:131], v[212:215], v[136:139]
    v_mfma_f32_16x16x32_bf16 v[140:143], v[124:127], v[216:219], v[140:143]
    v_mfma_f32_16x16x32_bf16 v[144:147], v[128:131], v[216:219], v[144:147]
    s_waitcnt lgkmcnt(0)
    v_mfma_f32_16x16x32_bf16 v[148:151], v[124:127], v[220:223], v[148:151]
    v_mfma_f32_16x16x32_bf16 v[152:155], v[128:131], v[220:223], v[152:155]
    v_mfma_f32_16x16x32_bf16 v[156:159], v[124:127], v[224:227], v[156:159]
    v_mfma_f32_16x16x32_bf16 v[160:163], v[128:131], v[224:227], v[160:163]
    s_bfe_u32 s52, s34, 0x30001
    s_mov_b32 s53, s45
    s_add_u32 s57, s37, 16777216
    v_cvt_pk_bf16_f32 v132, v132, v133
    v_cvt_pk_bf16_f32 v133, v134, v135
    v_cvt_pk_bf16_f32 v134, v136, v137
    v_cvt_pk_bf16_f32 v135, v138, v139
    v_cvt_pk_bf16_f32 v136, v140, v141
    v_cvt_pk_bf16_f32 v137, v142, v143
    v_cvt_pk_bf16_f32 v138, v144, v145
    v_cvt_pk_bf16_f32 v139, v146, v147
    v_cvt_pk_bf16_f32 v140, v148, v149
    v_cvt_pk_bf16_f32 v141, v150, v151
    v_cvt_pk_bf16_f32 v142, v152, v153
    v_cvt_pk_bf16_f32 v143, v154, v155
    v_cvt_pk_bf16_f32 v144, v156, v157
    v_cvt_pk_bf16_f32 v145, v158, v159
    v_cvt_pk_bf16_f32 v146, v160, v161
    v_cvt_pk_bf16_f32 v147, v162, v163
    v_mov_b32 v148, v180
    v_mov_b32 v149, v181
    v_mov_b32 v150, v182
    v_mov_b32 v151, v183
    v_mov_b32 v152, v184
    v_mov_b32 v153, v185
    v_mov_b32 v154, v186
    v_mov_b32 v155, v187
    v_mov_b32 v156, v188
    v_mov_b32 v157, v189
    v_mov_b32 v158, v190
    v_mov_b32 v159, v191
    v_mov_b32 v160, v192
    v_mov_b32 v161, v193
    v_mov_b32 v162, v194
    v_mov_b32 v163, v195
    s_branch L_k2_entry
L_k1_exit:
    s_endpgm
L_k2_entry:
    s_mov_b64 s[4:5], s[18:19]
    v_lshrrev_b32 v248, 6, v0
    v_and_b32 v246, 63, v0
    v_readfirstlane_b32 s28, v248
    v_lshlrev_b32 v243, 4, v246
    s_and_b32 s38, s2, 7
    s_lshl_b32 s38, s38, 2
    s_bfe_u32 s39, s2, 0x20003
    s_add_u32 s29, s38, s39
    s_lshr_b32 s38, s2, 5
    s_sub_u32 s39, 15, s38
    s_lshl_b32 s33, s39, 1
    s_add_u32 s33, s33, 2
    s_and_b32 s43, s28, 3
    s_lshr_b32 s42, s28, 2
    s_cmp_eq_u32 s42, 0
    s_cselect_b32 s30, s39, s38
    s_lshl_b32 s46, s30, 2
    s_add_u32 s46, s46, s43
    s_lshl_b32 s40, s29, 19
    s_lshl_b32 s36, s43, 12
    s_add_u32 s34, s40, s36
    s_mov_b32 s32, 0
    s_mov_b32 s51, 0
    s_lshl_b32 s40, s46, 15
    s_lshl_b32 s37, s28, 12
    s_lshl_b32 s47, s29, 8
    s_mov_b32 s10, 33554432
    s_mov_b32 s11, 0x20000
    s_mov_b32 s14, 2097152
    s_mov_b32 s15, 0x20000
    s_mov_b32 s12, s4
    s_mov_b32 s13, s5
    s_add_u32 s8, s4, 16777216
    s_addc_u32 s9, s5, 0
    s_add_u32 s45, s33, 4
    s_add_u32 s41, s40, 4096
    v_and_b32 v232, 0xffff, v232
    v_and_b32 v233, 0xffff, v233
    v_and_b32 v234, 0xffff, v234
    v_and_b32 v235, 0xffff, v235
    s_add_u32 s16, s4, 92276736
    s_addc_u32 s17, s5, 0
    s_mov_b32 s18, 2048
    s_mov_b32 s19, 0x20000
    s_add_u32 s20, s4, 67108864
    s_addc_u32 s21, s5, 0
    s_mov_b32 s22, 7340032
    s_mov_b32 s23, 0x20000
    s_mov_b32 s31, s46
    v_mov_b32 v241, v243
    v_add_u32 v242, 65536, v243
    s_mov_b32 s3, 65536
    v_and_b32 v244, 15, v246
    v_lshrrev_b32 v248, 4, v246
    v_lshlrev_b32 v248, 2, v248
    v_sub_u32 v244, v244, v248
    v_mov_b32 v245, 0xf149f2ca
    v_lshlrev_b32 v3, 7, v248
    v_and_b32 v248, 15, v246
    v_lshl_add_u32 v3, v248, 4, v3
    s_mul_i32 s44, s46, 114688
    s_lshl_b32 s38, s29, 12
    s_add_u32 s44, s44, s38
    s_cmp_lt_u32 s29, 28
    s_cselect_b32 s44, s44, 2147483648
    s_mov_b32 s55, 0xbdd2d3e8
    v_mov_b32 v252, 0xc0135761
    s_cmp_eq_u32 s42, 0
    s_cbranch_scc0 L_k2_B
L_k2_A:
    s_waitcnt vmcnt(5) lgkmcnt(0)
    s_barrier
    v_add_u32 v220, 0x10000, v232
    v_add_u32 v224, 0x20000, v232
    v_add_u32 v221, 0x10000, v233
    v_add_u32 v225, 0x20000, v233
    v_add_u32 v222, 0x10000, v234
    v_add_u32 v226, 0x20000, v234
    v_add_u32 v223, 0x10000, v235
    v_add_u32 v227, 0x20000, v235
    ds_read_b64_tr_b16 v[164:165], v232 offset:0
    ds_read_b64_tr_b16 v[166:167], v232 offset:512
    ds_read_b64_tr_b16 v[168:169], v233 offset:0
    ds_read_b64_tr_b16 v[170:171], v233 offset:512
    ds_read_b64_tr_b16 v[172:173], v234 offset:0
    ds_read_b64_tr_b16 v[174:175], v234 offset:512
    ds_read_b64_tr_b16 v[176:177], v235 offset:0
    ds_read_b64_tr_b16 v[178:179], v235 offset:512
    ds_read_b64_tr_b16 v[180:181], v232 offset:32768
    ds_read_b64_tr_b16 v[182:183], v232 offset:33280
    ds_read_b64_tr_b16 v[184:185], v233 offset:32768
    ds_read_b64_tr_b16 v[186:187], v233 offset:33280
    s_waitcnt vmcnt(5)
    s_waitcnt lgkmcnt(8)
    v_mfma_f32_16x16x32_bf16 v[36:39], v[164:167], v[4:7], 0
    ds_read_b64_tr_b16 v[188:189], v234 offset:32768
    v_mfma_f32_16x16x32_bf16 v[44:47], v[164:167], v[8:11], 0
    ds_read_b64_tr_b16 v[190:191], v234 offset:33280
    s_add_u32 s41, s40, 4096
    buffer_load_dwordx4 v[28:31], v243, s[12:15], s41 offen offset:2048 sc1
    v_mfma_f32_16x16x32_bf16 v[40:43], v[168:171], v[4:7], 0
    ds_read_b64_tr_b16 v[192:193], v235 offset:32768
    v_mfma_f32_16x16x32_bf16 v[48:51], v[168:171], v[8:11], 0
    ds_read_b64_tr_b16 v[194:195], v235 offset:33280
    buffer_load_dwordx4 v[32:35], v243, s[12:15], s41 offen offset:3072 sc1
    s_waitcnt lgkmcnt(8)
    v_mfma_f32_16x16x32_bf16 v[52:55], v[172:175], v[4:7], 0
    ds_read_b64_tr_b16 v[164:165], v220 offset:0
    v_mfma_f32_16x16x32_bf16 v[60:63], v[172:175], v[8:11], 0
    ds_read_b64_tr_b16 v[166:167], v220 offset:512
    s_add_u32 m0, s37, 98304
    s_add_u32 s48, s47, 2097152
    buffer_load_dwordx4 v228, s[24:27], s48 offen offset:0 lds
    v_mfma_f32_16x16x32_bf16 v[56:59], v[176:179], v[4:7], 0
    ds_read_b64_tr_b16 v[168:169], v221 offset:0
    v_mfma_f32_16x16x32_bf16 v[64:67], v[176:179], v[8:11], 0
    ds_read_b64_tr_b16 v[170:171], v221 offset:512
    buffer_load_dwordx4 v229, s[24:27], s48 offen offset:1024 lds
    s_waitcnt lgkmcnt(8)
    v_mfma_f32_16x16x32_bf16 v[68:71], v[180:183], v[4:7], 0
    ds_read_b64_tr_b16 v[172:173], v222 offset:0
    v_mfma_f32_16x16x32_bf16 v[76:79], v[180:183], v[8:11], 0
    ds_read_b64_tr_b16 v[174:175], v222 offset:512
    buffer_load_dwordx4 v230, s[24:27], s48 offen offset:2048 lds
    v_mfma_f32_16x16x32_bf16 v[72:75], v[184:187], v[4:7], 0
    ds_read_b64_tr_b16 v[176:177], v223 offset:0
    v_mfma_f32_16x16x32_bf16 v[80:83], v[184:187], v[8:11], 0
    ds_read_b64_tr_b16 v[178:179], v223 offset:512
    buffer_load_dwordx4 v231, s[24:27], s48 offen offset:3072 lds
    s_waitcnt lgkmcnt(8)
    v_mfma_f32_16x16x32_bf16 v[84:87], v[188:191], v[4:7], 0
    ds_read_b64_tr_b16 v[180:181], v232 offset:4096
    v_mfma_f32_16x16x32_bf16 v[92:95], v[188:191], v[8:11], 0
    ds_read_b64_tr_b16 v[182:183], v232 offset:4608
    v_mfma_f32_16x16x32_bf16 v[88:91], v[192:195], v[4:7], 0
    ds_read_b64_tr_b16 v[184:185], v233 offset:4096
    v_mfma_f32_16x16x32_bf16 v[96:99], v[192:195], v[8:11], 0
    ds_read_b64_tr_b16 v[186:187], v233 offset:4608
    s_waitcnt lgkmcnt(8)
    v_mfma_f32_16x16x32_bf16 v[100:103], v[164:167], v[4:7], 0
    ds_read_b64_tr_b16 v[188:189], v234 offset:4096
    v_mfma_f32_16x16x32_bf16 v[108:111], v[164:167], v[8:11], 0
    ds_read_b64_tr_b16 v[190:191], v234 offset:4608
    v_mfma_f32_16x16x32_bf16 v[104:107], v[168:171], v[4:7], 0
    ds_read_b64_tr_b16 v[192:193], v235 offset:4096
    v_mfma_f32_16x16x32_bf16 v[112:115], v[168:171], v[8:11], 0
    ds_read_b64_tr_b16 v[194:195], v235 offset:4608
    s_waitcnt lgkmcnt(8)
    v_mfma_f32_16x16x32_bf16 v[116:119], v[172:175], v[4:7], 0
    ds_read_b64_tr_b16 v[164:165], v232 offset:36864
    v_mfma_f32_16x16x32_bf16 v[124:127], v[172:175], v[8:11], 0
    ds_read_b64_tr_b16 v[166:167], v232 offset:37376
    v_mfma_f32_16x16x32_bf16 v[120:123], v[176:179], v[4:7], 0
    ds_read_b64_tr_b16 v[168:169], v233 offset:36864
    v_mfma_f32_16x16x32_bf16 v[128:131], v[176:179], v[8:11], 0
    ds_read_b64_tr_b16 v[170:171], v233 offset:37376
    s_waitcnt vmcnt(9)
    s_waitcnt lgkmcnt(8)
    v_mfma_f32_16x16x32_bf16 v[36:39], v[180:183], v[12:15], v[36:39]
    ds_read_b64_tr_b16 v[172:173], v234 offset:36864
    v_mfma_f32_16x16x32_bf16 v[44:47], v[180:183], v[16:19], v[44:47]
    ds_read_b64_tr_b16 v[174:175], v234 offset:37376
    s_add_u32 s41, s40, 8192
    buffer_load_dwordx4 v[4:7], v243, s[12:15], s41 offen offset:0 sc1
    v_mfma_f32_16x16x32_bf16 v[40:43], v[184:187], v[12:15], v[40:43]
    ds_read_b64_tr_b16 v[176:177], v235 offset:36864
    v_mfma_f32_16x16x32_bf16 v[48:51], v[184:187], v[16:19], v[48:51]
    ds_read_b64_tr_b16 v[178:179], v235 offset:37376
    buffer_load_dwordx4 v[8:11], v243, s[12:15], s41 offen offset:1024 sc1
    s_waitcnt lgkmcnt(8)
    v_mfma_f32_16x16x32_bf16 v[52:55], v[188:191], v[12:15], v[52:55]
    ds_read_b64_tr_b16 v[180:181], v220 offset:4096
    v_mfma_f32_16x16x32_bf16 v[60:63], v[188:191], v[16:19], v[60:63]
    ds_read_b64_tr_b16 v[182:183], v220 offset:4608
    s_add_u32 s56, s57, 524288
    buffer_store_dwordx4 v[148:151], v243, s[8:11], s56 offen offset:0 sc1
    v_mfma_f32_16x16x32_bf16 v[56:59], v[192:195], v[12:15], v[56:59]
    ds_read_b64_tr_b16 v[184:185], v221 offset:4096
    v_mfma_f32_16x16x32_bf16 v[64:67], v[192:195], v[16:19], v[64:67]
    ds_read_b64_tr_b16 v[186:187], v221 offset:4608
    s_waitcnt lgkmcnt(8)
    v_mfma_f32_16x16x32_bf16 v[68:71], v[164:167], v[12:15], v[68:71]
    ds_read_b64_tr_b16 v[188:189], v222 offset:4096
    v_mfma_f32_16x16x32_bf16 v[76:79], v[164:167], v[16:19], v[76:79]
    ds_read_b64_tr_b16 v[190:191], v222 offset:4608
    v_mfma_f32_16x16x32_bf16 v[72:75], v[168:171], v[12:15], v[72:75]
    ds_read_b64_tr_b16 v[192:193], v223 offset:4096
    v_mfma_f32_16x16x32_bf16 v[80:83], v[168:171], v[16:19], v[80:83]
    ds_read_b64_tr_b16 v[194:195], v223 offset:4608
    s_waitcnt lgkmcnt(8)
    v_mfma_f32_16x16x32_bf16 v[84:87], v[172:175], v[12:15], v[84:87]
    ds_read_b64_tr_b16 v[164:165], v232 offset:8192
    v_mfma_f32_16x16x32_bf16 v[92:95], v[172:175], v[16:19], v[92:95]
    ds_read_b64_tr_b16 v[166:167], v232 offset:8704
    v_mfma_f32_16x16x32_bf16 v[88:91], v[176:179], v[12:15], v[88:91]
    ds_read_b64_tr_b16 v[168:169], v233 offset:8192
    v_mfma_f32_16x16x32_bf16 v[96:99], v[176:179], v[16:19], v[96:99]
    ds_read_b64_tr_b16 v[170:171], v233 offset:8704
    s_waitcnt lgkmcnt(8)
    v_mfma_f32_16x16x32_bf16 v[100:103], v[180:183], v[12:15], v[100:103]
    ds_read_b64_tr_b16 v[172:173], v234 offset:8192
    v_mfma_f32_16x16x32_bf16 v[108:111], v[180:183], v[16:19], v[108:111]
    ds_read_b64_tr_b16 v[174:175], v234 offset:8704
    v_mfma_f32_16x16x32_bf16 v[104:107], v[184:187], v[12:15], v[104:107]
    ds_read_b64_tr_b16 v[176:177], v235 offset:8192
    v_mfma_f32_16x16x32_bf16 v[112:115], v[184:187], v[16:19], v[112:115]
    ds_read_b64_tr_b16 v[178:179], v235 offset:8704
    s_waitcnt lgkmcnt(8)
    v_mfma_f32_16x16x32_bf16 v[116:119], v[188:191], v[12:15], v[116:119]
    ds_read_b64_tr_b16 v[180:181], v232 offset:40960
    v_mfma_f32_16x16x32_bf16 v[124:127], v[188:191], v[16:19], v[124:127]
    ds_read_b64_tr_b16 v[182:183], v232 offset:41472
    v_mfma_f32_16x16x32_bf16 v[120:123], v[192:195], v[12:15], v[120:123]
    ds_read_b64_tr_b16 v[184:185], v233 offset:40960
    v_mfma_f32_16x16x32_bf16 v[128:131], v[192:195], v[16:19], v[128:131]
    ds_read_b64_tr_b16 v[186:187], v233 offset:41472
    s_waitcnt vmcnt(10)
    s_waitcnt lgkmcnt(8)
    v_mfma_f32_16x16x32_bf16 v[36:39], v[164:167], v[20:23], v[36:39]
    ds_read_b64_tr_b16 v[188:189], v234 offset:40960
    v_mfma_f32_16x16x32_bf16 v[44:47], v[164:167], v[24:27], v[44:47]
    ds_read_b64_tr_b16 v[190:191], v234 offset:41472
    s_add_u32 s41, s40, 8192
    buffer_load_dwordx4 v[12:15], v243, s[12:15], s41 offen offset:2048 sc1
    v_mfma_f32_16x16x32_bf16 v[40:43], v[168:171], v[20:23], v[40:43]
    ds_read_b64_tr_b16 v[192:193], v235 offset:40960
    v_mfma_f32_16x16x32_bf16 v[48:51], v[168:171], v[24:27], v[48:51]
    ds_read_b64_tr_b16 v[194:195], v235 offset:41472
    buffer_load_dwordx4 v[16:19], v243, s[12:15], s41 offen offset:3072 sc1
    s_waitcnt lgkmcnt(8)
    v_mfma_f32_16x16x32_bf16 v[52:55], v[172:175], v[20:23], v[52:55]
    ds_read_b64_tr_b16 v[164:165], v220 offset:8192
    v_mfma_f32_16x16x32_bf16 v[60:63], v[172:175], v[24:27], v[60:63]
    ds_read_b64_tr_b16 v[166:167], v220 offset:8704
    s_add_u32 s41, s40, 16384
    buffer_load_dwordx4 v[196:199], v243, s[12:15], s41 offen offset:0 sc1
    v_mfma_f32_16x16x32_bf16 v[56:59], v[176:179], v[20:23], v[56:59]
    ds_read_b64_tr_b16 v[168:169], v221 offset:8192
    v_mfma_f32_16x16x32_bf16 v[64:67], v[176:179], v[24:27], v[64:67]
    ds_read_b64_tr_b16 v[170:171], v221 offset:8704
    buffer_load_dwordx4 v[200:203], v243, s[12:15], s41 offen offset:1024 sc1
    s_waitcnt lgkmcnt(8)
    v_mfma_f32_16x16x32_bf16 v[68:71], v[180:183], v[20:23], v[68:71]
    ds_read_b64_tr_b16 v[172:173], v222 offset:8192
    v_mfma_f32_16x16x32_bf16 v[76:79], v[180:183], v[24:27], v[76:79]
    ds_read_b64_tr_b16 v[174:175], v222 offset:8704
    s_add_u32 s56, s57, 524288
    buffer_store_dwordx4 v[152:155], v243, s[8:11], s56 offen offset:1024 sc1
    v_mfma_f32_16x16x32_bf16 v[72:75], v[184:187], v[20:23], v[72:75]
    ds_read_b64_tr_b16 v[176:177], v223 offset:8192
    v_mfma_f32_16x16x32_bf16 v[80:83], v[184:187], v[24:27], v[80:83]
    ds_read_b64_tr_b16 v[178:179], v223 offset:8704
    s_waitcnt lgkmcnt(8)
    v_mfma_f32_16x16x32_bf16 v[84:87], v[188:191], v[20:23], v[84:87]
    ds_read_b64_tr_b16 v[180:181], v232 offset:12288
    v_mfma_f32_16x16x32_bf16 v[92:95], v[188:191], v[24:27], v[92:95]
    ds_read_b64_tr_b16 v[182:183], v232 offset:12800
    v_mfma_f32_16x16x32_bf16 v[88:91], v[192:195], v[20:23], v[88:91]
    ds_read_b64_tr_b16 v[184:185], v233 offset:12288
    v_mfma_f32_16x16x32_bf16 v[96:99], v[192:195], v[24:27], v[96:99]
    ds_read_b64_tr_b16 v[186:187], v233 offset:12800
    s_waitcnt lgkmcnt(8)
    v_mfma_f32_16x16x32_bf16 v[100:103], v[164:167], v[20:23], v[100:103]
    ds_read_b64_tr_b16 v[188:189], v234 offset:12288
    v_mfma_f32_16x16x32_bf16 v[108:111], v[164:167], v[24:27], v[108:111]
    ds_read_b64_tr_b16 v[190:191], v234 offset:12800
    v_mfma_f32_16x16x32_bf16 v[104:107], v[168:171], v[20:23], v[104:107]
    ds_read_b64_tr_b16 v[192:193], v235 offset:12288
    v_mfma_f32_16x16x32_bf16 v[112:115], v[168:171], v[24:27], v[112:115]
    ds_read_b64_tr_b16 v[194:195], v235 offset:12800
    s_waitcnt lgkmcnt(8)
    v_mfma_f32_16x16x32_bf16 v[116:119], v[172:175], v[20:23], v[116:119]
    ds_read_b64_tr_b16 v[164:165], v232 offset:45056
    v_mfma_f32_16x16x32_bf16 v[124:127], v[172:175], v[24:27], v[124:127]
    ds_read_b64_tr_b16 v[166:167], v232 offset:45568
    v_mfma_f32_16x16x32_bf16 v[120:123], v[176:179], v[20:23], v[120:123]
    ds_read_b64_tr_b16 v[168:169], v233 offset:45056
    v_mfma_f32_16x16x32_bf16 v[128:131], v[176:179], v[24:27], v[128:131]
    ds_read_b64_tr_b16 v[170:171], v233 offset:45568
    s_waitcnt vmcnt(12)
    s_waitcnt lgkmcnt(8)
    v_mfma_f32_16x16x32_bf16 v[36:39], v[180:183], v[28:31], v[36:39]
    ds_read_b64_tr_b16 v[172:173], v234 offset:45056
    v_mfma_f32_16x16x32_bf16 v[44:47], v[180:183], v[32:35], v[44:47]
    ds_read_b64_tr_b16 v[174:175], v234 offset:45568
    s_add_u32 s41, s40, 12288
    buffer_load_dwordx4 v[20:23], v243, s[12:15], s41 offen offset:0 sc1
    v_mfma_f32_16x16x32_bf16 v[40:43], v[184:187], v[28:31], v[40:43]
    ds_read_b64_tr_b16 v[176:177], v235 offset:45056
    v_mfma_f32_16x16x32_bf16 v[48:51], v[184:187], v[32:35], v[48:51]
    ds_read_b64_tr_b16 v[178:179], v235 offset:45568
    buffer_load_dwordx4 v[24:27], v243, s[12:15], s41 offen offset:1024 sc1
    s_waitcnt lgkmcnt(8)
    v_mfma_f32_16x16x32_bf16 v[52:55], v[188:191], v[28:31], v[52:55]
    ds_read_b64_tr_b16 v[180:181], v220 offset:12288
    v_mfma_f32_16x16x32_bf16 v[60:63], v[188:191], v[32:35], v[60:63]
    ds_read_b64_tr_b16 v[182:183], v220 offset:12800
    s_add_u32 s41, s40, 16384
    buffer_load_dwordx4 v[204:207], v243, s[12:15], s41 offen offset:2048 sc1
    v_mfma_f32_16x16x32_bf16 v[56:59], v[192:195], v[28:31], v[56:59]
    ds_read_b64_tr_b16 v[184:185], v221 offset:12288
    v_mfma_f32_16x16x32_bf16 v[64:67], v[192:195], v[32:35], v[64:67]
    ds_read_b64_tr_b16 v[186:187], v221 offset:12800
    buffer_load_dwordx4 v[208:211], v243, s[12:15], s41 offen offset:3072 sc1
    s_waitcnt lgkmcnt(8)
    v_mfma_f32_16x16x32_bf16 v[68:71], v[164:167], v[28:31], v[68:71]
    ds_read_b64_tr_b16 v[188:189], v222 offset:12288
    v_mfma_f32_16x16x32_bf16 v[76:79], v[164:167], v[32:35], v[76:79]
    ds_read_b64_tr_b16 v[190:191], v222 offset:12800
    v_mfma_f32_16x16x32_bf16 v[72:75], v[168:171], v[28:31], v[72:75]
    ds_read_b64_tr_b16 v[192:193], v223 offset:12288
    v_mfma_f32_16x16x32_bf16 v[80:83], v[168:171], v[32:35], v[80:83]
    ds_read_b64_tr_b16 v[194:195], v223 offset:12800
    s_waitcnt lgkmcnt(8)
    v_mfma_f32_16x16x32_bf16 v[84:87], v[172:175], v[28:31], v[84:87]
    ds_read_b64_tr_b16 v[164:165], v232 offset:16384
    v_mfma_f32_16x16x32_bf16 v[92:95], v[172:175], v[32:35], v[92:95]
    ds_read_b64_tr_b16 v[166:167], v232 offset:16896
    v_mfma_f32_16x16x32_bf16 v[88:91], v[176:179], v[28:31], v[88:91]
    ds_read_b64_tr_b16 v[168:169], v233 offset:16384
    v_mfma_f32_16x16x32_bf16 v[96:99], v[176:179], v[32:35], v[96:99]
    ds_read_b64_tr_b16 v[170:171], v233 offset:16896
    s_waitcnt lgkmcnt(8)
    v_mfma_f32_16x16x32_bf16 v[100:103], v[180:183], v[28:31], v[100:103]
    ds_read_b64_tr_b16 v[172:173], v234 offset:16384
    v_mfma_f32_16x16x32_bf16 v[108:111], v[180:183], v[32:35], v[108:111]
    ds_read_b64_tr_b16 v[174:175], v234 offset:16896
    v_mfma_f32_16x16x32_bf16 v[104:107], v[184:187], v[28:31], v[104:107]
    ds_read_b64_tr_b16 v[176:177], v235 offset:16384
    v_mfma_f32_16x16x32_bf16 v[112:115], v[184:187], v[32:35], v[112:115]
    ds_read_b64_tr_b16 v[178:179], v235 offset:16896
    s_waitcnt lgkmcnt(8)
    v_mfma_f32_16x16x32_bf16 v[116:119], v[188:191], v[28:31], v[116:119]
    ds_read_b64_tr_b16 v[180:181], v232 offset:49152
    v_mfma_f32_16x16x32_bf16 v[124:127], v[188:191], v[32:35], v[124:127]
    ds_read_b64_tr_b16 v[182:183], v232 offset:49664
    v_mfma_f32_16x16x32_bf16 v[120:123], v[192:195], v[28:31], v[120:123]
    ds_read_b64_tr_b16 v[184:185], v233 offset:49152
    v_mfma_f32_16x16x32_bf16 v[128:131], v[192:195], v[32:35], v[128:131]
    ds_read_b64_tr_b16 v[186:187], v233 offset:49664
    s_waitcnt vmcnt(10)
    s_waitcnt lgkmcnt(8)
    v_mfma_f32_16x16x32_bf16 v[36:39], v[164:167], v[4:7], v[36:39]
    ds_read_b64_tr_b16 v[188:189], v234 offset:49152
    v_mfma_f32_16x16x32_bf16 v[44:47], v[164:167], v[8:11], v[44:47]
    ds_read_b64_tr_b16 v[190:191], v234 offset:49664
    s_add_u32 s41, s40, 12288
    buffer_load_dwordx4 v[28:31], v243, s[12:15], s41 offen offset:2048 sc1
    v_mfma_f32_16x16x32_bf16 v[40:43], v[168:171], v[4:7], v[40:43]
    ds_read_b64_tr_b16 v[192:193], v235 offset:49152
    v_mfma_f32_16x16x32_bf16 v[48:51], v[168:171], v[8:11], v[48:51]
    ds_read_b64_tr_b16 v[194:195], v235 offset:49664
    buffer_load_dwordx4 v[32:35], v243, s[12:15], s41 offen offset:3072 sc1
    s_waitcnt lgkmcnt(8)
    v_mfma_f32_16x16x32_bf16 v[52:55], v[172:175], v[4:7], v[52:55]
    ds_read_b64_tr_b16 v[164:165], v220 offset:16384
    v_mfma_f32_16x16x32_bf16 v[60:63], v[172:175], v[8:11], v[60:63]
    ds_read_b64_tr_b16 v[166:167], v220 offset:16896
    s_add_u32 s41, s40, 20480
    buffer_load_dwordx4 v[212:215], v243, s[12:15], s41 offen offset:0 sc1
    v_mfma_f32_16x16x32_bf16 v[56:59], v[176:179], v[4:7], v[56:59]
    ds_read_b64_tr_b16 v[168:169], v221 offset:16384
    v_mfma_f32_16x16x32_bf16 v[64:67], v[176:179], v[8:11], v[64:67]
    ds_read_b64_tr_b16 v[170:171], v221 offset:16896
    buffer_load_dwordx4 v[216:219], v243, s[12:15], s41 offen offset:1024 sc1
    s_waitcnt lgkmcnt(8)
    v_mfma_f32_16x16x32_bf16 v[68:71], v[180:183], v[4:7], v[68:71]
    ds_read_b64_tr_b16 v[172:173], v222 offset:16384
    v_mfma_f32_16x16x32_bf16 v[76:79], v[180:183], v[8:11], v[76:79]
    ds_read_b64_tr_b16 v[174:175], v222 offset:16896
    s_add_u32 s56, s57, 524288
    buffer_store_dwordx4 v[156:159], v243, s[8:11], s56 offen offset:2048 sc1
    v_mfma_f32_16x16x32_bf16 v[72:75], v[184:187], v[4:7], v[72:75]
    ds_read_b64_tr_b16 v[176:177], v223 offset:16384
    v_mfma_f32_16x16x32_bf16 v[80:83], v[184:187], v[8:11], v[80:83]
    ds_read_b64_tr_b16 v[178:179], v223 offset:16896
    s_waitcnt lgkmcnt(8)
    v_mfma_f32_16x16x32_bf16 v[84:87], v[188:191], v[4:7], v[84:87]
    ds_read_b64_tr_b16 v[180:181], v232 offset:20480
    v_mfma_f32_16x16x32_bf16 v[92:95], v[188:191], v[8:11], v[92:95]
    ds_read_b64_tr_b16 v[182:183], v232 offset:20992
    v_mfma_f32_16x16x32_bf16 v[88:91], v[192:195], v[4:7], v[88:91]
    ds_read_b64_tr_b16 v[184:185], v233 offset:20480
    v_mfma_f32_16x16x32_bf16 v[96:99], v[192:195], v[8:11], v[96:99]
    ds_read_b64_tr_b16 v[186:187], v233 offset:20992
    s_waitcnt lgkmcnt(8)
    v_mfma_f32_16x16x32_bf16 v[100:103], v[164:167], v[4:7], v[100:103]
    ds_read_b64_tr_b16 v[188:189], v234 offset:20480
    v_mfma_f32_16x16x32_bf16 v[108:111], v[164:167], v[8:11], v[108:111]
    ds_read_b64_tr_b16 v[190:191], v234 offset:20992
    v_mfma_f32_16x16x32_bf16 v[104:107], v[168:171], v[4:7], v[104:107]
    ds_read_b64_tr_b16 v[192:193], v235 offset:20480
    v_mfma_f32_16x16x32_bf16 v[112:115], v[168:171], v[8:11], v[112:115]
    ds_read_b64_tr_b16 v[194:195], v235 offset:20992
    s_waitcnt lgkmcnt(8)
    v_mfma_f32_16x16x32_bf16 v[116:119], v[172:175], v[4:7], v[116:119]
    ds_read_b64_tr_b16 v[164:165], v232 offset:53248
    v_mfma_f32_16x16x32_bf16 v[124:127], v[172:175], v[8:11], v[124:127]
    ds_read_b64_tr_b16 v[166:167], v232 offset:53760
    v_mfma_f32_16x16x32_bf16 v[120:123], v[176:179], v[4:7], v[120:123]
    ds_read_b64_tr_b16 v[168:169], v233 offset:53248
    v_mfma_f32_16x16x32_bf16 v[128:131], v[176:179], v[8:11], v[128:131]
    ds_read_b64_tr_b16 v[170:171], v233 offset:53760
    s_waitcnt vmcnt(12)
    s_waitcnt lgkmcnt(8)
    v_mfma_f32_16x16x32_bf16 v[36:39], v[180:183], v[12:15], v[36:39]
    ds_read_b64_tr_b16 v[172:173], v234 offset:53248
    v_mfma_f32_16x16x32_bf16 v[44:47], v[180:183], v[16:19], v[44:47]
    ds_read_b64_tr_b16 v[174:175], v234 offset:53760
    s_add_u32 s41, s40, 20480
    buffer_load_dwordx4 v[4:7], v243, s[12:15], s41 offen offset:2048 sc1
    v_mfma_f32_16x16x32_bf16 v[40:43], v[184:187], v[12:15], v[40:43]
    ds_read_b64_tr_b16 v[176:177], v235 offset:53248
    v_mfma_f32_16x16x32_bf16 v[48:51], v[184:187], v[16:19], v[48:51]
    ds_read_b64_tr_b16 v[178:179], v235 offset:53760
    buffer_load_dwordx4 v[8:11], v243, s[12:15], s41 offen offset:3072 sc1
    s_waitcnt lgkmcnt(8)
    v_mfma_f32_16x16x32_bf16 v[52:55], v[188:191], v[12:15], v[52:55]
    ds_read_b64_tr_b16 v[180:181], v220 offset:20480
    v_mfma_f32_16x16x32_bf16 v[60:63], v[188:191], v[16:19], v[60:63]
    ds_read_b64_tr_b16 v[182:183], v220 offset:20992
    s_add_u32 s56, s57, 524288
    buffer_store_dwordx4 v[160:163], v243, s[8:11], s56 offen offset:3072 sc1
    v_mfma_f32_16x16x32_bf16 v[56:59], v[192:195], v[12:15], v[56:59]
    ds_read_b64_tr_b16 v[184:185], v221 offset:20480
    v_mfma_f32_16x16x32_bf16 v[64:67], v[192:195], v[16:19], v[64:67]
    ds_read_b64_tr_b16 v[186:187], v221 offset:20992
    s_waitcnt lgkmcnt(8)
    v_mfma_f32_16x16x32_bf16 v[68:71], v[164:167], v[12:15], v[68:71]
    ds_read_b64_tr_b16 v[188:189], v222 offset:20480
    v_mfma_f32_16x16x32_bf16 v[76:79], v[164:167], v[16:19], v[76:79]
    ds_read_b64_tr_b16 v[190:191], v222 offset:20992
    v_mfma_f32_16x16x32_bf16 v[72:75], v[168:171], v[12:15], v[72:75]
    ds_read_b64_tr_b16 v[192:193], v223 offset:20480
    v_mfma_f32_16x16x32_bf16 v[80:83], v[168:171], v[16:19], v[80:83]
    ds_read_b64_tr_b16 v[194:195], v223 offset:20992
    s_waitcnt lgkmcnt(8)
    v_mfma_f32_16x16x32_bf16 v[84:87], v[172:175], v[12:15], v[84:87]
    ds_read_b64_tr_b16 v[164:165], v232 offset:24576
    v_mfma_f32_16x16x32_bf16 v[92:95], v[172:175], v[16:19], v[92:95]
    ds_read_b64_tr_b16 v[166:167], v232 offset:25088
    v_mfma_f32_16x16x32_bf16 v[88:91], v[176:179], v[12:15], v[88:91]
    ds_read_b64_tr_b16 v[168:169], v233 offset:24576
    v_mfma_f32_16x16x32_bf16 v[96:99], v[176:179], v[16:19], v[96:99]
    ds_read_b64_tr_b16 v[170:171], v233 offset:25088
    s_waitcnt lgkmcnt(8)
    v_mfma_f32_16x16x32_bf16 v[100:103], v[180:183], v[12:15], v[100:103]
    ds_read_b64_tr_b16 v[172:173], v234 offset:24576
    v_mfma_f32_16x16x32_bf16 v[108:111], v[180:183], v[16:19], v[108:111]
    ds_read_b64_tr_b16 v[174:175], v234 offset:25088
    v_mfma_f32_16x16x32_bf16 v[104:107], v[184:187], v[12:15], v[104:107]
    ds_read_b64_tr_b16 v[176:177], v235 offset:24576
    v_mfma_f32_16x16x32_bf16 v[112:115], v[184:187], v[16:19], v[112:115]
    ds_read_b64_tr_b16 v[178:179], v235 offset:25088
    s_waitcnt lgkmcnt(8)
    v_mfma_f32_16x16x32_bf16 v[116:119], v[188:191], v[12:15], v[116:119]
    ds_read_b64_tr_b16 v[180:181], v232 offset:57344
    v_mfma_f32_16x16x32_bf16 v[124:127], v[188:191], v[16:19], v[124:127]
    ds_read_b64_tr_b16 v[182:183], v232 offset:57856
    v_mfma_f32_16x16x32_bf16 v[120:123], v[192:195], v[12:15], v[120:123]
    ds_read_b64_tr_b16 v[184:185], v233 offset:57344
    v_mfma_f32_16x16x32_bf16 v[128:131], v[192:195], v[16:19], v[128:131]
    ds_read_b64_tr_b16 v[186:187], v233 offset:57856
    s_waitcnt vmcnt(10)
    s_waitcnt lgkmcnt(8)
    v_mfma_f32_16x16x32_bf16 v[36:39], v[164:167], v[20:23], v[36:39]
    ds_read_b64_tr_b16 v[188:189], v234 offset:57344
    v_mfma_f32_16x16x32_bf16 v[44:47], v[164:167], v[24:27], v[44:47]
    ds_read_b64_tr_b16 v[190:191], v234 offset:57856
    s_add_u32 s41, s40, 24576
    buffer_load_dwordx4 v[12:15], v243, s[12:15], s41 offen offset:0 sc1
    v_mfma_f32_16x16x32_bf16 v[40:43], v[168:171], v[20:23], v[40:43]
    ds_read_b64_tr_b16 v[192:193], v235 offset:57344
    v_mfma_f32_16x16x32_bf16 v[48:51], v[168:171], v[24:27], v[48:51]
    ds_read_b64_tr_b16 v[194:195], v235 offset:57856
    buffer_load_dwordx4 v[16:19], v243, s[12:15], s41 offen offset:1024 sc1
    s_waitcnt lgkmcnt(8)
    v_mfma_f32_16x16x32_bf16 v[52:55], v[172:175], v[20:23], v[52:55]
    ds_read_b64_tr_b16 v[164:165], v220 offset:24576
    v_mfma_f32_16x16x32_bf16 v[60:63], v[172:175], v[24:27], v[60:63]
    ds_read_b64_tr_b16 v[166:167], v220 offset:25088
    v_mfma_f32_16x16x32_bf16 v[56:59], v[176:179], v[20:23], v[56:59]
    ds_read_b64_tr_b16 v[168:169], v221 offset:24576
    v_mfma_f32_16x16x32_bf16 v[64:67], v[176:179], v[24:27], v[64:67]
    ds_read_b64_tr_b16 v[170:171], v221 offset:25088
    s_waitcnt lgkmcnt(8)
    v_mfma_f32_16x16x32_bf16 v[68:71], v[180:183], v[20:23], v[68:71]
    ds_read_b64_tr_b16 v[172:173], v222 offset:24576
    v_mfma_f32_16x16x32_bf16 v[76:79], v[180:183], v[24:27], v[76:79]
    ds_read_b64_tr_b16 v[174:175], v222 offset:25088
    v_mfma_f32_16x16x32_bf16 v[72:75], v[184:187], v[20:23], v[72:75]
    ds_read_b64_tr_b16 v[176:177], v223 offset:24576
    v_mfma_f32_16x16x32_bf16 v[80:83], v[184:187], v[24:27], v[80:83]
    ds_read_b64_tr_b16 v[178:179], v223 offset:25088
    s_waitcnt lgkmcnt(8)
    v_mfma_f32_16x16x32_bf16 v[84:87], v[188:191], v[20:23], v[84:87]
    ds_read_b64_tr_b16 v[180:181], v232 offset:28672
    v_mfma_f32_16x16x32_bf16 v[92:95], v[188:191], v[24:27], v[92:95]
    ds_read_b64_tr_b16 v[182:183], v232 offset:29184
    v_mfma_f32_16x16x32_bf16 v[88:91], v[192:195], v[20:23], v[88:91]
    ds_read_b64_tr_b16 v[184:185], v233 offset:28672
    v_mfma_f32_16x16x32_bf16 v[96:99], v[192:195], v[24:27], v[96:99]
    ds_read_b64_tr_b16 v[186:187], v233 offset:29184
    s_waitcnt lgkmcnt(8)
    v_mfma_f32_16x16x32_bf16 v[100:103], v[164:167], v[20:23], v[100:103]
    ds_read_b64_tr_b16 v[188:189], v234 offset:28672
    v_mfma_f32_16x16x32_bf16 v[108:111], v[164:167], v[24:27], v[108:111]
    ds_read_b64_tr_b16 v[190:191], v234 offset:29184
    v_mfma_f32_16x16x32_bf16 v[104:107], v[168:171], v[20:23], v[104:107]
    ds_read_b64_tr_b16 v[192:193], v235 offset:28672
    v_mfma_f32_16x16x32_bf16 v[112:115], v[168:171], v[24:27], v[112:115]
    ds_read_b64_tr_b16 v[194:195], v235 offset:29184
    s_waitcnt lgkmcnt(8)
    v_mfma_f32_16x16x32_bf16 v[116:119], v[172:175], v[20:23], v[116:119]
    ds_read_b64_tr_b16 v[164:165], v232 offset:61440
    v_mfma_f32_16x16x32_bf16 v[124:127], v[172:175], v[24:27], v[124:127]
    ds_read_b64_tr_b16 v[166:167], v232 offset:61952
    v_mfma_f32_16x16x32_bf16 v[120:123], v[176:179], v[20:23], v[120:123]
    ds_read_b64_tr_b16 v[168:169], v233 offset:61440
    v_mfma_f32_16x16x32_bf16 v[128:131], v[176:179], v[24:27], v[128:131]
    ds_read_b64_tr_b16 v[170:171], v233 offset:61952
    s_waitcnt vmcnt(8)
    s_waitcnt lgkmcnt(8)
    v_mfma_f32_16x16x32_bf16 v[36:39], v[180:183], v[28:31], v[36:39]
    ds_read_b64_tr_b16 v[172:173], v234 offset:61440
    v_mfma_f32_16x16x32_bf16 v[44:47], v[180:183], v[32:35], v[44:47]
    ds_read_b64_tr_b16 v[174:175], v234 offset:61952
    s_add_u32 s41, s40, 24576
    buffer_load_dwordx4 v[20:23], v243, s[12:15], s41 offen offset:2048 sc1
    v_mfma_f32_16x16x32_bf16 v[40:43], v[184:187], v[28:31], v[40:43]
    ds_read_b64_tr_b16 v[176:177], v235 offset:61440
    v_mfma_f32_16x16x32_bf16 v[48:51], v[184:187], v[32:35], v[48:51]
    ds_read_b64_tr_b16 v[178:179], v235 offset:61952
    buffer_load_dwordx4 v[24:27], v243, s[12:15], s41 offen offset:3072 sc1
    s_waitcnt lgkmcnt(8)
    v_mfma_f32_16x16x32_bf16 v[52:55], v[188:191], v[28:31], v[52:55]
    ds_read_b64_tr_b16 v[180:181], v220 offset:28672
    v_mfma_f32_16x16x32_bf16 v[60:63], v[188:191], v[32:35], v[60:63]
    ds_read_b64_tr_b16 v[182:183], v220 offset:29184
    s_add_u32 s41, s40, 28672
    buffer_load_dwordx4 v[148:151], v243, s[12:15], s41 offen offset:0 sc1
    v_mfma_f32_16x16x32_bf16 v[56:59], v[192:195], v[28:31], v[56:59]
    ds_read_b64_tr_b16 v[184:185], v221 offset:28672
    v_mfma_f32_16x16x32_bf16 v[64:67], v[192:195], v[32:35], v[64:67]
    ds_read_b64_tr_b16 v[186:187], v221 offset:29184
    buffer_load_dwordx4 v[152:155], v243, s[12:15], s41 offen offset:1024 sc1
    s_waitcnt lgkmcnt(8)
    v_mfma_f32_16x16x32_bf16 v[68:71], v[164:167], v[28:31], v[68:71]
    ds_read_b64_tr_b16 v[188:189], v222 offset:28672
    v_mfma_f32_16x16x32_bf16 v[76:79], v[164:167], v[32:35], v[76:79]
    ds_read_b64_tr_b16 v[190:191], v222 offset:29184
    s_add_u32 s56, s57, 528384
    buffer_store_dwordx4 v[132:135], v243, s[8:11], s56 offen offset:0 sc1
    v_mfma_f32_16x16x32_bf16 v[72:75], v[168:171], v[28:31], v[72:75]
    ds_read_b64_tr_b16 v[192:193], v223 offset:28672
    v_mfma_f32_16x16x32_bf16 v[80:83], v[168:171], v[32:35], v[80:83]
    ds_read_b64_tr_b16 v[194:195], v223 offset:29184
    s_waitcnt lgkmcnt(8)
    v_mfma_f32_16x16x32_bf16 v[84:87], v[172:175], v[28:31], v[84:87]
    ds_read_b64_tr_b16 v[164:165], v224 offset:0
    v_mfma_f32_16x16x32_bf16 v[92:95], v[172:175], v[32:35], v[92:95]
    ds_read_b64_tr_b16 v[166:167], v224 offset:512
    v_mfma_f32_16x16x32_bf16 v[88:91], v[176:179], v[28:31], v[88:91]
    ds_read_b64_tr_b16 v[168:169], v225 offset:0
    v_mfma_f32_16x16x32_bf16 v[96:99], v[176:179], v[32:35], v[96:99]
    ds_read_b64_tr_b16 v[170:171], v225 offset:512
    s_waitcnt lgkmcnt(8)
    v_mfma_f32_16x16x32_bf16 v[100:103], v[180:183], v[28:31], v[100:103]
    ds_read_b64_tr_b16 v[172:173], v226 offset:0
    v_mfma_f32_16x16x32_bf16 v[108:111], v[180:183], v[32:35], v[108:111]
    ds_read_b64_tr_b16 v[174:175], v226 offset:512
    v_mfma_f32_16x16x32_bf16 v[104:107], v[184:187], v[28:31], v[104:107]
    ds_read_b64_tr_b16 v[176:177], v227 offset:0
    v_mfma_f32_16x16x32_bf16 v[112:115], v[184:187], v[32:35], v[112:115]
    ds_read_b64_tr_b16 v[178:179], v227 offset:512
    s_waitcnt lgkmcnt(8)
    v_mfma_f32_16x16x32_bf16 v[116:119], v[188:191], v[28:31], v[116:119]
    ds_read_b64_tr_b16 v[180:181], v224 offset:4096
    v_mfma_f32_16x16x32_bf16 v[124:127], v[188:191], v[32:35], v[124:127]
    ds_read_b64_tr_b16 v[182:183], v224 offset:4608
    v_mfma_f32_16x16x32_bf16 v[120:123], v[192:195], v[28:31], v[120:123]
    ds_read_b64_tr_b16 v[184:185], v225 offset:4096
    v_mfma_f32_16x16x32_bf16 v[128:131], v[192:195], v[32:35], v[128:131]
    ds_read_b64_tr_b16 v[186:187], v225 offset:4608
    s_barrier
    s_waitcnt vmcnt(20)
    s_waitcnt lgkmcnt(8)
    v_mfma_f32_16x16x32_bf16 v[100:103], v[164:167], v[196:199], v[100:103]
    ds_read_b64_tr_b16 v[188:189], v226 offset:4096
    v_mfma_f32_16x16x32_bf16 v[108:111], v[164:167], v[200:203], v[108:111]
    ds_read_b64_tr_b16 v[190:191], v226 offset:4608
    s_add_u32 s41, s40, 28672
    buffer_load_dwordx4 v[28:31], v243, s[12:15], s41 offen offset:2048 sc1
    buffer_load_dwordx4 v[32:35], v243, s[12:15], s41 offen offset:3072 sc1
    v_mfma_f32_16x16x32_bf16 v[104:107], v[168:171], v[196:199], v[104:107]
    ds_read_b64_tr_b16 v[192:193], v227 offset:4096
    v_mfma_f32_16x16x32_bf16 v[112:115], v[168:171], v[200:203], v[112:115]
    ds_read_b64_tr_b16 v[194:195], v227 offset:4608
    s_add_u32 s56, s57, 528384
    buffer_store_dwordx4 v[136:139], v243, s[8:11], s56 offen offset:1024 sc1
    s_add_u32 m0, s37, 32768
    s_add_u32 s48, s47, 2097280
    buffer_load_dwordx4 v228, s[24:27], s48 offen offset:0 lds
    s_waitcnt lgkmcnt(8)
    v_mfma_f32_16x16x32_bf16 v[116:119], v[172:175], v[196:199], v[116:119]
    ds_read_b64_tr_b16 v[164:165], v224 offset:8192
    v_mfma_f32_16x16x32_bf16 v[124:127], v[172:175], v[200:203], v[124:127]
    ds_read_b64_tr_b16 v[166:167], v224 offset:8704
    buffer_load_dwordx4 v229, s[24:27], s48 offen offset:1024 lds
    buffer_load_dwordx4 v230, s[24:27], s48 offen offset:2048 lds
    v_mfma_f32_16x16x32_bf16 v[120:123], v[176:179], v[196:199], v[120:123]
    ds_read_b64_tr_b16 v[168:169], v225 offset:8192
    v_mfma_f32_16x16x32_bf16 v[128:131], v[176:179], v[200:203], v[128:131]
    ds_read_b64_tr_b16 v[170:171], v225 offset:8704
    buffer_load_dwordx4 v231, s[24:27], s48 offen offset:3072 lds
    s_waitcnt vmcnt(22)
    s_waitcnt lgkmcnt(8)
    v_mfma_f32_16x16x32_bf16 v[100:103], v[180:183], v[204:207], v[100:103]
    ds_read_b64_tr_b16 v[172:173], v226 offset:8192
    v_mfma_f32_16x16x32_bf16 v[108:111], v[180:183], v[208:211], v[108:111]
    ds_read_b64_tr_b16 v[174:175], v226 offset:8704
    v_mfma_f32_16x16x32_bf16 v[104:107], v[184:187], v[204:207], v[104:107]
    ds_read_b64_tr_b16 v[176:177], v227 offset:8192
    v_mfma_f32_16x16x32_bf16 v[112:115], v[184:187], v[208:211], v[112:115]
    ds_read_b64_tr_b16 v[178:179], v227 offset:8704
    s_waitcnt lgkmcnt(8)
    v_mfma_f32_16x16x32_bf16 v[116:119], v[188:191], v[204:207], v[116:119]
    ds_read_b64_tr_b16 v[180:181], v224 offset:12288
    v_mfma_f32_16x16x32_bf16 v[124:127], v[188:191], v[208:211], v[124:127]
    ds_read_b64_tr_b16 v[182:183], v224 offset:12800
    v_mfma_f32_16x16x32_bf16 v[120:123], v[192:195], v[204:207], v[120:123]
    ds_read_b64_tr_b16 v[184:185], v225 offset:12288
    v_mfma_f32_16x16x32_bf16 v[128:131], v[192:195], v[208:211], v[128:131]
    ds_read_b64_tr_b16 v[186:187], v225 offset:12800
    s_waitcnt vmcnt(18)
    s_waitcnt lgkmcnt(8)
    v_mfma_f32_16x16x32_bf16 v[100:103], v[164:167], v[212:215], v[100:103]
    ds_read_b64_tr_b16 v[188:189], v226 offset:12288
    v_mfma_f32_16x16x32_bf16 v[108:111], v[164:167], v[216:219], v[108:111]
    ds_read_b64_tr_b16 v[190:191], v226 offset:12800
    s_add_u32 s56, s57, 528384
    buffer_store_dwordx4 v[140:143], v243, s[8:11], s56 offen offset:2048 sc1
    v_mfma_f32_16x16x32_bf16 v[104:107], v[168:171], v[212:215], v[104:107]
    ds_read_b64_tr_b16 v[192:193], v227 offset:12288
    v_mfma_f32_16x16x32_bf16 v[112:115], v[168:171], v[216:219], v[112:115]
    ds_read_b64_tr_b16 v[194:195], v227 offset:12800
    s_waitcnt lgkmcnt(8)
    v_mfma_f32_16x16x32_bf16 v[116:119], v[172:175], v[212:215], v[116:119]
    ds_read_b64_tr_b16 v[164:165], v224 offset:16384
    v_mfma_f32_16x16x32_bf16 v[124:127], v[172:175], v[216:219], v[124:127]
    ds_read_b64_tr_b16 v[166:167], v224 offset:16896
    v_mfma_f32_16x16x32_bf16 v[120:123], v[176:179], v[212:215], v[120:123]
    ds_read_b64_tr_b16 v[168:169], v225 offset:16384
    v_mfma_f32_16x16x32_bf16 v[128:131], v[176:179], v[216:219], v[128:131]
    ds_read_b64_tr_b16 v[170:171], v225 offset:16896
    s_waitcnt vmcnt(16)
    s_waitcnt lgkmcnt(8)
    v_mfma_f32_16x16x32_bf16 v[100:103], v[180:183], v[4:7], v[100:103]
    ds_read_b64_tr_b16 v[172:173], v226 offset:16384
    v_mfma_f32_16x16x32_bf16 v[108:111], v[180:183], v[8:11], v[108:111]
    ds_read_b64_tr_b16 v[174:175], v226 offset:16896
    s_add_u32 s56, s57, 528384
    buffer_store_dwordx4 v[144:147], v243, s[8:11], s56 offen offset:3072 sc1
    v_mfma_f32_16x16x32_bf16 v[104:107], v[184:187], v[4:7], v[104:107]
    ds_read_b64_tr_b16 v[176:177], v227 offset:16384
    v_mfma_f32_16x16x32_bf16 v[112:115], v[184:187], v[8:11], v[112:115]
    ds_read_b64_tr_b16 v[178:179], v227 offset:16896
    s_waitcnt lgkmcnt(8)
    v_mfma_f32_16x16x32_bf16 v[116:119], v[188:191], v[4:7], v[116:119]
    ds_read_b64_tr_b16 v[180:181], v224 offset:20480
    v_mfma_f32_16x16x32_bf16 v[124:127], v[188:191], v[8:11], v[124:127]
    ds_read_b64_tr_b16 v[182:183], v224 offset:20992
    v_mfma_f32_16x16x32_bf16 v[120:123], v[192:195], v[4:7], v[120:123]
    ds_read_b64_tr_b16 v[184:185], v225 offset:20480
    v_mfma_f32_16x16x32_bf16 v[128:131], v[192:195], v[8:11], v[128:131]
    ds_read_b64_tr_b16 v[186:187], v225 offset:20992
    s_waitcnt vmcnt(14)
    s_waitcnt lgkmcnt(8)
    v_mfma_f32_16x16x32_bf16 v[100:103], v[164:167], v[12:15], v[100:103]
    ds_read_b64_tr_b16 v[188:189], v226 offset:20480
    v_mfma_f32_16x16x32_bf16 v[108:111], v[164:167], v[16:19], v[108:111]
    ds_read_b64_tr_b16 v[190:191], v226 offset:20992
    v_mfma_f32_16x16x32_bf16 v[104:107], v[168:171], v[12:15], v[104:107]
    ds_read_b64_tr_b16 v[192:193], v227 offset:20480
    v_mfma_f32_16x16x32_bf16 v[112:115], v[168:171], v[16:19], v[112:115]
    ds_read_b64_tr_b16 v[194:195], v227 offset:20992
    s_waitcnt lgkmcnt(8)
    v_mfma_f32_16x16x32_bf16 v[116:119], v[172:175], v[12:15], v[116:119]
    ds_read_b64_tr_b16 v[164:165], v224 offset:24576
    v_mfma_f32_16x16x32_bf16 v[124:127], v[172:175], v[16:19], v[124:127]
    ds_read_b64_tr_b16 v[166:167], v224 offset:25088
    v_mfma_f32_16x16x32_bf16 v[120:123], v[176:179], v[12:15], v[120:123]
    ds_read_b64_tr_b16 v[168:169], v225 offset:24576
    v_mfma_f32_16x16x32_bf16 v[128:131], v[176:179], v[16:19], v[128:131]
    ds_read_b64_tr_b16 v[170:171], v225 offset:25088
    s_waitcnt vmcnt(12)
    s_waitcnt lgkmcnt(8)
    v_mfma_f32_16x16x32_bf16 v[100:103], v[180:183], v[20:23], v[100:103]
    ds_read_b64_tr_b16 v[172:173], v226 offset:24576
    v_mfma_f32_16x16x32_bf16 v[108:111], v[180:183], v[24:27], v[108:111]
    ds_read_b64_tr_b16 v[174:175], v226 offset:25088
    v_mfma_f32_16x16x32_bf16 v[104:107], v[184:187], v[20:23], v[104:107]
    ds_read_b64_tr_b16 v[176:177], v227 offset:24576
    v_mfma_f32_16x16x32_bf16 v[112:115], v[184:187], v[24:27], v[112:115]
    ds_read_b64_tr_b16 v[178:179], v227 offset:25088
    s_waitcnt lgkmcnt(8)
    v_mfma_f32_16x16x32_bf16 v[116:119], v[188:191], v[20:23], v[116:119]
    ds_read_b64_tr_b16 v[180:181], v224 offset:28672
    v_mfma_f32_16x16x32_bf16 v[124:127], v[188:191], v[24:27], v[124:127]
    ds_read_b64_tr_b16 v[182:183], v224 offset:29184
    v_mfma_f32_16x16x32_bf16 v[120:123], v[192:195], v[20:23], v[120:123]
    ds_read_b64_tr_b16 v[184:185], v225 offset:28672
    v_mfma_f32_16x16x32_bf16 v[128:131], v[192:195], v[24:27], v[128:131]
    ds_read_b64_tr_b16 v[186:187], v225 offset:29184
    s_waitcnt vmcnt(2)
    s_barrier
    s_waitcnt vmcnt(10)
    s_waitcnt lgkmcnt(8)
    v_mfma_f32_16x16x32_bf16 v[100:103], v[164:167], v[148:151], v[100:103]
    ds_read_b64_tr_b16 v[188:189], v226 offset:28672
    v_mfma_f32_16x16x32_bf16 v[108:111], v[164:167], v[152:155], v[108:111]
    ds_read_b64_tr_b16 v[190:191], v226 offset:29184
    v_mfma_f32_16x16x32_bf16 v[104:107], v[168:171], v[148:151], v[104:107]
    ds_read_b64_tr_b16 v[192:193], v227 offset:28672
    v_mfma_f32_16x16x32_bf16 v[112:115], v[168:171], v[152:155], v[112:115]
    ds_read_b64_tr_b16 v[194:195], v227 offset:29184
    s_waitcnt lgkmcnt(8)
    v_mfma_f32_16x16x32_bf16 v[116:119], v[172:175], v[148:151], v[116:119]
    ds_read_b64_tr_b16 v[164:165], v220 offset:32768
    v_mfma_f32_16x16x32_bf16 v[124:127], v[172:175], v[152:155], v[124:127]
    ds_read_b64_tr_b16 v[166:167], v220 offset:33280
    v_mfma_f32_16x16x32_bf16 v[120:123], v[176:179], v[148:151], v[120:123]
    ds_read_b64_tr_b16 v[168:169], v221 offset:32768
    v_mfma_f32_16x16x32_bf16 v[128:131], v[176:179], v[152:155], v[128:131]
    ds_read_b64_tr_b16 v[170:171], v221 offset:33280
    s_waitcnt vmcnt(7)
    s_waitcnt lgkmcnt(8)
    v_mfma_f32_16x16x32_bf16 v[100:103], v[180:183], v[28:31], v[100:103]
    ds_read_b64_tr_b16 v[172:173], v222 offset:32768
    v_mfma_f32_16x16x32_bf16 v[108:111], v[180:183], v[32:35], v[108:111]
    ds_read_b64_tr_b16 v[174:175], v222 offset:33280
    v_mfma_f32_16x16x32_bf16 v[104:107], v[184:187], v[28:31], v[104:107]
    ds_read_b64_tr_b16 v[176:177], v223 offset:32768
    v_mfma_f32_16x16x32_bf16 v[112:115], v[184:187], v[32:35], v[112:115]
    ds_read_b64_tr_b16 v[178:179], v223 offset:33280
    s_waitcnt lgkmcnt(8)
    v_mfma_f32_16x16x32_bf16 v[116:119], v[188:191], v[28:31], v[116:119]
    ds_read_b64_tr_b16 v[180:181], v232 offset:32768
    v_mfma_f32_16x16x32_bf16 v[124:127], v[188:191], v[32:35], v[124:127]
    ds_read_b64_tr_b16 v[182:183], v232 offset:33280
    v_mfma_f32_16x16x32_bf16 v[120:123], v[192:195], v[28:31], v[120:123]
    ds_read_b64_tr_b16 v[184:185], v233 offset:32768
    v_mfma_f32_16x16x32_bf16 v[128:131], v[192:195], v[32:35], v[128:131]
    ds_read_b64_tr_b16 v[186:187], v233 offset:33280
    s_waitcnt vmcnt(0)
    s_barrier
    s_waitcnt lgkmcnt(8)
    v_mfma_f32_16x16x32_bf16 v[36:39], v[164:167], v[196:199], v[36:39]
    ds_read_b64_tr_b16 v[188:189], v234 offset:32768
    v_mfma_f32_16x16x32_bf16 v[44:47], v[164:167], v[200:203], v[44:47]
    ds_read_b64_tr_b16 v[190:191], v234 offset:33280
    v_mfma_f32_16x16x32_bf16 v[40:43], v[168:171], v[196:199], v[40:43]
    ds_read_b64_tr_b16 v[192:193], v235 offset:32768
    v_mfma_f32_16x16x32_bf16 v[48:51], v[168:171], v[200:203], v[48:51]
    ds_read_b64_tr_b16 v[194:195], v235 offset:33280
    s_waitcnt lgkmcnt(8)
    v_mfma_f32_16x16x32_bf16 v[52:55], v[172:175], v[196:199], v[52:55]
    ds_read_b64_tr_b16 v[164:165], v220 offset:36864
    v_mfma_f32_16x16x32_bf16 v[60:63], v[172:175], v[200:203], v[60:63]
    ds_read_b64_tr_b16 v[166:167], v220 offset:37376
    v_mfma_f32_16x16x32_bf16 v[56:59], v[176:179], v[196:199], v[56:59]
    ds_read_b64_tr_b16 v[168:169], v221 offset:36864
    v_mfma_f32_16x16x32_bf16 v[64:67], v[176:179], v[200:203], v[64:67]
    ds_read_b64_tr_b16 v[170:171], v221 offset:37376
    s_waitcnt lgkmcnt(8)
    v_mfma_f32_16x16x32_bf16 v[68:71], v[180:183], v[196:199], v[68:71]
    ds_read_b64_tr_b16 v[172:173], v222 offset:36864
    v_mul_f32 v248, v100, v100
    v_mul_f32 v249, v101, v101
    v_mfma_f32_16x16x32_bf16 v[76:79], v[180:183], v[200:203], v[76:79]
    ds_read_b64_tr_b16 v[174:175], v222 offset:37376
    v_mul_f32 v250, v102, v102
    v_mul_f32 v251, v103, v103
    v_mfma_f32_16x16x32_bf16 v[72:75], v[184:187], v[196:199], v[72:75]
    ds_read_b64_tr_b16 v[176:177], v223 offset:36864
    v_fma_f32 v248, v248, s55, v252
    v_fma_f32 v249, v249, s55, v252
    v_mfma_f32_16x16x32_bf16 v[80:83], v[184:187], v[200:203], v[80:83]
    ds_read_b64_tr_b16 v[178:179], v223 offset:37376
    v_fma_f32 v250, v250, s55, v252
    v_fma_f32 v251, v251, s55, v252
    s_waitcnt lgkmcnt(8)
    v_mfma_f32_16x16x32_bf16 v[84:87], v[188:191], v[196:199], v[84:87]
    ds_read_b64_tr_b16 v[180:181], v232 offset:36864
    v_mul_f32 v248, v248, v100
    v_mul_f32 v249, v249, v101
    v_mfma_f32_16x16x32_bf16 v[92:95], v[188:191], v[200:203], v[92:95]
    ds_read_b64_tr_b16 v[182:183], v232 offset:37376
    v_mul_f32 v250, v250, v102
    v_mul_f32 v251, v251, v103
    v_mfma_f32_16x16x32_bf16 v[88:91], v[192:195], v[196:199], v[88:91]
    ds_read_b64_tr_b16 v[184:185], v233 offset:36864
    v_exp_f32 v248, v248
    v_exp_f32 v249, v249
    v_mfma_f32_16x16x32_bf16 v[96:99], v[192:195], v[200:203], v[96:99]
    ds_read_b64_tr_b16 v[186:187], v233 offset:37376
    v_exp_f32 v250, v250
    v_exp_f32 v251, v251
    s_waitcnt lgkmcnt(8)
    v_mfma_f32_16x16x32_bf16 v[36:39], v[164:167], v[204:207], v[36:39]
    ds_read_b64_tr_b16 v[188:189], v234 offset:36864
    v_add_f32 v248, 1.0, v248
    v_add_f32 v249, 1.0, v249
    v_mfma_f32_16x16x32_bf16 v[44:47], v[164:167], v[208:211], v[44:47]
    ds_read_b64_tr_b16 v[190:191], v234 offset:37376
    v_add_f32 v250, 1.0, v250
    v_add_f32 v251, 1.0, v251
    v_mfma_f32_16x16x32_bf16 v[40:43], v[168:171], v[204:207], v[40:43]
    ds_read_b64_tr_b16 v[192:193], v235 offset:36864
    v_rcp_f32 v248, v248
    v_rcp_f32 v249, v249
    v_mfma_f32_16x16x32_bf16 v[48:51], v[168:171], v[208:211], v[48:51]
    ds_read_b64_tr_b16 v[194:195], v235 offset:37376
    v_rcp_f32 v250, v250
    v_rcp_f32 v251, v251
    s_waitcnt lgkmcnt(8)
    v_mfma_f32_16x16x32_bf16 v[52:55], v[172:175], v[204:207], v[52:55]
    ds_read_b64_tr_b16 v[164:165], v220 offset:40960
    v_mul_f32 v100, v248, v100
    v_mul_f32 v101, v249, v101
    v_mfma_f32_16x16x32_bf16 v[60:63], v[172:175], v[208:211], v[60:63]
    ds_read_b64_tr_b16 v[166:167], v220 offset:41472
    v_mul_f32 v102, v250, v102
    v_mul_f32 v103, v251, v103
    v_mfma_f32_16x16x32_bf16 v[56:59], v[176:179], v[204:207], v[56:59]
    ds_read_b64_tr_b16 v[168:169], v221 offset:40960
    v_mul_f32 v248, v104, v104
    v_mul_f32 v249, v105, v105
    v_mfma_f32_16x16x32_bf16 v[64:67], v[176:179], v[208:211], v[64:67]
    ds_read_b64_tr_b16 v[170:171], v221 offset:41472
    v_mul_f32 v250, v106, v106
    v_mul_f32 v251, v107, v107
    s_waitcnt lgkmcnt(8)
    v_mfma_f32_16x16x32_bf16 v[68:71], v[180:183], v[204:207], v[68:71]
    ds_read_b64_tr_b16 v[172:173], v222 offset:40960
    v_fma_f32 v248, v248, s55, v252
    v_fma_f32 v249, v249, s55, v252
    v_mfma_f32_16x16x32_bf16 v[76:79], v[180:183], v[208:211], v[76:79]
    ds_read_b64_tr_b16 v[174:175], v222 offset:41472
    v_fma_f32 v250, v250, s55, v252
    v_fma_f32 v251, v251, s55, v252
    v_mfma_f32_16x16x32_bf16 v[72:75], v[184:187], v[204:207], v[72:75]
    ds_read_b64_tr_b16 v[176:177], v223 offset:40960
    v_mul_f32 v248, v248, v104
    v_mul_f32 v249, v249, v105
    v_mfma_f32_16x16x32_bf16 v[80:83], v[184:187], v[208:211], v[80:83]
    ds_read_b64_tr_b16 v[178:179], v223 offset:41472
    v_mul_f32 v250, v250, v106
    v_mul_f32 v251, v251, v107
    s_waitcnt lgkmcnt(8)
    v_mfma_f32_16x16x32_bf16 v[84:87], v[188:191], v[204:207], v[84:87]
    ds_read_b64_tr_b16 v[180:181], v232 offset:40960
    v_exp_f32 v248, v248
    v_exp_f32 v249, v249
    v_mfma_f32_16x16x32_bf16 v[92:95], v[188:191], v[208:211], v[92:95]
    ds_read_b64_tr_b16 v[182:183], v232 offset:41472
    v_exp_f32 v250, v250
    v_exp_f32 v251, v251
    v_mfma_f32_16x16x32_bf16 v[88:91], v[192:195], v[204:207], v[88:91]
    ds_read_b64_tr_b16 v[184:185], v233 offset:40960
    v_add_f32 v248, 1.0, v248
    v_add_f32 v249, 1.0, v249
    v_mfma_f32_16x16x32_bf16 v[96:99], v[192:195], v[208:211], v[96:99]
    ds_read_b64_tr_b16 v[186:187], v233 offset:41472
    v_add_f32 v250, 1.0, v250
    v_add_f32 v251, 1.0, v251
    s_waitcnt lgkmcnt(8)
    v_mfma_f32_16x16x32_bf16 v[36:39], v[164:167], v[212:215], v[36:39]
    ds_read_b64_tr_b16 v[188:189], v234 offset:40960
    v_rcp_f32 v248, v248
    v_rcp_f32 v249, v249
    v_mfma_f32_16x16x32_bf16 v[44:47], v[164:167], v[216:219], v[44:47]
    ds_read_b64_tr_b16 v[190:191], v234 offset:41472
    v_rcp_f32 v250, v250
    v_rcp_f32 v251, v251
    v_mfma_f32_16x16x32_bf16 v[40:43], v[168:171], v[212:215], v[40:43]
    ds_read_b64_tr_b16 v[192:193], v235 offset:40960
    v_mul_f32 v104, v248, v104
    v_mul_f32 v105, v249, v105
    v_mfma_f32_16x16x32_bf16 v[48:51], v[168:171], v[216:219], v[48:51]
    ds_read_b64_tr_b16 v[194:195], v235 offset:41472
    v_mul_f32 v106, v250, v106
    v_mul_f32 v107, v251, v107
    s_waitcnt lgkmcnt(8)
    v_mfma_f32_16x16x32_bf16 v[52:55], v[172:175], v[212:215], v[52:55]
    ds_read_b64_tr_b16 v[164:165], v220 offset:45056
    v_cvt_pk_bf16_f32 v100, v100, v101
    v_cvt_pk_bf16_f32 v101, v102, v103
    v_mfma_f32_16x16x32_bf16 v[60:63], v[172:175], v[216:219], v[60:63]
    ds_read_b64_tr_b16 v[166:167], v220 offset:45568
    v_cvt_pk_bf16_f32 v102, v104, v105
    v_cvt_pk_bf16_f32 v103, v106, v107
    v_mfma_f32_16x16x32_bf16 v[56:59], v[176:179], v[212:215], v[56:59]
    ds_read_b64_tr_b16 v[168:169], v221 offset:45056
    v_mul_f32 v248, v108, v108
    v_mul_f32 v249, v109, v109
    v_mfma_f32_16x16x32_bf16 v[64:67], v[176:179], v[216:219], v[64:67]
    ds_read_b64_tr_b16 v[170:171], v221 offset:45568
    v_mul_f32 v250, v110, v110
    v_mul_f32 v251, v111, v111
    s_waitcnt lgkmcnt(8)
    v_mfma_f32_16x16x32_bf16 v[68:71], v[180:183], v[212:215], v[68:71]
    ds_read_b64_tr_b16 v[172:173], v222 offset:45056
    v_fma_f32 v248, v248, s55, v252
    v_fma_f32 v249, v249, s55, v252
    v_mfma_f32_16x16x32_bf16 v[76:79], v[180:183], v[216:219], v[76:79]
    ds_read_b64_tr_b16 v[174:175], v222 offset:45568
    v_fma_f32 v250, v250, s55, v252
    v_fma_f32 v251, v251, s55, v252
    v_mfma_f32_16x16x32_bf16 v[72:75], v[184:187], v[212:215], v[72:75]
    ds_read_b64_tr_b16 v[176:177], v223 offset:45056
    v_mul_f32 v248, v248, v108
    v_mul_f32 v249, v249, v109
    v_mfma_f32_16x16x32_bf16 v[80:83], v[184:187], v[216:219], v[80:83]
    ds_read_b64_tr_b16 v[178:179], v223 offset:45568
    v_mul_f32 v250, v250, v110
    v_mul_f32 v251, v251, v111
    s_waitcnt lgkmcnt(8)
    v_mfma_f32_16x16x32_bf16 v[84:87], v[188:191], v[212:215], v[84:87]
    ds_read_b64_tr_b16 v[180:181], v232 offset:45056
    v_exp_f32 v248, v248
    v_exp_f32 v249, v249
    v_mfma_f32_16x16x32_bf16 v[92:95], v[188:191], v[216:219], v[92:95]
    ds_read_b64_tr_b16 v[182:183], v232 offset:45568
    v_exp_f32 v250, v250
    v_exp_f32 v251, v251
    v_mfma_f32_16x16x32_bf16 v[88:91], v[192:195], v[212:215], v[88:91]
    ds_read_b64_tr_b16 v[184:185], v233 offset:45056
    v_add_f32 v248, 1.0, v248
    v_add_f32 v249, 1.0, v249
    v_mfma_f32_16x16x32_bf16 v[96:99], v[192:195], v[216:219], v[96:99]
    ds_read_b64_tr_b16 v[186:187], v233 offset:45568
    v_add_f32 v250, 1.0, v250
    v_add_f32 v251, 1.0, v251
    s_waitcnt lgkmcnt(8)
    v_mfma_f32_16x16x32_bf16 v[36:39], v[164:167], v[4:7], v[36:39]
    ds_read_b64_tr_b16 v[188:189], v234 offset:45056
    v_rcp_f32 v248, v248
    v_rcp_f32 v249, v249
    v_mfma_f32_16x16x32_bf16 v[44:47], v[164:167], v[8:11], v[44:47]
    ds_read_b64_tr_b16 v[190:191], v234 offset:45568
    v_rcp_f32 v250, v250
    v_rcp_f32 v251, v251
    v_mfma_f32_16x16x32_bf16 v[40:43], v[168:171], v[4:7], v[40:43]
    ds_read_b64_tr_b16 v[192:193], v235 offset:45056
    v_mul_f32 v108, v248, v108
    v_mul_f32 v109, v249, v109
    v_mfma_f32_16x16x32_bf16 v[48:51], v[168:171], v[8:11], v[48:51]
    ds_read_b64_tr_b16 v[194:195], v235 offset:45568
    v_mul_f32 v110, v250, v110
    v_mul_f32 v111, v251, v111
    s_waitcnt lgkmcnt(8)
    v_mfma_f32_16x16x32_bf16 v[52:55], v[172:175], v[4:7], v[52:55]
    ds_read_b64_tr_b16 v[164:165], v220 offset:49152
    v_mul_f32 v248, v112, v112
    v_mul_f32 v249, v113, v113
    v_mfma_f32_16x16x32_bf16 v[60:63], v[172:175], v[8:11], v[60:63]
    ds_read_b64_tr_b16 v[166:167], v220 offset:49664
    v_mul_f32 v250, v114, v114
    v_mul_f32 v251, v115, v115
    v_mfma_f32_16x16x32_bf16 v[56:59], v[176:179], v[4:7], v[56:59]
    ds_read_b64_tr_b16 v[168:169], v221 offset:49152
    v_fma_f32 v248, v248, s55, v252
    v_fma_f32 v249, v249, s55, v252
    v_mfma_f32_16x16x32_bf16 v[64:67], v[176:179], v[8:11], v[64:67]
    ds_read_b64_tr_b16 v[170:171], v221 offset:49664
    v_fma_f32 v250, v250, s55, v252
    v_fma_f32 v251, v251, s55, v252
    s_waitcnt lgkmcnt(8)
    v_mfma_f32_16x16x32_bf16 v[68:71], v[180:183], v[4:7], v[68:71]
    ds_read_b64_tr_b16 v[172:173], v222 offset:49152
    v_mul_f32 v248, v248, v112
    v_mul_f32 v249, v249, v113
    v_mfma_f32_16x16x32_bf16 v[76:79], v[180:183], v[8:11], v[76:79]
    ds_read_b64_tr_b16 v[174:175], v222 offset:49664
    v_mul_f32 v250, v250, v114
    v_mul_f32 v251, v251, v115
    v_mfma_f32_16x16x32_bf16 v[72:75], v[184:187], v[4:7], v[72:75]
    ds_read_b64_tr_b16 v[176:177], v223 offset:49152
    v_exp_f32 v248, v248
    v_exp_f32 v249, v249
    v_mfma_f32_16x16x32_bf16 v[80:83], v[184:187], v[8:11], v[80:83]
    ds_read_b64_tr_b16 v[178:179], v223 offset:49664
    v_exp_f32 v250, v250
    v_exp_f32 v251, v251
    s_waitcnt lgkmcnt(8)
    v_mfma_f32_16x16x32_bf16 v[84:87], v[188:191], v[4:7], v[84:87]
    ds_read_b64_tr_b16 v[180:181], v232 offset:49152
    v_add_f32 v248, 1.0, v248
    v_add_f32 v249, 1.0, v249
    v_mfma_f32_16x16x32_bf16 v[92:95], v[188:191], v[8:11], v[92:95]
    ds_read_b64_tr_b16 v[182:183], v232 offset:49664
    v_add_f32 v250, 1.0, v250
    v_add_f32 v251, 1.0, v251
    v_mfma_f32_16x16x32_bf16 v[88:91], v[192:195], v[4:7], v[88:91]
    ds_read_b64_tr_b16 v[184:185], v233 offset:49152
    v_rcp_f32 v248, v248
    v_rcp_f32 v249, v249
    v_mfma_f32_16x16x32_bf16 v[96:99], v[192:195], v[8:11], v[96:99]
    ds_read_b64_tr_b16 v[186:187], v233 offset:49664
    v_rcp_f32 v250, v250
    v_rcp_f32 v251, v251
    s_waitcnt lgkmcnt(8)
    v_mfma_f32_16x16x32_bf16 v[36:39], v[164:167], v[12:15], v[36:39]
    ds_read_b64_tr_b16 v[188:189], v234 offset:49152
    v_mul_f32 v112, v248, v112
    v_mul_f32 v113, v249, v113
    v_mfma_f32_16x16x32_bf16 v[44:47], v[164:167], v[16:19], v[44:47]
    ds_read_b64_tr_b16 v[190:191], v234 offset:49664
    v_mul_f32 v114, v250, v114
    v_mul_f32 v115, v251, v115
    v_mfma_f32_16x16x32_bf16 v[40:43], v[168:171], v[12:15], v[40:43]
    ds_read_b64_tr_b16 v[192:193], v235 offset:49152
    v_cvt_pk_bf16_f32 v108, v108, v109
    v_cvt_pk_bf16_f32 v109, v110, v111
    v_mfma_f32_16x16x32_bf16 v[48:51], v[168:171], v[16:19], v[48:51]
    ds_read_b64_tr_b16 v[194:195], v235 offset:49664
    v_cvt_pk_bf16_f32 v110, v112, v113
    v_cvt_pk_bf16_f32 v111, v114, v115
    s_waitcnt lgkmcnt(8)
    v_mfma_f32_16x16x32_bf16 v[52:55], v[172:175], v[12:15], v[52:55]
    ds_read_b64_tr_b16 v[164:165], v220 offset:53248
    v_mul_f32 v248, v116, v116
    v_mul_f32 v249, v117, v117
    v_mfma_f32_16x16x32_bf16 v[60:63], v[172:175], v[16:19], v[60:63]
    ds_read_b64_tr_b16 v[166:167], v220 offset:53760
    v_mul_f32 v250, v118, v118
    v_mul_f32 v251, v119, v119
    v_mfma_f32_16x16x32_bf16 v[56:59], v[176:179], v[12:15], v[56:59]
    ds_read_b64_tr_b16 v[168:169], v221 offset:53248
    v_fma_f32 v248, v248, s55, v252
    v_fma_f32 v249, v249, s55, v252
    v_mfma_f32_16x16x32_bf16 v[64:67], v[176:179], v[16:19], v[64:67]
    ds_read_b64_tr_b16 v[170:171], v221 offset:53760
    v_fma_f32 v250, v250, s55, v252
    v_fma_f32 v251, v251, s55, v252
    s_waitcnt lgkmcnt(8)
    v_mfma_f32_16x16x32_bf16 v[68:71], v[180:183], v[12:15], v[68:71]
    ds_read_b64_tr_b16 v[172:173], v222 offset:53248
    v_mul_f32 v248, v248, v116
    v_mul_f32 v249, v249, v117
    v_mfma_f32_16x16x32_bf16 v[76:79], v[180:183], v[16:19], v[76:79]
    ds_read_b64_tr_b16 v[174:175], v222 offset:53760
    v_mul_f32 v250, v250, v118
    v_mul_f32 v251, v251, v119
    v_mfma_f32_16x16x32_bf16 v[72:75], v[184:187], v[12:15], v[72:75]
    ds_read_b64_tr_b16 v[176:177], v223 offset:53248
    v_exp_f32 v248, v248
    v_exp_f32 v249, v249
    v_mfma_f32_16x16x32_bf16 v[80:83], v[184:187], v[16:19], v[80:83]
    ds_read_b64_tr_b16 v[178:179], v223 offset:53760
    v_exp_f32 v250, v250
    v_exp_f32 v251, v251
    s_waitcnt lgkmcnt(8)
    v_mfma_f32_16x16x32_bf16 v[84:87], v[188:191], v[12:15], v[84:87]
    ds_read_b64_tr_b16 v[180:181], v232 offset:53248
    v_add_f32 v248, 1.0, v248
    v_add_f32 v249, 1.0, v249
    v_mfma_f32_16x16x32_bf16 v[92:95], v[188:191], v[16:19], v[92:95]
    ds_read_b64_tr_b16 v[182:183], v232 offset:53760
    v_add_f32 v250, 1.0, v250
    v_add_f32 v251, 1.0, v251
    v_mfma_f32_16x16x32_bf16 v[88:91], v[192:195], v[12:15], v[88:91]
    ds_read_b64_tr_b16 v[184:185], v233 offset:53248
    v_rcp_f32 v248, v248
    v_rcp_f32 v249, v249
    v_mfma_f32_16x16x32_bf16 v[96:99], v[192:195], v[16:19], v[96:99]
    ds_read_b64_tr_b16 v[186:187], v233 offset:53760
    v_rcp_f32 v250, v250
    v_rcp_f32 v251, v251
    s_waitcnt lgkmcnt(8)
    v_mfma_f32_16x16x32_bf16 v[36:39], v[164:167], v[20:23], v[36:39]
    ds_read_b64_tr_b16 v[188:189], v234 offset:53248
    v_mul_f32 v116, v248, v116
    v_mul_f32 v117, v249, v117
    v_mfma_f32_16x16x32_bf16 v[44:47], v[164:167], v[24:27], v[44:47]
    ds_read_b64_tr_b16 v[190:191], v234 offset:53760
    v_mul_f32 v118, v250, v118
    v_mul_f32 v119, v251, v119
    v_mfma_f32_16x16x32_bf16 v[40:43], v[168:171], v[20:23], v[40:43]
    ds_read_b64_tr_b16 v[192:193], v235 offset:53248
    v_mul_f32 v248, v120, v120
    v_mul_f32 v249, v121, v121
    v_mfma_f32_16x16x32_bf16 v[48:51], v[168:171], v[24:27], v[48:51]
    ds_read_b64_tr_b16 v[194:195], v235 offset:53760
    v_mul_f32 v250, v122, v122
    v_mul_f32 v251, v123, v123
    s_waitcnt lgkmcnt(8)
    v_mfma_f32_16x16x32_bf16 v[52:55], v[172:175], v[20:23], v[52:55]
    ds_read_b64_tr_b16 v[164:165], v220 offset:57344
    v_fma_f32 v248, v248, s55, v252
    v_fma_f32 v249, v249, s55, v252
    v_mfma_f32_16x16x32_bf16 v[60:63], v[172:175], v[24:27], v[60:63]
    ds_read_b64_tr_b16 v[166:167], v220 offset:57856
    v_fma_f32 v250, v250, s55, v252
    v_fma_f32 v251, v251, s55, v252
    v_mfma_f32_16x16x32_bf16 v[56:59], v[176:179], v[20:23], v[56:59]
    ds_read_b64_tr_b16 v[168:169], v221 offset:57344
    v_mul_f32 v248, v248, v120
    v_mul_f32 v249, v249, v121
    v_mfma_f32_16x16x32_bf16 v[64:67], v[176:179], v[24:27], v[64:67]
    ds_read_b64_tr_b16 v[170:171], v221 offset:57856
    v_mul_f32 v250, v250, v122
    v_mul_f32 v251, v251, v123
    s_waitcnt lgkmcnt(8)
    v_mfma_f32_16x16x32_bf16 v[68:71], v[180:183], v[20:23], v[68:71]
    ds_read_b64_tr_b16 v[172:173], v222 offset:57344
    v_exp_f32 v248, v248
    v_exp_f32 v249, v249
    v_mfma_f32_16x16x32_bf16 v[76:79], v[180:183], v[24:27], v[76:79]
    ds_read_b64_tr_b16 v[174:175], v222 offset:57856
    v_exp_f32 v250, v250
    v_exp_f32 v251, v251
    v_mfma_f32_16x16x32_bf16 v[72:75], v[184:187], v[20:23], v[72:75]
    ds_read_b64_tr_b16 v[176:177], v223 offset:57344
    v_add_f32 v248, 1.0, v248
    v_add_f32 v249, 1.0, v249
    v_mfma_f32_16x16x32_bf16 v[80:83], v[184:187], v[24:27], v[80:83]
    ds_read_b64_tr_b16 v[178:179], v223 offset:57856
    v_add_f32 v250, 1.0, v250
    v_add_f32 v251, 1.0, v251
    s_waitcnt lgkmcnt(8)
    v_mfma_f32_16x16x32_bf16 v[84:87], v[188:191], v[20:23], v[84:87]
    ds_read_b64_tr_b16 v[180:181], v232 offset:57344
    v_rcp_f32 v248, v248
    v_rcp_f32 v249, v249
    v_mfma_f32_16x16x32_bf16 v[92:95], v[188:191], v[24:27], v[92:95]
    ds_read_b64_tr_b16 v[182:183], v232 offset:57856
    v_rcp_f32 v250, v250
    v_rcp_f32 v251, v251
    v_mfma_f32_16x16x32_bf16 v[88:91], v[192:195], v[20:23], v[88:91]
    ds_read_b64_tr_b16 v[184:185], v233 offset:57344
    v_mul_f32 v120, v248, v120
    v_mul_f32 v121, v249, v121
    v_mfma_f32_16x16x32_bf16 v[96:99], v[192:195], v[24:27], v[96:99]
    ds_read_b64_tr_b16 v[186:187], v233 offset:57856
    v_mul_f32 v122, v250, v122
    v_mul_f32 v123, v251, v123
    s_waitcnt lgkmcnt(8)
    v_mfma_f32_16x16x32_bf16 v[36:39], v[164:167], v[148:151], v[36:39]
    ds_read_b64_tr_b16 v[188:189], v234 offset:57344
    v_cvt_pk_bf16_f32 v116, v116, v117
    v_cvt_pk_bf16_f32 v117, v118, v119
    v_mfma_f32_16x16x32_bf16 v[44:47], v[164:167], v[152:155], v[44:47]
    ds_read_b64_tr_b16 v[190:191], v234 offset:57856
    v_cvt_pk_bf16_f32 v118, v120, v121
    v_cvt_pk_bf16_f32 v119, v122, v123
    v_mfma_f32_16x16x32_bf16 v[40:43], v[168:171], v[148:151], v[40:43]
    ds_read_b64_tr_b16 v[192:193], v235 offset:57344
    v_mul_f32 v248, v124, v124
    v_mul_f32 v249, v125, v125
    v_mfma_f32_16x16x32_bf16 v[48:51], v[168:171], v[152:155], v[48:51]
    ds_read_b64_tr_b16 v[194:195], v235 offset:57856
    v_mul_f32 v250, v126, v126
    v_mul_f32 v251, v127, v127
    s_waitcnt lgkmcnt(8)
    v_mfma_f32_16x16x32_bf16 v[52:55], v[172:175], v[148:151], v[52:55]
    ds_read_b64_tr_b16 v[164:165], v220 offset:61440
    v_fma_f32 v248, v248, s55, v252
    v_fma_f32 v249, v249, s55, v252
    v_mfma_f32_16x16x32_bf16 v[60:63], v[172:175], v[152:155], v[60:63]
    ds_read_b64_tr_b16 v[166:167], v220 offset:61952
    v_fma_f32 v250, v250, s55, v252
    v_fma_f32 v251, v251, s55, v252
    v_mfma_f32_16x16x32_bf16 v[56:59], v[176:179], v[148:151], v[56:59]
    ds_read_b64_tr_b16 v[168:169], v221 offset:61440
    v_mul_f32 v248, v248, v124
    v_mul_f32 v249, v249, v125
    v_mfma_f32_16x16x32_bf16 v[64:67], v[176:179], v[152:155], v[64:67]
    ds_read_b64_tr_b16 v[170:171], v221 offset:61952
    v_mul_f32 v250, v250, v126
    v_mul_f32 v251, v251, v127
    s_waitcnt lgkmcnt(8)
    v_mfma_f32_16x16x32_bf16 v[68:71], v[180:183], v[148:151], v[68:71]
    ds_read_b64_tr_b16 v[172:173], v222 offset:61440
    v_exp_f32 v248, v248
    v_exp_f32 v249, v249
    v_mfma_f32_16x16x32_bf16 v[76:79], v[180:183], v[152:155], v[76:79]
    ds_read_b64_tr_b16 v[174:175], v222 offset:61952
    v_exp_f32 v250, v250
    v_exp_f32 v251, v251
    v_mfma_f32_16x16x32_bf16 v[72:75], v[184:187], v[148:151], v[72:75]
    ds_read_b64_tr_b16 v[176:177], v223 offset:61440
    v_add_f32 v248, 1.0, v248
    v_add_f32 v249, 1.0, v249
    v_mfma_f32_16x16x32_bf16 v[80:83], v[184:187], v[152:155], v[80:83]
    ds_read_b64_tr_b16 v[178:179], v223 offset:61952
    v_add_f32 v250, 1.0, v250
    v_add_f32 v251, 1.0, v251
    s_waitcnt lgkmcnt(8)
    v_mfma_f32_16x16x32_bf16 v[84:87], v[188:191], v[148:151], v[84:87]
    ds_read_b64_tr_b16 v[180:181], v232 offset:61440
    v_rcp_f32 v248, v248
    v_rcp_f32 v249, v249
    v_mfma_f32_16x16x32_bf16 v[92:95], v[188:191], v[152:155], v[92:95]
    ds_read_b64_tr_b16 v[182:183], v232 offset:61952
    v_rcp_f32 v250, v250
    v_rcp_f32 v251, v251
    v_mfma_f32_16x16x32_bf16 v[88:91], v[192:195], v[148:151], v[88:91]
    ds_read_b64_tr_b16 v[184:185], v233 offset:61440
    v_mul_f32 v124, v248, v124
    v_mul_f32 v125, v249, v125
    v_mfma_f32_16x16x32_bf16 v[96:99], v[192:195], v[152:155], v[96:99]
    ds_read_b64_tr_b16 v[186:187], v233 offset:61952
    v_mul_f32 v126, v250, v126
    v_mul_f32 v127, v251, v127
    s_waitcnt lgkmcnt(8)
    v_mfma_f32_16x16x32_bf16 v[36:39], v[164:167], v[28:31], v[36:39]
    ds_read_b64_tr_b16 v[188:189], v234 offset:61440
    v_mul_f32 v248, v128, v128
    v_mul_f32 v249, v129, v129
    v_mfma_f32_16x16x32_bf16 v[44:47], v[164:167], v[32:35], v[44:47]
    ds_read_b64_tr_b16 v[190:191], v234 offset:61952
    v_mul_f32 v250, v130, v130
    v_mul_f32 v251, v131, v131
    v_mfma_f32_16x16x32_bf16 v[40:43], v[168:171], v[28:31], v[40:43]
    ds_read_b64_tr_b16 v[192:193], v235 offset:61440
    v_fma_f32 v248, v248, s55, v252
    v_fma_f32 v249, v249, s55, v252
    v_mfma_f32_16x16x32_bf16 v[48:51], v[168:171], v[32:35], v[48:51]
    ds_read_b64_tr_b16 v[194:195], v235 offset:61952
    v_fma_f32 v250, v250, s55, v252
    v_fma_f32 v251, v251, s55, v252
    s_waitcnt lgkmcnt(8)
    v_mfma_f32_16x16x32_bf16 v[52:55], v[172:175], v[28:31], v[52:55]
    v_mul_f32 v248, v248, v128
    v_mul_f32 v249, v249, v129
    v_mfma_f32_16x16x32_bf16 v[60:63], v[172:175], v[32:35], v[60:63]
    v_mul_f32 v250, v250, v130
    v_mul_f32 v251, v251, v131
    v_mfma_f32_16x16x32_bf16 v[56:59], v[176:179], v[28:31], v[56:59]
    v_exp_f32 v248, v248
    v_exp_f32 v249, v249
    v_mfma_f32_16x16x32_bf16 v[64:67], v[176:179], v[32:35], v[64:67]
    v_exp_f32 v250, v250
    v_exp_f32 v251, v251
    s_waitcnt lgkmcnt(4)
    v_mfma_f32_16x16x32_bf16 v[68:71], v[180:183], v[28:31], v[68:71]
    v_add_f32 v248, 1.0, v248
    v_add_f32 v249, 1.0, v249
    v_mfma_f32_16x16x32_bf16 v[76:79], v[180:183], v[32:35], v[76:79]
    v_add_f32 v250, 1.0, v250
    v_add_f32 v251, 1.0, v251
    v_mfma_f32_16x16x32_bf16 v[72:75], v[184:187], v[28:31], v[72:75]
    v_rcp_f32 v248, v248
    v_rcp_f32 v249, v249
    v_mfma_f32_16x16x32_bf16 v[80:83], v[184:187], v[32:35], v[80:83]
    v_rcp_f32 v250, v250
    v_rcp_f32 v251, v251
    s_waitcnt lgkmcnt(0)
    v_mfma_f32_16x16x32_bf16 v[84:87], v[188:191], v[28:31], v[84:87]
    v_mul_f32 v128, v248, v128
    v_mul_f32 v129, v249, v129
    v_mfma_f32_16x16x32_bf16 v[92:95], v[188:191], v[32:35], v[92:95]
    v_mul_f32 v130, v250, v130
    v_mul_f32 v131, v251, v131
    v_mfma_f32_16x16x32_bf16 v[88:91], v[192:195], v[28:31], v[88:91]
    v_cvt_pk_bf16_f32 v124, v124, v125
    v_cvt_pk_bf16_f32 v125, v126, v127
    v_mfma_f32_16x16x32_bf16 v[96:99], v[192:195], v[32:35], v[96:99]
    v_cvt_pk_bf16_f32 v126, v128, v129
    v_cvt_pk_bf16_f32 v127, v130, v131
    s_load_dwordx2 s[96:97], s[0:1], 40
    s_load_dwordx2 s[58:59], s[0:1], 64
    s_load_dwordx2 s[100:101], s[0:1], 80
    s_load_dwordx2 s[98:99], s[0:1], 72
    s_add_u32 s24, s4, 75497472
    s_addc_u32 s25, s5, 0
    s_mov_b32 s26, 3670016
    s_mov_b32 s27, 0x20000
    v_mov_b32 v132, 0
    v_mov_b32 v133, 0
    v_mov_b32 v134, 0
    v_mov_b32 v135, 0
    v_mov_b32 v136, 0
    v_mov_b32 v137, 0
    v_mov_b32 v138, 0
    v_mov_b32 v139, 0
    v_mov_b32 v140, 0
    v_mov_b32 v141, 0
    v_mov_b32 v142, 0
    v_mov_b32 v143, 0
    v_mov_b32 v144, 0
    v_mov_b32 v145, 0
    v_mov_b32 v146, 0
    v_mov_b32 v147, 0
    v_mov_b32 v156, 0
    v_mov_b32 v157, 0
    v_mov_b32 v158, 0
    v_mov_b32 v159, 0
    v_mov_b32 v160, 0
    v_mov_b32 v161, 0
    v_mov_b32 v162, 0
    v_mov_b32 v163, 0
    v_mov_b32 v228, 0
    v_mov_b32 v229, 0
    v_mov_b32 v230, 0
    v_mov_b32 v231, 0
    v_mov_b32 v232, 0
    v_mov_b32 v233, 0
    v_mov_b32 v234, 0
    v_mov_b32 v235, 0
    v_mov_b32 v236, 0x3f803f80
    v_mov_b32 v237, 0x3f803f80
    v_mov_b32 v238, 0x3f803f80
    v_mov_b32 v239, 0x3f803f80
    buffer_store_dwordx4 v[100:103], v3, s[20:23], s44 offen offset:0 sc1
    v_mul_f32 v36, 0x3e0293ee, v36
    v_mul_f32 v37, 0x3e0293ee, v37
    v_mul_f32 v38, 0x3e0293ee, v38
    v_mul_f32 v39, 0x3e0293ee, v39
    v_mul_f32 v40, 0x3e0293ee, v40
    v_mul_f32 v41, 0x3e0293ee, v41
    v_mul_f32 v42, 0x3e0293ee, v42
    v_mul_f32 v43, 0x3e0293ee, v43
    v_cvt_pk_bf16_f32 v4, v36, v37
    v_cvt_pk_bf16_f32 v5, v38, v39
    v_cvt_pk_bf16_f32 v6, v40, v41
    v_cvt_pk_bf16_f32 v7, v42, v43
    v_mov_b32 v36, 0
    v_mov_b32 v37, 0
    v_mov_b32 v38, 0
    v_mov_b32 v39, 0
    v_mov_b32 v40, 0
    v_mov_b32 v41, 0
    v_mov_b32 v42, 0
    v_mov_b32 v43, 0
    buffer_store_dwordx4 v[108:111], v3, s[20:23], s44 offen offset:256 sc1
    v_mul_f32 v44, 0x3e0293ee, v44
    v_mul_f32 v45, 0x3e0293ee, v45
    v_mul_f32 v46, 0x3e0293ee, v46
    v_mul_f32 v47, 0x3e0293ee, v47
    v_mul_f32 v48, 0x3e0293ee, v48
    v_mul_f32 v49, 0x3e0293ee, v49
    v_mul_f32 v50, 0x3e0293ee, v50
    v_mul_f32 v51, 0x3e0293ee, v51
    v_cvt_pk_bf16_f32 v8, v44, v45
    v_cvt_pk_bf16_f32 v9, v46, v47
    v_cvt_pk_bf16_f32 v10, v48, v49
    v_cvt_pk_bf16_f32 v11, v50, v51
    v_mov_b32 v44, 0
    v_mov_b32 v45, 0
    v_mov_b32 v46, 0
    v_mov_b32 v47, 0
    v_mov_b32 v48, 0
    v_mov_b32 v49, 0
    v_mov_b32 v50, 0
    v_mov_b32 v51, 0
    buffer_store_dwordx4 v[116:119], v3, s[20:23], s44 offen offset:2048 sc1
    v_mul_f32 v52, 0x3e0293ee, v52
    v_mul_f32 v53, 0x3e0293ee, v53
    v_mul_f32 v54, 0x3e0293ee, v54
    v_mul_f32 v55, 0x3e0293ee, v55
    v_mul_f32 v56, 0x3e0293ee, v56
    v_mul_f32 v57, 0x3e0293ee, v57
    v_mul_f32 v58, 0x3e0293ee, v58
    v_mul_f32 v59, 0x3e0293ee, v59
    v_cvt_pk_bf16_f32 v12, v52, v53
    v_cvt_pk_bf16_f32 v13, v54, v55
    v_cvt_pk_bf16_f32 v14, v56, v57
    v_cvt_pk_bf16_f32 v15, v58, v59
    v_mov_b32 v52, 0
    v_mov_b32 v53, 0
    v_mov_b32 v54, 0
    v_mov_b32 v55, 0
    v_mov_b32 v56, 0
    v_mov_b32 v57, 0
    v_mov_b32 v58, 0
    v_mov_b32 v59, 0
    buffer_store_dwordx4 v[124:127], v3, s[20:23], s44 offen offset:2304 sc1
    v_mul_f32 v60, 0x3e0293ee, v60
    v_mul_f32 v61, 0x3e0293ee, v61
    v_mul_f32 v62, 0x3e0293ee, v62
    v_mul_f32 v63, 0x3e0293ee, v63
    v_mul_f32 v64, 0x3e0293ee, v64
    v_mul_f32 v65, 0x3e0293ee, v65
    v_mul_f32 v66, 0x3e0293ee, v66
    v_mul_f32 v67, 0x3e0293ee, v67
    v_cvt_pk_bf16_f32 v16, v60, v61
    v_cvt_pk_bf16_f32 v17, v62, v63
    v_cvt_pk_bf16_f32 v18, v64, v65
    v_cvt_pk_bf16_f32 v19, v66, v67
    v_mov_b32 v60, 0
    v_mov_b32 v61, 0
    v_mov_b32 v62, 0
    v_mov_b32 v63, 0
    v_mov_b32 v64, 0
    v_mov_b32 v65, 0
    v_mov_b32 v66, 0
    v_mov_b32 v67, 0
    v_mul_f32 v68, 0x3e0293ee, v68
    v_mul_f32 v69, 0x3e0293ee, v69
    v_mul_f32 v70, 0x3e0293ee, v70
    v_mul_f32 v71, 0x3e0293ee, v71
    v_mul_f32 v72, 0x3e0293ee, v72
    v_mul_f32 v73, 0x3e0293ee, v73
    v_mul_f32 v74, 0x3e0293ee, v74
    v_mul_f32 v75, 0x3e0293ee, v75
    v_cvt_pk_bf16_f32 v20, v68, v69
    v_cvt_pk_bf16_f32 v21, v70, v71
    v_cvt_pk_bf16_f32 v22, v72, v73
    v_cvt_pk_bf16_f32 v23, v74, v75
    v_mov_b32 v68, 0
    v_mov_b32 v69, 0
    v_mov_b32 v70, 0
    v_mov_b32 v71, 0
    v_mov_b32 v72, 0
    v_mov_b32 v73, 0
    v_mov_b32 v74, 0
    v_mov_b32 v75, 0
    v_mul_f32 v76, 0x3e0293ee, v76
    v_mul_f32 v77, 0x3e0293ee, v77
    v_mul_f32 v78, 0x3e0293ee, v78
    v_mul_f32 v79, 0x3e0293ee, v79
    v_mul_f32 v80, 0x3e0293ee, v80
    v_mul_f32 v81, 0x3e0293ee, v81
    v_mul_f32 v82, 0x3e0293ee, v82
    v_mul_f32 v83, 0x3e0293ee, v83
    v_cvt_pk_bf16_f32 v24, v76, v77
    v_cvt_pk_bf16_f32 v25, v78, v79
    v_cvt_pk_bf16_f32 v26, v80, v81
    v_cvt_pk_bf16_f32 v27, v82, v83
    v_mov_b32 v76, 0
    v_mov_b32 v77, 0
    v_mov_b32 v78, 0
    v_mov_b32 v79, 0
    v_mov_b32 v80, 0
    v_mov_b32 v81, 0
    v_mov_b32 v82, 0
    v_mov_b32 v83, 0
    v_mul_f32 v84, 0x3e0293ee, v84
    v_mul_f32 v85, 0x3e0293ee, v85
    v_mul_f32 v86, 0x3e0293ee, v86
    v_mul_f32 v87, 0x3e0293ee, v87
    v_mul_f32 v88, 0x3e0293ee, v88
    v_mul_f32 v89, 0x3e0293ee, v89
    v_mul_f32 v90, 0x3e0293ee, v90
    v_mul_f32 v91, 0x3e0293ee, v91
    v_cvt_pk_bf16_f32 v28, v84, v85
    v_cvt_pk_bf16_f32 v29, v86, v87
    v_cvt_pk_bf16_f32 v30, v88, v89
    v_cvt_pk_bf16_f32 v31, v90, v91
    v_mov_b32 v84, 0
    v_mov_b32 v85, 0
    v_mov_b32 v86, 0
    v_mov_b32 v87, 0
    v_mov_b32 v88, 0
    v_mov_b32 v89, 0
    v_mov_b32 v90, 0
    v_mov_b32 v91, 0
    v_mul_f32 v92, 0x3e0293ee, v92
    v_mul_f32 v93, 0x3e0293ee, v93
    v_mul_f32 v94, 0x3e0293ee, v94
    v_mul_f32 v95, 0x3e0293ee, v95
    v_mul_f32 v96, 0x3e0293ee, v96
    v_mul_f32 v97, 0x3e0293ee, v97
    v_mul_f32 v98, 0x3e0293ee, v98
    v_mul_f32 v99, 0x3e0293ee, v99
    v_cvt_pk_bf16_f32 v32, v92, v93
    v_cvt_pk_bf16_f32 v33, v94, v95
    v_cvt_pk_bf16_f32 v34, v96, v97
    v_cvt_pk_bf16_f32 v35, v98, v99
    v_mov_b32 v92, 0
    v_mov_b32 v93, 0
    v_mov_b32 v94, 0
    v_mov_b32 v95, 0
    v_mov_b32 v96, 0
    v_mov_b32 v97, 0
    v_mov_b32 v98, 0
    v_mov_b32 v99, 0
    v_mov_b32 v3, 0
    s_mov_b32 s6, 1
    s_waitcnt lgkmcnt(0)
    s_cmp_eq_u32 s31, 0
    s_cbranch_scc1 L_k2mask_7
L_k2mret_8:
    s_barrier
L_k2nb_9:
    ds_read_b128 v[164:167], v241 offset:0
    ds_read_b128 v[168:171], v241 offset:1024
    ds_read_b128 v[172:175], v241 offset:2048
    ds_read_b128 v[176:179], v241 offset:3072
    ds_read_b128 v[180:183], v241 offset:4096
    ds_read_b128 v[184:187], v241 offset:5120
    ds_read_b128 v[188:191], v241 offset:6144
    ds_read_b128 v[192:195], v241 offset:7168
    s_waitcnt lgkmcnt(6)
    v_mfma_f32_16x16x32_bf16 v[100:103], v[164:167], v[4:7], v[132:135]
    v_mfma_f32_16x16x32_bf16 v[108:111], v[164:167], v[8:11], v[140:143]
    ds_read_b128 v[164:167], v241 offset:8192
    v_mfma_f32_16x16x32_bf16 v[104:107], v[168:171], v[4:7], v[136:139]
    s_add_u32 s51, s51, 1
    v_mfma_f32_16x16x32_bf16 v[112:115], v[168:171], v[8:11], v[144:147]
    ds_read_b128 v[168:171], v241 offset:9216
    s_waitcnt lgkmcnt(6)
    v_mfma_f32_16x16x32_bf16 v[100:103], v[172:175], v[12:15], v[100:103]
    v_mfma_f32_16x16x32_bf16 v[108:111], v[172:175], v[16:19], v[108:111]
    ds_read_b128 v[172:175], v241 offset:10240
    v_mfma_f32_16x16x32_bf16 v[104:107], v[176:179], v[12:15], v[104:107]
    v_mfma_f32_16x16x32_bf16 v[112:115], v[176:179], v[16:19], v[112:115]
    ds_read_b128 v[176:179], v241 offset:11264
    s_waitcnt lgkmcnt(6)
    v_mfma_f32_16x16x32_bf16 v[100:103], v[180:183], v[20:23], v[100:103]
    v_mfma_f32_16x16x32_bf16 v[108:111], v[180:183], v[24:27], v[108:111]
    ds_read_b128 v[180:183], v241 offset:12288
    v_mfma_f32_16x16x32_bf16 v[104:107], v[184:187], v[20:23], v[104:107]
    v_mfma_f32_16x16x32_bf16 v[112:115], v[184:187], v[24:27], v[112:115]
    ds_read_b128 v[184:187], v241 offset:13312
    s_waitcnt lgkmcnt(6)
    v_mfma_f32_16x16x32_bf16 v[100:103], v[188:191], v[28:31], v[100:103]
    v_mfma_f32_16x16x32_bf16 v[108:111], v[188:191], v[32:35], v[108:111]
    ds_read_b128 v[188:191], v241 offset:14336
    v_mfma_f32_16x16x32_bf16 v[104:107], v[192:195], v[28:31], v[104:107]
    v_mfma_f32_16x16x32_bf16 v[112:115], v[192:195], v[32:35], v[112:115]
    ds_read_b128 v[192:195], v241 offset:15360
    ds_read_b128 v[196:199], v241 offset:24576
    ds_read_b128 v[200:203], v241 offset:25600
    s_add_u32 s16, s4, 50331648
    s_addc_u32 s17, s5, 0
    s_mov_b32 s18, 16777216
    s_mov_b32 s19, 0x20000
    s_nop 7
    v_max3_f32 v248, v100, v101, v102
    v_max3_f32 v248, v248, v103, v104
    v_max3_f32 v248, v248, v105, v106
    v_max_f32 v248, v248, v107
    v_max3_f32 v249, v108, v109, v110
    v_max3_f32 v249, v249, v111, v112
    v_max3_f32 v249, v249, v113, v114
    v_max_f32 v249, v249, v115
    v_mov_b32 v250, v248
    v_mov_b32 v251, v249
    s_nop 1
    v_permlane16_swap_b32 v248, v250
    v_permlane16_swap_b32 v249, v251
    s_nop 1
    v_max_f32 v248, v248, v250
    v_max_f32 v249, v249, v251
    v_mov_b32 v250, v248
    v_mov_b32 v251, v249
    s_nop 1
    v_permlane32_swap_b32 v248, v250
    v_permlane32_swap_b32 v249, v251
    s_nop 1
    v_max_f32 v248, v248, v250
    v_max_f32 v249, v249, v251
    v_sub_f32 v132, v132, v248
    v_sub_f32 v133, v133, v248
    v_sub_f32 v134, v134, v248
    v_sub_f32 v135, v135, v248
    v_sub_f32 v136, v136, v248
    v_sub_f32 v137, v137, v248
    v_sub_f32 v138, v138, v248
    v_sub_f32 v139, v139, v248
    v_sub_f32 v140, v140, v249
    v_sub_f32 v141, v141, v249
    v_sub_f32 v142, v142, v249
    v_sub_f32 v143, v143, v249
    v_sub_f32 v144, v144, v249
    v_sub_f32 v145, v145, v249
    v_sub_f32 v146, v146, v249
    v_sub_f32 v147, v147, v249
    v_sub_f32 v100, v100, v248
    v_sub_f32 v101, v101, v248
    v_sub_f32 v102, v102, v248
    v_sub_f32 v103, v103, v248
    v_sub_f32 v104, v104, v248
    v_sub_f32 v105, v105, v248
    v_sub_f32 v106, v106, v248
    v_sub_f32 v107, v107, v248
    v_sub_f32 v108, v108, v249
    v_sub_f32 v109, v109, v249
    v_sub_f32 v110, v110, v249
    v_sub_f32 v111, v111, v249
    v_sub_f32 v112, v112, v249
    v_sub_f32 v113, v113, v249
    v_sub_f32 v114, v114, v249
    v_sub_f32 v115, v115, v249
    s_mov_b32 s20, s98
    s_mov_b32 s21, s99
    s_mov_b32 s22, 4096
    s_mov_b32 s23, 0x20000
    s_lshl_b32 s47, s2, 12
    v_lshlrev_b32 v240, 7, v246
    buffer_load_dword v255, v240, s[20:23], s47 offen
    s_mov_b32 s20, s58
    s_mov_b32 s21, s59
    s_mov_b32 s22, 0
    s_mov_b32 s23, 0x20000
    s_sub_u32 s48, s2, 128
    s_lshl_b32 s48, s48, 2
    s_add_u32 s48, s48, s43
    s_mov_b32 s47, 0
    s_mov_b32 s50, 2
    s_cmp_lt_u32 s2, 128
    s_cselect_b32 s49, 4, 0
    v_and_b32 v240, 31, v246
    v_lshlrev_b32 v240, 7, v240
    s_cmp_lt_u32 s31, 3
    s_cbranch_scc1 L_k2_A_odd
L_k2_A_loop:
    s_waitcnt lgkmcnt(6)
    v_mfma_f32_16x16x32_bf16 v[116:119], v[164:167], v[4:7], v[132:135]
    v_exp_f32 v100, v100
    v_mfma_f32_16x16x32_bf16 v[124:127], v[164:167], v[8:11], v[140:143]
    ds_read_b128 v[204:207], v241 offset:26624
    v_mfma_f32_16x16x32_bf16 v[120:123], v[168:171], v[4:7], v[136:139]
    v_exp_f32 v101, v101
    v_mfma_f32_16x16x32_bf16 v[128:131], v[168:171], v[8:11], v[144:147]
    ds_read_b128 v[208:211], v241 offset:27648
    v_mfma_f32_16x16x32_bf16 v[116:119], v[172:175], v[12:15], v[116:119]
    v_exp_f32 v102, v102
    v_mfma_f32_16x16x32_bf16 v[124:127], v[172:175], v[16:19], v[124:127]
    ds_read_b128 v[212:215], v241 offset:28672
    v_cvt_pk_bf16_f32 v148, v100, v101
    v_mfma_f32_16x16x32_bf16 v[120:123], v[176:179], v[12:15], v[120:123]
    v_exp_f32 v103, v103
    v_mfma_f32_16x16x32_bf16 v[128:131], v[176:179], v[16:19], v[128:131]
    ds_read_b128 v[216:219], v241 offset:29696
    s_waitcnt lgkmcnt(6)
    v_mfma_f32_16x16x32_bf16 v[116:119], v[180:183], v[20:23], v[116:119]
    v_exp_f32 v104, v104
    v_mfma_f32_16x16x32_bf16 v[124:127], v[180:183], v[24:27], v[124:127]
    ds_read_b128 v[220:223], v241 offset:30720
    v_cvt_pk_bf16_f32 v149, v102, v103
    v_mfma_f32_16x16x32_bf16 v[120:123], v[184:187], v[20:23], v[120:123]
    v_exp_f32 v105, v105
    v_mfma_f32_16x16x32_bf16 v[128:131], v[184:187], v[24:27], v[128:131]
    ds_read_b128 v[224:227], v241 offset:31744
    s_add_u32 s3, s3, 65536
    s_sub_u32 s7, s3, 163840
    v_mfma_f32_16x16x32_bf16 v[116:119], v[188:191], v[28:31], v[116:119]
    v_exp_f32 v106, v106
    v_mfma_f32_16x16x32_bf16 v[124:127], v[188:191], v[32:35], v[124:127]
    ds_read_b128 v[164:167], v242 offset:0
    v_cvt_pk_bf16_f32 v150, v104, v105
    v_mfma_f32_16x16x32_bf16 v[120:123], v[192:195], v[28:31], v[120:123]
    v_exp_f32 v107, v107
    v_mfma_f32_16x16x32_bf16 v[128:131], v[192:195], v[32:35], v[128:131]
    ds_read_b128 v[168:171], v242 offset:1024
    s_min_u32 s3, s3, s7
    s_waitcnt lgkmcnt(6)
    v_mfma_f32_16x16x32_bf16 v[36:39], v[196:199], v[156:159], v[36:39]
    v_exp_f32 v108, v108
    v_mfma_f32_16x16x32_bf16 v[44:47], v[196:199], v[160:163], v[44:47]
    ds_read_b128 v[172:175], v242 offset:2048
    v_cvt_pk_bf16_f32 v151, v106, v107
    v_mfma_f32_16x16x32_bf16 v[40:43], v[200:203], v[156:159], v[40:43]
    v_exp_f32 v109, v109
    v_mfma_f32_16x16x32_bf16 v[48:51], v[200:203], v[160:163], v[48:51]
    ds_read_b128 v[176:179], v242 offset:3072
    v_mfma_f32_16x16x32_bf16 v[52:55], v[204:207], v[156:159], v[52:55]
    v_exp_f32 v110, v110
    v_mfma_f32_16x16x32_bf16 v[60:63], v[204:207], v[160:163], v[60:63]
    ds_read_b128 v[180:183], v242 offset:4096
    v_cvt_pk_bf16_f32 v152, v108, v109
    v_mfma_f32_16x16x32_bf16 v[56:59], v[208:211], v[156:159], v[56:59]
    v_exp_f32 v111, v111
    v_mfma_f32_16x16x32_bf16 v[64:67], v[208:211], v[160:163], v[64:67]
    ds_read_b128 v[184:187], v242 offset:5120
    v_mfma_f32_16x16x32_bf16 v[228:231], v[236:239], v[156:159], v[228:231]
    v_exp_f32 v112, v112
    v_mfma_f32_16x16x32_bf16 v[232:235], v[236:239], v[160:163], v[232:235]
    v_cvt_pk_bf16_f32 v153, v110, v111
    s_waitcnt lgkmcnt(6)
    v_mfma_f32_16x16x32_bf16 v[68:71], v[212:215], v[156:159], v[68:71]
    v_exp_f32 v113, v113
    v_mfma_f32_16x16x32_bf16 v[76:79], v[212:215], v[160:163], v[76:79]
    ds_read_b128 v[188:191], v242 offset:6144
    v_mfma_f32_16x16x32_bf16 v[72:75], v[216:219], v[156:159], v[72:75]
    v_exp_f32 v114, v114
    v_mfma_f32_16x16x32_bf16 v[80:83], v[216:219], v[160:163], v[80:83]
    ds_read_b128 v[192:195], v242 offset:7168
    v_cvt_pk_bf16_f32 v154, v112, v113
    v_mfma_f32_16x16x32_bf16 v[84:87], v[220:223], v[156:159], v[84:87]
    v_exp_f32 v115, v115
    v_mfma_f32_16x16x32_bf16 v[92:95], v[220:223], v[160:163], v[92:95]
    ds_read_b128 v[196:199], v242 offset:16384
    v_mfma_f32_16x16x32_bf16 v[88:91], v[224:227], v[156:159], v[88:91]
    v_cvt_pk_bf16_f32 v155, v114, v115
    v_mfma_f32_16x16x32_bf16 v[96:99], v[224:227], v[160:163], v[96:99]
    ds_read_b128 v[200:203], v242 offset:17408
    v_mov_b32 v241, v242
    v_add_u32 v242, s3, v243
    s_bitcmp1_b32 s51, 0
    s_cbranch_scc1 L_k2nb_10
    s_cmp_eq_u32 s6, 1
    s_cbranch_scc1 L_k2zs_11
L_k2zr_12:
    s_barrier
L_k2nb_10:
    s_waitcnt lgkmcnt(6)
    v_mfma_f32_16x16x32_bf16 v[100:103], v[164:167], v[4:7], v[132:135]
    v_exp_f32 v116, v116
    v_mfma_f32_16x16x32_bf16 v[108:111], v[164:167], v[8:11], v[140:143]
    ds_read_b128 v[204:207], v241 offset:18432
    s_cmp_lt_u32 s49, 4
    s_cbranch_scc1 L_k2_pfnext
L_k2_pfret:
    v_mfma_f32_16x16x32_bf16 v[104:107], v[168:171], v[4:7], v[136:139]
    v_exp_f32 v117, v117
    v_mfma_f32_16x16x32_bf16 v[112:115], v[168:171], v[8:11], v[144:147]
    ds_read_b128 v[208:211], v241 offset:19456
    s_add_u32 s51, s51, 1
    v_mfma_f32_16x16x32_bf16 v[100:103], v[172:175], v[12:15], v[100:103]
    v_exp_f32 v118, v118
    v_mfma_f32_16x16x32_bf16 v[108:111], v[172:175], v[16:19], v[108:111]
    ds_read_b128 v[212:215], v241 offset:20480
    v_cvt_pk_bf16_f32 v156, v116, v117
    v_mfma_f32_16x16x32_bf16 v[104:107], v[176:179], v[12:15], v[104:107]
    v_exp_f32 v119, v119
    v_mfma_f32_16x16x32_bf16 v[112:115], v[176:179], v[16:19], v[112:115]
    ds_read_b128 v[216:219], v241 offset:21504
    s_waitcnt lgkmcnt(6)
    v_mfma_f32_16x16x32_bf16 v[100:103], v[180:183], v[20:23], v[100:103]
    v_exp_f32 v120, v120
    v_mfma_f32_16x16x32_bf16 v[108:111], v[180:183], v[24:27], v[108:111]
    ds_read_b128 v[220:223], v241 offset:22528
    v_cvt_pk_bf16_f32 v157, v118, v119
    v_mfma_f32_16x16x32_bf16 v[104:107], v[184:187], v[20:23], v[104:107]
    v_exp_f32 v121, v121
    v_mfma_f32_16x16x32_bf16 v[112:115], v[184:187], v[24:27], v[112:115]
    ds_read_b128 v[224:227], v241 offset:23552
    v_mfma_f32_16x16x32_bf16 v[100:103], v[188:191], v[28:31], v[100:103]
    v_exp_f32 v122, v122
    v_mfma_f32_16x16x32_bf16 v[108:111], v[188:191], v[32:35], v[108:111]
    ds_read_b128 v[164:167], v241 offset:8192
    v_cvt_pk_bf16_f32 v158, v120, v121
    v_mfma_f32_16x16x32_bf16 v[104:107], v[192:195], v[28:31], v[104:107]
    v_exp_f32 v123, v123
    v_mfma_f32_16x16x32_bf16 v[112:115], v[192:195], v[32:35], v[112:115]
    ds_read_b128 v[168:171], v241 offset:9216
    s_waitcnt lgkmcnt(6)
    v_mfma_f32_16x16x32_bf16 v[36:39], v[196:199], v[148:151], v[36:39]
    v_exp_f32 v124, v124
    v_mfma_f32_16x16x32_bf16 v[44:47], v[196:199], v[152:155], v[44:47]
    ds_read_b128 v[172:175], v241 offset:10240
    v_cvt_pk_bf16_f32 v159, v122, v123
    v_mfma_f32_16x16x32_bf16 v[40:43], v[200:203], v[148:151], v[40:43]
    v_exp_f32 v125, v125
    v_mfma_f32_16x16x32_bf16 v[48:51], v[200:203], v[152:155], v[48:51]
    ds_read_b128 v[176:179], v241 offset:11264
    v_mfma_f32_16x16x32_bf16 v[52:55], v[204:207], v[148:151], v[52:55]
    v_exp_f32 v126, v126
    v_mfma_f32_16x16x32_bf16 v[60:63], v[204:207], v[152:155], v[60:63]
    ds_read_b128 v[180:183], v241 offset:12288
    v_cvt_pk_bf16_f32 v160, v124, v125
    v_mfma_f32_16x16x32_bf16 v[56:59], v[208:211], v[148:151], v[56:59]
    v_exp_f32 v127, v127
    v_mfma_f32_16x16x32_bf16 v[64:67], v[208:211], v[152:155], v[64:67]
    ds_read_b128 v[184:187], v241 offset:13312
    v_mfma_f32_16x16x32_bf16 v[228:231], v[236:239], v[148:151], v[228:231]
    v_exp_f32 v128, v128
    v_mfma_f32_16x16x32_bf16 v[232:235], v[236:239], v[152:155], v[232:235]
    v_cvt_pk_bf16_f32 v161, v126, v127
    s_waitcnt lgkmcnt(6)
    v_mfma_f32_16x16x32_bf16 v[68:71], v[212:215], v[148:151], v[68:71]
    v_exp_f32 v129, v129
    v_mfma_f32_16x16x32_bf16 v[76:79], v[212:215], v[152:155], v[76:79]
    ds_read_b128 v[188:191], v241 offset:14336
    v_mfma_f32_16x16x32_bf16 v[72:75], v[216:219], v[148:151], v[72:75]
    v_exp_f32 v130, v130
    v_mfma_f32_16x16x32_bf16 v[80:83], v[216:219], v[152:155], v[80:83]
    ds_read_b128 v[192:195], v241 offset:15360
    v_cvt_pk_bf16_f32 v162, v128, v129
    v_mfma_f32_16x16x32_bf16 v[84:87], v[220:223], v[148:151], v[84:87]
    v_exp_f32 v131, v131
    v_mfma_f32_16x16x32_bf16 v[92:95], v[220:223], v[152:155], v[92:95]
    ds_read_b128 v[196:199], v241 offset:24576
    v_mfma_f32_16x16x32_bf16 v[88:91], v[224:227], v[148:151], v[88:91]
    v_cvt_pk_bf16_f32 v163, v130, v131
    v_mfma_f32_16x16x32_bf16 v[96:99], v[224:227], v[152:155], v[96:99]
    ds_read_b128 v[200:203], v241 offset:25600
    s_sub_u32 s31, s31, 2
    s_cmp_ge_u32 s31, 3
    s_cbranch_scc1 L_k2_A_loop
L_k2_A_odd:
    s_cmp_eq_u32 s31, 0
    s_cbranch_scc1 L_k2_A_drain_odd
    s_cmp_eq_u32 s31, 1
    s_cbranch_scc1 L_k2mask_13
L_k2mret_14:
    s_waitcnt lgkmcnt(6)
    v_mfma_f32_16x16x32_bf16 v[116:119], v[164:167], v[4:7], v[132:135]
    v_exp_f32 v100, v100
    v_mfma_f32_16x16x32_bf16 v[124:127], v[164:167], v[8:11], v[140:143]
    ds_read_b128 v[204:207], v241 offset:26624
    v_mfma_f32_16x16x32_bf16 v[120:123], v[168:171], v[4:7], v[136:139]
    v_exp_f32 v101, v101
    v_mfma_f32_16x16x32_bf16 v[128:131], v[168:171], v[8:11], v[144:147]
    ds_read_b128 v[208:211], v241 offset:27648
    v_mfma_f32_16x16x32_bf16 v[116:119], v[172:175], v[12:15], v[116:119]
    v_exp_f32 v102, v102
    v_mfma_f32_16x16x32_bf16 v[124:127], v[172:175], v[16:19], v[124:127]
    ds_read_b128 v[212:215], v241 offset:28672
    v_cvt_pk_bf16_f32 v148, v100, v101
    v_mfma_f32_16x16x32_bf16 v[120:123], v[176:179], v[12:15], v[120:123]
    v_exp_f32 v103, v103
    v_mfma_f32_16x16x32_bf16 v[128:131], v[176:179], v[16:19], v[128:131]
    ds_read_b128 v[216:219], v241 offset:29696
    s_waitcnt lgkmcnt(6)
    v_mfma_f32_16x16x32_bf16 v[116:119], v[180:183], v[20:23], v[116:119]
    v_exp_f32 v104, v104
    v_mfma_f32_16x16x32_bf16 v[124:127], v[180:183], v[24:27], v[124:127]
    ds_read_b128 v[220:223], v241 offset:30720
    v_cvt_pk_bf16_f32 v149, v102, v103
    v_mfma_f32_16x16x32_bf16 v[120:123], v[184:187], v[20:23], v[120:123]
    v_exp_f32 v105, v105
    v_mfma_f32_16x16x32_bf16 v[128:131], v[184:187], v[24:27], v[128:131]
    ds_read_b128 v[224:227], v241 offset:31744
    s_add_u32 s3, s3, 65536
    s_sub_u32 s7, s3, 163840
    v_mfma_f32_16x16x32_bf16 v[116:119], v[188:191], v[28:31], v[116:119]
    v_exp_f32 v106, v106
    v_mfma_f32_16x16x32_bf16 v[124:127], v[188:191], v[32:35], v[124:127]
    ds_read_b128 v[164:167], v242 offset:0
    v_cvt_pk_bf16_f32 v150, v104, v105
    v_mfma_f32_16x16x32_bf16 v[120:123], v[192:195], v[28:31], v[120:123]
    v_exp_f32 v107, v107
    v_mfma_f32_16x16x32_bf16 v[128:131], v[192:195], v[32:35], v[128:131]
    ds_read_b128 v[168:171], v242 offset:1024
    s_min_u32 s3, s3, s7
    s_waitcnt lgkmcnt(6)
    v_mfma_f32_16x16x32_bf16 v[36:39], v[196:199], v[156:159], v[36:39]
    v_exp_f32 v108, v108
    v_mfma_f32_16x16x32_bf16 v[44:47], v[196:199], v[160:163], v[44:47]
    ds_read_b128 v[172:175], v242 offset:2048
    v_cvt_pk_bf16_f32 v151, v106, v107
    v_mfma_f32_16x16x32_bf16 v[40:43], v[200:203], v[156:159], v[40:43]
    v_exp_f32 v109, v109
    v_mfma_f32_16x16x32_bf16 v[48:51], v[200:203], v[160:163], v[48:51]
    ds_read_b128 v[176:179], v242 offset:3072
    v_mfma_f32_16x16x32_bf16 v[52:55], v[204:207], v[156:159], v[52:55]
    v_exp_f32 v110, v110
    v_mfma_f32_16x16x32_bf16 v[60:63], v[204:207], v[160:163], v[60:63]
    ds_read_b128 v[180:183], v242 offset:4096
    v_cvt_pk_bf16_f32 v152, v108, v109
    v_mfma_f32_16x16x32_bf16 v[56:59], v[208:211], v[156:159], v[56:59]
    v_exp_f32 v111, v111
    v_mfma_f32_16x16x32_bf16 v[64:67], v[208:211], v[160:163], v[64:67]
    ds_read_b128 v[184:187], v242 offset:5120
    v_mfma_f32_16x16x32_bf16 v[228:231], v[236:239], v[156:159], v[228:231]
    v_exp_f32 v112, v112
    v_mfma_f32_16x16x32_bf16 v[232:235], v[236:239], v[160:163], v[232:235]
    v_cvt_pk_bf16_f32 v153, v110, v111
    s_waitcnt lgkmcnt(6)
    v_mfma_f32_16x16x32_bf16 v[68:71], v[212:215], v[156:159], v[68:71]
    v_exp_f32 v113, v113
    v_mfma_f32_16x16x32_bf16 v[76:79], v[212:215], v[160:163], v[76:79]
    ds_read_b128 v[188:191], v242 offset:6144
    v_mfma_f32_16x16x32_bf16 v[72:75], v[216:219], v[156:159], v[72:75]
    v_exp_f32 v114, v114
    v_mfma_f32_16x16x32_bf16 v[80:83], v[216:219], v[160:163], v[80:83]
    ds_read_b128 v[192:195], v242 offset:7168
    v_cvt_pk_bf16_f32 v154, v112, v113
    v_mfma_f32_16x16x32_bf16 v[84:87], v[220:223], v[156:159], v[84:87]
    v_exp_f32 v115, v115
    v_mfma_f32_16x16x32_bf16 v[92:95], v[220:223], v[160:163], v[92:95]
    ds_read_b128 v[196:199], v242 offset:16384
    v_mfma_f32_16x16x32_bf16 v[88:91], v[224:227], v[156:159], v[88:91]
    v_cvt_pk_bf16_f32 v155, v114, v115
    v_mfma_f32_16x16x32_bf16 v[96:99], v[224:227], v[160:163], v[96:99]
    ds_read_b128 v[200:203], v242 offset:17408
    v_mov_b32 v241, v242
    v_add_u32 v242, s3, v243
    s_cmp_eq_u32 s31, 1
    s_cbranch_scc1 L_k2_A_drain_even
    v_cmp_gt_i32 s[52:53], 0, v244
    v_cmp_gt_i32 s[54:55], 1, v244
    v_cmp_gt_i32 s[56:57], 2, v244
    v_cndmask_b32 v132, v132, v245, s[52:53]
    v_cndmask_b32 v133, v133, v245, s[54:55]
    v_cndmask_b32 v134, v134, v245, s[56:57]
    v_cmp_gt_i32 s[52:53], 3, v244
    v_cmp_gt_i32 s[54:55], 16, v244
    v_cmp_gt_i32 s[56:57], 17, v244
    v_cndmask_b32 v135, v135, v245, s[52:53]
    v_cndmask_b32 v136, v136, v245, s[54:55]
    v_cndmask_b32 v137, v137, v245, s[56:57]
    v_cmp_gt_i32 s[52:53], 18, v244
    v_cmp_gt_i32 s[54:55], 19, v244
    v_cmp_gt_i32 s[56:57], 0, v244
    v_cndmask_b32 v138, v138, v245, s[52:53]
    v_cndmask_b32 v139, v139, v245, s[54:55]
    v_cndmask_b32 v144, v144, v245, s[56:57]
    v_cmp_gt_i32 s[52:53], 1, v244
    v_cmp_gt_i32 s[54:55], 2, v244
    v_cmp_gt_i32 s[56:57], 3, v244
    v_cndmask_b32 v145, v145, v245, s[52:53]
    v_cndmask_b32 v146, v146, v245, s[54:55]
    v_cndmask_b32 v147, v147, v245, s[56:57]
    s_nop 1
    s_bitcmp1_b32 s51, 0
    s_cbranch_scc1 L_k2nb_15
    s_cmp_eq_u32 s6, 1
    s_cbranch_scc1 L_k2zs_16
L_k2zr_17:
    s_barrier
L_k2nb_15:
    s_waitcnt lgkmcnt(6)
    v_mfma_f32_16x16x32_bf16 v[100:103], v[164:167], v[4:7], v[132:135]
    v_exp_f32 v116, v116
    v_mfma_f32_16x16x32_bf16 v[108:111], v[164:167], v[8:11], v[140:143]
    ds_read_b128 v[204:207], v241 offset:18432
    v_mfma_f32_16x16x32_bf16 v[104:107], v[168:171], v[4:7], v[136:139]
    v_exp_f32 v117, v117
    v_mfma_f32_16x16x32_bf16 v[112:115], v[168:171], v[8:11], v[144:147]
    ds_read_b128 v[208:211], v241 offset:19456
    s_add_u32 s51, s51, 1
    v_mfma_f32_16x16x32_bf16 v[100:103], v[172:175], v[12:15], v[100:103]
    v_exp_f32 v118, v118
    v_mfma_f32_16x16x32_bf16 v[108:111], v[172:175], v[16:19], v[108:111]
    ds_read_b128 v[212:215], v241 offset:20480
    v_cvt_pk_bf16_f32 v156, v116, v117
    v_mfma_f32_16x16x32_bf16 v[104:107], v[176:179], v[12:15], v[104:107]
    v_exp_f32 v119, v119
    v_mfma_f32_16x16x32_bf16 v[112:115], v[176:179], v[16:19], v[112:115]
    ds_read_b128 v[216:219], v241 offset:21504
    s_waitcnt lgkmcnt(6)
    v_mfma_f32_16x16x32_bf16 v[100:103], v[180:183], v[20:23], v[100:103]
    v_exp_f32 v120, v120
    v_mfma_f32_16x16x32_bf16 v[108:111], v[180:183], v[24:27], v[108:111]
    ds_read_b128 v[220:223], v241 offset:22528
    v_cvt_pk_bf16_f32 v157, v118, v119
    v_mfma_f32_16x16x32_bf16 v[104:107], v[184:187], v[20:23], v[104:107]
    v_exp_f32 v121, v121
    v_mfma_f32_16x16x32_bf16 v[112:115], v[184:187], v[24:27], v[112:115]
    ds_read_b128 v[224:227], v241 offset:23552
    v_mfma_f32_16x16x32_bf16 v[100:103], v[188:191], v[28:31], v[100:103]
    v_exp_f32 v122, v122
    v_mfma_f32_16x16x32_bf16 v[108:111], v[188:191], v[32:35], v[108:111]
    ds_read_b128 v[164:167], v241 offset:8192
    v_cvt_pk_bf16_f32 v158, v120, v121
    v_mfma_f32_16x16x32_bf16 v[104:107], v[192:195], v[28:31], v[104:107]
    v_exp_f32 v123, v123
    v_mfma_f32_16x16x32_bf16 v[112:115], v[192:195], v[32:35], v[112:115]
    ds_read_b128 v[168:171], v241 offset:9216
    s_waitcnt lgkmcnt(6)
    v_mfma_f32_16x16x32_bf16 v[36:39], v[196:199], v[148:151], v[36:39]
    v_exp_f32 v124, v124
    v_mfma_f32_16x16x32_bf16 v[44:47], v[196:199], v[152:155], v[44:47]
    ds_read_b128 v[172:175], v241 offset:10240
    v_cvt_pk_bf16_f32 v159, v122, v123
    v_mfma_f32_16x16x32_bf16 v[40:43], v[200:203], v[148:151], v[40:43]
    v_exp_f32 v125, v125
    v_mfma_f32_16x16x32_bf16 v[48:51], v[200:203], v[152:155], v[48:51]
    ds_read_b128 v[176:179], v241 offset:11264
    v_mfma_f32_16x16x32_bf16 v[52:55], v[204:207], v[148:151], v[52:55]
    v_exp_f32 v126, v126
    v_mfma_f32_16x16x32_bf16 v[60:63], v[204:207], v[152:155], v[60:63]
    ds_read_b128 v[180:183], v241 offset:12288
    v_cvt_pk_bf16_f32 v160, v124, v125
    v_mfma_f32_16x16x32_bf16 v[56:59], v[208:211], v[148:151], v[56:59]
    v_exp_f32 v127, v127
    v_mfma_f32_16x16x32_bf16 v[64:67], v[208:211], v[152:155], v[64:67]
    ds_read_b128 v[184:187], v241 offset:13312
    v_mfma_f32_16x16x32_bf16 v[228:231], v[236:239], v[148:151], v[228:231]
    v_exp_f32 v128, v128
    v_mfma_f32_16x16x32_bf16 v[232:235], v[236:239], v[152:155], v[232:235]
    v_cvt_pk_bf16_f32 v161, v126, v127
    s_waitcnt lgkmcnt(6)
    v_mfma_f32_16x16x32_bf16 v[68:71], v[212:215], v[148:151], v[68:71]
    v_exp_f32 v129, v129
    v_mfma_f32_16x16x32_bf16 v[76:79], v[212:215], v[152:155], v[76:79]
    ds_read_b128 v[188:191], v241 offset:14336
    v_mfma_f32_16x16x32_bf16 v[72:75], v[216:219], v[148:151], v[72:75]
    v_exp_f32 v130, v130
    v_mfma_f32_16x16x32_bf16 v[80:83], v[216:219], v[152:155], v[80:83]
    ds_read_b128 v[192:195], v241 offset:15360
    v_cvt_pk_bf16_f32 v162, v128, v129
    v_mfma_f32_16x16x32_bf16 v[84:87], v[220:223], v[148:151], v[84:87]
    v_exp_f32 v131, v131
    v_mfma_f32_16x16x32_bf16 v[92:95], v[220:223], v[152:155], v[92:95]
    ds_read_b128 v[196:199], v241 offset:24576
    v_mfma_f32_16x16x32_bf16 v[88:91], v[224:227], v[148:151], v[88:91]
    v_cvt_pk_bf16_f32 v163, v130, v131
    v_mfma_f32_16x16x32_bf16 v[96:99], v[224:227], v[152:155], v[96:99]
    ds_read_b128 v[200:203], v241 offset:25600
L_k2_A_drain_odd:
    s_waitcnt lgkmcnt(0)
    ds_read_b128 v[196:199], v241 offset:24576
    ds_read_b128 v[200:203], v241 offset:25600
    ds_read_b128 v[204:207], v241 offset:26624
    ds_read_b128 v[208:211], v241 offset:27648
    ds_read_b128 v[212:215], v241 offset:28672
    ds_read_b128 v[216:219], v241 offset:29696
    ds_read_b128 v[220:223], v241 offset:30720
    ds_read_b128 v[224:227], v241 offset:31744
    s_waitcnt lgkmcnt(6)
    v_mfma_f32_16x16x32_bf16 v[36:39], v[196:199], v[156:159], v[36:39]
    v_exp_f32 v100, v100
    v_mfma_f32_16x16x32_bf16 v[44:47], v[196:199], v[160:163], v[44:47]
    ds_read_b128 v[196:199], v242 offset:16384
    v_exp_f32 v101, v101
    v_mfma_f32_16x16x32_bf16 v[40:43], v[200:203], v[156:159], v[40:43]
    v_exp_f32 v102, v102
    v_mfma_f32_16x16x32_bf16 v[48:51], v[200:203], v[160:163], v[48:51]
    ds_read_b128 v[200:203], v242 offset:17408
    v_exp_f32 v103, v103
    v_cvt_pk_bf16_f32 v148, v100, v101
    s_waitcnt lgkmcnt(6)
    v_mfma_f32_16x16x32_bf16 v[52:55], v[204:207], v[156:159], v[52:55]
    v_exp_f32 v104, v104
    v_mfma_f32_16x16x32_bf16 v[60:63], v[204:207], v[160:163], v[60:63]
    ds_read_b128 v[204:207], v242 offset:18432
    v_exp_f32 v105, v105
    v_cvt_pk_bf16_f32 v149, v102, v103
    v_mfma_f32_16x16x32_bf16 v[56:59], v[208:211], v[156:159], v[56:59]
    v_exp_f32 v106, v106
    v_mfma_f32_16x16x32_bf16 v[64:67], v[208:211], v[160:163], v[64:67]
    ds_read_b128 v[208:211], v242 offset:19456
    v_exp_f32 v107, v107
    v_cvt_pk_bf16_f32 v150, v104, v105
    v_mfma_f32_16x16x32_bf16 v[228:231], v[236:239], v[156:159], v[228:231]
    v_exp_f32 v108, v108
    v_mfma_f32_16x16x32_bf16 v[232:235], v[236:239], v[160:163], v[232:235]
    v_exp_f32 v109, v109
    v_cvt_pk_bf16_f32 v151, v106, v107
    s_waitcnt lgkmcnt(6)
    v_mfma_f32_16x16x32_bf16 v[68:71], v[212:215], v[156:159], v[68:71]
    v_exp_f32 v110, v110
    v_mfma_f32_16x16x32_bf16 v[76:79], v[212:215], v[160:163], v[76:79]
    ds_read_b128 v[212:215], v242 offset:20480
    v_exp_f32 v111, v111
    v_cvt_pk_bf16_f32 v152, v108, v109
    s_add_u32 s3, s3, 65536
    s_sub_u32 s7, s3, 163840
    v_mfma_f32_16x16x32_bf16 v[72:75], v[216:219], v[156:159], v[72:75]
    v_exp_f32 v112, v112
    v_mfma_f32_16x16x32_bf16 v[80:83], v[216:219], v[160:163], v[80:83]
    ds_read_b128 v[216:219], v242 offset:21504
    v_exp_f32 v113, v113
    v_cvt_pk_bf16_f32 v153, v110, v111
    s_waitcnt lgkmcnt(6)
    v_mfma_f32_16x16x32_bf16 v[84:87], v[220:223], v[156:159], v[84:87]
    v_exp_f32 v114, v114
    v_mfma_f32_16x16x32_bf16 v[92:95], v[220:223], v[160:163], v[92:95]
    ds_read_b128 v[220:223], v242 offset:22528
    v_exp_f32 v115, v115
    v_cvt_pk_bf16_f32 v154, v112, v113
    s_min_u32 s3, s3, s7
    v_mfma_f32_16x16x32_bf16 v[88:91], v[224:227], v[156:159], v[88:91]
    v_cvt_pk_bf16_f32 v155, v114, v115
    v_mfma_f32_16x16x32_bf16 v[96:99], v[224:227], v[160:163], v[96:99]
    ds_read_b128 v[224:227], v242 offset:23552
    v_mov_b32 v241, v242
    v_add_u32 v242, s3, v243
    s_nop 1
    s_bitcmp1_b32 s51, 0
    s_cbranch_scc1 L_k2nb_18
    s_cmp_eq_u32 s6, 1
    s_cbranch_scc1 L_k2zs_19
L_k2zr_20:
    s_barrier
L_k2nb_18:
    s_waitcnt lgkmcnt(6)
    v_mfma_f32_16x16x32_bf16 v[36:39], v[196:199], v[148:151], v[36:39]
    v_mfma_f32_16x16x32_bf16 v[44:47], v[196:199], v[152:155], v[44:47]
    v_mfma_f32_16x16x32_bf16 v[40:43], v[200:203], v[148:151], v[40:43]
    s_add_u32 s51, s51, 1
    v_mfma_f32_16x16x32_bf16 v[48:51], v[200:203], v[152:155], v[48:51]
    s_waitcnt lgkmcnt(4)
    v_mfma_f32_16x16x32_bf16 v[52:55], v[204:207], v[148:151], v[52:55]
    v_mfma_f32_16x16x32_bf16 v[60:63], v[204:207], v[152:155], v[60:63]
    v_mfma_f32_16x16x32_bf16 v[56:59], v[208:211], v[148:151], v[56:59]
    v_mfma_f32_16x16x32_bf16 v[64:67], v[208:211], v[152:155], v[64:67]
    v_mfma_f32_16x16x32_bf16 v[228:231], v[236:239], v[148:151], v[228:231]
    v_mfma_f32_16x16x32_bf16 v[232:235], v[236:239], v[152:155], v[232:235]
    s_waitcnt lgkmcnt(2)
    v_mfma_f32_16x16x32_bf16 v[68:71], v[212:215], v[148:151], v[68:71]
    v_mfma_f32_16x16x32_bf16 v[76:79], v[212:215], v[152:155], v[76:79]
    v_mfma_f32_16x16x32_bf16 v[72:75], v[216:219], v[148:151], v[72:75]
    v_mfma_f32_16x16x32_bf16 v[80:83], v[216:219], v[152:155], v[80:83]
    s_waitcnt lgkmcnt(0)
    v_mfma_f32_16x16x32_bf16 v[84:87], v[220:223], v[148:151], v[84:87]
    v_mfma_f32_16x16x32_bf16 v[92:95], v[220:223], v[152:155], v[92:95]
    v_mfma_f32_16x16x32_bf16 v[88:91], v[224:227], v[148:151], v[88:91]
    v_mfma_f32_16x16x32_bf16 v[96:99], v[224:227], v[152:155], v[96:99]
    s_branch L_k2_epi
L_k2_A_drain_even:
    s_bitcmp1_b32 s51, 0
    s_cbranch_scc1 L_k2nb_21
    s_cmp_eq_u32 s6, 1
    s_cbranch_scc1 L_k2zs_22
L_k2zr_23:
    s_barrier
L_k2nb_21:
    s_waitcnt lgkmcnt(0)
    ds_read_b128 v[196:199], v241 offset:16384
    ds_read_b128 v[200:203], v241 offset:17408
    ds_read_b128 v[204:207], v241 offset:18432
    ds_read_b128 v[208:211], v241 offset:19456
    ds_read_b128 v[212:215], v241 offset:20480
    ds_read_b128 v[216:219], v241 offset:21504
    ds_read_b128 v[220:223], v241 offset:22528
    ds_read_b128 v[224:227], v241 offset:23552
    s_waitcnt lgkmcnt(6)
    v_mfma_f32_16x16x32_bf16 v[36:39], v[196:199], v[148:151], v[36:39]
    v_exp_f32 v116, v116
    v_mfma_f32_16x16x32_bf16 v[44:47], v[196:199], v[152:155], v[44:47]
    ds_read_b128 v[196:199], v241 offset:24576
    v_exp_f32 v117, v117
    v_mfma_f32_16x16x32_bf16 v[40:43], v[200:203], v[148:151], v[40:43]
    v_exp_f32 v118, v118
    v_mfma_f32_16x16x32_bf16 v[48:51], v[200:203], v[152:155], v[48:51]
    ds_read_b128 v[200:203], v241 offset:25600
    v_exp_f32 v119, v119
    v_cvt_pk_bf16_f32 v156, v116, v117
    s_add_u32 s51, s51, 1
    s_waitcnt lgkmcnt(6)
    v_mfma_f32_16x16x32_bf16 v[52:55], v[204:207], v[148:151], v[52:55]
    v_exp_f32 v120, v120
    v_mfma_f32_16x16x32_bf16 v[60:63], v[204:207], v[152:155], v[60:63]
    ds_read_b128 v[204:207], v241 offset:26624
    v_exp_f32 v121, v121
    v_cvt_pk_bf16_f32 v157, v118, v119
    v_mfma_f32_16x16x32_bf16 v[56:59], v[208:211], v[148:151], v[56:59]
    v_exp_f32 v122, v122
    v_mfma_f32_16x16x32_bf16 v[64:67], v[208:211], v[152:155], v[64:67]
    ds_read_b128 v[208:211], v241 offset:27648
    v_exp_f32 v123, v123
    v_cvt_pk_bf16_f32 v158, v120, v121
    v_mfma_f32_16x16x32_bf16 v[228:231], v[236:239], v[148:151], v[228:231]
    v_exp_f32 v124, v124
    v_mfma_f32_16x16x32_bf16 v[232:235], v[236:239], v[152:155], v[232:235]
    v_exp_f32 v125, v125
    v_cvt_pk_bf16_f32 v159, v122, v123
    s_waitcnt lgkmcnt(6)
    v_mfma_f32_16x16x32_bf16 v[68:71], v[212:215], v[148:151], v[68:71]
    v_exp_f32 v126, v126
    v_mfma_f32_16x16x32_bf16 v[76:79], v[212:215], v[152:155], v[76:79]
    ds_read_b128 v[212:215], v241 offset:28672
    v_exp_f32 v127, v127
    v_cvt_pk_bf16_f32 v160, v124, v125
    v_mfma_f32_16x16x32_bf16 v[72:75], v[216:219], v[148:151], v[72:75]
    v_exp_f32 v128, v128
    v_mfma_f32_16x16x32_bf16 v[80:83], v[216:219], v[152:155], v[80:83]
    ds_read_b128 v[216:219], v241 offset:29696
    v_exp_f32 v129, v129
    v_cvt_pk_bf16_f32 v161, v126, v127
    s_waitcnt lgkmcnt(6)
    v_mfma_f32_16x16x32_bf16 v[84:87], v[220:223], v[148:151], v[84:87]
    v_exp_f32 v130, v130
    v_mfma_f32_16x16x32_bf16 v[92:95], v[220:223], v[152:155], v[92:95]
    ds_read_b128 v[220:223], v241 offset:30720
    v_exp_f32 v131, v131
    v_cvt_pk_bf16_f32 v162, v128, v129
    v_mfma_f32_16x16x32_bf16 v[88:91], v[224:227], v[148:151], v[88:91]
    v_cvt_pk_bf16_f32 v163, v130, v131
    v_mfma_f32_16x16x32_bf16 v[96:99], v[224:227], v[152:155], v[96:99]
    ds_read_b128 v[224:227], v241 offset:31744
    s_nop 1
    s_waitcnt lgkmcnt(6)
    v_mfma_f32_16x16x32_bf16 v[36:39], v[196:199], v[156:159], v[36:39]
    v_mfma_f32_16x16x32_bf16 v[44:47], v[196:199], v[160:163], v[44:47]
    v_mfma_f32_16x16x32_bf16 v[40:43], v[200:203], v[156:159], v[40:43]
    v_mfma_f32_16x16x32_bf16 v[48:51], v[200:203], v[160:163], v[48:51]
    s_waitcnt lgkmcnt(4)
    v_mfma_f32_16x16x32_bf16 v[52:55], v[204:207], v[156:159], v[52:55]
    v_mfma_f32_16x16x32_bf16 v[60:63], v[204:207], v[160:163], v[60:63]
    v_mfma_f32_16x16x32_bf16 v[56:59], v[208:211], v[156:159], v[56:59]
    v_mfma_f32_16x16x32_bf16 v[64:67], v[208:211], v[160:163], v[64:67]
    v_mfma_f32_16x16x32_bf16 v[228:231], v[236:239], v[156:159], v[228:231]
    v_mfma_f32_16x16x32_bf16 v[232:235], v[236:239], v[160:163], v[232:235]
    s_waitcnt lgkmcnt(2)
    v_mfma_f32_16x16x32_bf16 v[68:71], v[212:215], v[156:159], v[68:71]
    s_add_u32 s3, s3, 65536
    s_sub_u32 s7, s3, 163840
    v_mfma_f32_16x16x32_bf16 v[76:79], v[212:215], v[160:163], v[76:79]
    v_mfma_f32_16x16x32_bf16 v[72:75], v[216:219], v[156:159], v[72:75]
    v_mfma_f32_16x16x32_bf16 v[80:83], v[216:219], v[160:163], v[80:83]
    s_waitcnt lgkmcnt(0)
    v_mfma_f32_16x16x32_bf16 v[84:87], v[220:223], v[156:159], v[84:87]
    s_min_u32 s3, s3, s7
    v_mfma_f32_16x16x32_bf16 v[92:95], v[220:223], v[160:163], v[92:95]
    v_mfma_f32_16x16x32_bf16 v[88:91], v[224:227], v[156:159], v[88:91]
    v_mfma_f32_16x16x32_bf16 v[96:99], v[224:227], v[160:163], v[96:99]
    v_mov_b32 v241, v242
    v_add_u32 v242, s3, v243
    s_branch L_k2_epi
L_k2_B:
    s_setprio 1
    s_waitcnt vmcnt(5) lgkmcnt(0)
    s_barrier
    v_add_u32 v220, 0x10000, v232
    v_add_u32 v224, 0x20000, v232
    v_add_u32 v221, 0x10000, v233
    v_add_u32 v225, 0x20000, v233
    v_add_u32 v222, 0x10000, v234
    v_add_u32 v226, 0x20000, v234
    v_add_u32 v223, 0x10000, v235
    v_add_u32 v227, 0x20000, v235
    ds_read_b64_tr_b16 v[164:165], v232 offset:0
    ds_read_b64_tr_b16 v[166:167], v232 offset:512
    ds_read_b64_tr_b16 v[168:169], v233 offset:0
    ds_read_b64_tr_b16 v[170:171], v233 offset:512
    ds_read_b64_tr_b16 v[172:173], v234 offset:0
    ds_read_b64_tr_b16 v[174:175], v234 offset:512
    ds_read_b64_tr_b16 v[176:177], v235 offset:0
    ds_read_b64_tr_b16 v[178:179], v235 offset:512
    ds_read_b64_tr_b16 v[180:181], v232 offset:32768
    ds_read_b64_tr_b16 v[182:183], v232 offset:33280
    ds_read_b64_tr_b16 v[184:185], v233 offset:32768
    ds_read_b64_tr_b16 v[186:187], v233 offset:33280
    s_waitcnt vmcnt(5)
    s_waitcnt lgkmcnt(8)
    v_mfma_f32_16x16x32_bf16 v[36:39], v[164:167], v[4:7], 0
    ds_read_b64_tr_b16 v[188:189], v234 offset:32768
    v_mfma_f32_16x16x32_bf16 v[44:47], v[164:167], v[8:11], 0
    ds_read_b64_tr_b16 v[190:191], v234 offset:33280
    s_add_u32 s41, s40, 4096
    buffer_load_dwordx4 v[28:31], v243, s[12:15], s41 offen offset:2048 sc1
    v_mfma_f32_16x16x32_bf16 v[40:43], v[168:171], v[4:7], 0
    ds_read_b64_tr_b16 v[192:193], v235 offset:32768
    v_mfma_f32_16x16x32_bf16 v[48:51], v[168:171], v[8:11], 0
    ds_read_b64_tr_b16 v[194:195], v235 offset:33280
    buffer_load_dwordx4 v[32:35], v243, s[12:15], s41 offen offset:3072 sc1
    s_waitcnt lgkmcnt(8)
    v_mfma_f32_16x16x32_bf16 v[52:55], v[172:175], v[4:7], 0
    ds_read_b64_tr_b16 v[164:165], v220 offset:0
    v_mfma_f32_16x16x32_bf16 v[60:63], v[172:175], v[8:11], 0
    ds_read_b64_tr_b16 v[166:167], v220 offset:512
    s_add_u32 m0, s37, 98304
    s_add_u32 s48, s47, 2097152
    buffer_load_dwordx4 v228, s[24:27], s48 offen offset:0 lds
    v_mfma_f32_16x16x32_bf16 v[56:59], v[176:179], v[4:7], 0
    ds_read_b64_tr_b16 v[168:169], v221 offset:0
    v_mfma_f32_16x16x32_bf16 v[64:67], v[176:179], v[8:11], 0
    ds_read_b64_tr_b16 v[170:171], v221 offset:512
    buffer_load_dwordx4 v229, s[24:27], s48 offen offset:1024 lds
    s_waitcnt lgkmcnt(8)
    v_mfma_f32_16x16x32_bf16 v[68:71], v[180:183], v[4:7], 0
    ds_read_b64_tr_b16 v[172:173], v222 offset:0
    v_mfma_f32_16x16x32_bf16 v[76:79], v[180:183], v[8:11], 0
    ds_read_b64_tr_b16 v[174:175], v222 offset:512
    buffer_load_dwordx4 v230, s[24:27], s48 offen offset:2048 lds
    v_mfma_f32_16x16x32_bf16 v[72:75], v[184:187], v[4:7], 0
    ds_read_b64_tr_b16 v[176:177], v223 offset:0
    v_mfma_f32_16x16x32_bf16 v[80:83], v[184:187], v[8:11], 0
    ds_read_b64_tr_b16 v[178:179], v223 offset:512
    buffer_load_dwordx4 v231, s[24:27], s48 offen offset:3072 lds
    s_waitcnt lgkmcnt(8)
    v_mfma_f32_16x16x32_bf16 v[84:87], v[188:191], v[4:7], 0
    ds_read_b64_tr_b16 v[180:181], v232 offset:4096
    v_mfma_f32_16x16x32_bf16 v[92:95], v[188:191], v[8:11], 0
    ds_read_b64_tr_b16 v[182:183], v232 offset:4608
    v_mfma_f32_16x16x32_bf16 v[88:91], v[192:195], v[4:7], 0
    ds_read_b64_tr_b16 v[184:185], v233 offset:4096
    v_mfma_f32_16x16x32_bf16 v[96:99], v[192:195], v[8:11], 0
    ds_read_b64_tr_b16 v[186:187], v233 offset:4608
    s_waitcnt lgkmcnt(8)
    v_mfma_f32_16x16x32_bf16 v[100:103], v[164:167], v[4:7], 0
    ds_read_b64_tr_b16 v[188:189], v234 offset:4096
    v_mfma_f32_16x16x32_bf16 v[108:111], v[164:167], v[8:11], 0
    ds_read_b64_tr_b16 v[190:191], v234 offset:4608
    v_mfma_f32_16x16x32_bf16 v[104:107], v[168:171], v[4:7], 0
    ds_read_b64_tr_b16 v[192:193], v235 offset:4096
    v_mfma_f32_16x16x32_bf16 v[112:115], v[168:171], v[8:11], 0
    ds_read_b64_tr_b16 v[194:195], v235 offset:4608
    s_waitcnt lgkmcnt(8)
    v_mfma_f32_16x16x32_bf16 v[116:119], v[172:175], v[4:7], 0
    ds_read_b64_tr_b16 v[164:165], v232 offset:36864
    v_mfma_f32_16x16x32_bf16 v[124:127], v[172:175], v[8:11], 0
    ds_read_b64_tr_b16 v[166:167], v232 offset:37376
    v_mfma_f32_16x16x32_bf16 v[120:123], v[176:179], v[4:7], 0
    ds_read_b64_tr_b16 v[168:169], v233 offset:36864
    v_mfma_f32_16x16x32_bf16 v[128:131], v[176:179], v[8:11], 0
    ds_read_b64_tr_b16 v[170:171], v233 offset:37376
    s_waitcnt vmcnt(9)
    s_waitcnt lgkmcnt(8)
    v_mfma_f32_16x16x32_bf16 v[36:39], v[180:183], v[12:15], v[36:39]
    ds_read_b64_tr_b16 v[172:173], v234 offset:36864
    v_mfma_f32_16x16x32_bf16 v[44:47], v[180:183], v[16:19], v[44:47]
    ds_read_b64_tr_b16 v[174:175], v234 offset:37376
    s_add_u32 s41, s40, 8192
    buffer_load_dwordx4 v[4:7], v243, s[12:15], s41 offen offset:0 sc1
    v_mfma_f32_16x16x32_bf16 v[40:43], v[184:187], v[12:15], v[40:43]
    ds_read_b64_tr_b16 v[176:177], v235 offset:36864
    v_mfma_f32_16x16x32_bf16 v[48:51], v[184:187], v[16:19], v[48:51]
    ds_read_b64_tr_b16 v[178:179], v235 offset:37376
    buffer_load_dwordx4 v[8:11], v243, s[12:15], s41 offen offset:1024 sc1
    s_waitcnt lgkmcnt(8)
    v_mfma_f32_16x16x32_bf16 v[52:55], v[188:191], v[12:15], v[52:55]
    ds_read_b64_tr_b16 v[180:181], v220 offset:4096
    v_mfma_f32_16x16x32_bf16 v[60:63], v[188:191], v[16:19], v[60:63]
    ds_read_b64_tr_b16 v[182:183], v220 offset:4608
    s_add_u32 s56, s57, 524288
    buffer_store_dwordx4 v[148:151], v243, s[8:11], s56 offen offset:0 sc1
    v_mfma_f32_16x16x32_bf16 v[56:59], v[192:195], v[12:15], v[56:59]
    ds_read_b64_tr_b16 v[184:185], v221 offset:4096
    v_mfma_f32_16x16x32_bf16 v[64:67], v[192:195], v[16:19], v[64:67]
    ds_read_b64_tr_b16 v[186:187], v221 offset:4608
    s_waitcnt lgkmcnt(8)
    v_mfma_f32_16x16x32_bf16 v[68:71], v[164:167], v[12:15], v[68:71]
    ds_read_b64_tr_b16 v[188:189], v222 offset:4096
    v_mfma_f32_16x16x32_bf16 v[76:79], v[164:167], v[16:19], v[76:79]
    ds_read_b64_tr_b16 v[190:191], v222 offset:4608
    v_mfma_f32_16x16x32_bf16 v[72:75], v[168:171], v[12:15], v[72:75]
    ds_read_b64_tr_b16 v[192:193], v223 offset:4096
    v_mfma_f32_16x16x32_bf16 v[80:83], v[168:171], v[16:19], v[80:83]
    ds_read_b64_tr_b16 v[194:195], v223 offset:4608
    s_waitcnt lgkmcnt(8)
    v_mfma_f32_16x16x32_bf16 v[84:87], v[172:175], v[12:15], v[84:87]
    ds_read_b64_tr_b16 v[164:165], v232 offset:8192
    v_mfma_f32_16x16x32_bf16 v[92:95], v[172:175], v[16:19], v[92:95]
    ds_read_b64_tr_b16 v[166:167], v232 offset:8704
    v_mfma_f32_16x16x32_bf16 v[88:91], v[176:179], v[12:15], v[88:91]
    ds_read_b64_tr_b16 v[168:169], v233 offset:8192
    v_mfma_f32_16x16x32_bf16 v[96:99], v[176:179], v[16:19], v[96:99]
    ds_read_b64_tr_b16 v[170:171], v233 offset:8704
    s_waitcnt lgkmcnt(8)
    v_mfma_f32_16x16x32_bf16 v[100:103], v[180:183], v[12:15], v[100:103]
    ds_read_b64_tr_b16 v[172:173], v234 offset:8192
    v_mfma_f32_16x16x32_bf16 v[108:111], v[180:183], v[16:19], v[108:111]
    ds_read_b64_tr_b16 v[174:175], v234 offset:8704
    v_mfma_f32_16x16x32_bf16 v[104:107], v[184:187], v[12:15], v[104:107]
    ds_read_b64_tr_b16 v[176:177], v235 offset:8192
    v_mfma_f32_16x16x32_bf16 v[112:115], v[184:187], v[16:19], v[112:115]
    ds_read_b64_tr_b16 v[178:179], v235 offset:8704
    s_waitcnt lgkmcnt(8)
    v_mfma_f32_16x16x32_bf16 v[116:119], v[188:191], v[12:15], v[116:119]
    ds_read_b64_tr_b16 v[180:181], v232 offset:40960
    v_mfma_f32_16x16x32_bf16 v[124:127], v[188:191], v[16:19], v[124:127]
    ds_read_b64_tr_b16 v[182:183], v232 offset:41472
    v_mfma_f32_16x16x32_bf16 v[120:123], v[192:195], v[12:15], v[120:123]
    ds_read_b64_tr_b16 v[184:185], v233 offset:40960
    v_mfma_f32_16x16x32_bf16 v[128:131], v[192:195], v[16:19], v[128:131]
    ds_read_b64_tr_b16 v[186:187], v233 offset:41472
    s_waitcnt vmcnt(10)
    s_waitcnt lgkmcnt(8)
    v_mfma_f32_16x16x32_bf16 v[36:39], v[164:167], v[20:23], v[36:39]
    ds_read_b64_tr_b16 v[188:189], v234 offset:40960
    v_mfma_f32_16x16x32_bf16 v[44:47], v[164:167], v[24:27], v[44:47]
    ds_read_b64_tr_b16 v[190:191], v234 offset:41472
    s_add_u32 s41, s40, 8192
    buffer_load_dwordx4 v[12:15], v243, s[12:15], s41 offen offset:2048 sc1
    v_mfma_f32_16x16x32_bf16 v[40:43], v[168:171], v[20:23], v[40:43]
    ds_read_b64_tr_b16 v[192:193], v235 offset:40960
    v_mfma_f32_16x16x32_bf16 v[48:51], v[168:171], v[24:27], v[48:51]
    ds_read_b64_tr_b16 v[194:195], v235 offset:41472
    buffer_load_dwordx4 v[16:19], v243, s[12:15], s41 offen offset:3072 sc1
    s_waitcnt lgkmcnt(8)
    v_mfma_f32_16x16x32_bf16 v[52:55], v[172:175], v[20:23], v[52:55]
    ds_read_b64_tr_b16 v[164:165], v220 offset:8192
    v_mfma_f32_16x16x32_bf16 v[60:63], v[172:175], v[24:27], v[60:63]
    ds_read_b64_tr_b16 v[166:167], v220 offset:8704
    s_add_u32 s41, s40, 16384
    buffer_load_dwordx4 v[196:199], v243, s[12:15], s41 offen offset:0 sc1
    v_mfma_f32_16x16x32_bf16 v[56:59], v[176:179], v[20:23], v[56:59]
    ds_read_b64_tr_b16 v[168:169], v221 offset:8192
    v_mfma_f32_16x16x32_bf16 v[64:67], v[176:179], v[24:27], v[64:67]
    ds_read_b64_tr_b16 v[170:171], v221 offset:8704
    buffer_load_dwordx4 v[200:203], v243, s[12:15], s41 offen offset:1024 sc1
    s_waitcnt lgkmcnt(8)
    v_mfma_f32_16x16x32_bf16 v[68:71], v[180:183], v[20:23], v[68:71]
    ds_read_b64_tr_b16 v[172:173], v222 offset:8192
    v_mfma_f32_16x16x32_bf16 v[76:79], v[180:183], v[24:27], v[76:79]
    ds_read_b64_tr_b16 v[174:175], v222 offset:8704
    s_add_u32 s56, s57, 524288
    buffer_store_dwordx4 v[152:155], v243, s[8:11], s56 offen offset:1024 sc1
    v_mfma_f32_16x16x32_bf16 v[72:75], v[184:187], v[20:23], v[72:75]
    ds_read_b64_tr_b16 v[176:177], v223 offset:8192
    v_mfma_f32_16x16x32_bf16 v[80:83], v[184:187], v[24:27], v[80:83]
    ds_read_b64_tr_b16 v[178:179], v223 offset:8704
    s_waitcnt lgkmcnt(8)
    v_mfma_f32_16x16x32_bf16 v[84:87], v[188:191], v[20:23], v[84:87]
    ds_read_b64_tr_b16 v[180:181], v232 offset:12288
    v_mfma_f32_16x16x32_bf16 v[92:95], v[188:191], v[24:27], v[92:95]
    ds_read_b64_tr_b16 v[182:183], v232 offset:12800
    v_mfma_f32_16x16x32_bf16 v[88:91], v[192:195], v[20:23], v[88:91]
    ds_read_b64_tr_b16 v[184:185], v233 offset:12288
    v_mfma_f32_16x16x32_bf16 v[96:99], v[192:195], v[24:27], v[96:99]
    ds_read_b64_tr_b16 v[186:187], v233 offset:12800
    s_waitcnt lgkmcnt(8)
    v_mfma_f32_16x16x32_bf16 v[100:103], v[164:167], v[20:23], v[100:103]
    ds_read_b64_tr_b16 v[188:189], v234 offset:12288
    v_mfma_f32_16x16x32_bf16 v[108:111], v[164:167], v[24:27], v[108:111]
    ds_read_b64_tr_b16 v[190:191], v234 offset:12800
    v_mfma_f32_16x16x32_bf16 v[104:107], v[168:171], v[20:23], v[104:107]
    ds_read_b64_tr_b16 v[192:193], v235 offset:12288
    v_mfma_f32_16x16x32_bf16 v[112:115], v[168:171], v[24:27], v[112:115]
    ds_read_b64_tr_b16 v[194:195], v235 offset:12800
    s_waitcnt lgkmcnt(8)
    v_mfma_f32_16x16x32_bf16 v[116:119], v[172:175], v[20:23], v[116:119]
    ds_read_b64_tr_b16 v[164:165], v232 offset:45056
    v_mfma_f32_16x16x32_bf16 v[124:127], v[172:175], v[24:27], v[124:127]
    ds_read_b64_tr_b16 v[166:167], v232 offset:45568
    v_mfma_f32_16x16x32_bf16 v[120:123], v[176:179], v[20:23], v[120:123]
    ds_read_b64_tr_b16 v[168:169], v233 offset:45056
    v_mfma_f32_16x16x32_bf16 v[128:131], v[176:179], v[24:27], v[128:131]
    ds_read_b64_tr_b16 v[170:171], v233 offset:45568
    s_waitcnt vmcnt(12)
    s_waitcnt lgkmcnt(8)
    v_mfma_f32_16x16x32_bf16 v[36:39], v[180:183], v[28:31], v[36:39]
    ds_read_b64_tr_b16 v[172:173], v234 offset:45056
    v_mfma_f32_16x16x32_bf16 v[44:47], v[180:183], v[32:35], v[44:47]
    ds_read_b64_tr_b16 v[174:175], v234 offset:45568
    s_add_u32 s41, s40, 12288
    buffer_load_dwordx4 v[20:23], v243, s[12:15], s41 offen offset:0 sc1
    v_mfma_f32_16x16x32_bf16 v[40:43], v[184:187], v[28:31], v[40:43]
    ds_read_b64_tr_b16 v[176:177], v235 offset:45056
    v_mfma_f32_16x16x32_bf16 v[48:51], v[184:187], v[32:35], v[48:51]
    ds_read_b64_tr_b16 v[178:179], v235 offset:45568
    buffer_load_dwordx4 v[24:27], v243, s[12:15], s41 offen offset:1024 sc1
    s_waitcnt lgkmcnt(8)
    v_mfma_f32_16x16x32_bf16 v[52:55], v[188:191], v[28:31], v[52:55]
    ds_read_b64_tr_b16 v[180:181], v220 offset:12288
    v_mfma_f32_16x16x32_bf16 v[60:63], v[188:191], v[32:35], v[60:63]
    ds_read_b64_tr_b16 v[182:183], v220 offset:12800
    s_add_u32 s41, s40, 16384
    buffer_load_dwordx4 v[204:207], v243, s[12:15], s41 offen offset:2048 sc1
    v_mfma_f32_16x16x32_bf16 v[56:59], v[192:195], v[28:31], v[56:59]
    ds_read_b64_tr_b16 v[184:185], v221 offset:12288
    v_mfma_f32_16x16x32_bf16 v[64:67], v[192:195], v[32:35], v[64:67]
    ds_read_b64_tr_b16 v[186:187], v221 offset:12800
    buffer_load_dwordx4 v[208:211], v243, s[12:15], s41 offen offset:3072 sc1
    s_waitcnt lgkmcnt(8)
    v_mfma_f32_16x16x32_bf16 v[68:71], v[164:167], v[28:31], v[68:71]
    ds_read_b64_tr_b16 v[188:189], v222 offset:12288
    v_mfma_f32_16x16x32_bf16 v[76:79], v[164:167], v[32:35], v[76:79]
    ds_read_b64_tr_b16 v[190:191], v222 offset:12800
    v_mfma_f32_16x16x32_bf16 v[72:75], v[168:171], v[28:31], v[72:75]
    ds_read_b64_tr_b16 v[192:193], v223 offset:12288
    v_mfma_f32_16x16x32_bf16 v[80:83], v[168:171], v[32:35], v[80:83]
    ds_read_b64_tr_b16 v[194:195], v223 offset:12800
    s_waitcnt lgkmcnt(8)
    v_mfma_f32_16x16x32_bf16 v[84:87], v[172:175], v[28:31], v[84:87]
    ds_read_b64_tr_b16 v[164:165], v232 offset:16384
    v_mfma_f32_16x16x32_bf16 v[92:95], v[172:175], v[32:35], v[92:95]
    ds_read_b64_tr_b16 v[166:167], v232 offset:16896
    v_mfma_f32_16x16x32_bf16 v[88:91], v[176:179], v[28:31], v[88:91]
    ds_read_b64_tr_b16 v[168:169], v233 offset:16384
    v_mfma_f32_16x16x32_bf16 v[96:99], v[176:179], v[32:35], v[96:99]
    ds_read_b64_tr_b16 v[170:171], v233 offset:16896
    s_waitcnt lgkmcnt(8)
    v_mfma_f32_16x16x32_bf16 v[100:103], v[180:183], v[28:31], v[100:103]
    ds_read_b64_tr_b16 v[172:173], v234 offset:16384
    v_mfma_f32_16x16x32_bf16 v[108:111], v[180:183], v[32:35], v[108:111]
    ds_read_b64_tr_b16 v[174:175], v234 offset:16896
    v_mfma_f32_16x16x32_bf16 v[104:107], v[184:187], v[28:31], v[104:107]
    ds_read_b64_tr_b16 v[176:177], v235 offset:16384
    v_mfma_f32_16x16x32_bf16 v[112:115], v[184:187], v[32:35], v[112:115]
    ds_read_b64_tr_b16 v[178:179], v235 offset:16896
    s_waitcnt lgkmcnt(8)
    v_mfma_f32_16x16x32_bf16 v[116:119], v[188:191], v[28:31], v[116:119]
    ds_read_b64_tr_b16 v[180:181], v232 offset:49152
    v_mfma_f32_16x16x32_bf16 v[124:127], v[188:191], v[32:35], v[124:127]
    ds_read_b64_tr_b16 v[182:183], v232 offset:49664
    v_mfma_f32_16x16x32_bf16 v[120:123], v[192:195], v[28:31], v[120:123]
    ds_read_b64_tr_b16 v[184:185], v233 offset:49152
    v_mfma_f32_16x16x32_bf16 v[128:131], v[192:195], v[32:35], v[128:131]
    ds_read_b64_tr_b16 v[186:187], v233 offset:49664
    s_waitcnt vmcnt(10)
    s_waitcnt lgkmcnt(8)
    v_mfma_f32_16x16x32_bf16 v[36:39], v[164:167], v[4:7], v[36:39]
    ds_read_b64_tr_b16 v[188:189], v234 offset:49152
    v_mfma_f32_16x16x32_bf16 v[44:47], v[164:167], v[8:11], v[44:47]
    ds_read_b64_tr_b16 v[190:191], v234 offset:49664
    s_add_u32 s41, s40, 12288
    buffer_load_dwordx4 v[28:31], v243, s[12:15], s41 offen offset:2048 sc1
    v_mfma_f32_16x16x32_bf16 v[40:43], v[168:171], v[4:7], v[40:43]
    ds_read_b64_tr_b16 v[192:193], v235 offset:49152
    v_mfma_f32_16x16x32_bf16 v[48:51], v[168:171], v[8:11], v[48:51]
    ds_read_b64_tr_b16 v[194:195], v235 offset:49664
    buffer_load_dwordx4 v[32:35], v243, s[12:15], s41 offen offset:3072 sc1
    s_waitcnt lgkmcnt(8)
    v_mfma_f32_16x16x32_bf16 v[52:55], v[172:175], v[4:7], v[52:55]
    ds_read_b64_tr_b16 v[164:165], v220 offset:16384
    v_mfma_f32_16x16x32_bf16 v[60:63], v[172:175], v[8:11], v[60:63]
    ds_read_b64_tr_b16 v[166:167], v220 offset:16896
    s_add_u32 s41, s40, 20480
    buffer_load_dwordx4 v[212:215], v243, s[12:15], s41 offen offset:0 sc1
    v_mfma_f32_16x16x32_bf16 v[56:59], v[176:179], v[4:7], v[56:59]
    ds_read_b64_tr_b16 v[168:169], v221 offset:16384
    v_mfma_f32_16x16x32_bf16 v[64:67], v[176:179], v[8:11], v[64:67]
    ds_read_b64_tr_b16 v[170:171], v221 offset:16896
    buffer_load_dwordx4 v[216:219], v243, s[12:15], s41 offen offset:1024 sc1
    s_waitcnt lgkmcnt(8)
    v_mfma_f32_16x16x32_bf16 v[68:71], v[180:183], v[4:7], v[68:71]
    ds_read_b64_tr_b16 v[172:173], v222 offset:16384
    v_mfma_f32_16x16x32_bf16 v[76:79], v[180:183], v[8:11], v[76:79]
    ds_read_b64_tr_b16 v[174:175], v222 offset:16896
    s_add_u32 s56, s57, 524288
    buffer_store_dwordx4 v[156:159], v243, s[8:11], s56 offen offset:2048 sc1
    v_mfma_f32_16x16x32_bf16 v[72:75], v[184:187], v[4:7], v[72:75]
    ds_read_b64_tr_b16 v[176:177], v223 offset:16384
    v_mfma_f32_16x16x32_bf16 v[80:83], v[184:187], v[8:11], v[80:83]
    ds_read_b64_tr_b16 v[178:179], v223 offset:16896
    s_waitcnt lgkmcnt(8)
    v_mfma_f32_16x16x32_bf16 v[84:87], v[188:191], v[4:7], v[84:87]
    ds_read_b64_tr_b16 v[180:181], v232 offset:20480
    v_mfma_f32_16x16x32_bf16 v[92:95], v[188:191], v[8:11], v[92:95]
    ds_read_b64_tr_b16 v[182:183], v232 offset:20992
    v_mfma_f32_16x16x32_bf16 v[88:91], v[192:195], v[4:7], v[88:91]
    ds_read_b64_tr_b16 v[184:185], v233 offset:20480
    v_mfma_f32_16x16x32_bf16 v[96:99], v[192:195], v[8:11], v[96:99]
    ds_read_b64_tr_b16 v[186:187], v233 offset:20992
    s_waitcnt lgkmcnt(8)
    v_mfma_f32_16x16x32_bf16 v[100:103], v[164:167], v[4:7], v[100:103]
    ds_read_b64_tr_b16 v[188:189], v234 offset:20480
    v_mfma_f32_16x16x32_bf16 v[108:111], v[164:167], v[8:11], v[108:111]
    ds_read_b64_tr_b16 v[190:191], v234 offset:20992
    v_mfma_f32_16x16x32_bf16 v[104:107], v[168:171], v[4:7], v[104:107]
    ds_read_b64_tr_b16 v[192:193], v235 offset:20480
    v_mfma_f32_16x16x32_bf16 v[112:115], v[168:171], v[8:11], v[112:115]
    ds_read_b64_tr_b16 v[194:195], v235 offset:20992
    s_waitcnt lgkmcnt(8)
    v_mfma_f32_16x16x32_bf16 v[116:119], v[172:175], v[4:7], v[116:119]
    ds_read_b64_tr_b16 v[164:165], v232 offset:53248
    v_mfma_f32_16x16x32_bf16 v[124:127], v[172:175], v[8:11], v[124:127]
    ds_read_b64_tr_b16 v[166:167], v232 offset:53760
    v_mfma_f32_16x16x32_bf16 v[120:123], v[176:179], v[4:7], v[120:123]
    ds_read_b64_tr_b16 v[168:169], v233 offset:53248
    v_mfma_f32_16x16x32_bf16 v[128:131], v[176:179], v[8:11], v[128:131]
    ds_read_b64_tr_b16 v[170:171], v233 offset:53760
    s_waitcnt vmcnt(12)
    s_waitcnt lgkmcnt(8)
    v_mfma_f32_16x16x32_bf16 v[36:39], v[180:183], v[12:15], v[36:39]
    ds_read_b64_tr_b16 v[172:173], v234 offset:53248
    v_mfma_f32_16x16x32_bf16 v[44:47], v[180:183], v[16:19], v[44:47]
    ds_read_b64_tr_b16 v[174:175], v234 offset:53760
    s_add_u32 s41, s40, 20480
    buffer_load_dwordx4 v[4:7], v243, s[12:15], s41 offen offset:2048 sc1
    v_mfma_f32_16x16x32_bf16 v[40:43], v[184:187], v[12:15], v[40:43]
    ds_read_b64_tr_b16 v[176:177], v235 offset:53248
    v_mfma_f32_16x16x32_bf16 v[48:51], v[184:187], v[16:19], v[48:51]
    ds_read_b64_tr_b16 v[178:179], v235 offset:53760
    buffer_load_dwordx4 v[8:11], v243, s[12:15], s41 offen offset:3072 sc1
    s_waitcnt lgkmcnt(8)
    v_mfma_f32_16x16x32_bf16 v[52:55], v[188:191], v[12:15], v[52:55]
    ds_read_b64_tr_b16 v[180:181], v220 offset:20480
    v_mfma_f32_16x16x32_bf16 v[60:63], v[188:191], v[16:19], v[60:63]
    ds_read_b64_tr_b16 v[182:183], v220 offset:20992
    s_add_u32 s56, s57, 524288
    buffer_store_dwordx4 v[160:163], v243, s[8:11], s56 offen offset:3072 sc1
    v_mfma_f32_16x16x32_bf16 v[56:59], v[192:195], v[12:15], v[56:59]
    ds_read_b64_tr_b16 v[184:185], v221 offset:20480
    v_mfma_f32_16x16x32_bf16 v[64:67], v[192:195], v[16:19], v[64:67]
    ds_read_b64_tr_b16 v[186:187], v221 offset:20992
    s_waitcnt lgkmcnt(8)
    v_mfma_f32_16x16x32_bf16 v[68:71], v[164:167], v[12:15], v[68:71]
    ds_read_b64_tr_b16 v[188:189], v222 offset:20480
    v_mfma_f32_16x16x32_bf16 v[76:79], v[164:167], v[16:19], v[76:79]
    ds_read_b64_tr_b16 v[190:191], v222 offset:20992
    v_mfma_f32_16x16x32_bf16 v[72:75], v[168:171], v[12:15], v[72:75]
    ds_read_b64_tr_b16 v[192:193], v223 offset:20480
    v_mfma_f32_16x16x32_bf16 v[80:83], v[168:171], v[16:19], v[80:83]
    ds_read_b64_tr_b16 v[194:195], v223 offset:20992
    s_waitcnt lgkmcnt(8)
    v_mfma_f32_16x16x32_bf16 v[84:87], v[172:175], v[12:15], v[84:87]
    ds_read_b64_tr_b16 v[164:165], v232 offset:24576
    v_mfma_f32_16x16x32_bf16 v[92:95], v[172:175], v[16:19], v[92:95]
    ds_read_b64_tr_b16 v[166:167], v232 offset:25088
    v_mfma_f32_16x16x32_bf16 v[88:91], v[176:179], v[12:15], v[88:91]
    ds_read_b64_tr_b16 v[168:169], v233 offset:24576
    v_mfma_f32_16x16x32_bf16 v[96:99], v[176:179], v[16:19], v[96:99]
    ds_read_b64_tr_b16 v[170:171], v233 offset:25088
    s_waitcnt lgkmcnt(8)
    v_mfma_f32_16x16x32_bf16 v[100:103], v[180:183], v[12:15], v[100:103]
    ds_read_b64_tr_b16 v[172:173], v234 offset:24576
    v_mfma_f32_16x16x32_bf16 v[108:111], v[180:183], v[16:19], v[108:111]
    ds_read_b64_tr_b16 v[174:175], v234 offset:25088
    v_mfma_f32_16x16x32_bf16 v[104:107], v[184:187], v[12:15], v[104:107]
    ds_read_b64_tr_b16 v[176:177], v235 offset:24576
    v_mfma_f32_16x16x32_bf16 v[112:115], v[184:187], v[16:19], v[112:115]
    ds_read_b64_tr_b16 v[178:179], v235 offset:25088
    s_waitcnt lgkmcnt(8)
    v_mfma_f32_16x16x32_bf16 v[116:119], v[188:191], v[12:15], v[116:119]
    ds_read_b64_tr_b16 v[180:181], v232 offset:57344
    v_mfma_f32_16x16x32_bf16 v[124:127], v[188:191], v[16:19], v[124:127]
    ds_read_b64_tr_b16 v[182:183], v232 offset:57856
    v_mfma_f32_16x16x32_bf16 v[120:123], v[192:195], v[12:15], v[120:123]
    ds_read_b64_tr_b16 v[184:185], v233 offset:57344
    v_mfma_f32_16x16x32_bf16 v[128:131], v[192:195], v[16:19], v[128:131]
    ds_read_b64_tr_b16 v[186:187], v233 offset:57856
    s_waitcnt vmcnt(10)
    s_waitcnt lgkmcnt(8)
    v_mfma_f32_16x16x32_bf16 v[36:39], v[164:167], v[20:23], v[36:39]
    ds_read_b64_tr_b16 v[188:189], v234 offset:57344
    v_mfma_f32_16x16x32_bf16 v[44:47], v[164:167], v[24:27], v[44:47]
    ds_read_b64_tr_b16 v[190:191], v234 offset:57856
    s_add_u32 s41, s40, 24576
    buffer_load_dwordx4 v[12:15], v243, s[12:15], s41 offen offset:0 sc1
    v_mfma_f32_16x16x32_bf16 v[40:43], v[168:171], v[20:23], v[40:43]
    ds_read_b64_tr_b16 v[192:193], v235 offset:57344
    v_mfma_f32_16x16x32_bf16 v[48:51], v[168:171], v[24:27], v[48:51]
    ds_read_b64_tr_b16 v[194:195], v235 offset:57856
    buffer_load_dwordx4 v[16:19], v243, s[12:15], s41 offen offset:1024 sc1
    s_waitcnt lgkmcnt(8)
    v_mfma_f32_16x16x32_bf16 v[52:55], v[172:175], v[20:23], v[52:55]
    ds_read_b64_tr_b16 v[164:165], v220 offset:24576
    v_mfma_f32_16x16x32_bf16 v[60:63], v[172:175], v[24:27], v[60:63]
    ds_read_b64_tr_b16 v[166:167], v220 offset:25088
    v_mfma_f32_16x16x32_bf16 v[56:59], v[176:179], v[20:23], v[56:59]
    ds_read_b64_tr_b16 v[168:169], v221 offset:24576
    v_mfma_f32_16x16x32_bf16 v[64:67], v[176:179], v[24:27], v[64:67]
    ds_read_b64_tr_b16 v[170:171], v221 offset:25088
    s_waitcnt lgkmcnt(8)
    v_mfma_f32_16x16x32_bf16 v[68:71], v[180:183], v[20:23], v[68:71]
    ds_read_b64_tr_b16 v[172:173], v222 offset:24576
    v_mfma_f32_16x16x32_bf16 v[76:79], v[180:183], v[24:27], v[76:79]
    ds_read_b64_tr_b16 v[174:175], v222 offset:25088
    v_mfma_f32_16x16x32_bf16 v[72:75], v[184:187], v[20:23], v[72:75]
    ds_read_b64_tr_b16 v[176:177], v223 offset:24576
    v_mfma_f32_16x16x32_bf16 v[80:83], v[184:187], v[24:27], v[80:83]
    ds_read_b64_tr_b16 v[178:179], v223 offset:25088
    s_waitcnt lgkmcnt(8)
    v_mfma_f32_16x16x32_bf16 v[84:87], v[188:191], v[20:23], v[84:87]
    ds_read_b64_tr_b16 v[180:181], v232 offset:28672
    v_mfma_f32_16x16x32_bf16 v[92:95], v[188:191], v[24:27], v[92:95]
    ds_read_b64_tr_b16 v[182:183], v232 offset:29184
    v_mfma_f32_16x16x32_bf16 v[88:91], v[192:195], v[20:23], v[88:91]
    ds_read_b64_tr_b16 v[184:185], v233 offset:28672
    v_mfma_f32_16x16x32_bf16 v[96:99], v[192:195], v[24:27], v[96:99]
    ds_read_b64_tr_b16 v[186:187], v233 offset:29184
    s_waitcnt lgkmcnt(8)
    v_mfma_f32_16x16x32_bf16 v[100:103], v[164:167], v[20:23], v[100:103]
    ds_read_b64_tr_b16 v[188:189], v234 offset:28672
    v_mfma_f32_16x16x32_bf16 v[108:111], v[164:167], v[24:27], v[108:111]
    ds_read_b64_tr_b16 v[190:191], v234 offset:29184
    v_mfma_f32_16x16x32_bf16 v[104:107], v[168:171], v[20:23], v[104:107]
    ds_read_b64_tr_b16 v[192:193], v235 offset:28672
    v_mfma_f32_16x16x32_bf16 v[112:115], v[168:171], v[24:27], v[112:115]
    ds_read_b64_tr_b16 v[194:195], v235 offset:29184
    s_waitcnt lgkmcnt(8)
    v_mfma_f32_16x16x32_bf16 v[116:119], v[172:175], v[20:23], v[116:119]
    ds_read_b64_tr_b16 v[164:165], v232 offset:61440
    v_mfma_f32_16x16x32_bf16 v[124:127], v[172:175], v[24:27], v[124:127]
    ds_read_b64_tr_b16 v[166:167], v232 offset:61952
    v_mfma_f32_16x16x32_bf16 v[120:123], v[176:179], v[20:23], v[120:123]
    ds_read_b64_tr_b16 v[168:169], v233 offset:61440
    v_mfma_f32_16x16x32_bf16 v[128:131], v[176:179], v[24:27], v[128:131]
    ds_read_b64_tr_b16 v[170:171], v233 offset:61952
    s_waitcnt vmcnt(8)
    s_waitcnt lgkmcnt(8)
    v_mfma_f32_16x16x32_bf16 v[36:39], v[180:183], v[28:31], v[36:39]
    ds_read_b64_tr_b16 v[172:173], v234 offset:61440
    v_mfma_f32_16x16x32_bf16 v[44:47], v[180:183], v[32:35], v[44:47]
    ds_read_b64_tr_b16 v[174:175], v234 offset:61952
    s_add_u32 s41, s40, 24576
    buffer_load_dwordx4 v[20:23], v243, s[12:15], s41 offen offset:2048 sc1
    v_mfma_f32_16x16x32_bf16 v[40:43], v[184:187], v[28:31], v[40:43]
    ds_read_b64_tr_b16 v[176:177], v235 offset:61440
    v_mfma_f32_16x16x32_bf16 v[48:51], v[184:187], v[32:35], v[48:51]
    ds_read_b64_tr_b16 v[178:179], v235 offset:61952
    buffer_load_dwordx4 v[24:27], v243, s[12:15], s41 offen offset:3072 sc1
    s_waitcnt lgkmcnt(8)
    v_mfma_f32_16x16x32_bf16 v[52:55], v[188:191], v[28:31], v[52:55]
    ds_read_b64_tr_b16 v[180:181], v220 offset:28672
    v_mfma_f32_16x16x32_bf16 v[60:63], v[188:191], v[32:35], v[60:63]
    ds_read_b64_tr_b16 v[182:183], v220 offset:29184
    s_add_u32 s41, s40, 28672
    buffer_load_dwordx4 v[148:151], v243, s[12:15], s41 offen offset:0 sc1
    v_mfma_f32_16x16x32_bf16 v[56:59], v[192:195], v[28:31], v[56:59]
    ds_read_b64_tr_b16 v[184:185], v221 offset:28672
    v_mfma_f32_16x16x32_bf16 v[64:67], v[192:195], v[32:35], v[64:67]
    ds_read_b64_tr_b16 v[186:187], v221 offset:29184
    buffer_load_dwordx4 v[152:155], v243, s[12:15], s41 offen offset:1024 sc1
    s_waitcnt lgkmcnt(8)
    v_mfma_f32_16x16x32_bf16 v[68:71], v[164:167], v[28:31], v[68:71]
    ds_read_b64_tr_b16 v[188:189], v222 offset:28672
    v_mfma_f32_16x16x32_bf16 v[76:79], v[164:167], v[32:35], v[76:79]
    ds_read_b64_tr_b16 v[190:191], v222 offset:29184
    s_add_u32 s56, s57, 528384
    buffer_store_dwordx4 v[132:135], v243, s[8:11], s56 offen offset:0 sc1
    v_mfma_f32_16x16x32_bf16 v[72:75], v[168:171], v[28:31], v[72:75]
    ds_read_b64_tr_b16 v[192:193], v223 offset:28672
    v_mfma_f32_16x16x32_bf16 v[80:83], v[168:171], v[32:35], v[80:83]
    ds_read_b64_tr_b16 v[194:195], v223 offset:29184
    s_waitcnt lgkmcnt(8)
    v_mfma_f32_16x16x32_bf16 v[84:87], v[172:175], v[28:31], v[84:87]
    ds_read_b64_tr_b16 v[164:165], v224 offset:0
    v_mfma_f32_16x16x32_bf16 v[92:95], v[172:175], v[32:35], v[92:95]
    ds_read_b64_tr_b16 v[166:167], v224 offset:512
    v_mfma_f32_16x16x32_bf16 v[88:91], v[176:179], v[28:31], v[88:91]
    ds_read_b64_tr_b16 v[168:169], v225 offset:0
    v_mfma_f32_16x16x32_bf16 v[96:99], v[176:179], v[32:35], v[96:99]
    ds_read_b64_tr_b16 v[170:171], v225 offset:512
    s_waitcnt lgkmcnt(8)
    v_mfma_f32_16x16x32_bf16 v[100:103], v[180:183], v[28:31], v[100:103]
    ds_read_b64_tr_b16 v[172:173], v226 offset:0
    v_mfma_f32_16x16x32_bf16 v[108:111], v[180:183], v[32:35], v[108:111]
    ds_read_b64_tr_b16 v[174:175], v226 offset:512
    v_mfma_f32_16x16x32_bf16 v[104:107], v[184:187], v[28:31], v[104:107]
    ds_read_b64_tr_b16 v[176:177], v227 offset:0
    v_mfma_f32_16x16x32_bf16 v[112:115], v[184:187], v[32:35], v[112:115]
    ds_read_b64_tr_b16 v[178:179], v227 offset:512
    s_waitcnt lgkmcnt(8)
    v_mfma_f32_16x16x32_bf16 v[116:119], v[188:191], v[28:31], v[116:119]
    ds_read_b64_tr_b16 v[180:181], v224 offset:4096
    v_mfma_f32_16x16x32_bf16 v[124:127], v[188:191], v[32:35], v[124:127]
    ds_read_b64_tr_b16 v[182:183], v224 offset:4608
    v_mfma_f32_16x16x32_bf16 v[120:123], v[192:195], v[28:31], v[120:123]
    ds_read_b64_tr_b16 v[184:185], v225 offset:4096
    v_mfma_f32_16x16x32_bf16 v[128:131], v[192:195], v[32:35], v[128:131]
    ds_read_b64_tr_b16 v[186:187], v225 offset:4608
    s_barrier
    s_waitcnt vmcnt(20)
    s_waitcnt lgkmcnt(8)
    v_mfma_f32_16x16x32_bf16 v[100:103], v[164:167], v[196:199], v[100:103]
    ds_read_b64_tr_b16 v[188:189], v226 offset:4096
    v_mfma_f32_16x16x32_bf16 v[108:111], v[164:167], v[200:203], v[108:111]
    ds_read_b64_tr_b16 v[190:191], v226 offset:4608
    s_add_u32 s41, s40, 28672
    buffer_load_dwordx4 v[28:31], v243, s[12:15], s41 offen offset:2048 sc1
    buffer_load_dwordx4 v[32:35], v243, s[12:15], s41 offen offset:3072 sc1
    v_mfma_f32_16x16x32_bf16 v[104:107], v[168:171], v[196:199], v[104:107]
    ds_read_b64_tr_b16 v[192:193], v227 offset:4096
    v_mfma_f32_16x16x32_bf16 v[112:115], v[168:171], v[200:203], v[112:115]
    ds_read_b64_tr_b16 v[194:195], v227 offset:4608
    s_add_u32 s56, s57, 528384
    buffer_store_dwordx4 v[136:139], v243, s[8:11], s56 offen offset:1024 sc1
    s_add_u32 m0, s37, 32768
    s_add_u32 s48, s47, 2097280
    buffer_load_dwordx4 v228, s[24:27], s48 offen offset:0 lds
    s_waitcnt lgkmcnt(8)
    v_mfma_f32_16x16x32_bf16 v[116:119], v[172:175], v[196:199], v[116:119]
    ds_read_b64_tr_b16 v[164:165], v224 offset:8192
    v_mfma_f32_16x16x32_bf16 v[124:127], v[172:175], v[200:203], v[124:127]
    ds_read_b64_tr_b16 v[166:167], v224 offset:8704
    buffer_load_dwordx4 v229, s[24:27], s48 offen offset:1024 lds
    buffer_load_dwordx4 v230, s[24:27], s48 offen offset:2048 lds
    v_mfma_f32_16x16x32_bf16 v[120:123], v[176:179], v[196:199], v[120:123]
    ds_read_b64_tr_b16 v[168:169], v225 offset:8192
    v_mfma_f32_16x16x32_bf16 v[128:131], v[176:179], v[200:203], v[128:131]
    ds_read_b64_tr_b16 v[170:171], v225 offset:8704
    buffer_load_dwordx4 v231, s[24:27], s48 offen offset:3072 lds
    s_waitcnt vmcnt(22)
    s_waitcnt lgkmcnt(8)
    v_mfma_f32_16x16x32_bf16 v[100:103], v[180:183], v[204:207], v[100:103]
    ds_read_b64_tr_b16 v[172:173], v226 offset:8192
    v_mfma_f32_16x16x32_bf16 v[108:111], v[180:183], v[208:211], v[108:111]
    ds_read_b64_tr_b16 v[174:175], v226 offset:8704
    v_mfma_f32_16x16x32_bf16 v[104:107], v[184:187], v[204:207], v[104:107]
    ds_read_b64_tr_b16 v[176:177], v227 offset:8192
    v_mfma_f32_16x16x32_bf16 v[112:115], v[184:187], v[208:211], v[112:115]
    ds_read_b64_tr_b16 v[178:179], v227 offset:8704
    s_waitcnt lgkmcnt(8)
    v_mfma_f32_16x16x32_bf16 v[116:119], v[188:191], v[204:207], v[116:119]
    ds_read_b64_tr_b16 v[180:181], v224 offset:12288
    v_mfma_f32_16x16x32_bf16 v[124:127], v[188:191], v[208:211], v[124:127]
    ds_read_b64_tr_b16 v[182:183], v224 offset:12800
    v_mfma_f32_16x16x32_bf16 v[120:123], v[192:195], v[204:207], v[120:123]
    ds_read_b64_tr_b16 v[184:185], v225 offset:12288
    v_mfma_f32_16x16x32_bf16 v[128:131], v[192:195], v[208:211], v[128:131]
    ds_read_b64_tr_b16 v[186:187], v225 offset:12800
    s_waitcnt vmcnt(18)
    s_waitcnt lgkmcnt(8)
    v_mfma_f32_16x16x32_bf16 v[100:103], v[164:167], v[212:215], v[100:103]
    ds_read_b64_tr_b16 v[188:189], v226 offset:12288
    v_mfma_f32_16x16x32_bf16 v[108:111], v[164:167], v[216:219], v[108:111]
    ds_read_b64_tr_b16 v[190:191], v226 offset:12800
    s_add_u32 s56, s57, 528384
    buffer_store_dwordx4 v[140:143], v243, s[8:11], s56 offen offset:2048 sc1
    v_mfma_f32_16x16x32_bf16 v[104:107], v[168:171], v[212:215], v[104:107]
    ds_read_b64_tr_b16 v[192:193], v227 offset:12288
    v_mfma_f32_16x16x32_bf16 v[112:115], v[168:171], v[216:219], v[112:115]
    ds_read_b64_tr_b16 v[194:195], v227 offset:12800
    s_waitcnt lgkmcnt(8)
    v_mfma_f32_16x16x32_bf16 v[116:119], v[172:175], v[212:215], v[116:119]
    ds_read_b64_tr_b16 v[164:165], v224 offset:16384
    v_mfma_f32_16x16x32_bf16 v[124:127], v[172:175], v[216:219], v[124:127]
    ds_read_b64_tr_b16 v[166:167], v224 offset:16896
    v_mfma_f32_16x16x32_bf16 v[120:123], v[176:179], v[212:215], v[120:123]
    ds_read_b64_tr_b16 v[168:169], v225 offset:16384
    v_mfma_f32_16x16x32_bf16 v[128:131], v[176:179], v[216:219], v[128:131]
    ds_read_b64_tr_b16 v[170:171], v225 offset:16896
    s_waitcnt vmcnt(16)
    s_waitcnt lgkmcnt(8)
    v_mfma_f32_16x16x32_bf16 v[100:103], v[180:183], v[4:7], v[100:103]
    ds_read_b64_tr_b16 v[172:173], v226 offset:16384
    v_mfma_f32_16x16x32_bf16 v[108:111], v[180:183], v[8:11], v[108:111]
    ds_read_b64_tr_b16 v[174:175], v226 offset:16896
    s_add_u32 s56, s57, 528384
    buffer_store_dwordx4 v[144:147], v243, s[8:11], s56 offen offset:3072 sc1
    v_mfma_f32_16x16x32_bf16 v[104:107], v[184:187], v[4:7], v[104:107]
    ds_read_b64_tr_b16 v[176:177], v227 offset:16384
    v_mfma_f32_16x16x32_bf16 v[112:115], v[184:187], v[8:11], v[112:115]
    ds_read_b64_tr_b16 v[178:179], v227 offset:16896
    s_waitcnt lgkmcnt(8)
    v_mfma_f32_16x16x32_bf16 v[116:119], v[188:191], v[4:7], v[116:119]
    ds_read_b64_tr_b16 v[180:181], v224 offset:20480
    v_mfma_f32_16x16x32_bf16 v[124:127], v[188:191], v[8:11], v[124:127]
    ds_read_b64_tr_b16 v[182:183], v224 offset:20992
    v_mfma_f32_16x16x32_bf16 v[120:123], v[192:195], v[4:7], v[120:123]
    ds_read_b64_tr_b16 v[184:185], v225 offset:20480
    v_mfma_f32_16x16x32_bf16 v[128:131], v[192:195], v[8:11], v[128:131]
    ds_read_b64_tr_b16 v[186:187], v225 offset:20992
    s_waitcnt vmcnt(14)
    s_waitcnt lgkmcnt(8)
    v_mfma_f32_16x16x32_bf16 v[100:103], v[164:167], v[12:15], v[100:103]
    ds_read_b64_tr_b16 v[188:189], v226 offset:20480
    v_mfma_f32_16x16x32_bf16 v[108:111], v[164:167], v[16:19], v[108:111]
    ds_read_b64_tr_b16 v[190:191], v226 offset:20992
    v_mfma_f32_16x16x32_bf16 v[104:107], v[168:171], v[12:15], v[104:107]
    ds_read_b64_tr_b16 v[192:193], v227 offset:20480
    v_mfma_f32_16x16x32_bf16 v[112:115], v[168:171], v[16:19], v[112:115]
    ds_read_b64_tr_b16 v[194:195], v227 offset:20992
    s_waitcnt lgkmcnt(8)
    v_mfma_f32_16x16x32_bf16 v[116:119], v[172:175], v[12:15], v[116:119]
    ds_read_b64_tr_b16 v[164:165], v224 offset:24576
    v_mfma_f32_16x16x32_bf16 v[124:127], v[172:175], v[16:19], v[124:127]
    ds_read_b64_tr_b16 v[166:167], v224 offset:25088
    v_mfma_f32_16x16x32_bf16 v[120:123], v[176:179], v[12:15], v[120:123]
    ds_read_b64_tr_b16 v[168:169], v225 offset:24576
    v_mfma_f32_16x16x32_bf16 v[128:131], v[176:179], v[16:19], v[128:131]
    ds_read_b64_tr_b16 v[170:171], v225 offset:25088
    s_waitcnt vmcnt(12)
    s_waitcnt lgkmcnt(8)
    v_mfma_f32_16x16x32_bf16 v[100:103], v[180:183], v[20:23], v[100:103]
    ds_read_b64_tr_b16 v[172:173], v226 offset:24576
    v_mfma_f32_16x16x32_bf16 v[108:111], v[180:183], v[24:27], v[108:111]
    ds_read_b64_tr_b16 v[174:175], v226 offset:25088
    v_mfma_f32_16x16x32_bf16 v[104:107], v[184:187], v[20:23], v[104:107]
    ds_read_b64_tr_b16 v[176:177], v227 offset:24576
    v_mfma_f32_16x16x32_bf16 v[112:115], v[184:187], v[24:27], v[112:115]
    ds_read_b64_tr_b16 v[178:179], v227 offset:25088
    s_waitcnt lgkmcnt(8)
    v_mfma_f32_16x16x32_bf16 v[116:119], v[188:191], v[20:23], v[116:119]
    ds_read_b64_tr_b16 v[180:181], v224 offset:28672
    v_mfma_f32_16x16x32_bf16 v[124:127], v[188:191], v[24:27], v[124:127]
    ds_read_b64_tr_b16 v[182:183], v224 offset:29184
    v_mfma_f32_16x16x32_bf16 v[120:123], v[192:195], v[20:23], v[120:123]
    ds_read_b64_tr_b16 v[184:185], v225 offset:28672
    v_mfma_f32_16x16x32_bf16 v[128:131], v[192:195], v[24:27], v[128:131]
    ds_read_b64_tr_b16 v[186:187], v225 offset:29184
    s_waitcnt vmcnt(2)
    s_barrier
    s_waitcnt vmcnt(10)
    s_waitcnt lgkmcnt(8)
    v_mfma_f32_16x16x32_bf16 v[100:103], v[164:167], v[148:151], v[100:103]
    ds_read_b64_tr_b16 v[188:189], v226 offset:28672
    v_mfma_f32_16x16x32_bf16 v[108:111], v[164:167], v[152:155], v[108:111]
    ds_read_b64_tr_b16 v[190:191], v226 offset:29184
    v_mfma_f32_16x16x32_bf16 v[104:107], v[168:171], v[148:151], v[104:107]
    ds_read_b64_tr_b16 v[192:193], v227 offset:28672
    v_mfma_f32_16x16x32_bf16 v[112:115], v[168:171], v[152:155], v[112:115]
    ds_read_b64_tr_b16 v[194:195], v227 offset:29184
    s_waitcnt lgkmcnt(8)
    v_mfma_f32_16x16x32_bf16 v[116:119], v[172:175], v[148:151], v[116:119]
    ds_read_b64_tr_b16 v[164:165], v220 offset:32768
    v_mfma_f32_16x16x32_bf16 v[124:127], v[172:175], v[152:155], v[124:127]
    ds_read_b64_tr_b16 v[166:167], v220 offset:33280
    v_mfma_f32_16x16x32_bf16 v[120:123], v[176:179], v[148:151], v[120:123]
    ds_read_b64_tr_b16 v[168:169], v221 offset:32768
    v_mfma_f32_16x16x32_bf16 v[128:131], v[176:179], v[152:155], v[128:131]
    ds_read_b64_tr_b16 v[170:171], v221 offset:33280
    s_waitcnt vmcnt(7)
    s_waitcnt lgkmcnt(8)
    v_mfma_f32_16x16x32_bf16 v[100:103], v[180:183], v[28:31], v[100:103]
    ds_read_b64_tr_b16 v[172:173], v222 offset:32768
    v_mfma_f32_16x16x32_bf16 v[108:111], v[180:183], v[32:35], v[108:111]
    ds_read_b64_tr_b16 v[174:175], v222 offset:33280
    v_mfma_f32_16x16x32_bf16 v[104:107], v[184:187], v[28:31], v[104:107]
    ds_read_b64_tr_b16 v[176:177], v223 offset:32768
    v_mfma_f32_16x16x32_bf16 v[112:115], v[184:187], v[32:35], v[112:115]
    ds_read_b64_tr_b16 v[178:179], v223 offset:33280
    s_waitcnt lgkmcnt(8)
    v_mfma_f32_16x16x32_bf16 v[116:119], v[188:191], v[28:31], v[116:119]
    ds_read_b64_tr_b16 v[180:181], v232 offset:32768
    v_mfma_f32_16x16x32_bf16 v[124:127], v[188:191], v[32:35], v[124:127]
    ds_read_b64_tr_b16 v[182:183], v232 offset:33280
    v_mfma_f32_16x16x32_bf16 v[120:123], v[192:195], v[28:31], v[120:123]
    ds_read_b64_tr_b16 v[184:185], v233 offset:32768
    v_mfma_f32_16x16x32_bf16 v[128:131], v[192:195], v[32:35], v[128:131]
    ds_read_b64_tr_b16 v[186:187], v233 offset:33280
    s_waitcnt vmcnt(0)
    s_barrier
    v_mov_b32 v2, 0
    s_cmp_lg_u32 s28, 7
    s_cbranch_scc1 L_k2_nosig
    s_lshl_b32 s52, s52, 7
    v_mov_b32 v1, 1
    s_mov_b64 exec, 1
    buffer_atomic_add v1, v2, s[16:19], s52 offen sc1
    s_mov_b64 exec, -1
L_k2_nosig:
    s_lshr_b32 s54, s29, 2
    s_lshl_b32 s54, s54, 7
    s_waitcnt lgkmcnt(8)
    v_mfma_f32_16x16x32_bf16 v[36:39], v[164:167], v[196:199], v[36:39]
    ds_read_b64_tr_b16 v[188:189], v234 offset:32768
    v_mfma_f32_16x16x32_bf16 v[44:47], v[164:167], v[200:203], v[44:47]
    ds_read_b64_tr_b16 v[190:191], v234 offset:33280
    v_mfma_f32_16x16x32_bf16 v[40:43], v[168:171], v[196:199], v[40:43]
    ds_read_b64_tr_b16 v[192:193], v235 offset:32768
    v_mfma_f32_16x16x32_bf16 v[48:51], v[168:171], v[200:203], v[48:51]
    ds_read_b64_tr_b16 v[194:195], v235 offset:33280
    s_waitcnt lgkmcnt(8)
    v_mfma_f32_16x16x32_bf16 v[52:55], v[172:175], v[196:199], v[52:55]
    ds_read_b64_tr_b16 v[164:165], v220 offset:36864
    v_mfma_f32_16x16x32_bf16 v[60:63], v[172:175], v[200:203], v[60:63]
    ds_read_b64_tr_b16 v[166:167], v220 offset:37376
    v_mfma_f32_16x16x32_bf16 v[56:59], v[176:179], v[196:199], v[56:59]
    ds_read_b64_tr_b16 v[168:169], v221 offset:36864
    v_mfma_f32_16x16x32_bf16 v[64:67], v[176:179], v[200:203], v[64:67]
    ds_read_b64_tr_b16 v[170:171], v221 offset:37376
    s_waitcnt lgkmcnt(8)
    v_mfma_f32_16x16x32_bf16 v[68:71], v[180:183], v[196:199], v[68:71]
    ds_read_b64_tr_b16 v[172:173], v222 offset:36864
    v_mul_f32 v248, v100, v100
    v_mul_f32 v249, v101, v101
    v_mfma_f32_16x16x32_bf16 v[76:79], v[180:183], v[200:203], v[76:79]
    ds_read_b64_tr_b16 v[174:175], v222 offset:37376
    v_mul_f32 v250, v102, v102
    v_mul_f32 v251, v103, v103
    v_mfma_f32_16x16x32_bf16 v[72:75], v[184:187], v[196:199], v[72:75]
    ds_read_b64_tr_b16 v[176:177], v223 offset:36864
    v_fma_f32 v248, v248, s55, v252
    v_fma_f32 v249, v249, s55, v252
    v_mfma_f32_16x16x32_bf16 v[80:83], v[184:187], v[200:203], v[80:83]
    ds_read_b64_tr_b16 v[178:179], v223 offset:37376
    v_fma_f32 v250, v250, s55, v252
    v_fma_f32 v251, v251, s55, v252
    s_waitcnt lgkmcnt(8)
    v_mfma_f32_16x16x32_bf16 v[84:87], v[188:191], v[196:199], v[84:87]
    ds_read_b64_tr_b16 v[180:181], v232 offset:36864
    v_mul_f32 v248, v248, v100
    v_mul_f32 v249, v249, v101
    v_mfma_f32_16x16x32_bf16 v[92:95], v[188:191], v[200:203], v[92:95]
    ds_read_b64_tr_b16 v[182:183], v232 offset:37376
    v_mul_f32 v250, v250, v102
    v_mul_f32 v251, v251, v103
    v_mfma_f32_16x16x32_bf16 v[88:91], v[192:195], v[196:199], v[88:91]
    ds_read_b64_tr_b16 v[184:185], v233 offset:36864
    v_exp_f32 v248, v248
    v_exp_f32 v249, v249
    v_mfma_f32_16x16x32_bf16 v[96:99], v[192:195], v[200:203], v[96:99]
    ds_read_b64_tr_b16 v[186:187], v233 offset:37376
    v_exp_f32 v250, v250
    v_exp_f32 v251, v251
    s_waitcnt lgkmcnt(8)
    v_mfma_f32_16x16x32_bf16 v[36:39], v[164:167], v[204:207], v[36:39]
    ds_read_b64_tr_b16 v[188:189], v234 offset:36864
    v_add_f32 v248, 1.0, v248
    v_add_f32 v249, 1.0, v249
    v_mfma_f32_16x16x32_bf16 v[44:47], v[164:167], v[208:211], v[44:47]
    ds_read_b64_tr_b16 v[190:191], v234 offset:37376
    v_add_f32 v250, 1.0, v250
    v_add_f32 v251, 1.0, v251
    v_mfma_f32_16x16x32_bf16 v[40:43], v[168:171], v[204:207], v[40:43]
    ds_read_b64_tr_b16 v[192:193], v235 offset:36864
    v_rcp_f32 v248, v248
    v_rcp_f32 v249, v249
    v_mfma_f32_16x16x32_bf16 v[48:51], v[168:171], v[208:211], v[48:51]
    ds_read_b64_tr_b16 v[194:195], v235 offset:37376
    v_rcp_f32 v250, v250
    v_rcp_f32 v251, v251
    s_waitcnt lgkmcnt(8)
    v_mfma_f32_16x16x32_bf16 v[52:55], v[172:175], v[204:207], v[52:55]
    ds_read_b64_tr_b16 v[164:165], v220 offset:40960
    v_mul_f32 v100, v248, v100
    v_mul_f32 v101, v249, v101
    v_mfma_f32_16x16x32_bf16 v[60:63], v[172:175], v[208:211], v[60:63]
    ds_read_b64_tr_b16 v[166:167], v220 offset:41472
    v_mul_f32 v102, v250, v102
    v_mul_f32 v103, v251, v103
    v_mfma_f32_16x16x32_bf16 v[56:59], v[176:179], v[204:207], v[56:59]
    ds_read_b64_tr_b16 v[168:169], v221 offset:40960
    v_mul_f32 v248, v104, v104
    v_mul_f32 v249, v105, v105
    v_mfma_f32_16x16x32_bf16 v[64:67], v[176:179], v[208:211], v[64:67]
    ds_read_b64_tr_b16 v[170:171], v221 offset:41472
    v_mul_f32 v250, v106, v106
    v_mul_f32 v251, v107, v107
    s_waitcnt lgkmcnt(8)
    v_mfma_f32_16x16x32_bf16 v[68:71], v[180:183], v[204:207], v[68:71]
    ds_read_b64_tr_b16 v[172:173], v222 offset:40960
    v_fma_f32 v248, v248, s55, v252
    v_fma_f32 v249, v249, s55, v252
    v_mfma_f32_16x16x32_bf16 v[76:79], v[180:183], v[208:211], v[76:79]
    ds_read_b64_tr_b16 v[174:175], v222 offset:41472
    v_fma_f32 v250, v250, s55, v252
    v_fma_f32 v251, v251, s55, v252
    v_mfma_f32_16x16x32_bf16 v[72:75], v[184:187], v[204:207], v[72:75]
    ds_read_b64_tr_b16 v[176:177], v223 offset:40960
    v_mul_f32 v248, v248, v104
    v_mul_f32 v249, v249, v105
    v_mfma_f32_16x16x32_bf16 v[80:83], v[184:187], v[208:211], v[80:83]
    ds_read_b64_tr_b16 v[178:179], v223 offset:41472
    v_mul_f32 v250, v250, v106
    v_mul_f32 v251, v251, v107
    s_waitcnt lgkmcnt(8)
    v_mfma_f32_16x16x32_bf16 v[84:87], v[188:191], v[204:207], v[84:87]
    ds_read_b64_tr_b16 v[180:181], v232 offset:40960
    v_exp_f32 v248, v248
    v_exp_f32 v249, v249
    v_mfma_f32_16x16x32_bf16 v[92:95], v[188:191], v[208:211], v[92:95]
    ds_read_b64_tr_b16 v[182:183], v232 offset:41472
    v_exp_f32 v250, v250
    v_exp_f32 v251, v251
    v_mfma_f32_16x16x32_bf16 v[88:91], v[192:195], v[204:207], v[88:91]
    ds_read_b64_tr_b16 v[184:185], v233 offset:40960
    v_add_f32 v248, 1.0, v248
    v_add_f32 v249, 1.0, v249
    v_mfma_f32_16x16x32_bf16 v[96:99], v[192:195], v[208:211], v[96:99]
    ds_read_b64_tr_b16 v[186:187], v233 offset:41472
    v_add_f32 v250, 1.0, v250
    v_add_f32 v251, 1.0, v251
    s_waitcnt lgkmcnt(8)
    v_mfma_f32_16x16x32_bf16 v[36:39], v[164:167], v[212:215], v[36:39]
    ds_read_b64_tr_b16 v[188:189], v234 offset:40960
    v_rcp_f32 v248, v248
    v_rcp_f32 v249, v249
    v_mfma_f32_16x16x32_bf16 v[44:47], v[164:167], v[216:219], v[44:47]
    ds_read_b64_tr_b16 v[190:191], v234 offset:41472
    v_rcp_f32 v250, v250
    v_rcp_f32 v251, v251
    buffer_load_dword v1, v2, s[16:19], s54 offen sc0 sc1
    v_mfma_f32_16x16x32_bf16 v[40:43], v[168:171], v[212:215], v[40:43]
    ds_read_b64_tr_b16 v[192:193], v235 offset:40960
    v_mul_f32 v104, v248, v104
    v_mul_f32 v105, v249, v105
    v_mfma_f32_16x16x32_bf16 v[48:51], v[168:171], v[216:219], v[48:51]
    ds_read_b64_tr_b16 v[194:195], v235 offset:41472
    v_mul_f32 v106, v250, v106
    v_mul_f32 v107, v251, v107
    s_waitcnt lgkmcnt(8)
    v_mfma_f32_16x16x32_bf16 v[52:55], v[172:175], v[212:215], v[52:55]
    ds_read_b64_tr_b16 v[164:165], v220 offset:45056
    v_cvt_pk_bf16_f32 v100, v100, v101
    v_cvt_pk_bf16_f32 v101, v102, v103
    v_mfma_f32_16x16x32_bf16 v[60:63], v[172:175], v[216:219], v[60:63]
    ds_read_b64_tr_b16 v[166:167], v220 offset:45568
    v_cvt_pk_bf16_f32 v102, v104, v105
    v_cvt_pk_bf16_f32 v103, v106, v107
    v_mfma_f32_16x16x32_bf16 v[56:59], v[176:179], v[212:215], v[56:59]
    ds_read_b64_tr_b16 v[168:169], v221 offset:45056
    v_mul_f32 v248, v108, v108
    v_mul_f32 v249, v109, v109
    v_mfma_f32_16x16x32_bf16 v[64:67], v[176:179], v[216:219], v[64:67]
    ds_read_b64_tr_b16 v[170:171], v221 offset:45568
    v_mul_f32 v250, v110, v110
    v_mul_f32 v251, v111, v111
    s_waitcnt lgkmcnt(8)
    v_mfma_f32_16x16x32_bf16 v[68:71], v[180:183], v[212:215], v[68:71]
    ds_read_b64_tr_b16 v[172:173], v222 offset:45056
    v_fma_f32 v248, v248, s55, v252
    v_fma_f32 v249, v249, s55, v252
    v_mfma_f32_16x16x32_bf16 v[76:79], v[180:183], v[216:219], v[76:79]
    ds_read_b64_tr_b16 v[174:175], v222 offset:45568
    v_fma_f32 v250, v250, s55, v252
    v_fma_f32 v251, v251, s55, v252
    v_mfma_f32_16x16x32_bf16 v[72:75], v[184:187], v[212:215], v[72:75]
    ds_read_b64_tr_b16 v[176:177], v223 offset:45056
    v_mul_f32 v248, v248, v108
    v_mul_f32 v249, v249, v109
    v_mfma_f32_16x16x32_bf16 v[80:83], v[184:187], v[216:219], v[80:83]
    ds_read_b64_tr_b16 v[178:179], v223 offset:45568
    v_mul_f32 v250, v250, v110
    v_mul_f32 v251, v251, v111
    s_waitcnt lgkmcnt(8)
    v_mfma_f32_16x16x32_bf16 v[84:87], v[188:191], v[212:215], v[84:87]
    ds_read_b64_tr_b16 v[180:181], v232 offset:45056
    v_exp_f32 v248, v248
    v_exp_f32 v249, v249
    v_mfma_f32_16x16x32_bf16 v[92:95], v[188:191], v[216:219], v[92:95]
    ds_read_b64_tr_b16 v[182:183], v232 offset:45568
    v_exp_f32 v250, v250
    v_exp_f32 v251, v251
    v_mfma_f32_16x16x32_bf16 v[88:91], v[192:195], v[212:215], v[88:91]
    ds_read_b64_tr_b16 v[184:185], v233 offset:45056
    v_add_f32 v248, 1.0, v248
    v_add_f32 v249, 1.0, v249
    v_mfma_f32_16x16x32_bf16 v[96:99], v[192:195], v[216:219], v[96:99]
    ds_read_b64_tr_b16 v[186:187], v233 offset:45568
    v_add_f32 v250, 1.0, v250
    v_add_f32 v251, 1.0, v251
    s_waitcnt lgkmcnt(8)
    v_mfma_f32_16x16x32_bf16 v[36:39], v[164:167], v[4:7], v[36:39]
    ds_read_b64_tr_b16 v[188:189], v234 offset:45056
    v_rcp_f32 v248, v248
    v_rcp_f32 v249, v249
    v_mfma_f32_16x16x32_bf16 v[44:47], v[164:167], v[8:11], v[44:47]
    ds_read_b64_tr_b16 v[190:191], v234 offset:45568
    v_rcp_f32 v250, v250
    v_rcp_f32 v251, v251
    v_mfma_f32_16x16x32_bf16 v[40:43], v[168:171], v[4:7], v[40:43]
    ds_read_b64_tr_b16 v[192:193], v235 offset:45056
    v_mul_f32 v108, v248, v108
    v_mul_f32 v109, v249, v109
    v_mfma_f32_16x16x32_bf16 v[48:51], v[168:171], v[8:11], v[48:51]
    ds_read_b64_tr_b16 v[194:195], v235 offset:45568
    v_mul_f32 v110, v250, v110
    v_mul_f32 v111, v251, v111
    s_waitcnt lgkmcnt(8)
    v_mfma_f32_16x16x32_bf16 v[52:55], v[172:175], v[4:7], v[52:55]
    ds_read_b64_tr_b16 v[164:165], v220 offset:49152
    v_mul_f32 v248, v112, v112
    v_mul_f32 v249, v113, v113
    v_mfma_f32_16x16x32_bf16 v[60:63], v[172:175], v[8:11], v[60:63]
    ds_read_b64_tr_b16 v[166:167], v220 offset:49664
    v_mul_f32 v250, v114, v114
    v_mul_f32 v251, v115, v115
    v_mfma_f32_16x16x32_bf16 v[56:59], v[176:179], v[4:7], v[56:59]
    ds_read_b64_tr_b16 v[168:169], v221 offset:49152
    v_fma_f32 v248, v248, s55, v252
    v_fma_f32 v249, v249, s55, v252
    v_mfma_f32_16x16x32_bf16 v[64:67], v[176:179], v[8:11], v[64:67]
    ds_read_b64_tr_b16 v[170:171], v221 offset:49664
    v_fma_f32 v250, v250, s55, v252
    v_fma_f32 v251, v251, s55, v252
    s_waitcnt lgkmcnt(8)
    v_mfma_f32_16x16x32_bf16 v[68:71], v[180:183], v[4:7], v[68:71]
    ds_read_b64_tr_b16 v[172:173], v222 offset:49152
    v_mul_f32 v248, v248, v112
    v_mul_f32 v249, v249, v113
    v_mfma_f32_16x16x32_bf16 v[76:79], v[180:183], v[8:11], v[76:79]
    ds_read_b64_tr_b16 v[174:175], v222 offset:49664
    v_mul_f32 v250, v250, v114
    v_mul_f32 v251, v251, v115
    v_mfma_f32_16x16x32_bf16 v[72:75], v[184:187], v[4:7], v[72:75]
    ds_read_b64_tr_b16 v[176:177], v223 offset:49152
    v_exp_f32 v248, v248
    v_exp_f32 v249, v249
    v_mfma_f32_16x16x32_bf16 v[80:83], v[184:187], v[8:11], v[80:83]
    ds_read_b64_tr_b16 v[178:179], v223 offset:49664
    v_exp_f32 v250, v250
    v_exp_f32 v251, v251
    s_waitcnt lgkmcnt(8)
    v_mfma_f32_16x16x32_bf16 v[84:87], v[188:191], v[4:7], v[84:87]
    ds_read_b64_tr_b16 v[180:181], v232 offset:49152
    v_add_f32 v248, 1.0, v248
    v_add_f32 v249, 1.0, v249
    v_mfma_f32_16x16x32_bf16 v[92:95], v[188:191], v[8:11], v[92:95]
    ds_read_b64_tr_b16 v[182:183], v232 offset:49664
    v_add_f32 v250, 1.0, v250
    v_add_f32 v251, 1.0, v251
    v_mfma_f32_16x16x32_bf16 v[88:91], v[192:195], v[4:7], v[88:91]
    ds_read_b64_tr_b16 v[184:185], v233 offset:49152
    v_rcp_f32 v248, v248
    v_rcp_f32 v249, v249
    v_mfma_f32_16x16x32_bf16 v[96:99], v[192:195], v[8:11], v[96:99]
    ds_read_b64_tr_b16 v[186:187], v233 offset:49664
    v_rcp_f32 v250, v250
    v_rcp_f32 v251, v251
    s_waitcnt vmcnt(0)
    s_mov_b32 s50, 0x200000
L_k2_kv:
    v_cmp_gt_u32 vcc, 32, v1
    s_cbranch_vccz L_k2_kvok
    s_sleep 6
    buffer_load_dword v1, v2, s[16:19], s54 offen sc0 sc1
    s_waitcnt vmcnt(0)
    s_sub_u32 s50, s50, 1
    s_cmp_lg_u32 s50, 0
    s_cbranch_scc1 L_k2_kv
L_k2_kvok:
    s_waitcnt lgkmcnt(8)
    v_mfma_f32_16x16x32_bf16 v[36:39], v[164:167], v[12:15], v[36:39]
    ds_read_b64_tr_b16 v[188:189], v234 offset:49152
    v_mul_f32 v112, v248, v112
    v_mul_f32 v113, v249, v113
    v_mfma_f32_16x16x32_bf16 v[44:47], v[164:167], v[16:19], v[44:47]
    ds_read_b64_tr_b16 v[190:191], v234 offset:49664
    v_mul_f32 v114, v250, v114
    v_mul_f32 v115, v251, v115
    s_cmp_lt_u32 s32, s33
    s_cselect_b32 s35, s34, 2147483648
    s_mov_b32 m0, s36
    s_sub_u32 s38, s32, 1
    buffer_load_dwordx4 v243, s[8:11], s35 offen offset:0 sc1 lds
    v_mfma_f32_16x16x32_bf16 v[40:43], v[168:171], v[12:15], v[40:43]
    ds_read_b64_tr_b16 v[192:193], v235 offset:49152
    v_cvt_pk_bf16_f32 v108, v108, v109
    v_cvt_pk_bf16_f32 v109, v110, v111
    v_mfma_f32_16x16x32_bf16 v[48:51], v[168:171], v[16:19], v[48:51]
    ds_read_b64_tr_b16 v[194:195], v235 offset:49664
    v_cvt_pk_bf16_f32 v110, v112, v113
    v_cvt_pk_bf16_f32 v111, v114, v115
    buffer_load_dwordx4 v243, s[8:11], s35 offen offset:1024 sc1 lds
    s_waitcnt lgkmcnt(8)
    v_mfma_f32_16x16x32_bf16 v[52:55], v[172:175], v[12:15], v[52:55]
    ds_read_b64_tr_b16 v[164:165], v220 offset:53248
    v_mul_f32 v248, v116, v116
    v_mul_f32 v249, v117, v117
    v_mfma_f32_16x16x32_bf16 v[60:63], v[172:175], v[16:19], v[60:63]
    ds_read_b64_tr_b16 v[166:167], v220 offset:53760
    v_mul_f32 v250, v118, v118
    v_mul_f32 v251, v119, v119
    buffer_load_dwordx4 v243, s[8:11], s35 offen offset:2048 sc1 lds
    v_mfma_f32_16x16x32_bf16 v[56:59], v[176:179], v[12:15], v[56:59]
    ds_read_b64_tr_b16 v[168:169], v221 offset:53248
    v_fma_f32 v248, v248, s55, v252
    v_fma_f32 v249, v249, s55, v252
    v_mfma_f32_16x16x32_bf16 v[64:67], v[176:179], v[16:19], v[64:67]
    ds_read_b64_tr_b16 v[170:171], v221 offset:53760
    v_fma_f32 v250, v250, s55, v252
    v_fma_f32 v251, v251, s55, v252
    buffer_load_dwordx4 v243, s[8:11], s35 offen offset:3072 sc1 lds
    s_waitcnt lgkmcnt(8)
    v_mfma_f32_16x16x32_bf16 v[68:71], v[180:183], v[12:15], v[68:71]
    ds_read_b64_tr_b16 v[172:173], v222 offset:53248
    v_mul_f32 v248, v248, v116
    v_mul_f32 v249, v249, v117
    v_mfma_f32_16x16x32_bf16 v[76:79], v[180:183], v[16:19], v[76:79]
    ds_read_b64_tr_b16 v[174:175], v222 offset:53760
    v_mul_f32 v250, v250, v118
    v_mul_f32 v251, v251, v119
    s_add_u32 s49, s34, 16760832
    s_cmp_lt_u32 s38, s33
    s_cselect_b32 s49, s49, 2147483648
    s_add_u32 m0, s36, 16384
    s_add_u32 s36, s36, 65536
    v_mfma_f32_16x16x32_bf16 v[72:75], v[184:187], v[12:15], v[72:75]
    ds_read_b64_tr_b16 v[176:177], v223 offset:53248
    v_exp_f32 v248, v248
    v_exp_f32 v249, v249
    v_mfma_f32_16x16x32_bf16 v[80:83], v[184:187], v[16:19], v[80:83]
    ds_read_b64_tr_b16 v[178:179], v223 offset:53760
    v_exp_f32 v250, v250
    v_exp_f32 v251, v251
    buffer_load_dwordx4 v243, s[8:11], s49 offen offset:0 sc1 lds
    s_waitcnt lgkmcnt(8)
    v_mfma_f32_16x16x32_bf16 v[84:87], v[188:191], v[12:15], v[84:87]
    ds_read_b64_tr_b16 v[180:181], v232 offset:53248
    v_add_f32 v248, 1.0, v248
    v_add_f32 v249, 1.0, v249
    v_mfma_f32_16x16x32_bf16 v[92:95], v[188:191], v[16:19], v[92:95]
    ds_read_b64_tr_b16 v[182:183], v232 offset:53760
    v_add_f32 v250, 1.0, v250
    v_add_f32 v251, 1.0, v251
    buffer_load_dwordx4 v243, s[8:11], s49 offen offset:1024 sc1 lds
    v_mfma_f32_16x16x32_bf16 v[88:91], v[192:195], v[12:15], v[88:91]
    ds_read_b64_tr_b16 v[184:185], v233 offset:53248
    v_rcp_f32 v248, v248
    v_rcp_f32 v249, v249
    v_mfma_f32_16x16x32_bf16 v[96:99], v[192:195], v[16:19], v[96:99]
    ds_read_b64_tr_b16 v[186:187], v233 offset:53760
    v_rcp_f32 v250, v250
    v_rcp_f32 v251, v251
    buffer_load_dwordx4 v243, s[8:11], s49 offen offset:2048 sc1 lds
    s_waitcnt lgkmcnt(8)
    v_mfma_f32_16x16x32_bf16 v[36:39], v[164:167], v[20:23], v[36:39]
    ds_read_b64_tr_b16 v[188:189], v234 offset:53248
    v_mul_f32 v116, v248, v116
    v_mul_f32 v117, v249, v117
    v_mfma_f32_16x16x32_bf16 v[44:47], v[164:167], v[24:27], v[44:47]
    ds_read_b64_tr_b16 v[190:191], v234 offset:53760
    v_mul_f32 v118, v250, v118
    v_mul_f32 v119, v251, v119
    buffer_load_dwordx4 v243, s[8:11], s49 offen offset:3072 sc1 lds
    s_cmp_ge_u32 s36, 163840
    s_cselect_b32 s38, 163840, 0
    s_sub_u32 s36, s36, s38
    s_add_u32 s32, s32, 1
    s_add_u32 s34, s34, 16384
    s_sub_u32 s45, s45, 1
    v_mfma_f32_16x16x32_bf16 v[40:43], v[168:171], v[20:23], v[40:43]
    ds_read_b64_tr_b16 v[192:193], v235 offset:53248
    v_mul_f32 v248, v120, v120
    v_mul_f32 v249, v121, v121
    v_mfma_f32_16x16x32_bf16 v[48:51], v[168:171], v[24:27], v[48:51]
    ds_read_b64_tr_b16 v[194:195], v235 offset:53760
    v_mul_f32 v250, v122, v122
    v_mul_f32 v251, v123, v123
    s_cmp_lt_u32 s32, s33
    s_cselect_b32 s35, s34, 2147483648
    s_mov_b32 m0, s36
    s_sub_u32 s38, s32, 1
    s_waitcnt lgkmcnt(8)
    v_mfma_f32_16x16x32_bf16 v[52:55], v[172:175], v[20:23], v[52:55]
    ds_read_b64_tr_b16 v[164:165], v220 offset:57344
    v_fma_f32 v248, v248, s55, v252
    v_fma_f32 v249, v249, s55, v252
    v_mfma_f32_16x16x32_bf16 v[60:63], v[172:175], v[24:27], v[60:63]
    ds_read_b64_tr_b16 v[166:167], v220 offset:57856
    v_fma_f32 v250, v250, s55, v252
    v_fma_f32 v251, v251, s55, v252
    buffer_load_dwordx4 v243, s[8:11], s35 offen offset:0 sc1 lds
    v_mfma_f32_16x16x32_bf16 v[56:59], v[176:179], v[20:23], v[56:59]
    ds_read_b64_tr_b16 v[168:169], v221 offset:57344
    v_mul_f32 v248, v248, v120
    v_mul_f32 v249, v249, v121
    v_mfma_f32_16x16x32_bf16 v[64:67], v[176:179], v[24:27], v[64:67]
    ds_read_b64_tr_b16 v[170:171], v221 offset:57856
    v_mul_f32 v250, v250, v122
    v_mul_f32 v251, v251, v123
    buffer_load_dwordx4 v243, s[8:11], s35 offen offset:1024 sc1 lds
    s_waitcnt lgkmcnt(8)
    v_mfma_f32_16x16x32_bf16 v[68:71], v[180:183], v[20:23], v[68:71]
    ds_read_b64_tr_b16 v[172:173], v222 offset:57344
    v_exp_f32 v248, v248
    v_exp_f32 v249, v249
    v_mfma_f32_16x16x32_bf16 v[76:79], v[180:183], v[24:27], v[76:79]
    ds_read_b64_tr_b16 v[174:175], v222 offset:57856
    v_exp_f32 v250, v250
    v_exp_f32 v251, v251
    buffer_load_dwordx4 v243, s[8:11], s35 offen offset:2048 sc1 lds
    v_mfma_f32_16x16x32_bf16 v[72:75], v[184:187], v[20:23], v[72:75]
    ds_read_b64_tr_b16 v[176:177], v223 offset:57344
    v_add_f32 v248, 1.0, v248
    v_add_f32 v249, 1.0, v249
    v_mfma_f32_16x16x32_bf16 v[80:83], v[184:187], v[24:27], v[80:83]
    ds_read_b64_tr_b16 v[178:179], v223 offset:57856
    v_add_f32 v250, 1.0, v250
    v_add_f32 v251, 1.0, v251
    buffer_load_dwordx4 v243, s[8:11], s35 offen offset:3072 sc1 lds
    s_waitcnt lgkmcnt(8)
    v_mfma_f32_16x16x32_bf16 v[84:87], v[188:191], v[20:23], v[84:87]
    ds_read_b64_tr_b16 v[180:181], v232 offset:57344
    v_rcp_f32 v248, v248
    v_rcp_f32 v249, v249
    v_mfma_f32_16x16x32_bf16 v[92:95], v[188:191], v[24:27], v[92:95]
    ds_read_b64_tr_b16 v[182:183], v232 offset:57856
    v_rcp_f32 v250, v250
    v_rcp_f32 v251, v251
    s_add_u32 s49, s34, 16760832
    s_cmp_lt_u32 s38, s33
    s_cselect_b32 s49, s49, 2147483648
    s_add_u32 m0, s36, 16384
    s_add_u32 s36, s36, 65536
    v_mfma_f32_16x16x32_bf16 v[88:91], v[192:195], v[20:23], v[88:91]
    ds_read_b64_tr_b16 v[184:185], v233 offset:57344
    v_mul_f32 v120, v248, v120
    v_mul_f32 v121, v249, v121
    v_mfma_f32_16x16x32_bf16 v[96:99], v[192:195], v[24:27], v[96:99]
    ds_read_b64_tr_b16 v[186:187], v233 offset:57856
    v_mul_f32 v122, v250, v122
    v_mul_f32 v123, v251, v123
    buffer_load_dwordx4 v243, s[8:11], s49 offen offset:0 sc1 lds
    s_waitcnt lgkmcnt(8)
    v_mfma_f32_16x16x32_bf16 v[36:39], v[164:167], v[148:151], v[36:39]
    ds_read_b64_tr_b16 v[188:189], v234 offset:57344
    v_cvt_pk_bf16_f32 v116, v116, v117
    v_cvt_pk_bf16_f32 v117, v118, v119
    v_mfma_f32_16x16x32_bf16 v[44:47], v[164:167], v[152:155], v[44:47]
    ds_read_b64_tr_b16 v[190:191], v234 offset:57856
    v_cvt_pk_bf16_f32 v118, v120, v121
    v_cvt_pk_bf16_f32 v119, v122, v123
    buffer_load_dwordx4 v243, s[8:11], s49 offen offset:1024 sc1 lds
    buffer_load_dwordx4 v243, s[8:11], s49 offen offset:2048 sc1 lds
    v_mfma_f32_16x16x32_bf16 v[40:43], v[168:171], v[148:151], v[40:43]
    ds_read_b64_tr_b16 v[192:193], v235 offset:57344
    v_mul_f32 v248, v124, v124
    v_mul_f32 v249, v125, v125
    v_mfma_f32_16x16x32_bf16 v[48:51], v[168:171], v[152:155], v[48:51]
    ds_read_b64_tr_b16 v[194:195], v235 offset:57856
    v_mul_f32 v250, v126, v126
    v_mul_f32 v251, v127, v127
    buffer_load_dwordx4 v243, s[8:11], s49 offen offset:3072 sc1 lds
    s_waitcnt lgkmcnt(8)
    v_mfma_f32_16x16x32_bf16 v[52:55], v[172:175], v[148:151], v[52:55]
    ds_read_b64_tr_b16 v[164:165], v220 offset:61440
    v_fma_f32 v248, v248, s55, v252
    v_fma_f32 v249, v249, s55, v252
    v_mfma_f32_16x16x32_bf16 v[60:63], v[172:175], v[152:155], v[60:63]
    ds_read_b64_tr_b16 v[166:167], v220 offset:61952
    v_fma_f32 v250, v250, s55, v252
    v_fma_f32 v251, v251, s55, v252
    s_cmp_ge_u32 s36, 163840
    s_cselect_b32 s38, 163840, 0
    s_sub_u32 s36, s36, s38
    s_add_u32 s32, s32, 1
    s_add_u32 s34, s34, 16384
    s_sub_u32 s45, s45, 1
    v_mfma_f32_16x16x32_bf16 v[56:59], v[176:179], v[148:151], v[56:59]
    ds_read_b64_tr_b16 v[168:169], v221 offset:61440
    v_mul_f32 v248, v248, v124
    v_mul_f32 v249, v249, v125
    v_mfma_f32_16x16x32_bf16 v[64:67], v[176:179], v[152:155], v[64:67]
    ds_read_b64_tr_b16 v[170:171], v221 offset:61952
    v_mul_f32 v250, v250, v126
    v_mul_f32 v251, v251, v127
    s_cmp_lt_u32 s32, s33
    s_cselect_b32 s35, s34, 2147483648
    s_mov_b32 m0, s36
    s_sub_u32 s38, s32, 1
    s_waitcnt lgkmcnt(8)
    v_mfma_f32_16x16x32_bf16 v[68:71], v[180:183], v[148:151], v[68:71]
    ds_read_b64_tr_b16 v[172:173], v222 offset:61440
    v_exp_f32 v248, v248
    v_exp_f32 v249, v249
    v_mfma_f32_16x16x32_bf16 v[76:79], v[180:183], v[152:155], v[76:79]
    ds_read_b64_tr_b16 v[174:175], v222 offset:61952
    v_exp_f32 v250, v250
    v_exp_f32 v251, v251
    buffer_load_dwordx4 v243, s[8:11], s35 offen offset:0 sc1 lds
    v_mfma_f32_16x16x32_bf16 v[72:75], v[184:187], v[148:151], v[72:75]
    ds_read_b64_tr_b16 v[176:177], v223 offset:61440
    v_add_f32 v248, 1.0, v248
    v_add_f32 v249, 1.0, v249
    v_mfma_f32_16x16x32_bf16 v[80:83], v[184:187], v[152:155], v[80:83]
    ds_read_b64_tr_b16 v[178:179], v223 offset:61952
    v_add_f32 v250, 1.0, v250
    v_add_f32 v251, 1.0, v251
    buffer_load_dwordx4 v243, s[8:11], s35 offen offset:1024 sc1 lds
    s_waitcnt lgkmcnt(8)
    v_mfma_f32_16x16x32_bf16 v[84:87], v[188:191], v[148:151], v[84:87]
    ds_read_b64_tr_b16 v[180:181], v232 offset:61440
    v_rcp_f32 v248, v248
    v_rcp_f32 v249, v249
    v_mfma_f32_16x16x32_bf16 v[92:95], v[188:191], v[152:155], v[92:95]
    ds_read_b64_tr_b16 v[182:183], v232 offset:61952
    v_rcp_f32 v250, v250
    v_rcp_f32 v251, v251
    buffer_load_dwordx4 v243, s[8:11], s35 offen offset:2048 sc1 lds
    v_mfma_f32_16x16x32_bf16 v[88:91], v[192:195], v[148:151], v[88:91]
    ds_read_b64_tr_b16 v[184:185], v233 offset:61440
    v_mul_f32 v124, v248, v124
    v_mul_f32 v125, v249, v125
    v_mfma_f32_16x16x32_bf16 v[96:99], v[192:195], v[152:155], v[96:99]
    ds_read_b64_tr_b16 v[186:187], v233 offset:61952
    v_mul_f32 v126, v250, v126
    v_mul_f32 v127, v251, v127
    buffer_load_dwordx4 v243, s[8:11], s35 offen offset:3072 sc1 lds
    s_waitcnt lgkmcnt(8)
    v_mfma_f32_16x16x32_bf16 v[36:39], v[164:167], v[28:31], v[36:39]
    ds_read_b64_tr_b16 v[188:189], v234 offset:61440
    v_mul_f32 v248, v128, v128
    v_mul_f32 v249, v129, v129
    v_mfma_f32_16x16x32_bf16 v[44:47], v[164:167], v[32:35], v[44:47]
    ds_read_b64_tr_b16 v[190:191], v234 offset:61952
    v_mul_f32 v250, v130, v130
    v_mul_f32 v251, v131, v131
    s_add_u32 s49, s34, 16760832
    s_cmp_lt_u32 s38, s33
    s_cselect_b32 s49, s49, 2147483648
    s_add_u32 m0, s36, 16384
    s_add_u32 s36, s36, 65536
    v_mfma_f32_16x16x32_bf16 v[40:43], v[168:171], v[28:31], v[40:43]
    ds_read_b64_tr_b16 v[192:193], v235 offset:61440
    v_fma_f32 v248, v248, s55, v252
    v_fma_f32 v249, v249, s55, v252
    v_mfma_f32_16x16x32_bf16 v[48:51], v[168:171], v[32:35], v[48:51]
    ds_read_b64_tr_b16 v[194:195], v235 offset:61952
    v_fma_f32 v250, v250, s55, v252
    v_fma_f32 v251, v251, s55, v252
    buffer_load_dwordx4 v243, s[8:11], s49 offen offset:0 sc1 lds
    s_waitcnt lgkmcnt(8)
    v_mfma_f32_16x16x32_bf16 v[52:55], v[172:175], v[28:31], v[52:55]
    v_mul_f32 v248, v248, v128
    v_mul_f32 v249, v249, v129
    v_mfma_f32_16x16x32_bf16 v[60:63], v[172:175], v[32:35], v[60:63]
    v_mul_f32 v250, v250, v130
    v_mul_f32 v251, v251, v131
    buffer_load_dwordx4 v243, s[8:11], s49 offen offset:1024 sc1 lds
    v_mfma_f32_16x16x32_bf16 v[56:59], v[176:179], v[28:31], v[56:59]
    v_exp_f32 v248, v248
    v_exp_f32 v249, v249
    v_mfma_f32_16x16x32_bf16 v[64:67], v[176:179], v[32:35], v[64:67]
    v_exp_f32 v250, v250
    v_exp_f32 v251, v251
    buffer_load_dwordx4 v243, s[8:11], s49 offen offset:2048 sc1 lds
    s_waitcnt lgkmcnt(4)
    v_mfma_f32_16x16x32_bf16 v[68:71], v[180:183], v[28:31], v[68:71]
    v_add_f32 v248, 1.0, v248
    v_add_f32 v249, 1.0, v249
    v_mfma_f32_16x16x32_bf16 v[76:79], v[180:183], v[32:35], v[76:79]
    v_add_f32 v250, 1.0, v250
    v_add_f32 v251, 1.0, v251
    buffer_load_dwordx4 v243, s[8:11], s49 offen offset:3072 sc1 lds
    v_mfma_f32_16x16x32_bf16 v[72:75], v[184:187], v[28:31], v[72:75]
    v_rcp_f32 v248, v248
    v_rcp_f32 v249, v249
    v_mfma_f32_16x16x32_bf16 v[80:83], v[184:187], v[32:35], v[80:83]
    v_rcp_f32 v250, v250
    v_rcp_f32 v251, v251
    s_cmp_ge_u32 s36, 163840
    s_cselect_b32 s38, 163840, 0
    s_sub_u32 s36, s36, s38
    s_add_u32 s32, s32, 1
    s_add_u32 s34, s34, 16384
    s_sub_u32 s45, s45, 1
    s_waitcnt lgkmcnt(0)
    v_mfma_f32_16x16x32_bf16 v[84:87], v[188:191], v[28:31], v[84:87]
    v_mul_f32 v128, v248, v128
    v_mul_f32 v129, v249, v129
    v_mfma_f32_16x16x32_bf16 v[92:95], v[188:191], v[32:35], v[92:95]
    v_mul_f32 v130, v250, v130
    v_mul_f32 v131, v251, v131
    v_mfma_f32_16x16x32_bf16 v[88:91], v[192:195], v[28:31], v[88:91]
    v_cvt_pk_bf16_f32 v124, v124, v125
    v_cvt_pk_bf16_f32 v125, v126, v127
    v_mfma_f32_16x16x32_bf16 v[96:99], v[192:195], v[32:35], v[96:99]
    v_cvt_pk_bf16_f32 v126, v128, v129
    v_cvt_pk_bf16_f32 v127, v130, v131
    s_add_u32 s24, s4, 75497472
    s_addc_u32 s25, s5, 0
    s_mov_b32 s26, 3670016
    s_mov_b32 s27, 0x20000
    v_mov_b32 v132, 0
    v_mov_b32 v133, 0
    v_mov_b32 v134, 0
    v_mov_b32 v135, 0
    v_mov_b32 v136, 0
    v_mov_b32 v137, 0
    v_mov_b32 v138, 0
    v_mov_b32 v139, 0
    v_mov_b32 v140, 0
    v_mov_b32 v141, 0
    v_mov_b32 v142, 0
    v_mov_b32 v143, 0
    v_mov_b32 v144, 0
    v_mov_b32 v145, 0
    v_mov_b32 v146, 0
    v_mov_b32 v147, 0
    v_mov_b32 v156, 0
    v_mov_b32 v157, 0
    v_mov_b32 v158, 0
    v_mov_b32 v159, 0
    v_mov_b32 v160, 0
    v_mov_b32 v161, 0
    v_mov_b32 v162, 0
    v_mov_b32 v163, 0
    v_mov_b32 v228, 0
    v_mov_b32 v229, 0
    v_mov_b32 v230, 0
    v_mov_b32 v231, 0
    v_mov_b32 v232, 0
    v_mov_b32 v233, 0
    v_mov_b32 v234, 0
    v_mov_b32 v235, 0
    v_mov_b32 v236, 0x3f803f80
    v_mov_b32 v237, 0x3f803f80
    v_mov_b32 v238, 0x3f803f80
    v_mov_b32 v239, 0x3f803f80
    buffer_store_dwordx4 v[100:103], v3, s[20:23], s44 offen offset:0 sc1
    v_mul_f32 v36, 0x3e0293ee, v36
    v_mul_f32 v37, 0x3e0293ee, v37
    v_mul_f32 v38, 0x3e0293ee, v38
    v_mul_f32 v39, 0x3e0293ee, v39
    v_mul_f32 v40, 0x3e0293ee, v40
    v_mul_f32 v41, 0x3e0293ee, v41
    v_mul_f32 v42, 0x3e0293ee, v42
    v_mul_f32 v43, 0x3e0293ee, v43
    v_cvt_pk_bf16_f32 v4, v36, v37
    v_cvt_pk_bf16_f32 v5, v38, v39
    v_cvt_pk_bf16_f32 v6, v40, v41
    v_cvt_pk_bf16_f32 v7, v42, v43
    v_mov_b32 v36, 0
    v_mov_b32 v37, 0
    v_mov_b32 v38, 0
    v_mov_b32 v39, 0
    v_mov_b32 v40, 0
    v_mov_b32 v41, 0
    v_mov_b32 v42, 0
    v_mov_b32 v43, 0
    buffer_store_dwordx4 v[108:111], v3, s[20:23], s44 offen offset:256 sc1
    v_mul_f32 v44, 0x3e0293ee, v44
    v_mul_f32 v45, 0x3e0293ee, v45
    v_mul_f32 v46, 0x3e0293ee, v46
    v_mul_f32 v47, 0x3e0293ee, v47
    v_mul_f32 v48, 0x3e0293ee, v48
    v_mul_f32 v49, 0x3e0293ee, v49
    v_mul_f32 v50, 0x3e0293ee, v50
    v_mul_f32 v51, 0x3e0293ee, v51
    v_cvt_pk_bf16_f32 v8, v44, v45
    v_cvt_pk_bf16_f32 v9, v46, v47
    v_cvt_pk_bf16_f32 v10, v48, v49
    v_cvt_pk_bf16_f32 v11, v50, v51
    v_mov_b32 v44, 0
    v_mov_b32 v45, 0
    v_mov_b32 v46, 0
    v_mov_b32 v47, 0
    v_mov_b32 v48, 0
    v_mov_b32 v49, 0
    v_mov_b32 v50, 0
    v_mov_b32 v51, 0
    buffer_store_dwordx4 v[116:119], v3, s[20:23], s44 offen offset:2048 sc1
    v_mul_f32 v52, 0x3e0293ee, v52
    v_mul_f32 v53, 0x3e0293ee, v53
    v_mul_f32 v54, 0x3e0293ee, v54
    v_mul_f32 v55, 0x3e0293ee, v55
    v_mul_f32 v56, 0x3e0293ee, v56
    v_mul_f32 v57, 0x3e0293ee, v57
    v_mul_f32 v58, 0x3e0293ee, v58
    v_mul_f32 v59, 0x3e0293ee, v59
    v_cvt_pk_bf16_f32 v12, v52, v53
    v_cvt_pk_bf16_f32 v13, v54, v55
    v_cvt_pk_bf16_f32 v14, v56, v57
    v_cvt_pk_bf16_f32 v15, v58, v59
    v_mov_b32 v52, 0
    v_mov_b32 v53, 0
    v_mov_b32 v54, 0
    v_mov_b32 v55, 0
    v_mov_b32 v56, 0
    v_mov_b32 v57, 0
    v_mov_b32 v58, 0
    v_mov_b32 v59, 0
    buffer_store_dwordx4 v[124:127], v3, s[20:23], s44 offen offset:2304 sc1
    v_mul_f32 v60, 0x3e0293ee, v60
    v_mul_f32 v61, 0x3e0293ee, v61
    v_mul_f32 v62, 0x3e0293ee, v62
    v_mul_f32 v63, 0x3e0293ee, v63
    v_mul_f32 v64, 0x3e0293ee, v64
    v_mul_f32 v65, 0x3e0293ee, v65
    v_mul_f32 v66, 0x3e0293ee, v66
    v_mul_f32 v67, 0x3e0293ee, v67
    v_cvt_pk_bf16_f32 v16, v60, v61
    v_cvt_pk_bf16_f32 v17, v62, v63
    v_cvt_pk_bf16_f32 v18, v64, v65
    v_cvt_pk_bf16_f32 v19, v66, v67
    v_mov_b32 v60, 0
    v_mov_b32 v61, 0
    v_mov_b32 v62, 0
    v_mov_b32 v63, 0
    v_mov_b32 v64, 0
    v_mov_b32 v65, 0
    v_mov_b32 v66, 0
    v_mov_b32 v67, 0
    v_mul_f32 v68, 0x3e0293ee, v68
    v_mul_f32 v69, 0x3e0293ee, v69
    v_mul_f32 v70, 0x3e0293ee, v70
    v_mul_f32 v71, 0x3e0293ee, v71
    v_mul_f32 v72, 0x3e0293ee, v72
    v_mul_f32 v73, 0x3e0293ee, v73
    v_mul_f32 v74, 0x3e0293ee, v74
    v_mul_f32 v75, 0x3e0293ee, v75
    v_cvt_pk_bf16_f32 v20, v68, v69
    v_cvt_pk_bf16_f32 v21, v70, v71
    v_cvt_pk_bf16_f32 v22, v72, v73
    v_cvt_pk_bf16_f32 v23, v74, v75
    v_mov_b32 v68, 0
    v_mov_b32 v69, 0
    v_mov_b32 v70, 0
    v_mov_b32 v71, 0
    v_mov_b32 v72, 0
    v_mov_b32 v73, 0
    v_mov_b32 v74, 0
    v_mov_b32 v75, 0
    v_mul_f32 v76, 0x3e0293ee, v76
    v_mul_f32 v77, 0x3e0293ee, v77
    v_mul_f32 v78, 0x3e0293ee, v78
    v_mul_f32 v79, 0x3e0293ee, v79
    v_mul_f32 v80, 0x3e0293ee, v80
    v_mul_f32 v81, 0x3e0293ee, v81
    v_mul_f32 v82, 0x3e0293ee, v82
    v_mul_f32 v83, 0x3e0293ee, v83
    v_cvt_pk_bf16_f32 v24, v76, v77
    v_cvt_pk_bf16_f32 v25, v78, v79
    v_cvt_pk_bf16_f32 v26, v80, v81
    v_cvt_pk_bf16_f32 v27, v82, v83
    v_mov_b32 v76, 0
    v_mov_b32 v77, 0
    v_mov_b32 v78, 0
    v_mov_b32 v79, 0
    v_mov_b32 v80, 0
    v_mov_b32 v81, 0
    v_mov_b32 v82, 0
    v_mov_b32 v83, 0
    v_mul_f32 v84, 0x3e0293ee, v84
    v_mul_f32 v85, 0x3e0293ee, v85
    v_mul_f32 v86, 0x3e0293ee, v86
    v_mul_f32 v87, 0x3e0293ee, v87
    v_mul_f32 v88, 0x3e0293ee, v88
    v_mul_f32 v89, 0x3e0293ee, v89
    v_mul_f32 v90, 0x3e0293ee, v90
    v_mul_f32 v91, 0x3e0293ee, v91
    v_cvt_pk_bf16_f32 v28, v84, v85
    v_cvt_pk_bf16_f32 v29, v86, v87
    v_cvt_pk_bf16_f32 v30, v88, v89
    v_cvt_pk_bf16_f32 v31, v90, v91
    v_mov_b32 v84, 0
    v_mov_b32 v85, 0
    v_mov_b32 v86, 0
    v_mov_b32 v87, 0
    v_mov_b32 v88, 0
    v_mov_b32 v89, 0
    v_mov_b32 v90, 0
    v_mov_b32 v91, 0
    v_mul_f32 v92, 0x3e0293ee, v92
    v_mul_f32 v93, 0x3e0293ee, v93
    v_mul_f32 v94, 0x3e0293ee, v94
    v_mul_f32 v95, 0x3e0293ee, v95
    v_mul_f32 v96, 0x3e0293ee, v96
    v_mul_f32 v97, 0x3e0293ee, v97
    v_mul_f32 v98, 0x3e0293ee, v98
    v_mul_f32 v99, 0x3e0293ee, v99
    v_cvt_pk_bf16_f32 v32, v92, v93
    v_cvt_pk_bf16_f32 v33, v94, v95
    v_cvt_pk_bf16_f32 v34, v96, v97
    v_cvt_pk_bf16_f32 v35, v98, v99
    v_mov_b32 v92, 0
    v_mov_b32 v93, 0
    v_mov_b32 v94, 0
    v_mov_b32 v95, 0
    v_mov_b32 v96, 0
    v_mov_b32 v97, 0
    v_mov_b32 v98, 0
    v_mov_b32 v99, 0
    v_mov_b32 v3, 0
    s_mov_b32 s6, 1
    s_waitcnt lgkmcnt(0)
    s_cmp_eq_u32 s31, 0
    s_cbranch_scc1 L_k2mask_24
L_k2mret_25:
    s_waitcnt vmcnt(4)
    s_barrier
L_k2nb_26:
    ds_read_b128 v[164:167], v241 offset:0
    ds_read_b128 v[168:171], v241 offset:1024
    ds_read_b128 v[172:175], v241 offset:2048
    ds_read_b128 v[176:179], v241 offset:3072
    ds_read_b128 v[180:183], v241 offset:4096
    ds_read_b128 v[184:187], v241 offset:5120
    ds_read_b128 v[188:191], v241 offset:6144
    ds_read_b128 v[192:195], v241 offset:7168
    s_waitcnt lgkmcnt(6)
    v_mfma_f32_16x16x32_bf16 v[100:103], v[164:167], v[4:7], v[132:135]
    s_cmp_lt_u32 s32, s33
    s_cselect_b32 s35, s34, 2147483648
    s_mov_b32 m0, s36
    s_sub_u32 s38, s32, 1
    buffer_load_dwordx4 v243, s[8:11], s35 offen offset:0 sc1 lds
    v_mfma_f32_16x16x32_bf16 v[108:111], v[164:167], v[8:11], v[140:143]
    ds_read_b128 v[164:167], v241 offset:8192
    v_mfma_f32_16x16x32_bf16 v[104:107], v[168:171], v[4:7], v[136:139]
    s_add_u32 s51, s51, 1
    buffer_load_dwordx4 v243, s[8:11], s35 offen offset:1024 sc1 lds
    v_mfma_f32_16x16x32_bf16 v[112:115], v[168:171], v[8:11], v[144:147]
    ds_read_b128 v[168:171], v241 offset:9216
    s_waitcnt lgkmcnt(6)
    v_mfma_f32_16x16x32_bf16 v[100:103], v[172:175], v[12:15], v[100:103]
    buffer_load_dwordx4 v243, s[8:11], s35 offen offset:2048 sc1 lds
    buffer_load_dwordx4 v243, s[8:11], s35 offen offset:3072 sc1 lds
    v_mfma_f32_16x16x32_bf16 v[108:111], v[172:175], v[16:19], v[108:111]
    ds_read_b128 v[172:175], v241 offset:10240
    v_mfma_f32_16x16x32_bf16 v[104:107], v[176:179], v[12:15], v[104:107]
    s_add_u32 s49, s34, 16760832
    s_cmp_lt_u32 s38, s33
    s_cselect_b32 s49, s49, 2147483648
    s_add_u32 m0, s36, 16384
    s_add_u32 s36, s36, 65536
    v_mfma_f32_16x16x32_bf16 v[112:115], v[176:179], v[16:19], v[112:115]
    ds_read_b128 v[176:179], v241 offset:11264
    s_waitcnt lgkmcnt(6)
    v_mfma_f32_16x16x32_bf16 v[100:103], v[180:183], v[20:23], v[100:103]
    buffer_load_dwordx4 v243, s[8:11], s49 offen offset:0 sc1 lds
    v_mfma_f32_16x16x32_bf16 v[108:111], v[180:183], v[24:27], v[108:111]
    ds_read_b128 v[180:183], v241 offset:12288
    v_mfma_f32_16x16x32_bf16 v[104:107], v[184:187], v[20:23], v[104:107]
    buffer_load_dwordx4 v243, s[8:11], s49 offen offset:1024 sc1 lds
    buffer_load_dwordx4 v243, s[8:11], s49 offen offset:2048 sc1 lds
    v_mfma_f32_16x16x32_bf16 v[112:115], v[184:187], v[24:27], v[112:115]
    ds_read_b128 v[184:187], v241 offset:13312
    s_waitcnt lgkmcnt(6)
    v_mfma_f32_16x16x32_bf16 v[100:103], v[188:191], v[28:31], v[100:103]
    buffer_load_dwordx4 v243, s[8:11], s49 offen offset:3072 sc1 lds
    v_mfma_f32_16x16x32_bf16 v[108:111], v[188:191], v[32:35], v[108:111]
    ds_read_b128 v[188:191], v241 offset:14336
    v_mfma_f32_16x16x32_bf16 v[104:107], v[192:195], v[28:31], v[104:107]
    s_cmp_ge_u32 s36, 163840
    s_cselect_b32 s38, 163840, 0
    s_sub_u32 s36, s36, s38
    s_add_u32 s32, s32, 1
    s_add_u32 s34, s34, 16384
    s_sub_u32 s45, s45, 1
    v_mfma_f32_16x16x32_bf16 v[112:115], v[192:195], v[32:35], v[112:115]
    ds_read_b128 v[192:195], v241 offset:15360
    ds_read_b128 v[196:199], v241 offset:24576
    ds_read_b128 v[200:203], v241 offset:25600
    s_add_u32 s16, s4, 50331648
    s_addc_u32 s17, s5, 0
    s_mov_b32 s18, 16777216
    s_mov_b32 s19, 0x20000
    s_nop 7
    v_max3_f32 v248, v100, v101, v102
    v_max3_f32 v248, v248, v103, v104
    v_max3_f32 v248, v248, v105, v106
    v_max_f32 v248, v248, v107
    v_max3_f32 v249, v108, v109, v110
    v_max3_f32 v249, v249, v111, v112
    v_max3_f32 v249, v249, v113, v114
    v_max_f32 v249, v249, v115
    v_mov_b32 v250, v248
    v_mov_b32 v251, v249
    s_nop 1
    v_permlane16_swap_b32 v248, v250
    v_permlane16_swap_b32 v249, v251
    s_nop 1
    v_max_f32 v248, v248, v250
    v_max_f32 v249, v249, v251
    v_mov_b32 v250, v248
    v_mov_b32 v251, v249
    s_nop 1
    v_permlane32_swap_b32 v248, v250
    v_permlane32_swap_b32 v249, v251
    s_nop 1
    v_max_f32 v248, v248, v250
    v_max_f32 v249, v249, v251
    v_sub_f32 v132, v132, v248
    v_sub_f32 v133, v133, v248
    v_sub_f32 v134, v134, v248
    v_sub_f32 v135, v135, v248
    v_sub_f32 v136, v136, v248
    v_sub_f32 v137, v137, v248
    v_sub_f32 v138, v138, v248
    v_sub_f32 v139, v139, v248
    v_sub_f32 v140, v140, v249
    v_sub_f32 v141, v141, v249
    v_sub_f32 v142, v142, v249
    v_sub_f32 v143, v143, v249
    v_sub_f32 v144, v144, v249
    v_sub_f32 v145, v145, v249
    v_sub_f32 v146, v146, v249
    v_sub_f32 v147, v147, v249
    v_sub_f32 v100, v100, v248
    v_sub_f32 v101, v101, v248
    v_sub_f32 v102, v102, v248
    v_sub_f32 v103, v103, v248
    v_sub_f32 v104, v104, v248
    v_sub_f32 v105, v105, v248
    v_sub_f32 v106, v106, v248
    v_sub_f32 v107, v107, v248
    v_sub_f32 v108, v108, v249
    v_sub_f32 v109, v109, v249
    v_sub_f32 v110, v110, v249
    v_sub_f32 v111, v111, v249
    v_sub_f32 v112, v112, v249
    v_sub_f32 v113, v113, v249
    v_sub_f32 v114, v114, v249
    v_sub_f32 v115, v115, v249
    s_cmp_lt_u32 s31, 3
    s_cbranch_scc1 L_k2_B_odd
L_k2_B_loop:
    s_waitcnt lgkmcnt(6)
    v_mfma_f32_16x16x32_bf16 v[116:119], v[164:167], v[4:7], v[132:135]
    v_exp_f32 v100, v100
    v_mfma_f32_16x16x32_bf16 v[124:127], v[164:167], v[8:11], v[140:143]
    ds_read_b128 v[204:207], v241 offset:26624
    v_mfma_f32_16x16x32_bf16 v[120:123], v[168:171], v[4:7], v[136:139]
    v_exp_f32 v101, v101
    v_mfma_f32_16x16x32_bf16 v[128:131], v[168:171], v[8:11], v[144:147]
    ds_read_b128 v[208:211], v241 offset:27648
    v_mfma_f32_16x16x32_bf16 v[116:119], v[172:175], v[12:15], v[116:119]
    v_exp_f32 v102, v102
    v_mfma_f32_16x16x32_bf16 v[124:127], v[172:175], v[16:19], v[124:127]
    ds_read_b128 v[212:215], v241 offset:28672
    v_cvt_pk_bf16_f32 v148, v100, v101
    v_mfma_f32_16x16x32_bf16 v[120:123], v[176:179], v[12:15], v[120:123]
    v_exp_f32 v103, v103
    v_mfma_f32_16x16x32_bf16 v[128:131], v[176:179], v[16:19], v[128:131]
    ds_read_b128 v[216:219], v241 offset:29696
    s_waitcnt lgkmcnt(6)
    v_mfma_f32_16x16x32_bf16 v[116:119], v[180:183], v[20:23], v[116:119]
    v_exp_f32 v104, v104
    v_mfma_f32_16x16x32_bf16 v[124:127], v[180:183], v[24:27], v[124:127]
    ds_read_b128 v[220:223], v241 offset:30720
    v_cvt_pk_bf16_f32 v149, v102, v103
    v_mfma_f32_16x16x32_bf16 v[120:123], v[184:187], v[20:23], v[120:123]
    v_exp_f32 v105, v105
    v_mfma_f32_16x16x32_bf16 v[128:131], v[184:187], v[24:27], v[128:131]
    ds_read_b128 v[224:227], v241 offset:31744
    s_add_u32 s3, s3, 65536
    s_sub_u32 s7, s3, 163840
    v_mfma_f32_16x16x32_bf16 v[116:119], v[188:191], v[28:31], v[116:119]
    v_exp_f32 v106, v106
    v_mfma_f32_16x16x32_bf16 v[124:127], v[188:191], v[32:35], v[124:127]
    ds_read_b128 v[164:167], v242 offset:0
    v_cvt_pk_bf16_f32 v150, v104, v105
    v_mfma_f32_16x16x32_bf16 v[120:123], v[192:195], v[28:31], v[120:123]
    v_exp_f32 v107, v107
    v_mfma_f32_16x16x32_bf16 v[128:131], v[192:195], v[32:35], v[128:131]
    ds_read_b128 v[168:171], v242 offset:1024
    s_min_u32 s3, s3, s7
    s_waitcnt lgkmcnt(6)
    v_mfma_f32_16x16x32_bf16 v[36:39], v[196:199], v[156:159], v[36:39]
    v_exp_f32 v108, v108
    v_mfma_f32_16x16x32_bf16 v[44:47], v[196:199], v[160:163], v[44:47]
    ds_read_b128 v[172:175], v242 offset:2048
    v_cvt_pk_bf16_f32 v151, v106, v107
    v_mfma_f32_16x16x32_bf16 v[40:43], v[200:203], v[156:159], v[40:43]
    v_exp_f32 v109, v109
    v_mfma_f32_16x16x32_bf16 v[48:51], v[200:203], v[160:163], v[48:51]
    ds_read_b128 v[176:179], v242 offset:3072
    v_mfma_f32_16x16x32_bf16 v[52:55], v[204:207], v[156:159], v[52:55]
    v_exp_f32 v110, v110
    v_mfma_f32_16x16x32_bf16 v[60:63], v[204:207], v[160:163], v[60:63]
    ds_read_b128 v[180:183], v242 offset:4096
    v_cvt_pk_bf16_f32 v152, v108, v109
    v_mfma_f32_16x16x32_bf16 v[56:59], v[208:211], v[156:159], v[56:59]
    v_exp_f32 v111, v111
    v_mfma_f32_16x16x32_bf16 v[64:67], v[208:211], v[160:163], v[64:67]
    ds_read_b128 v[184:187], v242 offset:5120
    v_mfma_f32_16x16x32_bf16 v[228:231], v[236:239], v[156:159], v[228:231]
    v_exp_f32 v112, v112
    v_mfma_f32_16x16x32_bf16 v[232:235], v[236:239], v[160:163], v[232:235]
    v_cvt_pk_bf16_f32 v153, v110, v111
    s_waitcnt lgkmcnt(6)
    v_mfma_f32_16x16x32_bf16 v[68:71], v[212:215], v[156:159], v[68:71]
    v_exp_f32 v113, v113
    v_mfma_f32_16x16x32_bf16 v[76:79], v[212:215], v[160:163], v[76:79]
    ds_read_b128 v[188:191], v242 offset:6144
    v_mfma_f32_16x16x32_bf16 v[72:75], v[216:219], v[156:159], v[72:75]
    v_exp_f32 v114, v114
    v_mfma_f32_16x16x32_bf16 v[80:83], v[216:219], v[160:163], v[80:83]
    ds_read_b128 v[192:195], v242 offset:7168
    v_cvt_pk_bf16_f32 v154, v112, v113
    v_mfma_f32_16x16x32_bf16 v[84:87], v[220:223], v[156:159], v[84:87]
    v_exp_f32 v115, v115
    v_mfma_f32_16x16x32_bf16 v[92:95], v[220:223], v[160:163], v[92:95]
    ds_read_b128 v[196:199], v242 offset:16384
    v_mfma_f32_16x16x32_bf16 v[88:91], v[224:227], v[156:159], v[88:91]
    v_cvt_pk_bf16_f32 v155, v114, v115
    v_mfma_f32_16x16x32_bf16 v[96:99], v[224:227], v[160:163], v[96:99]
    ds_read_b128 v[200:203], v242 offset:17408
    v_mov_b32 v241, v242
    v_add_u32 v242, s3, v243
    s_bitcmp1_b32 s51, 0
    s_cbranch_scc1 L_k2nb_27
    s_waitcnt vmcnt(0)
    s_barrier
    s_cmp_eq_u32 s6, 1
    s_cbranch_scc1 L_k2zs_28
L_k2zr_29:
L_k2nb_27:
    s_waitcnt lgkmcnt(6)
    v_mfma_f32_16x16x32_bf16 v[100:103], v[164:167], v[4:7], v[132:135]
    v_exp_f32 v116, v116
    v_mfma_f32_16x16x32_bf16 v[108:111], v[164:167], v[8:11], v[140:143]
    ds_read_b128 v[204:207], v241 offset:18432
    s_cmp_lt_u32 s32, s33
    s_cselect_b32 s35, s34, 2147483648
    s_mov_b32 m0, s36
    s_sub_u32 s38, s32, 1
    v_mfma_f32_16x16x32_bf16 v[104:107], v[168:171], v[4:7], v[136:139]
    v_exp_f32 v117, v117
    v_mfma_f32_16x16x32_bf16 v[112:115], v[168:171], v[8:11], v[144:147]
    ds_read_b128 v[208:211], v241 offset:19456
    s_add_u32 s51, s51, 1
    buffer_load_dwordx4 v243, s[8:11], s35 offen offset:0 sc1 lds
    v_mfma_f32_16x16x32_bf16 v[100:103], v[172:175], v[12:15], v[100:103]
    v_exp_f32 v118, v118
    v_mfma_f32_16x16x32_bf16 v[108:111], v[172:175], v[16:19], v[108:111]
    ds_read_b128 v[212:215], v241 offset:20480
    v_cvt_pk_bf16_f32 v156, v116, v117
    buffer_load_dwordx4 v243, s[8:11], s35 offen offset:1024 sc1 lds
    v_mfma_f32_16x16x32_bf16 v[104:107], v[176:179], v[12:15], v[104:107]
    v_exp_f32 v119, v119
    v_mfma_f32_16x16x32_bf16 v[112:115], v[176:179], v[16:19], v[112:115]
    ds_read_b128 v[216:219], v241 offset:21504
    s_waitcnt lgkmcnt(6)
    v_mfma_f32_16x16x32_bf16 v[100:103], v[180:183], v[20:23], v[100:103]
    v_exp_f32 v120, v120
    v_mfma_f32_16x16x32_bf16 v[108:111], v[180:183], v[24:27], v[108:111]
    ds_read_b128 v[220:223], v241 offset:22528
    v_cvt_pk_bf16_f32 v157, v118, v119
    buffer_load_dwordx4 v243, s[8:11], s35 offen offset:2048 sc1 lds
    v_mfma_f32_16x16x32_bf16 v[104:107], v[184:187], v[20:23], v[104:107]
    v_exp_f32 v121, v121
    v_mfma_f32_16x16x32_bf16 v[112:115], v[184:187], v[24:27], v[112:115]
    ds_read_b128 v[224:227], v241 offset:23552
    buffer_load_dwordx4 v243, s[8:11], s35 offen offset:3072 sc1 lds
    v_mfma_f32_16x16x32_bf16 v[100:103], v[188:191], v[28:31], v[100:103]
    v_exp_f32 v122, v122
    v_mfma_f32_16x16x32_bf16 v[108:111], v[188:191], v[32:35], v[108:111]
    ds_read_b128 v[164:167], v241 offset:8192
    v_cvt_pk_bf16_f32 v158, v120, v121
    v_mfma_f32_16x16x32_bf16 v[104:107], v[192:195], v[28:31], v[104:107]
    v_exp_f32 v123, v123
    v_mfma_f32_16x16x32_bf16 v[112:115], v[192:195], v[32:35], v[112:115]
    ds_read_b128 v[168:171], v241 offset:9216
    s_add_u32 s49, s34, 16760832
    s_cmp_lt_u32 s38, s33
    s_cselect_b32 s49, s49, 2147483648
    s_add_u32 m0, s36, 16384
    s_add_u32 s36, s36, 65536
    s_waitcnt lgkmcnt(6)
    v_mfma_f32_16x16x32_bf16 v[36:39], v[196:199], v[148:151], v[36:39]
    v_exp_f32 v124, v124
    v_mfma_f32_16x16x32_bf16 v[44:47], v[196:199], v[152:155], v[44:47]
    ds_read_b128 v[172:175], v241 offset:10240
    v_cvt_pk_bf16_f32 v159, v122, v123
    buffer_load_dwordx4 v243, s[8:11], s49 offen offset:0 sc1 lds
    v_mfma_f32_16x16x32_bf16 v[40:43], v[200:203], v[148:151], v[40:43]
    v_exp_f32 v125, v125
    v_mfma_f32_16x16x32_bf16 v[48:51], v[200:203], v[152:155], v[48:51]
    ds_read_b128 v[176:179], v241 offset:11264
    v_mfma_f32_16x16x32_bf16 v[52:55], v[204:207], v[148:151], v[52:55]
    v_exp_f32 v126, v126
    v_mfma_f32_16x16x32_bf16 v[60:63], v[204:207], v[152:155], v[60:63]
    ds_read_b128 v[180:183], v241 offset:12288
    v_cvt_pk_bf16_f32 v160, v124, v125
    buffer_load_dwordx4 v243, s[8:11], s49 offen offset:1024 sc1 lds
    v_mfma_f32_16x16x32_bf16 v[56:59], v[208:211], v[148:151], v[56:59]
    v_exp_f32 v127, v127
    v_mfma_f32_16x16x32_bf16 v[64:67], v[208:211], v[152:155], v[64:67]
    ds_read_b128 v[184:187], v241 offset:13312
    buffer_load_dwordx4 v243, s[8:11], s49 offen offset:2048 sc1 lds
    v_mfma_f32_16x16x32_bf16 v[228:231], v[236:239], v[148:151], v[228:231]
    v_exp_f32 v128, v128
    v_mfma_f32_16x16x32_bf16 v[232:235], v[236:239], v[152:155], v[232:235]
    v_cvt_pk_bf16_f32 v161, v126, v127
    s_waitcnt lgkmcnt(6)
    v_mfma_f32_16x16x32_bf16 v[68:71], v[212:215], v[148:151], v[68:71]
    v_exp_f32 v129, v129
    v_mfma_f32_16x16x32_bf16 v[76:79], v[212:215], v[152:155], v[76:79]
    ds_read_b128 v[188:191], v241 offset:14336
    buffer_load_dwordx4 v243, s[8:11], s49 offen offset:3072 sc1 lds
    v_mfma_f32_16x16x32_bf16 v[72:75], v[216:219], v[148:151], v[72:75]
    v_exp_f32 v130, v130
    v_mfma_f32_16x16x32_bf16 v[80:83], v[216:219], v[152:155], v[80:83]
    ds_read_b128 v[192:195], v241 offset:15360
    v_cvt_pk_bf16_f32 v162, v128, v129
    s_cmp_ge_u32 s36, 163840
    s_cselect_b32 s38, 163840, 0
    s_sub_u32 s36, s36, s38
    s_add_u32 s32, s32, 1
    s_add_u32 s34, s34, 16384
    s_sub_u32 s45, s45, 1
    v_mfma_f32_16x16x32_bf16 v[84:87], v[220:223], v[148:151], v[84:87]
    v_exp_f32 v131, v131
    v_mfma_f32_16x16x32_bf16 v[92:95], v[220:223], v[152:155], v[92:95]
    ds_read_b128 v[196:199], v241 offset:24576
    v_mfma_f32_16x16x32_bf16 v[88:91], v[224:227], v[148:151], v[88:91]
    v_cvt_pk_bf16_f32 v163, v130, v131
    v_mfma_f32_16x16x32_bf16 v[96:99], v[224:227], v[152:155], v[96:99]
    ds_read_b128 v[200:203], v241 offset:25600
    s_sub_u32 s31, s31, 2
    s_cmp_ge_u32 s31, 3
    s_cbranch_scc1 L_k2_B_loop
L_k2_B_odd:
    s_cmp_eq_u32 s31, 0
    s_cbranch_scc1 L_k2_B_drain_odd
    s_cmp_eq_u32 s31, 1
    s_cbranch_scc1 L_k2mask_30
L_k2mret_31:
    s_waitcnt lgkmcnt(6)
    v_mfma_f32_16x16x32_bf16 v[116:119], v[164:167], v[4:7], v[132:135]
    v_exp_f32 v100, v100
    v_mfma_f32_16x16x32_bf16 v[124:127], v[164:167], v[8:11], v[140:143]
    ds_read_b128 v[204:207], v241 offset:26624
    v_mfma_f32_16x16x32_bf16 v[120:123], v[168:171], v[4:7], v[136:139]
    v_exp_f32 v101, v101
    v_mfma_f32_16x16x32_bf16 v[128:131], v[168:171], v[8:11], v[144:147]
    ds_read_b128 v[208:211], v241 offset:27648
    v_mfma_f32_16x16x32_bf16 v[116:119], v[172:175], v[12:15], v[116:119]
    v_exp_f32 v102, v102
    v_mfma_f32_16x16x32_bf16 v[124:127], v[172:175], v[16:19], v[124:127]
    ds_read_b128 v[212:215], v241 offset:28672
    v_cvt_pk_bf16_f32 v148, v100, v101
    v_mfma_f32_16x16x32_bf16 v[120:123], v[176:179], v[12:15], v[120:123]
    v_exp_f32 v103, v103
    v_mfma_f32_16x16x32_bf16 v[128:131], v[176:179], v[16:19], v[128:131]
    ds_read_b128 v[216:219], v241 offset:29696
    s_waitcnt lgkmcnt(6)
    v_mfma_f32_16x16x32_bf16 v[116:119], v[180:183], v[20:23], v[116:119]
    v_exp_f32 v104, v104
    v_mfma_f32_16x16x32_bf16 v[124:127], v[180:183], v[24:27], v[124:127]
    ds_read_b128 v[220:223], v241 offset:30720
    v_cvt_pk_bf16_f32 v149, v102, v103
    v_mfma_f32_16x16x32_bf16 v[120:123], v[184:187], v[20:23], v[120:123]
    v_exp_f32 v105, v105
    v_mfma_f32_16x16x32_bf16 v[128:131], v[184:187], v[24:27], v[128:131]
    ds_read_b128 v[224:227], v241 offset:31744
    s_add_u32 s3, s3, 65536
    s_sub_u32 s7, s3, 163840
    v_mfma_f32_16x16x32_bf16 v[116:119], v[188:191], v[28:31], v[116:119]
    v_exp_f32 v106, v106
    v_mfma_f32_16x16x32_bf16 v[124:127], v[188:191], v[32:35], v[124:127]
    ds_read_b128 v[164:167], v242 offset:0
    v_cvt_pk_bf16_f32 v150, v104, v105
    v_mfma_f32_16x16x32_bf16 v[120:123], v[192:195], v[28:31], v[120:123]
    v_exp_f32 v107, v107
    v_mfma_f32_16x16x32_bf16 v[128:131], v[192:195], v[32:35], v[128:131]
    ds_read_b128 v[168:171], v242 offset:1024
    s_min_u32 s3, s3, s7
    s_waitcnt lgkmcnt(6)
    v_mfma_f32_16x16x32_bf16 v[36:39], v[196:199], v[156:159], v[36:39]
    v_exp_f32 v108, v108
    v_mfma_f32_16x16x32_bf16 v[44:47], v[196:199], v[160:163], v[44:47]
    ds_read_b128 v[172:175], v242 offset:2048
    v_cvt_pk_bf16_f32 v151, v106, v107
    v_mfma_f32_16x16x32_bf16 v[40:43], v[200:203], v[156:159], v[40:43]
    v_exp_f32 v109, v109
    v_mfma_f32_16x16x32_bf16 v[48:51], v[200:203], v[160:163], v[48:51]
    ds_read_b128 v[176:179], v242 offset:3072
    v_mfma_f32_16x16x32_bf16 v[52:55], v[204:207], v[156:159], v[52:55]
    v_exp_f32 v110, v110
    v_mfma_f32_16x16x32_bf16 v[60:63], v[204:207], v[160:163], v[60:63]
    ds_read_b128 v[180:183], v242 offset:4096
    v_cvt_pk_bf16_f32 v152, v108, v109
    v_mfma_f32_16x16x32_bf16 v[56:59], v[208:211], v[156:159], v[56:59]
    v_exp_f32 v111, v111
    v_mfma_f32_16x16x32_bf16 v[64:67], v[208:211], v[160:163], v[64:67]
    ds_read_b128 v[184:187], v242 offset:5120
    v_mfma_f32_16x16x32_bf16 v[228:231], v[236:239], v[156:159], v[228:231]
    v_exp_f32 v112, v112
    v_mfma_f32_16x16x32_bf16 v[232:235], v[236:239], v[160:163], v[232:235]
    v_cvt_pk_bf16_f32 v153, v110, v111
    s_waitcnt lgkmcnt(6)
    v_mfma_f32_16x16x32_bf16 v[68:71], v[212:215], v[156:159], v[68:71]
    v_exp_f32 v113, v113
    v_mfma_f32_16x16x32_bf16 v[76:79], v[212:215], v[160:163], v[76:79]
    ds_read_b128 v[188:191], v242 offset:6144
    v_mfma_f32_16x16x32_bf16 v[72:75], v[216:219], v[156:159], v[72:75]
    v_exp_f32 v114, v114
    v_mfma_f32_16x16x32_bf16 v[80:83], v[216:219], v[160:163], v[80:83]
    ds_read_b128 v[192:195], v242 offset:7168
    v_cvt_pk_bf16_f32 v154, v112, v113
    v_mfma_f32_16x16x32_bf16 v[84:87], v[220:223], v[156:159], v[84:87]
    v_exp_f32 v115, v115
    v_mfma_f32_16x16x32_bf16 v[92:95], v[220:223], v[160:163], v[92:95]
    ds_read_b128 v[196:199], v242 offset:16384
    v_mfma_f32_16x16x32_bf16 v[88:91], v[224:227], v[156:159], v[88:91]
    v_cvt_pk_bf16_f32 v155, v114, v115
    v_mfma_f32_16x16x32_bf16 v[96:99], v[224:227], v[160:163], v[96:99]
    ds_read_b128 v[200:203], v242 offset:17408
    v_mov_b32 v241, v242
    v_add_u32 v242, s3, v243
    s_cmp_eq_u32 s31, 1
    s_cbranch_scc1 L_k2_B_drain_even
    v_cmp_gt_i32 s[52:53], 0, v244
    v_cmp_gt_i32 s[54:55], 1, v244
    v_cmp_gt_i32 s[56:57], 2, v244
    v_cndmask_b32 v132, v132, v245, s[52:53]
    v_cndmask_b32 v133, v133, v245, s[54:55]
    v_cndmask_b32 v134, v134, v245, s[56:57]
    v_cmp_gt_i32 s[52:53], 3, v244
    v_cmp_gt_i32 s[54:55], 16, v244
    v_cmp_gt_i32 s[56:57], 17, v244
    v_cndmask_b32 v135, v135, v245, s[52:53]
    v_cndmask_b32 v136, v136, v245, s[54:55]
    v_cndmask_b32 v137, v137, v245, s[56:57]
    v_cmp_gt_i32 s[52:53], 18, v244
    v_cmp_gt_i32 s[54:55], 19, v244
    v_cmp_gt_i32 s[56:57], 0, v244
    v_cndmask_b32 v138, v138, v245, s[52:53]
    v_cndmask_b32 v139, v139, v245, s[54:55]
    v_cndmask_b32 v144, v144, v245, s[56:57]
    v_cmp_gt_i32 s[52:53], 1, v244
    v_cmp_gt_i32 s[54:55], 2, v244
    v_cmp_gt_i32 s[56:57], 3, v244
    v_cndmask_b32 v145, v145, v245, s[52:53]
    v_cndmask_b32 v146, v146, v245, s[54:55]
    v_cndmask_b32 v147, v147, v245, s[56:57]
    s_nop 1
    s_bitcmp1_b32 s51, 0
    s_cbranch_scc1 L_k2nb_32
    s_waitcnt vmcnt(0)
    s_barrier
    s_cmp_eq_u32 s6, 1
    s_cbranch_scc1 L_k2zs_33
L_k2zr_34:
L_k2nb_32:
    s_waitcnt lgkmcnt(6)
    v_mfma_f32_16x16x32_bf16 v[100:103], v[164:167], v[4:7], v[132:135]
    v_exp_f32 v116, v116
    v_mfma_f32_16x16x32_bf16 v[108:111], v[164:167], v[8:11], v[140:143]
    ds_read_b128 v[204:207], v241 offset:18432
    s_cmp_lt_u32 s32, s33
    s_cselect_b32 s35, s34, 2147483648
    s_mov_b32 m0, s36
    s_sub_u32 s38, s32, 1
    v_mfma_f32_16x16x32_bf16 v[104:107], v[168:171], v[4:7], v[136:139]
    v_exp_f32 v117, v117
    v_mfma_f32_16x16x32_bf16 v[112:115], v[168:171], v[8:11], v[144:147]
    ds_read_b128 v[208:211], v241 offset:19456
    s_add_u32 s51, s51, 1
    buffer_load_dwordx4 v243, s[8:11], s35 offen offset:0 sc1 lds
    v_mfma_f32_16x16x32_bf16 v[100:103], v[172:175], v[12:15], v[100:103]
    v_exp_f32 v118, v118
    v_mfma_f32_16x16x32_bf16 v[108:111], v[172:175], v[16:19], v[108:111]
    ds_read_b128 v[212:215], v241 offset:20480
    v_cvt_pk_bf16_f32 v156, v116, v117
    buffer_load_dwordx4 v243, s[8:11], s35 offen offset:1024 sc1 lds
    v_mfma_f32_16x16x32_bf16 v[104:107], v[176:179], v[12:15], v[104:107]
    v_exp_f32 v119, v119
    v_mfma_f32_16x16x32_bf16 v[112:115], v[176:179], v[16:19], v[112:115]
    ds_read_b128 v[216:219], v241 offset:21504
    s_waitcnt lgkmcnt(6)
    v_mfma_f32_16x16x32_bf16 v[100:103], v[180:183], v[20:23], v[100:103]
    v_exp_f32 v120, v120
    v_mfma_f32_16x16x32_bf16 v[108:111], v[180:183], v[24:27], v[108:111]
    ds_read_b128 v[220:223], v241 offset:22528
    v_cvt_pk_bf16_f32 v157, v118, v119
    buffer_load_dwordx4 v243, s[8:11], s35 offen offset:2048 sc1 lds
    v_mfma_f32_16x16x32_bf16 v[104:107], v[184:187], v[20:23], v[104:107]
    v_exp_f32 v121, v121
    v_mfma_f32_16x16x32_bf16 v[112:115], v[184:187], v[24:27], v[112:115]
    ds_read_b128 v[224:227], v241 offset:23552
    buffer_load_dwordx4 v243, s[8:11], s35 offen offset:3072 sc1 lds
    v_mfma_f32_16x16x32_bf16 v[100:103], v[188:191], v[28:31], v[100:103]
    v_exp_f32 v122, v122
    v_mfma_f32_16x16x32_bf16 v[108:111], v[188:191], v[32:35], v[108:111]
    ds_read_b128 v[164:167], v241 offset:8192
    v_cvt_pk_bf16_f32 v158, v120, v121
    v_mfma_f32_16x16x32_bf16 v[104:107], v[192:195], v[28:31], v[104:107]
    v_exp_f32 v123, v123
    v_mfma_f32_16x16x32_bf16 v[112:115], v[192:195], v[32:35], v[112:115]
    ds_read_b128 v[168:171], v241 offset:9216
    s_add_u32 s49, s34, 16760832
    s_cmp_lt_u32 s38, s33
    s_cselect_b32 s49, s49, 2147483648
    s_add_u32 m0, s36, 16384
    s_add_u32 s36, s36, 65536
    s_waitcnt lgkmcnt(6)
    v_mfma_f32_16x16x32_bf16 v[36:39], v[196:199], v[148:151], v[36:39]
    v_exp_f32 v124, v124
    v_mfma_f32_16x16x32_bf16 v[44:47], v[196:199], v[152:155], v[44:47]
    ds_read_b128 v[172:175], v241 offset:10240
    v_cvt_pk_bf16_f32 v159, v122, v123
    buffer_load_dwordx4 v243, s[8:11], s49 offen offset:0 sc1 lds
    v_mfma_f32_16x16x32_bf16 v[40:43], v[200:203], v[148:151], v[40:43]
    v_exp_f32 v125, v125
    v_mfma_f32_16x16x32_bf16 v[48:51], v[200:203], v[152:155], v[48:51]
    ds_read_b128 v[176:179], v241 offset:11264
    v_mfma_f32_16x16x32_bf16 v[52:55], v[204:207], v[148:151], v[52:55]
    v_exp_f32 v126, v126
    v_mfma_f32_16x16x32_bf16 v[60:63], v[204:207], v[152:155], v[60:63]
    ds_read_b128 v[180:183], v241 offset:12288
    v_cvt_pk_bf16_f32 v160, v124, v125
    buffer_load_dwordx4 v243, s[8:11], s49 offen offset:1024 sc1 lds
    v_mfma_f32_16x16x32_bf16 v[56:59], v[208:211], v[148:151], v[56:59]
    v_exp_f32 v127, v127
    v_mfma_f32_16x16x32_bf16 v[64:67], v[208:211], v[152:155], v[64:67]
    ds_read_b128 v[184:187], v241 offset:13312
    buffer_load_dwordx4 v243, s[8:11], s49 offen offset:2048 sc1 lds
    v_mfma_f32_16x16x32_bf16 v[228:231], v[236:239], v[148:151], v[228:231]
    v_exp_f32 v128, v128
    v_mfma_f32_16x16x32_bf16 v[232:235], v[236:239], v[152:155], v[232:235]
    v_cvt_pk_bf16_f32 v161, v126, v127
    s_waitcnt lgkmcnt(6)
    v_mfma_f32_16x16x32_bf16 v[68:71], v[212:215], v[148:151], v[68:71]
    v_exp_f32 v129, v129
    v_mfma_f32_16x16x32_bf16 v[76:79], v[212:215], v[152:155], v[76:79]
    ds_read_b128 v[188:191], v241 offset:14336
    buffer_load_dwordx4 v243, s[8:11], s49 offen offset:3072 sc1 lds
    v_mfma_f32_16x16x32_bf16 v[72:75], v[216:219], v[148:151], v[72:75]
    v_exp_f32 v130, v130
    v_mfma_f32_16x16x32_bf16 v[80:83], v[216:219], v[152:155], v[80:83]
    ds_read_b128 v[192:195], v241 offset:15360
    v_cvt_pk_bf16_f32 v162, v128, v129
    s_cmp_ge_u32 s36, 163840
    s_cselect_b32 s38, 163840, 0
    s_sub_u32 s36, s36, s38
    s_add_u32 s32, s32, 1
    s_add_u32 s34, s34, 16384
    s_sub_u32 s45, s45, 1
    v_mfma_f32_16x16x32_bf16 v[84:87], v[220:223], v[148:151], v[84:87]
    v_exp_f32 v131, v131
    v_mfma_f32_16x16x32_bf16 v[92:95], v[220:223], v[152:155], v[92:95]
    ds_read_b128 v[196:199], v241 offset:24576
    v_mfma_f32_16x16x32_bf16 v[88:91], v[224:227], v[148:151], v[88:91]
    v_cvt_pk_bf16_f32 v163, v130, v131
    v_mfma_f32_16x16x32_bf16 v[96:99], v[224:227], v[152:155], v[96:99]
    ds_read_b128 v[200:203], v241 offset:25600
L_k2_B_drain_odd:
    s_waitcnt lgkmcnt(0)
    ds_read_b128 v[196:199], v241 offset:24576
    ds_read_b128 v[200:203], v241 offset:25600
    ds_read_b128 v[204:207], v241 offset:26624
    ds_read_b128 v[208:211], v241 offset:27648
    ds_read_b128 v[212:215], v241 offset:28672
    ds_read_b128 v[216:219], v241 offset:29696
    ds_read_b128 v[220:223], v241 offset:30720
    ds_read_b128 v[224:227], v241 offset:31744
    s_waitcnt lgkmcnt(6)
    v_mfma_f32_16x16x32_bf16 v[36:39], v[196:199], v[156:159], v[36:39]
    v_exp_f32 v100, v100
    v_mfma_f32_16x16x32_bf16 v[44:47], v[196:199], v[160:163], v[44:47]
    ds_read_b128 v[196:199], v242 offset:16384
    v_exp_f32 v101, v101
    v_mfma_f32_16x16x32_bf16 v[40:43], v[200:203], v[156:159], v[40:43]
    v_exp_f32 v102, v102
    v_mfma_f32_16x16x32_bf16 v[48:51], v[200:203], v[160:163], v[48:51]
    ds_read_b128 v[200:203], v242 offset:17408
    v_exp_f32 v103, v103
    v_cvt_pk_bf16_f32 v148, v100, v101
    s_waitcnt lgkmcnt(6)
    v_mfma_f32_16x16x32_bf16 v[52:55], v[204:207], v[156:159], v[52:55]
    v_exp_f32 v104, v104
    v_mfma_f32_16x16x32_bf16 v[60:63], v[204:207], v[160:163], v[60:63]
    ds_read_b128 v[204:207], v242 offset:18432
    v_exp_f32 v105, v105
    v_cvt_pk_bf16_f32 v149, v102, v103
    v_mfma_f32_16x16x32_bf16 v[56:59], v[208:211], v[156:159], v[56:59]
    v_exp_f32 v106, v106
    v_mfma_f32_16x16x32_bf16 v[64:67], v[208:211], v[160:163], v[64:67]
    ds_read_b128 v[208:211], v242 offset:19456
    v_exp_f32 v107, v107
    v_cvt_pk_bf16_f32 v150, v104, v105
    v_mfma_f32_16x16x32_bf16 v[228:231], v[236:239], v[156:159], v[228:231]
    v_exp_f32 v108, v108
    v_mfma_f32_16x16x32_bf16 v[232:235], v[236:239], v[160:163], v[232:235]
    v_exp_f32 v109, v109
    v_cvt_pk_bf16_f32 v151, v106, v107
    s_waitcnt lgkmcnt(6)
    v_mfma_f32_16x16x32_bf16 v[68:71], v[212:215], v[156:159], v[68:71]
    v_exp_f32 v110, v110
    v_mfma_f32_16x16x32_bf16 v[76:79], v[212:215], v[160:163], v[76:79]
    ds_read_b128 v[212:215], v242 offset:20480
    v_exp_f32 v111, v111
    v_cvt_pk_bf16_f32 v152, v108, v109
    s_add_u32 s3, s3, 65536
    s_sub_u32 s7, s3, 163840
    v_mfma_f32_16x16x32_bf16 v[72:75], v[216:219], v[156:159], v[72:75]
    v_exp_f32 v112, v112
    v_mfma_f32_16x16x32_bf16 v[80:83], v[216:219], v[160:163], v[80:83]
    ds_read_b128 v[216:219], v242 offset:21504
    v_exp_f32 v113, v113
    v_cvt_pk_bf16_f32 v153, v110, v111
    s_waitcnt lgkmcnt(6)
    v_mfma_f32_16x16x32_bf16 v[84:87], v[220:223], v[156:159], v[84:87]
    v_exp_f32 v114, v114
    v_mfma_f32_16x16x32_bf16 v[92:95], v[220:223], v[160:163], v[92:95]
    ds_read_b128 v[220:223], v242 offset:22528
    v_exp_f32 v115, v115
    v_cvt_pk_bf16_f32 v154, v112, v113
    s_min_u32 s3, s3, s7
    v_mfma_f32_16x16x32_bf16 v[88:91], v[224:227], v[156:159], v[88:91]
    v_cvt_pk_bf16_f32 v155, v114, v115
    v_mfma_f32_16x16x32_bf16 v[96:99], v[224:227], v[160:163], v[96:99]
    ds_read_b128 v[224:227], v242 offset:23552
    v_mov_b32 v241, v242
    v_add_u32 v242, s3, v243
    s_nop 1
    s_bitcmp1_b32 s51, 0
    s_cbranch_scc1 L_k2nb_35
    s_waitcnt vmcnt(0)
    s_barrier
    s_cmp_eq_u32 s6, 1
    s_cbranch_scc1 L_k2zs_36
L_k2zr_37:
L_k2nb_35:
    s_waitcnt lgkmcnt(6)
    v_mfma_f32_16x16x32_bf16 v[36:39], v[196:199], v[148:151], v[36:39]
    s_cmp_lt_u32 s32, s33
    s_cselect_b32 s35, s34, 2147483648
    s_mov_b32 m0, s36
    s_sub_u32 s38, s32, 1
    buffer_load_dwordx4 v243, s[8:11], s35 offen offset:0 sc1 lds
    v_mfma_f32_16x16x32_bf16 v[44:47], v[196:199], v[152:155], v[44:47]
    v_mfma_f32_16x16x32_bf16 v[40:43], v[200:203], v[148:151], v[40:43]
    s_add_u32 s51, s51, 1
    buffer_load_dwordx4 v243, s[8:11], s35 offen offset:1024 sc1 lds
    v_mfma_f32_16x16x32_bf16 v[48:51], v[200:203], v[152:155], v[48:51]
    s_waitcnt lgkmcnt(4)
    v_mfma_f32_16x16x32_bf16 v[52:55], v[204:207], v[148:151], v[52:55]
    buffer_load_dwordx4 v243, s[8:11], s35 offen offset:2048 sc1 lds
    buffer_load_dwordx4 v243, s[8:11], s35 offen offset:3072 sc1 lds
    v_mfma_f32_16x16x32_bf16 v[60:63], v[204:207], v[152:155], v[60:63]
    v_mfma_f32_16x16x32_bf16 v[56:59], v[208:211], v[148:151], v[56:59]
    s_add_u32 s49, s34, 16760832
    s_cmp_lt_u32 s38, s33
    s_cselect_b32 s49, s49, 2147483648
    s_add_u32 m0, s36, 16384
    s_add_u32 s36, s36, 65536
    v_mfma_f32_16x16x32_bf16 v[64:67], v[208:211], v[152:155], v[64:67]
    v_mfma_f32_16x16x32_bf16 v[228:231], v[236:239], v[148:151], v[228:231]
    buffer_load_dwordx4 v243, s[8:11], s49 offen offset:0 sc1 lds
    v_mfma_f32_16x16x32_bf16 v[232:235], v[236:239], v[152:155], v[232:235]
    s_waitcnt lgkmcnt(2)
    v_mfma_f32_16x16x32_bf16 v[68:71], v[212:215], v[148:151], v[68:71]
    buffer_load_dwordx4 v243, s[8:11], s49 offen offset:1024 sc1 lds
    buffer_load_dwordx4 v243, s[8:11], s49 offen offset:2048 sc1 lds
    v_mfma_f32_16x16x32_bf16 v[76:79], v[212:215], v[152:155], v[76:79]
    v_mfma_f32_16x16x32_bf16 v[72:75], v[216:219], v[148:151], v[72:75]
    buffer_load_dwordx4 v243, s[8:11], s49 offen offset:3072 sc1 lds
    v_mfma_f32_16x16x32_bf16 v[80:83], v[216:219], v[152:155], v[80:83]
    s_waitcnt lgkmcnt(0)
    v_mfma_f32_16x16x32_bf16 v[84:87], v[220:223], v[148:151], v[84:87]
    s_cmp_ge_u32 s36, 163840
    s_cselect_b32 s38, 163840, 0
    s_sub_u32 s36, s36, s38
    s_add_u32 s32, s32, 1
    s_add_u32 s34, s34, 16384
    s_sub_u32 s45, s45, 1
    v_mfma_f32_16x16x32_bf16 v[92:95], v[220:223], v[152:155], v[92:95]
    v_mfma_f32_16x16x32_bf16 v[88:91], v[224:227], v[148:151], v[88:91]
    v_mfma_f32_16x16x32_bf16 v[96:99], v[224:227], v[152:155], v[96:99]
    s_branch L_k2_epi
L_k2_B_drain_even:
    s_bitcmp1_b32 s51, 0
    s_cbranch_scc1 L_k2nb_38
    s_waitcnt vmcnt(0)
    s_barrier
    s_cmp_eq_u32 s6, 1
    s_cbranch_scc1 L_k2zs_39
L_k2zr_40:
L_k2nb_38:
    s_waitcnt lgkmcnt(0)
    ds_read_b128 v[196:199], v241 offset:16384
    ds_read_b128 v[200:203], v241 offset:17408
    ds_read_b128 v[204:207], v241 offset:18432
    ds_read_b128 v[208:211], v241 offset:19456
    ds_read_b128 v[212:215], v241 offset:20480
    ds_read_b128 v[216:219], v241 offset:21504
    ds_read_b128 v[220:223], v241 offset:22528
    ds_read_b128 v[224:227], v241 offset:23552
    s_waitcnt lgkmcnt(6)
    v_mfma_f32_16x16x32_bf16 v[36:39], v[196:199], v[148:151], v[36:39]
    v_exp_f32 v116, v116
    v_mfma_f32_16x16x32_bf16 v[44:47], v[196:199], v[152:155], v[44:47]
    ds_read_b128 v[196:199], v241 offset:24576
    v_exp_f32 v117, v117
    s_cmp_lt_u32 s32, s33
    s_cselect_b32 s35, s34, 2147483648
    s_mov_b32 m0, s36
    s_sub_u32 s38, s32, 1
    buffer_load_dwordx4 v243, s[8:11], s35 offen offset:0 sc1 lds
    v_mfma_f32_16x16x32_bf16 v[40:43], v[200:203], v[148:151], v[40:43]
    v_exp_f32 v118, v118
    v_mfma_f32_16x16x32_bf16 v[48:51], v[200:203], v[152:155], v[48:51]
    ds_read_b128 v[200:203], v241 offset:25600
    v_exp_f32 v119, v119
    v_cvt_pk_bf16_f32 v156, v116, v117
    s_add_u32 s51, s51, 1
    buffer_load_dwordx4 v243, s[8:11], s35 offen offset:1024 sc1 lds
    s_waitcnt lgkmcnt(6)
    v_mfma_f32_16x16x32_bf16 v[52:55], v[204:207], v[148:151], v[52:55]
    v_exp_f32 v120, v120
    v_mfma_f32_16x16x32_bf16 v[60:63], v[204:207], v[152:155], v[60:63]
    ds_read_b128 v[204:207], v241 offset:26624
    v_exp_f32 v121, v121
    v_cvt_pk_bf16_f32 v157, v118, v119
    buffer_load_dwordx4 v243, s[8:11], s35 offen offset:2048 sc1 lds
    buffer_load_dwordx4 v243, s[8:11], s35 offen offset:3072 sc1 lds
    v_mfma_f32_16x16x32_bf16 v[56:59], v[208:211], v[148:151], v[56:59]
    v_exp_f32 v122, v122
    v_mfma_f32_16x16x32_bf16 v[64:67], v[208:211], v[152:155], v[64:67]
    ds_read_b128 v[208:211], v241 offset:27648
    v_exp_f32 v123, v123
    v_cvt_pk_bf16_f32 v158, v120, v121
    s_add_u32 s49, s34, 16760832
    s_cmp_lt_u32 s38, s33
    s_cselect_b32 s49, s49, 2147483648
    s_add_u32 m0, s36, 16384
    s_add_u32 s36, s36, 65536
    v_mfma_f32_16x16x32_bf16 v[228:231], v[236:239], v[148:151], v[228:231]
    v_exp_f32 v124, v124
    v_mfma_f32_16x16x32_bf16 v[232:235], v[236:239], v[152:155], v[232:235]
    v_exp_f32 v125, v125
    v_cvt_pk_bf16_f32 v159, v122, v123
    buffer_load_dwordx4 v243, s[8:11], s49 offen offset:0 sc1 lds
    s_waitcnt lgkmcnt(6)
    v_mfma_f32_16x16x32_bf16 v[68:71], v[212:215], v[148:151], v[68:71]
    v_exp_f32 v126, v126
    v_mfma_f32_16x16x32_bf16 v[76:79], v[212:215], v[152:155], v[76:79]
    ds_read_b128 v[212:215], v241 offset:28672
    v_exp_f32 v127, v127
    v_cvt_pk_bf16_f32 v160, v124, v125
    buffer_load_dwordx4 v243, s[8:11], s49 offen offset:1024 sc1 lds
    buffer_load_dwordx4 v243, s[8:11], s49 offen offset:2048 sc1 lds
    v_mfma_f32_16x16x32_bf16 v[72:75], v[216:219], v[148:151], v[72:75]
    v_exp_f32 v128, v128
    v_mfma_f32_16x16x32_bf16 v[80:83], v[216:219], v[152:155], v[80:83]
    ds_read_b128 v[216:219], v241 offset:29696
    v_exp_f32 v129, v129
    v_cvt_pk_bf16_f32 v161, v126, v127
    buffer_load_dwordx4 v243, s[8:11], s49 offen offset:3072 sc1 lds
    s_waitcnt lgkmcnt(6)
    v_mfma_f32_16x16x32_bf16 v[84:87], v[220:223], v[148:151], v[84:87]
    v_exp_f32 v130, v130
    v_mfma_f32_16x16x32_bf16 v[92:95], v[220:223], v[152:155], v[92:95]
    ds_read_b128 v[220:223], v241 offset:30720
    v_exp_f32 v131, v131
    v_cvt_pk_bf16_f32 v162, v128, v129
    s_cmp_ge_u32 s36, 163840
    s_cselect_b32 s38, 163840, 0
    s_sub_u32 s36, s36, s38
    s_add_u32 s32, s32, 1
    s_add_u32 s34, s34, 16384
    s_sub_u32 s45, s45, 1
    v_mfma_f32_16x16x32_bf16 v[88:91], v[224:227], v[148:151], v[88:91]
    v_cvt_pk_bf16_f32 v163, v130, v131
    v_mfma_f32_16x16x32_bf16 v[96:99], v[224:227], v[152:155], v[96:99]
    ds_read_b128 v[224:227], v241 offset:31744
    s_nop 1
    s_waitcnt lgkmcnt(6)
    v_mfma_f32_16x16x32_bf16 v[36:39], v[196:199], v[156:159], v[36:39]
    v_mfma_f32_16x16x32_bf16 v[44:47], v[196:199], v[160:163], v[44:47]
    v_mfma_f32_16x16x32_bf16 v[40:43], v[200:203], v[156:159], v[40:43]
    v_mfma_f32_16x16x32_bf16 v[48:51], v[200:203], v[160:163], v[48:51]
    s_waitcnt lgkmcnt(4)
    v_mfma_f32_16x16x32_bf16 v[52:55], v[204:207], v[156:159], v[52:55]
    v_mfma_f32_16x16x32_bf16 v[60:63], v[204:207], v[160:163], v[60:63]
    v_mfma_f32_16x16x32_bf16 v[56:59], v[208:211], v[156:159], v[56:59]
    v_mfma_f32_16x16x32_bf16 v[64:67], v[208:211], v[160:163], v[64:67]
    v_mfma_f32_16x16x32_bf16 v[228:231], v[236:239], v[156:159], v[228:231]
    v_mfma_f32_16x16x32_bf16 v[232:235], v[236:239], v[160:163], v[232:235]
    s_waitcnt lgkmcnt(2)
    v_mfma_f32_16x16x32_bf16 v[68:71], v[212:215], v[156:159], v[68:71]
    s_add_u32 s3, s3, 65536
    s_sub_u32 s7, s3, 163840
    v_mfma_f32_16x16x32_bf16 v[76:79], v[212:215], v[160:163], v[76:79]
    v_mfma_f32_16x16x32_bf16 v[72:75], v[216:219], v[156:159], v[72:75]
    v_mfma_f32_16x16x32_bf16 v[80:83], v[216:219], v[160:163], v[80:83]
    s_waitcnt lgkmcnt(0)
    v_mfma_f32_16x16x32_bf16 v[84:87], v[220:223], v[156:159], v[84:87]
    s_min_u32 s3, s3, s7
    v_mfma_f32_16x16x32_bf16 v[92:95], v[220:223], v[160:163], v[92:95]
    v_mfma_f32_16x16x32_bf16 v[88:91], v[224:227], v[156:159], v[88:91]
    v_mfma_f32_16x16x32_bf16 v[96:99], v[224:227], v[160:163], v[96:99]
    v_mov_b32 v241, v242
    v_add_u32 v242, s3, v243
L_k2_epi:
    s_lshl_b32 s44, s46, 18
    s_lshl_b32 s38, s29, 13
    s_add_u32 s44, s44, s38
    s_add_u32 s38, s44, 4096
    s_nop 3
    v_add_f32 v248, v228, v232
    v_cmp_nge_f32 vcc, 0x5f800000, v248
    s_cbranch_vccnz L_k2_exact
L_k2_exact_ret:
    v_rcp_f32 v248, v228
    v_rcp_f32 v249, v232
    s_nop 0
    v_mul_f32 v36, v36, v248
    v_mul_f32 v37, v37, v248
    v_mul_f32 v38, v38, v248
    v_mul_f32 v39, v39, v248
    v_mul_f32 v40, v40, v248
    v_mul_f32 v41, v41, v248
    v_mul_f32 v42, v42, v248
    v_mul_f32 v43, v43, v248
    v_cvt_pk_bf16_f32 v100, v36, v37
    v_cvt_pk_bf16_f32 v101, v38, v39
    v_cvt_pk_bf16_f32 v102, v40, v41
    v_cvt_pk_bf16_f32 v103, v42, v43
    buffer_store_dwordx4 v[100:103], v243, s[16:19], s44 offen offset:0 sc1
    v_mul_f32 v44, v44, v249
    v_mul_f32 v45, v45, v249
    v_mul_f32 v46, v46, v249
    v_mul_f32 v47, v47, v249
    v_mul_f32 v48, v48, v249
    v_mul_f32 v49, v49, v249
    v_mul_f32 v50, v50, v249
    v_mul_f32 v51, v51, v249
    v_cvt_pk_bf16_f32 v104, v44, v45
    v_cvt_pk_bf16_f32 v105, v46, v47
    v_cvt_pk_bf16_f32 v106, v48, v49
    v_cvt_pk_bf16_f32 v107, v50, v51
    buffer_store_dwordx4 v[104:107], v243, s[16:19], s44 offen offset:1024 sc1
    v_mul_f32 v52, v52, v248
    v_mul_f32 v53, v53, v248
    v_mul_f32 v54, v54, v248
    v_mul_f32 v55, v55, v248
    v_mul_f32 v56, v56, v248
    v_mul_f32 v57, v57, v248
    v_mul_f32 v58, v58, v248
    v_mul_f32 v59, v59, v248
    v_cvt_pk_bf16_f32 v108, v52, v53
    v_cvt_pk_bf16_f32 v109, v54, v55
    v_cvt_pk_bf16_f32 v110, v56, v57
    v_cvt_pk_bf16_f32 v111, v58, v59
    buffer_store_dwordx4 v[108:111], v243, s[16:19], s44 offen offset:2048 sc1
    v_mul_f32 v60, v60, v249
    v_mul_f32 v61, v61, v249
    v_mul_f32 v62, v62, v249
    v_mul_f32 v63, v63, v249
    v_mul_f32 v64, v64, v249
    v_mul_f32 v65, v65, v249
    v_mul_f32 v66, v66, v249
    v_mul_f32 v67, v67, v249
    v_cvt_pk_bf16_f32 v112, v60, v61
    v_cvt_pk_bf16_f32 v113, v62, v63
    v_cvt_pk_bf16_f32 v114, v64, v65
    v_cvt_pk_bf16_f32 v115, v66, v67
    buffer_store_dwordx4 v[112:115], v243, s[16:19], s44 offen offset:3072 sc1
    v_mul_f32 v68, v68, v248
    v_mul_f32 v69, v69, v248
    v_mul_f32 v70, v70, v248
    v_mul_f32 v71, v71, v248
    v_mul_f32 v72, v72, v248
    v_mul_f32 v73, v73, v248
    v_mul_f32 v74, v74, v248
    v_mul_f32 v75, v75, v248
    v_cvt_pk_bf16_f32 v116, v68, v69
    v_cvt_pk_bf16_f32 v117, v70, v71
    v_cvt_pk_bf16_f32 v118, v72, v73
    v_cvt_pk_bf16_f32 v119, v74, v75
    buffer_store_dwordx4 v[116:119], v243, s[16:19], s38 offen offset:0 sc1
    v_mul_f32 v76, v76, v249
    v_mul_f32 v77, v77, v249
    v_mul_f32 v78, v78, v249
    v_mul_f32 v79, v79, v249
    v_mul_f32 v80, v80, v249
    v_mul_f32 v81, v81, v249
    v_mul_f32 v82, v82, v249
    v_mul_f32 v83, v83, v249
    v_cvt_pk_bf16_f32 v120, v76, v77
    v_cvt_pk_bf16_f32 v121, v78, v79
    v_cvt_pk_bf16_f32 v122, v80, v81
    v_cvt_pk_bf16_f32 v123, v82, v83
    buffer_store_dwordx4 v[120:123], v243, s[16:19], s38 offen offset:1024 sc1
    v_mul_f32 v84, v84, v248
    v_mul_f32 v85, v85, v248
    v_mul_f32 v86, v86, v248
    v_mul_f32 v87, v87, v248
    v_mul_f32 v88, v88, v248
    v_mul_f32 v89, v89, v248
    v_mul_f32 v90, v90, v248
    v_mul_f32 v91, v91, v248
    v_cvt_pk_bf16_f32 v124, v84, v85
    v_cvt_pk_bf16_f32 v125, v86, v87
    v_cvt_pk_bf16_f32 v126, v88, v89
    v_cvt_pk_bf16_f32 v127, v90, v91
    buffer_store_dwordx4 v[124:127], v243, s[16:19], s38 offen offset:2048 sc1
    v_mul_f32 v92, v92, v249
    v_mul_f32 v93, v93, v249
    v_mul_f32 v94, v94, v249
    v_mul_f32 v95, v95, v249
    v_mul_f32 v96, v96, v249
    v_mul_f32 v97, v97, v249
    v_mul_f32 v98, v98, v249
    v_mul_f32 v99, v99, v249
    v_cvt_pk_bf16_f32 v128, v92, v93
    v_cvt_pk_bf16_f32 v129, v94, v95
    v_cvt_pk_bf16_f32 v130, v96, v97
    v_cvt_pk_bf16_f32 v131, v98, v99
    buffer_store_dwordx4 v[128:131], v243, s[16:19], s38 offen offset:3072 sc1
    s_setprio 0
    s_add_u32 s12, s4, 92274688
    s_addc_u32 s13, s5, 0
    s_mov_b32 s14, 24576
    s_mov_b32 s15, 0x20000
    v_mov_b32 v250, 0
    v_mov_b32 v251, 1
    s_lshl_b32 s44, s30, 3
    s_lshr_b32 s38, s29, 2
    s_add_u32 s44, s44, s38
    s_add_u32 s44, s44, 64
    s_lshl_b32 s44, s44, 7
    s_cmp_eq_u32 s42, 0
    s_cbranch_scc0 L_k2_Btail
    s_cmp_ge_u32 s43, 2
    s_cbranch_scc1 L_k2_Asig
    s_barrier
L_k2_Asig:
    s_waitcnt vmcnt(0)
    s_mov_b64 exec, 1
    buffer_atomic_add v251, v250, s[12:15], s44 offen sc1
    s_mov_b64 exec, -1
    s_branch L_k2_end
L_k2_Btail:
L_k2w_41:
    s_cmp_le_u32 s45, 0
    s_cbranch_scc1 L_k2we_42
    s_bitcmp1_b32 s51, 0
    s_cbranch_scc1 L_k2nb_44
    s_waitcnt vmcnt(0)
    s_barrier
    s_cmp_eq_u32 s6, 1
    s_cbranch_scc1 L_k2zs_45
L_k2zr_46:
L_k2nb_44:
    s_add_u32 s51, s51, 1
    s_cmp_lt_u32 s32, s33
    s_cselect_b32 s35, s34, 2147483648
    s_mov_b32 m0, s36
    s_sub_u32 s38, s32, 1
    buffer_load_dwordx4 v243, s[8:11], s35 offen offset:0 sc1 lds
    buffer_load_dwordx4 v243, s[8:11], s35 offen offset:1024 sc1 lds
    buffer_load_dwordx4 v243, s[8:11], s35 offen offset:2048 sc1 lds
    buffer_load_dwordx4 v243, s[8:11], s35 offen offset:3072 sc1 lds
    s_add_u32 s49, s34, 16760832
    s_cmp_lt_u32 s38, s33
    s_cselect_b32 s49, s49, 2147483648
    s_add_u32 m0, s36, 16384
    s_add_u32 s36, s36, 65536
    buffer_load_dwordx4 v243, s[8:11], s49 offen offset:0 sc1 lds
    buffer_load_dwordx4 v243, s[8:11], s49 offen offset:1024 sc1 lds
    buffer_load_dwordx4 v243, s[8:11], s49 offen offset:2048 sc1 lds
    buffer_load_dwordx4 v243, s[8:11], s49 offen offset:3072 sc1 lds
    s_cmp_ge_u32 s36, 163840
    s_cselect_b32 s38, 163840, 0
    s_sub_u32 s36, s36, s38
    s_add_u32 s32, s32, 1
    s_add_u32 s34, s34, 16384
    s_sub_u32 s45, s45, 1
    s_bitcmp0_b32 s51, 0
    s_cbranch_scc1 L_k2w_41
    s_mov_b64 exec, 1
    buffer_atomic_add v251, v250, s[12:15], s44 offen sc1
    s_mov_b64 exec, -1
    s_cmp_le_u32 s45, 0
    s_cbranch_scc1 L_k2wx_43
    s_bitcmp1_b32 s51, 0
    s_cbranch_scc1 L_k2nb_47
    s_waitcnt vmcnt(0)
    s_barrier
    s_cmp_eq_u32 s6, 1
    s_cbranch_scc1 L_k2zs_48
L_k2zr_49:
L_k2nb_47:
    s_add_u32 s51, s51, 1
    s_cmp_lt_u32 s32, s33
    s_cselect_b32 s35, s34, 2147483648
    s_mov_b32 m0, s36
    s_sub_u32 s38, s32, 1
    buffer_load_dwordx4 v243, s[8:11], s35 offen offset:0 sc1 lds
    buffer_load_dwordx4 v243, s[8:11], s35 offen offset:1024 sc1 lds
    buffer_load_dwordx4 v243, s[8:11], s35 offen offset:2048 sc1 lds
    buffer_load_dwordx4 v243, s[8:11], s35 offen offset:3072 sc1 lds
    s_add_u32 s49, s34, 16760832
    s_cmp_lt_u32 s38, s33
    s_cselect_b32 s49, s49, 2147483648
    s_add_u32 m0, s36, 16384
    s_add_u32 s36, s36, 65536
    buffer_load_dwordx4 v243, s[8:11], s49 offen offset:0 sc1 lds
    buffer_load_dwordx4 v243, s[8:11], s49 offen offset:1024 sc1 lds
    buffer_load_dwordx4 v243, s[8:11], s49 offen offset:2048 sc1 lds
    buffer_load_dwordx4 v243, s[8:11], s49 offen offset:3072 sc1 lds
    s_cmp_ge_u32 s36, 163840
    s_cselect_b32 s38, 163840, 0
    s_sub_u32 s36, s36, s38
    s_add_u32 s32, s32, 1
    s_add_u32 s34, s34, 16384
    s_sub_u32 s45, s45, 1
    s_branch L_k2wx_43
L_k2we_42:
    s_waitcnt vmcnt(0)
    s_mov_b64 exec, 1
    buffer_atomic_add v251, v250, s[12:15], s44 offen sc1
    s_mov_b64 exec, -1
L_k2wx_43:
    s_cmp_ge_u32 s2, 128
    s_cbranch_scc1 L_k2_noz
    s_mov_b32 s50, 0x200000
L_k2_zw:
    buffer_load_dword v3, v2, s[12:15], 0 offen offset:3072 sc0 sc1
L_k2w_50:
    s_cmp_le_u32 s45, 0
    s_cbranch_scc1 L_k2we_51
    s_bitcmp1_b32 s51, 0
    s_cbranch_scc1 L_k2nb_53
    s_waitcnt vmcnt(0)
    s_barrier
    s_cmp_eq_u32 s6, 1
    s_cbranch_scc1 L_k2zs_54
L_k2zr_55:
L_k2nb_53:
    s_add_u32 s51, s51, 1
    s_cmp_lt_u32 s32, s33
    s_cselect_b32 s35, s34, 2147483648
    s_mov_b32 m0, s36
    s_sub_u32 s38, s32, 1
    buffer_load_dwordx4 v243, s[8:11], s35 offen offset:0 sc1 lds
    buffer_load_dwordx4 v243, s[8:11], s35 offen offset:1024 sc1 lds
    buffer_load_dwordx4 v243, s[8:11], s35 offen offset:2048 sc1 lds
    buffer_load_dwordx4 v243, s[8:11], s35 offen offset:3072 sc1 lds
    s_add_u32 s49, s34, 16760832
    s_cmp_lt_u32 s38, s33
    s_cselect_b32 s49, s49, 2147483648
    s_add_u32 m0, s36, 16384
    s_add_u32 s36, s36, 65536
    buffer_load_dwordx4 v243, s[8:11], s49 offen offset:0 sc1 lds
    buffer_load_dwordx4 v243, s[8:11], s49 offen offset:1024 sc1 lds
    buffer_load_dwordx4 v243, s[8:11], s49 offen offset:2048 sc1 lds
    buffer_load_dwordx4 v243, s[8:11], s49 offen offset:3072 sc1 lds
    s_cmp_ge_u32 s36, 163840
    s_cselect_b32 s38, 163840, 0
    s_sub_u32 s36, s36, s38
    s_add_u32 s32, s32, 1
    s_add_u32 s34, s34, 16384
    s_sub_u32 s45, s45, 1
    s_bitcmp0_b32 s51, 0
    s_cbranch_scc1 L_k2w_50
    s_cmp_le_u32 s45, 0
    s_cbranch_scc1 L_k2wx_52
    s_bitcmp1_b32 s51, 0
    s_cbranch_scc1 L_k2nb_56
    s_waitcnt vmcnt(0)
    s_barrier
    s_cmp_eq_u32 s6, 1
    s_cbranch_scc1 L_k2zs_57
L_k2zr_58:
L_k2nb_56:
    s_add_u32 s51, s51, 1
    s_cmp_lt_u32 s32, s33
    s_cselect_b32 s35, s34, 2147483648
    s_mov_b32 m0, s36
    s_sub_u32 s38, s32, 1
    buffer_load_dwordx4 v243, s[8:11], s35 offen offset:0 sc1 lds
    buffer_load_dwordx4 v243, s[8:11], s35 offen offset:1024 sc1 lds
    buffer_load_dwordx4 v243, s[8:11], s35 offen offset:2048 sc1 lds
    buffer_load_dwordx4 v243, s[8:11], s35 offen offset:3072 sc1 lds
    s_add_u32 s49, s34, 16760832
    s_cmp_lt_u32 s38, s33
    s_cselect_b32 s49, s49, 2147483648
    s_add_u32 m0, s36, 16384
    s_add_u32 s36, s36, 65536
    buffer_load_dwordx4 v243, s[8:11], s49 offen offset:0 sc1 lds
    buffer_load_dwordx4 v243, s[8:11], s49 offen offset:1024 sc1 lds
    buffer_load_dwordx4 v243, s[8:11], s49 offen offset:2048 sc1 lds
    buffer_load_dwordx4 v243, s[8:11], s49 offen offset:3072 sc1 lds
    s_cmp_ge_u32 s36, 163840
    s_cselect_b32 s38, 163840, 0
    s_sub_u32 s36, s36, s38
    s_add_u32 s32, s32, 1
    s_add_u32 s34, s34, 16384
    s_sub_u32 s45, s45, 1
    s_branch L_k2wx_52
L_k2we_51:
    s_waitcnt vmcnt(0)
L_k2wx_52:
    v_cmp_gt_u32 vcc, 224, v3
    s_cbranch_vccz L_k2_zok
    s_sleep 6
    s_sub_u32 s50, s50, 1
    s_cmp_lg_u32 s50, 0
    s_cbranch_scc1 L_k2_zw
L_k2_zok:
    s_mov_b32 s48, s2
L_k2_zround:
    s_lshr_b32 s47, s48, 1
    s_mul_i32 s47, s47, 114688
    s_and_b32 s50, s48, 1
    s_lshl_b32 s50, s50, 8
    s_add_u32 s47, s47, s50
    s_lshl_b32 s50, s43, 6
    s_add_u32 s47, s47, s50
    s_add_u32 s47, s47, 57344
    v_lshrrev_b32 v192, 3, v246
    v_lshlrev_b32 v192, 10, v192
    v_and_b32 v193, 3, v246
    v_lshl_add_u32 v192, v193, 4, v192
    v_bfe_u32 v193, v246, 2, 1
    v_lshl_add_u32 v192, v193, 3, v192
    buffer_load_dwordx2 v[164:165], v192, s[20:23], s47 offen sc1
    buffer_load_dwordx2 v[166:167], v192, s[20:23], s47 offen offset:512 sc1
    s_add_u32 s47, s47, 8192
    buffer_load_dwordx2 v[168:169], v192, s[20:23], s47 offen sc1
    buffer_load_dwordx2 v[170:171], v192, s[20:23], s47 offen offset:512 sc1
    s_add_u32 s47, s47, 8192
    buffer_load_dwordx2 v[172:173], v192, s[20:23], s47 offen sc1
    buffer_load_dwordx2 v[174:175], v192, s[20:23], s47 offen offset:512 sc1
    s_add_u32 s47, s47, 8192
    buffer_load_dwordx2 v[176:177], v192, s[20:23], s47 offen sc1
    buffer_load_dwordx2 v[178:179], v192, s[20:23], s47 offen offset:512 sc1
    s_add_u32 s47, s47, 8192
    buffer_load_dwordx2 v[180:181], v192, s[20:23], s47 offen sc1
    buffer_load_dwordx2 v[182:183], v192, s[20:23], s47 offen offset:512 sc1
    s_add_u32 s47, s47, 8192
    buffer_load_dwordx2 v[184:185], v192, s[20:23], s47 offen sc1
    buffer_load_dwordx2 v[186:187], v192, s[20:23], s47 offen offset:512 sc1
    s_add_u32 s47, s47, 8192
    buffer_load_dwordx2 v[188:189], v192, s[20:23], s47 offen sc1
    buffer_load_dwordx2 v[190:191], v192, s[20:23], s47 offen offset:512 sc1
    s_add_u32 s47, s47, 8192
L_k2w_59:
    s_cmp_le_u32 s45, 0
    s_cbranch_scc1 L_k2we_60
    s_bitcmp1_b32 s51, 0
    s_cbranch_scc1 L_k2nb_62
    s_waitcnt vmcnt(0)
    s_barrier
    s_cmp_eq_u32 s6, 1
    s_cbranch_scc1 L_k2zs_63
L_k2zr_64:
L_k2nb_62:
    s_add_u32 s51, s51, 1
    s_cmp_lt_u32 s32, s33
    s_cselect_b32 s35, s34, 2147483648
    s_mov_b32 m0, s36
    s_sub_u32 s38, s32, 1
    buffer_load_dwordx4 v243, s[8:11], s35 offen offset:0 sc1 lds
    buffer_load_dwordx4 v243, s[8:11], s35 offen offset:1024 sc1 lds
    buffer_load_dwordx4 v243, s[8:11], s35 offen offset:2048 sc1 lds
    buffer_load_dwordx4 v243, s[8:11], s35 offen offset:3072 sc1 lds
    s_add_u32 s49, s34, 16760832
    s_cmp_lt_u32 s38, s33
    s_cselect_b32 s49, s49, 2147483648
    s_add_u32 m0, s36, 16384
    s_add_u32 s36, s36, 65536
    buffer_load_dwordx4 v243, s[8:11], s49 offen offset:0 sc1 lds
    buffer_load_dwordx4 v243, s[8:11], s49 offen offset:1024 sc1 lds
    buffer_load_dwordx4 v243, s[8:11], s49 offen offset:2048 sc1 lds
    buffer_load_dwordx4 v243, s[8:11], s49 offen offset:3072 sc1 lds
    s_cmp_ge_u32 s36, 163840
    s_cselect_b32 s38, 163840, 0
    s_sub_u32 s36, s36, s38
    s_add_u32 s32, s32, 1
    s_add_u32 s34, s34, 16384
    s_sub_u32 s45, s45, 1
    s_bitcmp0_b32 s51, 0
    s_cbranch_scc1 L_k2w_59
    s_cmp_le_u32 s45, 0
    s_cbranch_scc1 L_k2wx_61
    s_bitcmp1_b32 s51, 0
    s_cbranch_scc1 L_k2nb_65
    s_waitcnt vmcnt(0)
    s_barrier
    s_cmp_eq_u32 s6, 1
    s_cbranch_scc1 L_k2zs_66
L_k2zr_67:
L_k2nb_65:
    s_add_u32 s51, s51, 1
    s_cmp_lt_u32 s32, s33
    s_cselect_b32 s35, s34, 2147483648
    s_mov_b32 m0, s36
    s_sub_u32 s38, s32, 1
    buffer_load_dwordx4 v243, s[8:11], s35 offen offset:0 sc1 lds
    buffer_load_dwordx4 v243, s[8:11], s35 offen offset:1024 sc1 lds
    buffer_load_dwordx4 v243, s[8:11], s35 offen offset:2048 sc1 lds
    buffer_load_dwordx4 v243, s[8:11], s35 offen offset:3072 sc1 lds
    s_add_u32 s49, s34, 16760832
    s_cmp_lt_u32 s38, s33
    s_cselect_b32 s49, s49, 2147483648
    s_add_u32 m0, s36, 16384
    s_add_u32 s36, s36, 65536
    buffer_load_dwordx4 v243, s[8:11], s49 offen offset:0 sc1 lds
    buffer_load_dwordx4 v243, s[8:11], s49 offen offset:1024 sc1 lds
    buffer_load_dwordx4 v243, s[8:11], s49 offen offset:2048 sc1 lds
    buffer_load_dwordx4 v243, s[8:11], s49 offen offset:3072 sc1 lds
    s_cmp_ge_u32 s36, 163840
    s_cselect_b32 s38, 163840, 0
    s_sub_u32 s36, s36, s38
    s_add_u32 s32, s32, 1
    s_add_u32 s34, s34, 16384
    s_sub_u32 s45, s45, 1
    s_branch L_k2wx_61
L_k2we_60:
    s_waitcnt vmcnt(0)
L_k2wx_61:
    v_mov_b32 v38, 0x3f803f80
    v_mov_b32 v36, 0
    v_mov_b32 v37, 0
    s_setprio 3
    v_lshlrev_b32 v100, 16, v164
    v_and_b32 v101, 0xffff0000, v164
    v_add_f32 v39, v100, v101
    v_fmac_f32 v37, v100, v100
    v_add_f32 v36, v36, v39
    v_fmac_f32 v37, v101, v101
    v_lshlrev_b32 v102, 16, v165
    v_and_b32 v103, 0xffff0000, v165
    v_add_f32 v39, v102, v103
    v_fmac_f32 v37, v102, v102
    v_add_f32 v36, v36, v39
    v_fmac_f32 v37, v103, v103
    v_lshlrev_b32 v104, 16, v166
    v_and_b32 v105, 0xffff0000, v166
    v_add_f32 v39, v104, v105
    v_fmac_f32 v37, v104, v104
    v_add_f32 v36, v36, v39
    v_fmac_f32 v37, v105, v105
    v_lshlrev_b32 v106, 16, v167
    v_and_b32 v107, 0xffff0000, v167
    v_add_f32 v39, v106, v107
    v_fmac_f32 v37, v106, v106
    v_add_f32 v36, v36, v39
    v_fmac_f32 v37, v107, v107
    v_lshlrev_b32 v108, 16, v168
    v_and_b32 v109, 0xffff0000, v168
    v_add_f32 v39, v108, v109
    v_fmac_f32 v37, v108, v108
    v_add_f32 v36, v36, v39
    v_fmac_f32 v37, v109, v109
    v_lshlrev_b32 v110, 16, v169
    v_and_b32 v111, 0xffff0000, v169
    v_add_f32 v39, v110, v111
    v_fmac_f32 v37, v110, v110
    v_add_f32 v36, v36, v39
    v_fmac_f32 v37, v111, v111
    v_lshlrev_b32 v112, 16, v170
    v_and_b32 v113, 0xffff0000, v170
    v_add_f32 v39, v112, v113
    v_fmac_f32 v37, v112, v112
    v_add_f32 v36, v36, v39
    v_fmac_f32 v37, v113, v113
    v_lshlrev_b32 v114, 16, v171
    v_and_b32 v115, 0xffff0000, v171
    v_add_f32 v39, v114, v115
    v_fmac_f32 v37, v114, v114
    v_add_f32 v36, v36, v39
    v_fmac_f32 v37, v115, v115
    v_lshlrev_b32 v116, 16, v172
    v_and_b32 v117, 0xffff0000, v172
    v_add_f32 v39, v116, v117
    v_fmac_f32 v37, v116, v116
    v_add_f32 v36, v36, v39
    v_fmac_f32 v37, v117, v117
    v_lshlrev_b32 v118, 16, v173
    v_and_b32 v119, 0xffff0000, v173
    v_add_f32 v39, v118, v119
    v_fmac_f32 v37, v118, v118
    v_add_f32 v36, v36, v39
    v_fmac_f32 v37, v119, v119
    v_lshlrev_b32 v120, 16, v174
    v_and_b32 v121, 0xffff0000, v174
    v_add_f32 v39, v120, v121
    v_fmac_f32 v37, v120, v120
    v_add_f32 v36, v36, v39
    v_fmac_f32 v37, v121, v121
    v_lshlrev_b32 v122, 16, v175
    v_and_b32 v123, 0xffff0000, v175
    v_add_f32 v39, v122, v123
    v_fmac_f32 v37, v122, v122
    v_add_f32 v36, v36, v39
    v_fmac_f32 v37, v123, v123
    v_lshlrev_b32 v124, 16, v176
    v_and_b32 v125, 0xffff0000, v176
    v_add_f32 v39, v124, v125
    v_fmac_f32 v37, v124, v124
    v_add_f32 v36, v36, v39
    v_fmac_f32 v37, v125, v125
    v_lshlrev_b32 v126, 16, v177
    v_and_b32 v127, 0xffff0000, v177
    v_add_f32 v39, v126, v127
    v_fmac_f32 v37, v126, v126
    v_add_f32 v36, v36, v39
    v_fmac_f32 v37, v127, v127
    v_lshlrev_b32 v128, 16, v178
    v_and_b32 v129, 0xffff0000, v178
    v_add_f32 v39, v128, v129
    v_fmac_f32 v37, v128, v128
    v_add_f32 v36, v36, v39
    v_fmac_f32 v37, v129, v129
    v_lshlrev_b32 v130, 16, v179
    v_and_b32 v131, 0xffff0000, v179
    v_add_f32 v39, v130, v131
    v_fmac_f32 v37, v130, v130
    v_add_f32 v36, v36, v39
    v_fmac_f32 v37, v131, v131
    v_lshlrev_b32 v132, 16, v180
    v_and_b32 v133, 0xffff0000, v180
    v_add_f32 v39, v132, v133
    v_fmac_f32 v37, v132, v132
    v_add_f32 v36, v36, v39
    v_fmac_f32 v37, v133, v133
    v_lshlrev_b32 v134, 16, v181
    v_and_b32 v135, 0xffff0000, v181
    v_add_f32 v39, v134, v135
    v_fmac_f32 v37, v134, v134
    v_add_f32 v36, v36, v39
    v_fmac_f32 v37, v135, v135
    v_lshlrev_b32 v136, 16, v182
    v_and_b32 v137, 0xffff0000, v182
    v_add_f32 v39, v136, v137
    v_fmac_f32 v37, v136, v136
    v_add_f32 v36, v36, v39
    v_fmac_f32 v37, v137, v137
    v_lshlrev_b32 v138, 16, v183
    v_and_b32 v139, 0xffff0000, v183
    v_add_f32 v39, v138, v139
    v_fmac_f32 v37, v138, v138
    v_add_f32 v36, v36, v39
    v_fmac_f32 v37, v139, v139
    v_lshlrev_b32 v140, 16, v184
    v_and_b32 v141, 0xffff0000, v184
    v_add_f32 v39, v140, v141
    v_fmac_f32 v37, v140, v140
    v_add_f32 v36, v36, v39
    v_fmac_f32 v37, v141, v141
    v_lshlrev_b32 v142, 16, v185
    v_and_b32 v143, 0xffff0000, v185
    v_add_f32 v39, v142, v143
    v_fmac_f32 v37, v142, v142
    v_add_f32 v36, v36, v39
    v_fmac_f32 v37, v143, v143
    v_lshlrev_b32 v144, 16, v186
    v_and_b32 v145, 0xffff0000, v186
    v_add_f32 v39, v144, v145
    v_fmac_f32 v37, v144, v144
    v_add_f32 v36, v36, v39
    v_fmac_f32 v37, v145, v145
    v_lshlrev_b32 v146, 16, v187
    v_and_b32 v147, 0xffff0000, v187
    v_add_f32 v39, v146, v147
    v_fmac_f32 v37, v146, v146
    v_add_f32 v36, v36, v39
    v_fmac_f32 v37, v147, v147
    v_lshlrev_b32 v148, 16, v188
    v_and_b32 v149, 0xffff0000, v188
    v_add_f32 v39, v148, v149
    v_fmac_f32 v37, v148, v148
    v_add_f32 v36, v36, v39
    v_fmac_f32 v37, v149, v149
    v_lshlrev_b32 v150, 16, v189
    v_and_b32 v151, 0xffff0000, v189
    v_add_f32 v39, v150, v151
    v_fmac_f32 v37, v150, v150
    v_add_f32 v36, v36, v39
    v_fmac_f32 v37, v151, v151
    v_lshlrev_b32 v152, 16, v190
    v_and_b32 v153, 0xffff0000, v190
    v_add_f32 v39, v152, v153
    v_fmac_f32 v37, v152, v152
    v_add_f32 v36, v36, v39
    v_fmac_f32 v37, v153, v153
    v_lshlrev_b32 v154, 16, v191
    v_and_b32 v155, 0xffff0000, v191
    v_add_f32 v39, v154, v155
    v_fmac_f32 v37, v154, v154
    v_add_f32 v36, v36, v39
    v_fmac_f32 v37, v155, v155
    s_nop 2
    v_add_f32_dpp v36, v36, v36 row_ror:4 row_mask:0xf bank_mask:0xf
    v_add_f32_dpp v37, v37, v37 row_ror:4 row_mask:0xf bank_mask:0xf
    s_nop 0
    v_add_f32_dpp v36, v36, v36 row_ror:8 row_mask:0xf bank_mask:0xf
    v_add_f32_dpp v37, v37, v37 row_ror:8 row_mask:0xf bank_mask:0xf
    s_nop 0
    v_mov_b32 v39, v36
    v_mov_b32 v40, v37
    s_nop 1
    v_permlane16_swap_b32 v36, v39
    v_permlane16_swap_b32 v37, v40
    s_nop 1
    v_add_f32 v36, v36, v39
    v_add_f32 v37, v37, v40
    v_mov_b32 v39, v36
    v_mov_b32 v40, v37
    s_nop 1
    v_permlane32_swap_b32 v36, v39
    v_permlane32_swap_b32 v37, v40
    s_nop 1
    v_add_f32 v36, v36, v39
    v_add_f32 v37, v37, v40
    v_mul_f32 v41, 0x3a924925, v36
    v_mul_f32 v42, 0x3a924925, v37
    v_fma_f32 v42, -v41, v41, v42
    v_max_f32 v42, 0, v42
    v_add_f32 v42, 0x3727c5ac, v42
    v_rsq_f32 v43, v42
    v_and_b32 v45, 3, v246
    v_mul_u32_u24 v45, 1792, v45
    v_lshrrev_b32 v39, 2, v246
    v_lshl_add_u32 v45, v39, 4, v45
    s_lshl_b32 s47, s48, 2
    s_add_u32 s47, s47, s43
    s_mul_i32 s47, s47, 7168
    v_mul_f32 v44, v41, v43
    v_sub_f32 v44, 0, v44
L_k2w_68:
    s_cmp_le_u32 s45, 0
    s_cbranch_scc1 L_k2we_69
    s_bitcmp1_b32 s51, 0
    s_cbranch_scc1 L_k2nb_71
    s_waitcnt vmcnt(0)
    s_barrier
    s_cmp_eq_u32 s6, 1
    s_cbranch_scc1 L_k2zs_72
L_k2zr_73:
L_k2nb_71:
    s_add_u32 s51, s51, 1
    s_cmp_lt_u32 s32, s33
    s_cselect_b32 s35, s34, 2147483648
    s_mov_b32 m0, s36
    s_sub_u32 s38, s32, 1
    buffer_load_dwordx4 v243, s[8:11], s35 offen offset:0 sc1 lds
    buffer_load_dwordx4 v243, s[8:11], s35 offen offset:1024 sc1 lds
    buffer_load_dwordx4 v243, s[8:11], s35 offen offset:2048 sc1 lds
    buffer_load_dwordx4 v243, s[8:11], s35 offen offset:3072 sc1 lds
    s_add_u32 s49, s34, 16760832
    s_cmp_lt_u32 s38, s33
    s_cselect_b32 s49, s49, 2147483648
    s_add_u32 m0, s36, 16384
    s_add_u32 s36, s36, 65536
    buffer_load_dwordx4 v243, s[8:11], s49 offen offset:0 sc1 lds
    buffer_load_dwordx4 v243, s[8:11], s49 offen offset:1024 sc1 lds
    buffer_load_dwordx4 v243, s[8:11], s49 offen offset:2048 sc1 lds
    buffer_load_dwordx4 v243, s[8:11], s49 offen offset:3072 sc1 lds
    s_cmp_ge_u32 s36, 163840
    s_cselect_b32 s38, 163840, 0
    s_sub_u32 s36, s36, s38
    s_add_u32 s32, s32, 1
    s_add_u32 s34, s34, 16384
    s_sub_u32 s45, s45, 1
    s_bitcmp0_b32 s51, 0
    s_cbranch_scc1 L_k2w_68
    s_cmp_le_u32 s45, 0
    s_cbranch_scc1 L_k2wx_70
    s_bitcmp1_b32 s51, 0
    s_cbranch_scc1 L_k2nb_74
    s_waitcnt vmcnt(0)
    s_barrier
    s_cmp_eq_u32 s6, 1
    s_cbranch_scc1 L_k2zs_75
L_k2zr_76:
L_k2nb_74:
    s_add_u32 s51, s51, 1
    s_cmp_lt_u32 s32, s33
    s_cselect_b32 s35, s34, 2147483648
    s_mov_b32 m0, s36
    s_sub_u32 s38, s32, 1
    buffer_load_dwordx4 v243, s[8:11], s35 offen offset:0 sc1 lds
    buffer_load_dwordx4 v243, s[8:11], s35 offen offset:1024 sc1 lds
    buffer_load_dwordx4 v243, s[8:11], s35 offen offset:2048 sc1 lds
    buffer_load_dwordx4 v243, s[8:11], s35 offen offset:3072 sc1 lds
    s_add_u32 s49, s34, 16760832
    s_cmp_lt_u32 s38, s33
    s_cselect_b32 s49, s49, 2147483648
    s_add_u32 m0, s36, 16384
    s_add_u32 s36, s36, 65536
    buffer_load_dwordx4 v243, s[8:11], s49 offen offset:0 sc1 lds
    buffer_load_dwordx4 v243, s[8:11], s49 offen offset:1024 sc1 lds
    buffer_load_dwordx4 v243, s[8:11], s49 offen offset:2048 sc1 lds
    buffer_load_dwordx4 v243, s[8:11], s49 offen offset:3072 sc1 lds
    s_cmp_ge_u32 s36, 163840
    s_cselect_b32 s38, 163840, 0
    s_sub_u32 s36, s36, s38
    s_add_u32 s32, s32, 1
    s_add_u32 s34, s34, 16384
    s_sub_u32 s45, s45, 1
    s_branch L_k2wx_70
L_k2we_69:
    s_waitcnt vmcnt(0)
L_k2wx_70:
    v_fma_f32 v39, v100, v43, v44
    v_fma_f32 v40, v101, v43, v44
    v_cvt_pk_bf16_f32 v164, v39, v40
    v_fma_f32 v39, v102, v43, v44
    v_fma_f32 v40, v103, v43, v44
    v_cvt_pk_bf16_f32 v165, v39, v40
    v_fma_f32 v39, v104, v43, v44
    v_fma_f32 v40, v105, v43, v44
    v_cvt_pk_bf16_f32 v166, v39, v40
    v_fma_f32 v39, v106, v43, v44
    v_fma_f32 v40, v107, v43, v44
    v_cvt_pk_bf16_f32 v167, v39, v40
    buffer_store_dwordx4 v[164:167], v45, s[24:27], s47 offen offset:0 sc1
    v_fma_f32 v39, v108, v43, v44
    v_fma_f32 v40, v109, v43, v44
    v_cvt_pk_bf16_f32 v168, v39, v40
    v_fma_f32 v39, v110, v43, v44
    v_fma_f32 v40, v111, v43, v44
    v_cvt_pk_bf16_f32 v169, v39, v40
    v_fma_f32 v39, v112, v43, v44
    v_fma_f32 v40, v113, v43, v44
    v_cvt_pk_bf16_f32 v170, v39, v40
    v_fma_f32 v39, v114, v43, v44
    v_fma_f32 v40, v115, v43, v44
    v_cvt_pk_bf16_f32 v171, v39, v40
    buffer_store_dwordx4 v[168:171], v45, s[24:27], s47 offen offset:256 sc1
    v_fma_f32 v39, v116, v43, v44
    v_fma_f32 v40, v117, v43, v44
    v_cvt_pk_bf16_f32 v172, v39, v40
    v_fma_f32 v39, v118, v43, v44
    v_fma_f32 v40, v119, v43, v44
    v_cvt_pk_bf16_f32 v173, v39, v40
    v_fma_f32 v39, v120, v43, v44
    v_fma_f32 v40, v121, v43, v44
    v_cvt_pk_bf16_f32 v174, v39, v40
    v_fma_f32 v39, v122, v43, v44
    v_fma_f32 v40, v123, v43, v44
    v_cvt_pk_bf16_f32 v175, v39, v40
    buffer_store_dwordx4 v[172:175], v45, s[24:27], s47 offen offset:512 sc1
    v_fma_f32 v39, v124, v43, v44
    v_fma_f32 v40, v125, v43, v44
    v_cvt_pk_bf16_f32 v176, v39, v40
    v_fma_f32 v39, v126, v43, v44
    v_fma_f32 v40, v127, v43, v44
    v_cvt_pk_bf16_f32 v177, v39, v40
    v_fma_f32 v39, v128, v43, v44
    v_fma_f32 v40, v129, v43, v44
    v_cvt_pk_bf16_f32 v178, v39, v40
    v_fma_f32 v39, v130, v43, v44
    v_fma_f32 v40, v131, v43, v44
    v_cvt_pk_bf16_f32 v179, v39, v40
    buffer_store_dwordx4 v[176:179], v45, s[24:27], s47 offen offset:768 sc1
    v_fma_f32 v39, v132, v43, v44
    v_fma_f32 v40, v133, v43, v44
    v_cvt_pk_bf16_f32 v180, v39, v40
    v_fma_f32 v39, v134, v43, v44
    v_fma_f32 v40, v135, v43, v44
    v_cvt_pk_bf16_f32 v181, v39, v40
    v_fma_f32 v39, v136, v43, v44
    v_fma_f32 v40, v137, v43, v44
    v_cvt_pk_bf16_f32 v182, v39, v40
    v_fma_f32 v39, v138, v43, v44
    v_fma_f32 v40, v139, v43, v44
    v_cvt_pk_bf16_f32 v183, v39, v40
    buffer_store_dwordx4 v[180:183], v45, s[24:27], s47 offen offset:1024 sc1
    v_fma_f32 v39, v140, v43, v44
    v_fma_f32 v40, v141, v43, v44
    v_cvt_pk_bf16_f32 v184, v39, v40
    v_fma_f32 v39, v142, v43, v44
    v_fma_f32 v40, v143, v43, v44
    v_cvt_pk_bf16_f32 v185, v39, v40
    v_fma_f32 v39, v144, v43, v44
    v_fma_f32 v40, v145, v43, v44
    v_cvt_pk_bf16_f32 v186, v39, v40
    v_fma_f32 v39, v146, v43, v44
    v_fma_f32 v40, v147, v43, v44
    v_cvt_pk_bf16_f32 v187, v39, v40
    buffer_store_dwordx4 v[184:187], v45, s[24:27], s47 offen offset:1280 sc1
    v_fma_f32 v39, v148, v43, v44
    v_fma_f32 v40, v149, v43, v44
    v_cvt_pk_bf16_f32 v188, v39, v40
    v_fma_f32 v39, v150, v43, v44
    v_fma_f32 v40, v151, v43, v44
    v_cvt_pk_bf16_f32 v189, v39, v40
    v_fma_f32 v39, v152, v43, v44
    v_fma_f32 v40, v153, v43, v44
    v_cvt_pk_bf16_f32 v190, v39, v40
    v_fma_f32 v39, v154, v43, v44
    v_fma_f32 v40, v155, v43, v44
    v_cvt_pk_bf16_f32 v191, v39, v40
    buffer_store_dwordx4 v[188:191], v45, s[24:27], s47 offen offset:1536 sc1
    s_setprio 0
    s_add_u32 s48, s48, 128
    s_cmp_lt_u32 s48, 128
    s_cbranch_scc1 L_k2_zround
    s_and_b32 s48, s48, 7
    s_add_u32 s48, s48, 48
    s_lshl_b32 s48, s48, 7
L_k2w_77:
    s_cmp_le_u32 s45, 0
    s_cbranch_scc1 L_k2we_78
    s_bitcmp1_b32 s51, 0
    s_cbranch_scc1 L_k2nb_80
    s_waitcnt vmcnt(0)
    s_barrier
    s_cmp_eq_u32 s6, 1
    s_cbranch_scc1 L_k2zs_81
L_k2zr_82:
L_k2nb_80:
    s_add_u32 s51, s51, 1
    s_cmp_lt_u32 s32, s33
    s_cselect_b32 s35, s34, 2147483648
    s_mov_b32 m0, s36
    s_sub_u32 s38, s32, 1
    buffer_load_dwordx4 v243, s[8:11], s35 offen offset:0 sc1 lds
    buffer_load_dwordx4 v243, s[8:11], s35 offen offset:1024 sc1 lds
    buffer_load_dwordx4 v243, s[8:11], s35 offen offset:2048 sc1 lds
    buffer_load_dwordx4 v243, s[8:11], s35 offen offset:3072 sc1 lds
    s_add_u32 s49, s34, 16760832
    s_cmp_lt_u32 s38, s33
    s_cselect_b32 s49, s49, 2147483648
    s_add_u32 m0, s36, 16384
    s_add_u32 s36, s36, 65536
    buffer_load_dwordx4 v243, s[8:11], s49 offen offset:0 sc1 lds
    buffer_load_dwordx4 v243, s[8:11], s49 offen offset:1024 sc1 lds
    buffer_load_dwordx4 v243, s[8:11], s49 offen offset:2048 sc1 lds
    buffer_load_dwordx4 v243, s[8:11], s49 offen offset:3072 sc1 lds
    s_cmp_ge_u32 s36, 163840
    s_cselect_b32 s38, 163840, 0
    s_sub_u32 s36, s36, s38
    s_add_u32 s32, s32, 1
    s_add_u32 s34, s34, 16384
    s_sub_u32 s45, s45, 1
    s_bitcmp0_b32 s51, 0
    s_cbranch_scc1 L_k2w_77
    s_mov_b64 exec, 1
    buffer_atomic_add v251, v250, s[12:15], s48 offen sc1
    s_mov_b64 exec, -1
    s_cmp_le_u32 s45, 0
    s_cbranch_scc1 L_k2wx_79
    s_bitcmp1_b32 s51, 0
    s_cbranch_scc1 L_k2nb_83
    s_waitcnt vmcnt(0)
    s_barrier
    s_cmp_eq_u32 s6, 1
    s_cbranch_scc1 L_k2zs_84
L_k2zr_85:
L_k2nb_83:
    s_add_u32 s51, s51, 1
    s_cmp_lt_u32 s32, s33
    s_cselect_b32 s35, s34, 2147483648
    s_mov_b32 m0, s36
    s_sub_u32 s38, s32, 1
    buffer_load_dwordx4 v243, s[8:11], s35 offen offset:0 sc1 lds
    buffer_load_dwordx4 v243, s[8:11], s35 offen offset:1024 sc1 lds
    buffer_load_dwordx4 v243, s[8:11], s35 offen offset:2048 sc1 lds
    buffer_load_dwordx4 v243, s[8:11], s35 offen offset:3072 sc1 lds
    s_add_u32 s49, s34, 16760832
    s_cmp_lt_u32 s38, s33
    s_cselect_b32 s49, s49, 2147483648
    s_add_u32 m0, s36, 16384
    s_add_u32 s36, s36, 65536
    buffer_load_dwordx4 v243, s[8:11], s49 offen offset:0 sc1 lds
    buffer_load_dwordx4 v243, s[8:11], s49 offen offset:1024 sc1 lds
    buffer_load_dwordx4 v243, s[8:11], s49 offen offset:2048 sc1 lds
    buffer_load_dwordx4 v243, s[8:11], s49 offen offset:3072 sc1 lds
    s_cmp_ge_u32 s36, 163840
    s_cselect_b32 s38, 163840, 0
    s_sub_u32 s36, s36, s38
    s_add_u32 s32, s32, 1
    s_add_u32 s34, s34, 16384
    s_sub_u32 s45, s45, 1
    s_branch L_k2wx_79
L_k2we_78:
    s_waitcnt vmcnt(0)
    s_mov_b64 exec, 1
    buffer_atomic_add v251, v250, s[12:15], s48 offen sc1
    s_mov_b64 exec, -1
L_k2wx_79:
L_k2_noz:
L_k2_idle_loop:
    s_cmp_le_u32 s45, 0
    s_cbranch_scc1 L_k2_end
    s_bitcmp1_b32 s51, 0
    s_cbranch_scc1 L_k2nb_86
    s_waitcnt vmcnt(0)
    s_barrier
    s_cmp_eq_u32 s6, 1
    s_cbranch_scc1 L_k2zs_87
L_k2zr_88:
L_k2nb_86:
    s_add_u32 s51, s51, 1
    s_cmp_lt_u32 s32, s33
    s_cselect_b32 s35, s34, 2147483648
    s_mov_b32 m0, s36
    s_sub_u32 s38, s32, 1
    buffer_load_dwordx4 v243, s[8:11], s35 offen offset:0 sc1 lds
    buffer_load_dwordx4 v243, s[8:11], s35 offen offset:1024 sc1 lds
    buffer_load_dwordx4 v243, s[8:11], s35 offen offset:2048 sc1 lds
    buffer_load_dwordx4 v243, s[8:11], s35 offen offset:3072 sc1 lds
    s_add_u32 s49, s34, 16760832
    s_cmp_lt_u32 s38, s33
    s_cselect_b32 s49, s49, 2147483648
    s_add_u32 m0, s36, 16384
    s_add_u32 s36, s36, 65536
    buffer_load_dwordx4 v243, s[8:11], s49 offen offset:0 sc1 lds
    buffer_load_dwordx4 v243, s[8:11], s49 offen offset:1024 sc1 lds
    buffer_load_dwordx4 v243, s[8:11], s49 offen offset:2048 sc1 lds
    buffer_load_dwordx4 v243, s[8:11], s49 offen offset:3072 sc1 lds
    s_cmp_ge_u32 s36, 163840
    s_cselect_b32 s38, 163840, 0
    s_sub_u32 s36, s36, s38
    s_add_u32 s32, s32, 1
    s_add_u32 s34, s34, 16384
    s_sub_u32 s45, s45, 1
    s_branch L_k2_idle_loop
L_k2_end:
    s_branch L_k3_entry
L_k2mask_7:
    v_cmp_gt_i32 s[52:53], 0, v244
    v_cmp_gt_i32 s[54:55], 1, v244
    v_cmp_gt_i32 s[56:57], 2, v244
    v_cndmask_b32 v132, v132, v245, s[52:53]
    v_cndmask_b32 v133, v133, v245, s[54:55]
    v_cndmask_b32 v134, v134, v245, s[56:57]
    v_cmp_gt_i32 s[52:53], 3, v244
    v_cmp_gt_i32 s[54:55], 16, v244
    v_cmp_gt_i32 s[56:57], 17, v244
    v_cndmask_b32 v135, v135, v245, s[52:53]
    v_cndmask_b32 v136, v136, v245, s[54:55]
    v_cndmask_b32 v137, v137, v245, s[56:57]
    v_cmp_gt_i32 s[52:53], 18, v244
    v_cmp_gt_i32 s[54:55], 19, v244
    v_cmp_gt_i32 s[56:57], 0, v244
    v_cndmask_b32 v138, v138, v245, s[52:53]
    v_cndmask_b32 v139, v139, v245, s[54:55]
    v_cndmask_b32 v144, v144, v245, s[56:57]
    v_cmp_gt_i32 s[52:53], 1, v244
    v_cmp_gt_i32 s[54:55], 2, v244
    v_cmp_gt_i32 s[56:57], 3, v244
    v_cndmask_b32 v145, v145, v245, s[52:53]
    v_cndmask_b32 v146, v146, v245, s[54:55]
    v_cndmask_b32 v147, v147, v245, s[56:57]
    s_nop 1
    s_branch L_k2mret_8
L_k2_pfnext:
    buffer_load_dword v255, v240, s[20:23], s47 offen
    s_add_u32 s47, s47, 4096
    s_sub_u32 s50, s50, 1
    s_cmp_lg_u32 s50, 0
    s_cbranch_scc1 L_k2_pfret
    s_add_u32 s49, s49, 1
    s_mov_b32 s22, 8388608
    s_mov_b32 s50, 4
    s_lshl_b32 s47, s48, 14
    s_cmp_eq_u32 s49, 1
    s_cbranch_scc1 L_k2_pfret
    s_mov_b32 s20, s96
    s_mov_b32 s21, s97
    s_mov_b32 s22, 4194304
    s_mov_b32 s50, 2
    s_lshl_b32 s47, s48, 13
    s_cmp_eq_u32 s49, 2
    s_cbranch_scc1 L_k2_pfret
    s_mov_b32 s20, s100
    s_mov_b32 s21, s101
    s_mov_b32 s22, 917504
    s_mov_b32 s50, 1
    s_lshl_b32 s47, s48, 12
    s_branch L_k2_pfret
L_k2zs_11:
    s_waitcnt vmcnt(0)
    s_mov_b32 s6, 0
    s_branch L_k2zr_12
L_k2mask_13:
    v_cmp_gt_i32 s[52:53], 0, v244
    v_cmp_gt_i32 s[54:55], 1, v244
    v_cmp_gt_i32 s[56:57], 2, v244
    v_cndmask_b32 v132, v132, v245, s[52:53]
    v_cndmask_b32 v133, v133, v245, s[54:55]
    v_cndmask_b32 v134, v134, v245, s[56:57]
    v_cmp_gt_i32 s[52:53], 3, v244
    v_cmp_gt_i32 s[54:55], 16, v244
    v_cmp_gt_i32 s[56:57], 17, v244
    v_cndmask_b32 v135, v135, v245, s[52:53]
    v_cndmask_b32 v136, v136, v245, s[54:55]
    v_cndmask_b32 v137, v137, v245, s[56:57]
    v_cmp_gt_i32 s[52:53], 18, v244
    v_cmp_gt_i32 s[54:55], 19, v244
    v_cmp_gt_i32 s[56:57], 0, v244
    v_cndmask_b32 v138, v138, v245, s[52:53]
    v_cndmask_b32 v139, v139, v245, s[54:55]
    v_cndmask_b32 v144, v144, v245, s[56:57]
    v_cmp_gt_i32 s[52:53], 1, v244
    v_cmp_gt_i32 s[54:55], 2, v244
    v_cmp_gt_i32 s[56:57], 3, v244
    v_cndmask_b32 v145, v145, v245, s[52:53]
    v_cndmask_b32 v146, v146, v245, s[54:55]
    v_cndmask_b32 v147, v147, v245, s[56:57]
    s_nop 1
    s_branch L_k2mret_14
L_k2zs_16:
    s_waitcnt vmcnt(0)
    s_mov_b32 s6, 0
    s_branch L_k2zr_17
L_k2zs_19:
    s_waitcnt vmcnt(0)
    s_mov_b32 s6, 0
    s_branch L_k2zr_20
L_k2zs_22:
    s_waitcnt vmcnt(0)
    s_mov_b32 s6, 0
    s_branch L_k2zr_23
L_k2mask_24:
    v_cmp_gt_i32 s[52:53], 0, v244
    v_cmp_gt_i32 s[54:55], 1, v244
    v_cmp_gt_i32 s[56:57], 2, v244
    v_cndmask_b32 v132, v132, v245, s[52:53]
    v_cndmask_b32 v133, v133, v245, s[54:55]
    v_cndmask_b32 v134, v134, v245, s[56:57]
    v_cmp_gt_i32 s[52:53], 3, v244
    v_cmp_gt_i32 s[54:55], 16, v244
    v_cmp_gt_i32 s[56:57], 17, v244
    v_cndmask_b32 v135, v135, v245, s[52:53]
    v_cndmask_b32 v136, v136, v245, s[54:55]
    v_cndmask_b32 v137, v137, v245, s[56:57]
    v_cmp_gt_i32 s[52:53], 18, v244
    v_cmp_gt_i32 s[54:55], 19, v244
    v_cmp_gt_i32 s[56:57], 0, v244
    v_cndmask_b32 v138, v138, v245, s[52:53]
    v_cndmask_b32 v139, v139, v245, s[54:55]
    v_cndmask_b32 v144, v144, v245, s[56:57]
    v_cmp_gt_i32 s[52:53], 1, v244
    v_cmp_gt_i32 s[54:55], 2, v244
    v_cmp_gt_i32 s[56:57], 3, v244
    v_cndmask_b32 v145, v145, v245, s[52:53]
    v_cndmask_b32 v146, v146, v245, s[54:55]
    v_cndmask_b32 v147, v147, v245, s[56:57]
    s_nop 1
    s_branch L_k2mret_25
L_k2zs_28:
    s_mov_b32 s6, 0
    s_cmp_lg_u32 s28, 7
    s_cbranch_scc1 L_k2zr_29
    s_cmp_ge_u32 s29, 28
    s_cbranch_scc1 L_k2zr_29
    s_add_u32 s52, s4, 92277760
    s_addc_u32 s53, s5, 0
    s_mov_b32 s54, 128
    s_mov_b32 s55, 0x20000
    v_mov_b32 v1, 1
    s_mov_b64 exec, 1
    buffer_atomic_add v1, v2, s[52:55], 0 offen sc1
    s_mov_b64 exec, -1
    s_branch L_k2zr_29
L_k2mask_30:
    v_cmp_gt_i32 s[52:53], 0, v244
    v_cmp_gt_i32 s[54:55], 1, v244
    v_cmp_gt_i32 s[56:57], 2, v244
    v_cndmask_b32 v132, v132, v245, s[52:53]
    v_cndmask_b32 v133, v133, v245, s[54:55]
    v_cndmask_b32 v134, v134, v245, s[56:57]
    v_cmp_gt_i32 s[52:53], 3, v244
    v_cmp_gt_i32 s[54:55], 16, v244
    v_cmp_gt_i32 s[56:57], 17, v244
    v_cndmask_b32 v135, v135, v245, s[52:53]
    v_cndmask_b32 v136, v136, v245, s[54:55]
    v_cndmask_b32 v137, v137, v245, s[56:57]
    v_cmp_gt_i32 s[52:53], 18, v244
    v_cmp_gt_i32 s[54:55], 19, v244
    v_cmp_gt_i32 s[56:57], 0, v244
    v_cndmask_b32 v138, v138, v245, s[52:53]
    v_cndmask_b32 v139, v139, v245, s[54:55]
    v_cndmask_b32 v144, v144, v245, s[56:57]
    v_cmp_gt_i32 s[52:53], 1, v244
    v_cmp_gt_i32 s[54:55], 2, v244
    v_cmp_gt_i32 s[56:57], 3, v244
    v_cndmask_b32 v145, v145, v245, s[52:53]
    v_cndmask_b32 v146, v146, v245, s[54:55]
    v_cndmask_b32 v147, v147, v245, s[56:57]
    s_nop 1
    s_branch L_k2mret_31
L_k2zs_33:
    s_mov_b32 s6, 0
    s_cmp_lg_u32 s28, 7
    s_cbranch_scc1 L_k2zr_34
    s_cmp_ge_u32 s29, 28
    s_cbranch_scc1 L_k2zr_34
    s_add_u32 s52, s4, 92277760
    s_addc_u32 s53, s5, 0
    s_mov_b32 s54, 128
    s_mov_b32 s55, 0x20000
    v_mov_b32 v1, 1
    s_mov_b64 exec, 1
    buffer_atomic_add v1, v2, s[52:55], 0 offen sc1
    s_mov_b64 exec, -1
    s_branch L_k2zr_34
L_k2zs_36:
    s_mov_b32 s6, 0
    s_cmp_lg_u32 s28, 7
    s_cbranch_scc1 L_k2zr_37
    s_cmp_ge_u32 s29, 28
    s_cbranch_scc1 L_k2zr_37
    s_add_u32 s52, s4, 92277760
    s_addc_u32 s53, s5, 0
    s_mov_b32 s54, 128
    s_mov_b32 s55, 0x20000
    v_mov_b32 v1, 1
    s_mov_b64 exec, 1
    buffer_atomic_add v1, v2, s[52:55], 0 offen sc1
    s_mov_b64 exec, -1
    s_branch L_k2zr_37
L_k2zs_39:
    s_mov_b32 s6, 0
    s_cmp_lg_u32 s28, 7
    s_cbranch_scc1 L_k2zr_40
    s_cmp_ge_u32 s29, 28
    s_cbranch_scc1 L_k2zr_40
    s_add_u32 s52, s4, 92277760
    s_addc_u32 s53, s5, 0
    s_mov_b32 s54, 128
    s_mov_b32 s55, 0x20000
    v_mov_b32 v1, 1
    s_mov_b64 exec, 1
    buffer_atomic_add v1, v2, s[52:55], 0 offen sc1
    s_mov_b64 exec, -1
    s_branch L_k2zr_40
L_k2_exact:
    v_mov_b32 v36, 0
    v_mov_b32 v37, 0
    v_mov_b32 v38, 0
    v_mov_b32 v39, 0
    v_mov_b32 v40, 0
    v_mov_b32 v41, 0
    v_mov_b32 v42, 0
    v_mov_b32 v43, 0
    v_mov_b32 v44, 0
    v_mov_b32 v45, 0
    v_mov_b32 v46, 0
    v_mov_b32 v47, 0
    v_mov_b32 v48, 0
    v_mov_b32 v49, 0
    v_mov_b32 v50, 0
    v_mov_b32 v51, 0
    v_mov_b32 v52, 0
    v_mov_b32 v53, 0
    v_mov_b32 v54, 0
    v_mov_b32 v55, 0
    v_mov_b32 v56, 0
    v_mov_b32 v57, 0
    v_mov_b32 v58, 0
    v_mov_b32 v59, 0
    v_mov_b32 v60, 0
    v_mov_b32 v61, 0
    v_mov_b32 v62, 0
    v_mov_b32 v63, 0
    v_mov_b32 v64, 0
    v_mov_b32 v65, 0
    v_mov_b32 v66, 0
    v_mov_b32 v67, 0
    v_mov_b32 v68, 0
    v_mov_b32 v69, 0
    v_mov_b32 v70, 0
    v_mov_b32 v71, 0
    v_mov_b32 v72, 0
    v_mov_b32 v73, 0
    v_mov_b32 v74, 0
    v_mov_b32 v75, 0
    v_mov_b32 v76, 0
    v_mov_b32 v77, 0
    v_mov_b32 v78, 0
    v_mov_b32 v79, 0
    v_mov_b32 v80, 0
    v_mov_b32 v81, 0
    v_mov_b32 v82, 0
    v_mov_b32 v83, 0
    v_mov_b32 v84, 0
    v_mov_b32 v85, 0
    v_mov_b32 v86, 0
    v_mov_b32 v87, 0
    v_mov_b32 v88, 0
    v_mov_b32 v89, 0
    v_mov_b32 v90, 0
    v_mov_b32 v91, 0
    v_mov_b32 v92, 0
    v_mov_b32 v93, 0
    v_mov_b32 v94, 0
    v_mov_b32 v95, 0
    v_mov_b32 v96, 0
    v_mov_b32 v97, 0
    v_mov_b32 v98, 0
    v_mov_b32 v99, 0
    v_mov_b32 v132, 0
    v_mov_b32 v133, 0
    v_mov_b32 v134, 0
    v_mov_b32 v135, 0
    v_mov_b32 v136, 0
    v_mov_b32 v137, 0
    v_mov_b32 v138, 0
    v_mov_b32 v139, 0
    v_mov_b32 v140, 0
    v_mov_b32 v141, 0
    v_mov_b32 v142, 0
    v_mov_b32 v143, 0
    v_mov_b32 v144, 0
    v_mov_b32 v145, 0
    v_mov_b32 v146, 0
    v_mov_b32 v147, 0
    v_mov_b32 v228, 0
    v_mov_b32 v229, 0
    v_mov_b32 v230, 0
    v_mov_b32 v231, 0
    v_mov_b32 v232, 0
    v_mov_b32 v233, 0
    v_mov_b32 v234, 0
    v_mov_b32 v235, 0
    s_lshl_b32 s40, s29, 19
    s_mov_b32 s31, 0
L_k2_exact_loop:
    s_add_u32 s41, s40, 0
    s_add_u32 s7, s40, 4096
    buffer_load_dwordx4 v[196:199], v243, s[8:11], s41 offen offset:0 sc1
    buffer_load_dwordx4 v[200:203], v243, s[8:11], s41 offen offset:1024 sc1
    buffer_load_dwordx4 v[204:207], v243, s[8:11], s41 offen offset:2048 sc1
    buffer_load_dwordx4 v[208:211], v243, s[8:11], s41 offen offset:3072 sc1
    buffer_load_dwordx4 v[212:215], v243, s[8:11], s7 offen offset:0 sc1
    buffer_load_dwordx4 v[216:219], v243, s[8:11], s7 offen offset:1024 sc1
    buffer_load_dwordx4 v[220:223], v243, s[8:11], s7 offen offset:2048 sc1
    buffer_load_dwordx4 v[224:227], v243, s[8:11], s7 offen offset:3072 sc1
    s_cmp_lg_u32 s31, s46
    s_cbranch_scc1 L_k2_exact_nm
    v_cmp_gt_i32 s[52:53], 0, v244
    v_cmp_gt_i32 s[54:55], 1, v244
    v_cmp_gt_i32 s[56:57], 2, v244
    v_cndmask_b32 v132, v132, v245, s[52:53]
    v_cndmask_b32 v133, v133, v245, s[54:55]
    v_cndmask_b32 v134, v134, v245, s[56:57]
    v_cmp_gt_i32 s[52:53], 3, v244
    v_cmp_gt_i32 s[54:55], 16, v244
    v_cmp_gt_i32 s[56:57], 17, v244
    v_cndmask_b32 v135, v135, v245, s[52:53]
    v_cndmask_b32 v136, v136, v245, s[54:55]
    v_cndmask_b32 v137, v137, v245, s[56:57]
    v_cmp_gt_i32 s[52:53], 18, v244
    v_cmp_gt_i32 s[54:55], 19, v244
    v_cmp_gt_i32 s[56:57], 0, v244
    v_cndmask_b32 v138, v138, v245, s[52:53]
    v_cndmask_b32 v139, v139, v245, s[54:55]
    v_cndmask_b32 v144, v144, v245, s[56:57]
    v_cmp_gt_i32 s[52:53], 1, v244
    v_cmp_gt_i32 s[54:55], 2, v244
    v_cmp_gt_i32 s[56:57], 3, v244
    v_cndmask_b32 v145, v145, v245, s[52:53]
    v_cndmask_b32 v146, v146, v245, s[54:55]
    v_cndmask_b32 v147, v147, v245, s[56:57]
    s_nop 1
L_k2_exact_nm:
    s_waitcnt vmcnt(0)
    v_mfma_f32_16x16x32_bf16 v[100:103], v[196:199], v[4:7], v[132:135]
    v_mfma_f32_16x16x32_bf16 v[108:111], v[196:199], v[8:11], v[140:143]
    v_mfma_f32_16x16x32_bf16 v[104:107], v[200:203], v[4:7], v[136:139]
    v_mfma_f32_16x16x32_bf16 v[112:115], v[200:203], v[8:11], v[144:147]
    v_mfma_f32_16x16x32_bf16 v[100:103], v[204:207], v[12:15], v[100:103]
    v_mfma_f32_16x16x32_bf16 v[108:111], v[204:207], v[16:19], v[108:111]
    v_mfma_f32_16x16x32_bf16 v[104:107], v[208:211], v[12:15], v[104:107]
    v_mfma_f32_16x16x32_bf16 v[112:115], v[208:211], v[16:19], v[112:115]
    v_mfma_f32_16x16x32_bf16 v[100:103], v[212:215], v[20:23], v[100:103]
    v_mfma_f32_16x16x32_bf16 v[108:111], v[212:215], v[24:27], v[108:111]
    v_mfma_f32_16x16x32_bf16 v[104:107], v[216:219], v[20:23], v[104:107]
    v_mfma_f32_16x16x32_bf16 v[112:115], v[216:219], v[24:27], v[112:115]
    v_mfma_f32_16x16x32_bf16 v[100:103], v[220:223], v[28:31], v[100:103]
    v_mfma_f32_16x16x32_bf16 v[108:111], v[220:223], v[32:35], v[108:111]
    v_mfma_f32_16x16x32_bf16 v[104:107], v[224:227], v[28:31], v[104:107]
    v_mfma_f32_16x16x32_bf16 v[112:115], v[224:227], v[32:35], v[112:115]
    s_nop 7
    s_add_u32 s41, s40, 16777216
    s_add_u32 s7, s40, 16781312
    buffer_load_dwordx4 v[196:199], v243, s[8:11], s41 offen offset:0 sc1
    buffer_load_dwordx4 v[200:203], v243, s[8:11], s41 offen offset:1024 sc1
    buffer_load_dwordx4 v[204:207], v243, s[8:11], s41 offen offset:2048 sc1
    buffer_load_dwordx4 v[208:211], v243, s[8:11], s41 offen offset:3072 sc1
    buffer_load_dwordx4 v[212:215], v243, s[8:11], s7 offen offset:0 sc1
    buffer_load_dwordx4 v[216:219], v243, s[8:11], s7 offen offset:1024 sc1
    buffer_load_dwordx4 v[220:223], v243, s[8:11], s7 offen offset:2048 sc1
    buffer_load_dwordx4 v[224:227], v243, s[8:11], s7 offen offset:3072 sc1
    s_cmp_eq_u32 s31, 0
    s_cbranch_scc1 L_k2_exact_i
    s_nop 7
    v_max3_f32 v248, v100, v101, v102
    v_max3_f32 v248, v248, v103, v104
    v_max3_f32 v248, v248, v105, v106
    v_max_f32 v248, v248, v107
    v_max3_f32 v249, v108, v109, v110
    v_max3_f32 v249, v249, v111, v112
    v_max3_f32 v249, v249, v113, v114
    v_max_f32 v249, v249, v115
    v_mov_b32 v250, v248
    v_mov_b32 v251, v249
    s_nop 1
    v_permlane16_swap_b32 v248, v250
    v_permlane16_swap_b32 v249, v251
    s_nop 1
    v_max_f32 v248, v248, v250
    v_max_f32 v249, v249, v251
    v_mov_b32 v250, v248
    v_mov_b32 v251, v249
    s_nop 1
    v_permlane32_swap_b32 v248, v250
    v_permlane32_swap_b32 v249, v251
    s_nop 1
    v_max_f32 v248, v248, v250
    v_max_f32 v249, v249, v251
    v_max_f32 v248, 0, v248
    v_max_f32 v249, 0, v249
    v_exp_f32 v250, -v248
    v_exp_f32 v251, -v249
    s_nop 0
    v_mul_f32 v36, v36, v250
    v_mul_f32 v37, v37, v250
    v_mul_f32 v38, v38, v250
    v_mul_f32 v39, v39, v250
    v_mul_f32 v40, v40, v250
    v_mul_f32 v41, v41, v250
    v_mul_f32 v42, v42, v250
    v_mul_f32 v43, v43, v250
    v_mul_f32 v44, v44, v251
    v_mul_f32 v45, v45, v251
    v_mul_f32 v46, v46, v251
    v_mul_f32 v47, v47, v251
    v_mul_f32 v48, v48, v251
    v_mul_f32 v49, v49, v251
    v_mul_f32 v50, v50, v251
    v_mul_f32 v51, v51, v251
    v_mul_f32 v52, v52, v250
    v_mul_f32 v53, v53, v250
    v_mul_f32 v54, v54, v250
    v_mul_f32 v55, v55, v250
    v_mul_f32 v56, v56, v250
    v_mul_f32 v57, v57, v250
    v_mul_f32 v58, v58, v250
    v_mul_f32 v59, v59, v250
    v_mul_f32 v60, v60, v251
    v_mul_f32 v61, v61, v251
    v_mul_f32 v62, v62, v251
    v_mul_f32 v63, v63, v251
    v_mul_f32 v64, v64, v251
    v_mul_f32 v65, v65, v251
    v_mul_f32 v66, v66, v251
    v_mul_f32 v67, v67, v251
    v_mul_f32 v68, v68, v250
    v_mul_f32 v69, v69, v250
    v_mul_f32 v70, v70, v250
    v_mul_f32 v71, v71, v250
    v_mul_f32 v72, v72, v250
    v_mul_f32 v73, v73, v250
    v_mul_f32 v74, v74, v250
    v_mul_f32 v75, v75, v250
    v_mul_f32 v76, v76, v251
    v_mul_f32 v77, v77, v251
    v_mul_f32 v78, v78, v251
    v_mul_f32 v79, v79, v251
    v_mul_f32 v80, v80, v251
    v_mul_f32 v81, v81, v251
    v_mul_f32 v82, v82, v251
    v_mul_f32 v83, v83, v251
    v_mul_f32 v84, v84, v250
    v_mul_f32 v85, v85, v250
    v_mul_f32 v86, v86, v250
    v_mul_f32 v87, v87, v250
    v_mul_f32 v88, v88, v250
    v_mul_f32 v89, v89, v250
    v_mul_f32 v90, v90, v250
    v_mul_f32 v91, v91, v250
    v_mul_f32 v92, v92, v251
    v_mul_f32 v93, v93, v251
    v_mul_f32 v94, v94, v251
    v_mul_f32 v95, v95, v251
    v_mul_f32 v96, v96, v251
    v_mul_f32 v97, v97, v251
    v_mul_f32 v98, v98, v251
    v_mul_f32 v99, v99, v251
    v_mul_f32 v228, v228, v250
    v_mul_f32 v229, v229, v250
    v_mul_f32 v230, v230, v250
    v_mul_f32 v231, v231, v250
    v_mul_f32 v232, v232, v251
    v_mul_f32 v233, v233, v251
    v_mul_f32 v234, v234, v251
    v_mul_f32 v235, v235, v251
    v_sub_f32 v132, v132, v248
    v_sub_f32 v133, v133, v248
    v_sub_f32 v134, v134, v248
    v_sub_f32 v135, v135, v248
    v_sub_f32 v136, v136, v248
    v_sub_f32 v137, v137, v248
    v_sub_f32 v138, v138, v248
    v_sub_f32 v139, v139, v248
    v_sub_f32 v140, v140, v249
    v_sub_f32 v141, v141, v249
    v_sub_f32 v142, v142, v249
    v_sub_f32 v143, v143, v249
    v_sub_f32 v144, v144, v249
    v_sub_f32 v145, v145, v249
    v_sub_f32 v146, v146, v249
    v_sub_f32 v147, v147, v249
    v_sub_f32 v100, v100, v248
    v_sub_f32 v101, v101, v248
    v_sub_f32 v102, v102, v248
    v_sub_f32 v103, v103, v248
    v_sub_f32 v104, v104, v248
    v_sub_f32 v105, v105, v248
    v_sub_f32 v106, v106, v248
    v_sub_f32 v107, v107, v248
    v_sub_f32 v108, v108, v249
    v_sub_f32 v109, v109, v249
    v_sub_f32 v110, v110, v249
    v_sub_f32 v111, v111, v249
    v_sub_f32 v112, v112, v249
    v_sub_f32 v113, v113, v249
    v_sub_f32 v114, v114, v249
    v_sub_f32 v115, v115, v249
    s_branch L_k2_exact_j
L_k2_exact_i:
    s_nop 7
    v_max3_f32 v248, v100, v101, v102
    v_max3_f32 v248, v248, v103, v104
    v_max3_f32 v248, v248, v105, v106
    v_max_f32 v248, v248, v107
    v_max3_f32 v249, v108, v109, v110
    v_max3_f32 v249, v249, v111, v112
    v_max3_f32 v249, v249, v113, v114
    v_max_f32 v249, v249, v115
    v_mov_b32 v250, v248
    v_mov_b32 v251, v249
    s_nop 1
    v_permlane16_swap_b32 v248, v250
    v_permlane16_swap_b32 v249, v251
    s_nop 1
    v_max_f32 v248, v248, v250
    v_max_f32 v249, v249, v251
    v_mov_b32 v250, v248
    v_mov_b32 v251, v249
    s_nop 1
    v_permlane32_swap_b32 v248, v250
    v_permlane32_swap_b32 v249, v251
    s_nop 1
    v_max_f32 v248, v248, v250
    v_max_f32 v249, v249, v251
    v_sub_f32 v132, v132, v248
    v_sub_f32 v133, v133, v248
    v_sub_f32 v134, v134, v248
    v_sub_f32 v135, v135, v248
    v_sub_f32 v136, v136, v248
    v_sub_f32 v137, v137, v248
    v_sub_f32 v138, v138, v248
    v_sub_f32 v139, v139, v248
    v_sub_f32 v140, v140, v249
    v_sub_f32 v141, v141, v249
    v_sub_f32 v142, v142, v249
    v_sub_f32 v143, v143, v249
    v_sub_f32 v144, v144, v249
    v_sub_f32 v145, v145, v249
    v_sub_f32 v146, v146, v249
    v_sub_f32 v147, v147, v249
    v_sub_f32 v100, v100, v248
    v_sub_f32 v101, v101, v248
    v_sub_f32 v102, v102, v248
    v_sub_f32 v103, v103, v248
    v_sub_f32 v104, v104, v248
    v_sub_f32 v105, v105, v248
    v_sub_f32 v106, v106, v248
    v_sub_f32 v107, v107, v248
    v_sub_f32 v108, v108, v249
    v_sub_f32 v109, v109, v249
    v_sub_f32 v110, v110, v249
    v_sub_f32 v111, v111, v249
    v_sub_f32 v112, v112, v249
    v_sub_f32 v113, v113, v249
    v_sub_f32 v114, v114, v249
    v_sub_f32 v115, v115, v249
L_k2_exact_j:
    v_exp_f32 v100, v100
    v_exp_f32 v101, v101
    v_exp_f32 v102, v102
    v_exp_f32 v103, v103
    v_exp_f32 v104, v104
    v_exp_f32 v105, v105
    v_exp_f32 v106, v106
    v_exp_f32 v107, v107
    v_exp_f32 v108, v108
    v_exp_f32 v109, v109
    v_exp_f32 v110, v110
    v_exp_f32 v111, v111
    v_exp_f32 v112, v112
    v_exp_f32 v113, v113
    v_exp_f32 v114, v114
    v_exp_f32 v115, v115
    v_cvt_pk_bf16_f32 v148, v100, v101
    v_cvt_pk_bf16_f32 v149, v102, v103
    v_cvt_pk_bf16_f32 v150, v104, v105
    v_cvt_pk_bf16_f32 v151, v106, v107
    v_cvt_pk_bf16_f32 v152, v108, v109
    v_cvt_pk_bf16_f32 v153, v110, v111
    v_cvt_pk_bf16_f32 v154, v112, v113
    v_cvt_pk_bf16_f32 v155, v114, v115
    s_waitcnt vmcnt(0)
    s_nop 1
    v_mfma_f32_16x16x32_bf16 v[36:39], v[196:199], v[148:151], v[36:39]
    v_mfma_f32_16x16x32_bf16 v[44:47], v[196:199], v[152:155], v[44:47]
    v_mfma_f32_16x16x32_bf16 v[40:43], v[200:203], v[148:151], v[40:43]
    v_mfma_f32_16x16x32_bf16 v[48:51], v[200:203], v[152:155], v[48:51]
    v_mfma_f32_16x16x32_bf16 v[52:55], v[204:207], v[148:151], v[52:55]
    v_mfma_f32_16x16x32_bf16 v[60:63], v[204:207], v[152:155], v[60:63]
    v_mfma_f32_16x16x32_bf16 v[56:59], v[208:211], v[148:151], v[56:59]
    v_mfma_f32_16x16x32_bf16 v[64:67], v[208:211], v[152:155], v[64:67]
    v_mfma_f32_16x16x32_bf16 v[68:71], v[212:215], v[148:151], v[68:71]
    v_mfma_f32_16x16x32_bf16 v[76:79], v[212:215], v[152:155], v[76:79]
    v_mfma_f32_16x16x32_bf16 v[72:75], v[216:219], v[148:151], v[72:75]
    v_mfma_f32_16x16x32_bf16 v[80:83], v[216:219], v[152:155], v[80:83]
    v_mfma_f32_16x16x32_bf16 v[84:87], v[220:223], v[148:151], v[84:87]
    v_mfma_f32_16x16x32_bf16 v[92:95], v[220:223], v[152:155], v[92:95]
    v_mfma_f32_16x16x32_bf16 v[88:91], v[224:227], v[148:151], v[88:91]
    v_mfma_f32_16x16x32_bf16 v[96:99], v[224:227], v[152:155], v[96:99]
    v_mfma_f32_16x16x32_bf16 v[228:231], v[236:239], v[148:151], v[228:231]
    v_mfma_f32_16x16x32_bf16 v[232:235], v[236:239], v[152:155], v[232:235]
    s_nop 7
    s_add_u32 s40, s40, 8192
    s_add_u32 s31, s31, 1
    s_cmp_le_u32 s31, s46
    s_cbranch_scc1 L_k2_exact_loop
    s_branch L_k2_exact_ret
L_k2zs_45:
    s_mov_b32 s6, 0
    s_cmp_lg_u32 s28, 7
    s_cbranch_scc1 L_k2zr_46
    s_cmp_ge_u32 s29, 28
    s_cbranch_scc1 L_k2zr_46
    s_add_u32 s52, s4, 92277760
    s_addc_u32 s53, s5, 0
    s_mov_b32 s54, 128
    s_mov_b32 s55, 0x20000
    v_mov_b32 v1, 1
    s_mov_b64 exec, 1
    buffer_atomic_add v1, v2, s[52:55], 0 offen sc1
    s_mov_b64 exec, -1
    s_branch L_k2zr_46
L_k2zs_48:
    s_mov_b32 s6, 0
    s_cmp_lg_u32 s28, 7
    s_cbranch_scc1 L_k2zr_49
    s_cmp_ge_u32 s29, 28
    s_cbranch_scc1 L_k2zr_49
    s_add_u32 s52, s4, 92277760
    s_addc_u32 s53, s5, 0
    s_mov_b32 s54, 128
    s_mov_b32 s55, 0x20000
    v_mov_b32 v1, 1
    s_mov_b64 exec, 1
    buffer_atomic_add v1, v2, s[52:55], 0 offen sc1
    s_mov_b64 exec, -1
    s_branch L_k2zr_49
L_k2zs_54:
    s_mov_b32 s6, 0
    s_cmp_lg_u32 s28, 7
    s_cbranch_scc1 L_k2zr_55
    s_cmp_ge_u32 s29, 28
    s_cbranch_scc1 L_k2zr_55
    s_add_u32 s52, s4, 92277760
    s_addc_u32 s53, s5, 0
    s_mov_b32 s54, 128
    s_mov_b32 s55, 0x20000
    v_mov_b32 v1, 1
    s_mov_b64 exec, 1
    buffer_atomic_add v1, v2, s[52:55], 0 offen sc1
    s_mov_b64 exec, -1
    s_branch L_k2zr_55
L_k2zs_57:
    s_mov_b32 s6, 0
    s_cmp_lg_u32 s28, 7
    s_cbranch_scc1 L_k2zr_58
    s_cmp_ge_u32 s29, 28
    s_cbranch_scc1 L_k2zr_58
    s_add_u32 s52, s4, 92277760
    s_addc_u32 s53, s5, 0
    s_mov_b32 s54, 128
    s_mov_b32 s55, 0x20000
    v_mov_b32 v1, 1
    s_mov_b64 exec, 1
    buffer_atomic_add v1, v2, s[52:55], 0 offen sc1
    s_mov_b64 exec, -1
    s_branch L_k2zr_58
L_k2zs_63:
    s_mov_b32 s6, 0
    s_cmp_lg_u32 s28, 7
    s_cbranch_scc1 L_k2zr_64
    s_cmp_ge_u32 s29, 28
    s_cbranch_scc1 L_k2zr_64
    s_add_u32 s52, s4, 92277760
    s_addc_u32 s53, s5, 0
    s_mov_b32 s54, 128
    s_mov_b32 s55, 0x20000
    v_mov_b32 v1, 1
    s_mov_b64 exec, 1
    buffer_atomic_add v1, v2, s[52:55], 0 offen sc1
    s_mov_b64 exec, -1
    s_branch L_k2zr_64
L_k2zs_66:
    s_mov_b32 s6, 0
    s_cmp_lg_u32 s28, 7
    s_cbranch_scc1 L_k2zr_67
    s_cmp_ge_u32 s29, 28
    s_cbranch_scc1 L_k2zr_67
    s_add_u32 s52, s4, 92277760
    s_addc_u32 s53, s5, 0
    s_mov_b32 s54, 128
    s_mov_b32 s55, 0x20000
    v_mov_b32 v1, 1
    s_mov_b64 exec, 1
    buffer_atomic_add v1, v2, s[52:55], 0 offen sc1
    s_mov_b64 exec, -1
    s_branch L_k2zr_67
L_k2zs_72:
    s_mov_b32 s6, 0
    s_cmp_lg_u32 s28, 7
    s_cbranch_scc1 L_k2zr_73
    s_cmp_ge_u32 s29, 28
    s_cbranch_scc1 L_k2zr_73
    s_add_u32 s52, s4, 92277760
    s_addc_u32 s53, s5, 0
    s_mov_b32 s54, 128
    s_mov_b32 s55, 0x20000
    v_mov_b32 v1, 1
    s_mov_b64 exec, 1
    buffer_atomic_add v1, v2, s[52:55], 0 offen sc1
    s_mov_b64 exec, -1
    s_branch L_k2zr_73
L_k2zs_75:
    s_mov_b32 s6, 0
    s_cmp_lg_u32 s28, 7
    s_cbranch_scc1 L_k2zr_76
    s_cmp_ge_u32 s29, 28
    s_cbranch_scc1 L_k2zr_76
    s_add_u32 s52, s4, 92277760
    s_addc_u32 s53, s5, 0
    s_mov_b32 s54, 128
    s_mov_b32 s55, 0x20000
    v_mov_b32 v1, 1
    s_mov_b64 exec, 1
    buffer_atomic_add v1, v2, s[52:55], 0 offen sc1
    s_mov_b64 exec, -1
    s_branch L_k2zr_76
L_k2zs_81:
    s_mov_b32 s6, 0
    s_cmp_lg_u32 s28, 7
    s_cbranch_scc1 L_k2zr_82
    s_cmp_ge_u32 s29, 28
    s_cbranch_scc1 L_k2zr_82
    s_add_u32 s52, s4, 92277760
    s_addc_u32 s53, s5, 0
    s_mov_b32 s54, 128
    s_mov_b32 s55, 0x20000
    v_mov_b32 v1, 1
    s_mov_b64 exec, 1
    buffer_atomic_add v1, v2, s[52:55], 0 offen sc1
    s_mov_b64 exec, -1
    s_branch L_k2zr_82
L_k2zs_84:
    s_mov_b32 s6, 0
    s_cmp_lg_u32 s28, 7
    s_cbranch_scc1 L_k2zr_85
    s_cmp_ge_u32 s29, 28
    s_cbranch_scc1 L_k2zr_85
    s_add_u32 s52, s4, 92277760
    s_addc_u32 s53, s5, 0
    s_mov_b32 s54, 128
    s_mov_b32 s55, 0x20000
    v_mov_b32 v1, 1
    s_mov_b64 exec, 1
    buffer_atomic_add v1, v2, s[52:55], 0 offen sc1
    s_mov_b64 exec, -1
    s_branch L_k2zr_85
L_k2zs_87:
    s_mov_b32 s6, 0
    s_cmp_lg_u32 s28, 7
    s_cbranch_scc1 L_k2zr_88
    s_cmp_ge_u32 s29, 28
    s_cbranch_scc1 L_k2zr_88
    s_add_u32 s52, s4, 92277760
    s_addc_u32 s53, s5, 0
    s_mov_b32 s54, 128
    s_mov_b32 s55, 0x20000
    v_mov_b32 v1, 1
    s_mov_b64 exec, 1
    buffer_atomic_add v1, v2, s[52:55], 0 offen sc1
    s_mov_b64 exec, -1
    s_branch L_k2zr_88
L_k3_entry:
    s_load_dwordx2 s[4:5], s[0:1], 104
    s_load_dwordx2 s[6:7], s[0:1], 40
    s_load_dwordx4 s[8:11], s[0:1], 64
    s_load_dwordx4 s[12:15], s[0:1], 80
    s_load_dwordx2 s[16:17], s[0:1], 0
    v_lshrrev_b32 v168, 6, v0
    v_and_b32 v163, 63, v0
    v_readfirstlane_b32 s40, v168
    v_lshlrev_b32 v162, 4, v163
    s_and_b32 s53, s2, 7
    s_lshr_b32 s54, s2, 3
    s_lshr_b32 s41, s40, 2
    s_and_b32 s42, s40, 1
    s_bfe_u32 s43, s40, 0x10001
    s_lshl_b32 s50, s40, 12
    s_cmp_lt_u32 s53, 4
    s_cbranch_scc1 L_k3_O
    s_cmp_lt_u32 s54, 4
    s_cbranch_scc1 L_k3_O
    s_sub_u32 s54, s54, 4
L_k3_S:
    s_mul_i32 s44, s54, 37
    s_lshr_b32 s44, s44, 8
    s_mul_i32 s45, s44, 7
    s_sub_u32 s45, s54, s45
    s_sub_u32 s53, s53, 4
    s_lshl_b32 s53, s53, 2
    s_add_u32 s44, s44, s53
    s_lshl_b32 s47, s44, 19
    s_lshl_b32 s48, s45, 8
    v_lshrrev_b32 v168, 3, v163
    s_lshl_b32 s53, s40, 4
    v_add_u32 v168, s53, v168
    v_lshlrev_b32 v168, 12, v168
    v_lshrrev_b32 v169, 4, v163
    v_and_b32 v170, 7, v163
    v_xor_b32 v169, v169, v170
    v_lshl_add_u32 v158, v169, 4, v168
    v_xor_b32 v159, 64, v158
    v_add_u32 v159, 31744, v159
    v_lshrrev_b32 v168, 4, v163
    v_lshlrev_b32 v169, 2, v168
    v_and_b32 v170, 15, v163
    v_xor_b32 v169, v169, v170
    s_lshl_b32 s53, s40, 3
    v_add_u32 v168, s53, v168
    v_mul_u32_u24 v168, 1792, v168
    v_lshl_add_u32 v160, v169, 4, v168
    s_lshl_b32 s53, s42, 4
    v_xor_b32 v160, s53, v160
    v_add_u32 v161, 6144, v160
    s_waitcnt lgkmcnt(0)
    s_mov_b32 s20, s8
    s_mov_b32 s21, s9
    s_mov_b32 s22, 8388608
    s_mov_b32 s23, 0x20000
    s_add_u32 s24, s4, 75495424
    s_addc_u32 s25, s5, 0
    s_mov_b32 s26, 3672064
    s_mov_b32 s27, 0x20000
    s_waitcnt vmcnt(0)
    s_cmp_lg_u32 s40, 7
    s_cbranch_scc1 L_k3_dep_okS
    s_add_u32 s32, s4, 92274688
    s_addc_u32 s33, s5, 0
    s_mov_b32 s34, 24576
    s_mov_b32 s35, 0x20000
    v_and_b32 v174, 7, v163
    v_lshlrev_b32 v174, 7, v174
    s_mov_b32 s53, 6144
    s_mov_b32 s51, 0x200000
L_k3_depS:
    buffer_load_dword v175, v174, s[32:35], s53 offen sc0 sc1
    s_waitcnt vmcnt(0)
    v_cmp_gt_u32 vcc, 64, v175
    s_cbranch_vccz L_k3_dep_okS
    s_sleep 1
    s_sub_u32 s51, s51, 1
    s_cmp_lg_u32 s51, 0
    s_cbranch_scc1 L_k3_depS
L_k3_dep_okS:
    s_barrier
    s_add_u32 m0, s50, 0
    s_nop 0
    buffer_load_dwordx4 v158, s[20:23], s47 offen lds
    buffer_load_dwordx4 v159, s[20:23], s47 offen offset:1024 lds
    s_add_u32 s47, s47, 128
    buffer_load_dwordx4 v160, s[24:27], s48 offen offset:2048 sc1 lds
    buffer_load_dwordx4 v161, s[24:27], s48 offen offset:3072 sc1 lds
    s_add_u32 s48, s48, 114688
    v_and_b32 v169, 15, v163
    v_lshlrev_b32 v169, 7, v169
    v_bfe_u32 v170, v163, 1, 3
    v_lshrrev_b32 v171, 4, v163
    s_lshl_b32 s53, s41, 2
    v_add_u32 v171, s53, v171
    v_xor_b32 v170, v170, v171
    v_lshl_add_u32 v169, v170, 4, v169
    s_lshl_b32 s53, s42, 14
    v_add_u32 v148, s53, v169
    s_add_u32 m0, s50, 32768
    s_nop 0
    buffer_load_dwordx4 v158, s[20:23], s47 offen lds
    buffer_load_dwordx4 v159, s[20:23], s47 offen offset:1024 lds
    s_add_u32 s47, s47, 128
    buffer_load_dwordx4 v160, s[24:27], s48 offen offset:2048 sc1 lds
    buffer_load_dwordx4 v161, s[24:27], s48 offen offset:3072 sc1 lds
    s_add_u32 s48, s48, 114688
    v_bfe_u32 v168, v163, 2, 2
    v_lshlrev_b32 v169, 8, v168
    s_lshl_b32 s53, s43, 1
    v_xor_b32 v168, s53, v168
    v_lshl_add_u32 v169, v168, 6, v169
    v_bfe_u32 v168, v163, 1, 1
    v_lshl_add_u32 v169, v168, 5, v169
    v_and_b32 v168, 1, v163
    v_lshl_add_u32 v169, v168, 3, v169
    v_bfe_u32 v168, v163, 4, 1
    v_lshl_add_u32 v169, v168, 4, v169
    v_lshl_add_u32 v169, v168, 12, v169
    v_lshrrev_b32 v168, 5, v163
    v_lshl_add_u32 v169, v168, 13, v169
    s_lshl_b32 s53, s41, 14
    s_add_u32 s53, s53, 2048
    v_add_u32 v150, s53, v169
    v_xor_b32 v151, 16, v150
    v_xor_b32 v152, 64, v150
    v_xor_b32 v153, 80, v150
    v_add_u32 v149, 0x10000, v148
    v_add_u32 v154, 0x10000, v150
    v_add_u32 v155, 0x10000, v151
    v_add_u32 v156, 0x10000, v152
    v_add_u32 v157, 0x10000, v153
    s_add_u32 m0, s50, 65536
    s_nop 0
    buffer_load_dwordx4 v158, s[20:23], s47 offen lds
    buffer_load_dwordx4 v159, s[20:23], s47 offen offset:1024 lds
    s_add_u32 s47, s47, 128
    buffer_load_dwordx4 v160, s[24:27], s48 offen offset:2048 sc1 lds
    buffer_load_dwordx4 v161, s[24:27], s48 offen offset:3072 sc1 lds
    s_add_u32 s48, s48, 114688
    v_and_b32 v168, 15, v163
    v_lshlrev_b32 v166, 4, v168
    v_lshrrev_b32 v169, 4, v163
    v_lshl_add_u32 v166, v169, 9, v166
    s_and_b32 s18, s2, 7
    s_lshl_b32 s18, s18, 2
    s_bfe_u32 s53, s2, 0x20003
    s_add_u32 s18, s18, s53
    s_lshr_b32 s19, s2, 5
    s_mov_b32 s96, s12
    s_mov_b32 s97, s13
    s_mov_b32 s98, 917504
    s_mov_b32 s99, 0x20000
    v_lshrrev_b32 v170, 3, v163
    v_lshlrev_b32 v170, 10, v170
    v_bfe_u32 v171, v163, 4, 1
    v_lshlrev_b32 v171, 2, v171
    v_and_b32 v172, 7, v163
    v_xor_b32 v171, v171, v172
    v_lshl_add_u32 v176, v171, 4, v170
    v_add_u32 v177, 7168, v176
    v_add_u32 v178, 14336, v176
    v_add_u32 v179, 21504, v176
    s_lshl_b32 s55, s40, 15
    s_lshl_b32 s53, s19, 7
    s_add_u32 s55, s55, s53
    s_lshl_b32 s57, s44, 2
    s_lshl_b32 s53, s42, 1
    s_add_u32 s57, s57, s53
    s_add_u32 s57, s57, s41
    s_add_u32 s28, s4, 104857600
    s_addc_u32 s29, s5, 0
    s_mov_b32 s30, 3670016
    s_mov_b32 s31, 0x20000
    s_add_u32 s32, s4, 67108864
    s_addc_u32 s33, s5, 0
    s_mov_b32 s34, 7340032
    s_mov_b32 s35, 0x20000
    s_mov_b32 s36, s10
    s_mov_b32 s37, s11
    s_mov_b32 s38, 4096
    s_mov_b32 s39, 0x20000
    s_lshl_b32 s53, s45, 2
    s_lshl_b32 s54, s43, 1
    s_add_u32 s53, s53, s54
    s_lshl_b32 s53, s53, 11
    s_mul_i32 s58, s57, 57344
    s_add_u32 s58, s58, s53
    s_mul_i32 s46, s57, 114688
    s_add_u32 s46, s46, s53
    v_and_b32 v252, 15, v163
    v_lshlrev_b32 v252, 1, v252
    s_lshl_b32 s57, s57, 6
    v_mov_b32 v4, 0
    v_mov_b32 v5, 0
    v_mov_b32 v6, 0
    v_mov_b32 v7, 0
    v_mov_b32 v8, 0
    v_mov_b32 v9, 0
    v_mov_b32 v10, 0
    v_mov_b32 v11, 0
    v_mov_b32 v12, 0
    v_mov_b32 v13, 0
    v_mov_b32 v14, 0
    v_mov_b32 v15, 0
    v_mov_b32 v16, 0
    v_mov_b32 v17, 0
    v_mov_b32 v18, 0
    v_mov_b32 v19, 0
    v_mov_b32 v20, 0
    v_mov_b32 v21, 0
    v_mov_b32 v22, 0
    v_mov_b32 v23, 0
    v_mov_b32 v24, 0
    v_mov_b32 v25, 0
    v_mov_b32 v26, 0
    v_mov_b32 v27, 0
    v_mov_b32 v28, 0
    v_mov_b32 v29, 0
    v_mov_b32 v30, 0
    v_mov_b32 v31, 0
    v_mov_b32 v32, 0
    v_mov_b32 v33, 0
    v_mov_b32 v34, 0
    v_mov_b32 v35, 0
    v_mov_b32 v36, 0
    v_mov_b32 v37, 0
    v_mov_b32 v38, 0
    v_mov_b32 v39, 0
    v_mov_b32 v40, 0
    v_mov_b32 v41, 0
    v_mov_b32 v42, 0
    v_mov_b32 v43, 0
    v_mov_b32 v44, 0
    v_mov_b32 v45, 0
    v_mov_b32 v46, 0
    v_mov_b32 v47, 0
    v_mov_b32 v48, 0
    v_mov_b32 v49, 0
    v_mov_b32 v50, 0
    v_mov_b32 v51, 0
    v_mov_b32 v52, 0
    v_mov_b32 v53, 0
    v_mov_b32 v54, 0
    v_mov_b32 v55, 0
    v_mov_b32 v56, 0
    v_mov_b32 v57, 0
    v_mov_b32 v58, 0
    v_mov_b32 v59, 0
    v_mov_b32 v60, 0
    v_mov_b32 v61, 0
    v_mov_b32 v62, 0
    v_mov_b32 v63, 0
    v_mov_b32 v64, 0
    v_mov_b32 v65, 0
    v_mov_b32 v66, 0
    v_mov_b32 v67, 0
    s_add_u32 m0, s50, 98304
    s_nop 0
    buffer_load_dwordx4 v158, s[20:23], s47 offen lds
    buffer_load_dwordx4 v159, s[20:23], s47 offen offset:1024 lds
    s_add_u32 s47, s47, 128
    buffer_load_dwordx4 v160, s[24:27], s48 offen offset:2048 sc1 lds
    buffer_load_dwordx4 v161, s[24:27], s48 offen offset:3072 sc1 lds
    s_add_u32 s48, s48, 114688
    s_waitcnt vmcnt(12)
    s_barrier
    ds_read_b128 v[68:71], v148 offset:0
    ds_read_b64_tr_b16 v[84:85], v150 offset:0
    ds_read_b64_tr_b16 v[86:87], v150 offset:1024
    ds_read_b64_tr_b16 v[88:89], v151 offset:0
    ds_read_b64_tr_b16 v[90:91], v151 offset:1024
    ds_read_b128 v[72:75], v148 offset:4096
    ds_read_b64_tr_b16 v[92:93], v152 offset:0
    ds_read_b64_tr_b16 v[94:95], v152 offset:1024
    ds_read_b64_tr_b16 v[96:97], v153 offset:0
    ds_read_b64_tr_b16 v[98:99], v153 offset:1024
    ds_read_b128 v[76:79], v148 offset:8192
    ds_read_b128 v[80:83], v148 offset:12288
    s_mov_b32 s51, 0
L_k3_S_loop:
    s_waitcnt vmcnt(8) lgkmcnt(0)
    s_barrier
    v_mfma_f32_16x16x32_bf16 v[4:7], v[84:87], v[68:71], v[4:7]
    ds_read_b128 v[100:103], v148 offset:32768
    s_add_u32 m0, s50, 0
    s_nop 0
    buffer_load_dwordx4 v158, s[20:23], s47 offen lds
    v_mfma_f32_16x16x32_bf16 v[8:11], v[88:91], v[68:71], v[8:11]
    ds_read_b64_tr_b16 v[116:117], v150 offset:32768
    v_mfma_f32_16x16x32_bf16 v[12:15], v[84:87], v[72:75], v[12:15]
    ds_read_b64_tr_b16 v[118:119], v150 offset:33792
    v_mfma_f32_16x16x32_bf16 v[16:19], v[88:91], v[72:75], v[16:19]
    ds_read_b64_tr_b16 v[120:121], v151 offset:32768
    buffer_load_dwordx4 v159, s[20:23], s47 offen offset:1024 lds
    s_add_u32 s47, s47, 128
    v_mfma_f32_16x16x32_bf16 v[20:23], v[92:95], v[68:71], v[20:23]
    ds_read_b64_tr_b16 v[122:123], v151 offset:33792
    v_mfma_f32_16x16x32_bf16 v[28:31], v[92:95], v[72:75], v[28:31]
    ds_read_b128 v[104:107], v148 offset:36864
    v_mfma_f32_16x16x32_bf16 v[24:27], v[96:99], v[68:71], v[24:27]
    ds_read_b64_tr_b16 v[124:125], v152 offset:32768
    buffer_load_dwordx4 v160, s[24:27], s48 offen offset:2048 sc1 lds
    v_mfma_f32_16x16x32_bf16 v[32:35], v[96:99], v[72:75], v[32:35]
    ds_read_b64_tr_b16 v[126:127], v152 offset:33792
    v_mfma_f32_16x16x32_bf16 v[36:39], v[84:87], v[76:79], v[36:39]
    ds_read_b64_tr_b16 v[128:129], v153 offset:32768
    v_mfma_f32_16x16x32_bf16 v[40:43], v[88:91], v[76:79], v[40:43]
    ds_read_b64_tr_b16 v[130:131], v153 offset:33792
    buffer_load_dwordx4 v161, s[24:27], s48 offen offset:3072 sc1 lds
    s_add_u32 s48, s48, 114688
    v_mfma_f32_16x16x32_bf16 v[52:55], v[92:95], v[76:79], v[52:55]
    ds_read_b128 v[108:111], v148 offset:40960
    v_mfma_f32_16x16x32_bf16 v[56:59], v[96:99], v[76:79], v[56:59]
    ds_read_b128 v[112:115], v148 offset:45056
    v_mfma_f32_16x16x32_bf16 v[44:47], v[84:87], v[80:83], v[44:47]
    v_mfma_f32_16x16x32_bf16 v[48:51], v[88:91], v[80:83], v[48:51]
    v_mfma_f32_16x16x32_bf16 v[60:63], v[92:95], v[80:83], v[60:63]
    v_mfma_f32_16x16x32_bf16 v[64:67], v[96:99], v[80:83], v[64:67]
    s_waitcnt vmcnt(8) lgkmcnt(0)
    s_barrier
    v_mfma_f32_16x16x32_bf16 v[4:7], v[116:119], v[100:103], v[4:7]
    ds_read_b128 v[68:71], v149 offset:0
    s_add_u32 m0, s50, 32768
    s_nop 0
    buffer_load_dwordx4 v158, s[20:23], s47 offen lds
    v_mfma_f32_16x16x32_bf16 v[8:11], v[120:123], v[100:103], v[8:11]
    ds_read_b64_tr_b16 v[84:85], v154 offset:0
    v_mfma_f32_16x16x32_bf16 v[12:15], v[116:119], v[104:107], v[12:15]
    ds_read_b64_tr_b16 v[86:87], v154 offset:1024
    v_mfma_f32_16x16x32_bf16 v[16:19], v[120:123], v[104:107], v[16:19]
    ds_read_b64_tr_b16 v[88:89], v155 offset:0
    buffer_load_dwordx4 v159, s[20:23], s47 offen offset:1024 lds
    s_add_u32 s47, s47, 128
    v_mfma_f32_16x16x32_bf16 v[20:23], v[124:127], v[100:103], v[20:23]
    ds_read_b64_tr_b16 v[90:91], v155 offset:1024
    v_mfma_f32_16x16x32_bf16 v[28:31], v[124:127], v[104:107], v[28:31]
    ds_read_b128 v[72:75], v149 offset:4096
    v_mfma_f32_16x16x32_bf16 v[24:27], v[128:131], v[100:103], v[24:27]
    ds_read_b64_tr_b16 v[92:93], v156 offset:0
    buffer_load_dwordx4 v160, s[24:27], s48 offen offset:2048 sc1 lds
    v_mfma_f32_16x16x32_bf16 v[32:35], v[128:131], v[104:107], v[32:35]
    ds_read_b64_tr_b16 v[94:95], v156 offset:1024
    v_mfma_f32_16x16x32_bf16 v[36:39], v[116:119], v[108:111], v[36:39]
    ds_read_b64_tr_b16 v[96:97], v157 offset:0
    v_mfma_f32_16x16x32_bf16 v[40:43], v[120:123], v[108:111], v[40:43]
    ds_read_b64_tr_b16 v[98:99], v157 offset:1024
    buffer_load_dwordx4 v161, s[24:27], s48 offen offset:3072 sc1 lds
    s_add_u32 s48, s48, 114688
    v_mfma_f32_16x16x32_bf16 v[52:55], v[124:127], v[108:111], v[52:55]
    ds_read_b128 v[76:79], v149 offset:8192
    v_mfma_f32_16x16x32_bf16 v[56:59], v[128:131], v[108:111], v[56:59]
    ds_read_b128 v[80:83], v149 offset:12288
    v_mfma_f32_16x16x32_bf16 v[44:47], v[116:119], v[112:115], v[44:47]
    v_mfma_f32_16x16x32_bf16 v[48:51], v[120:123], v[112:115], v[48:51]
    v_mfma_f32_16x16x32_bf16 v[60:63], v[124:127], v[112:115], v[60:63]
    v_mfma_f32_16x16x32_bf16 v[64:67], v[128:131], v[112:115], v[64:67]
    s_waitcnt vmcnt(8) lgkmcnt(0)
    s_barrier
    v_mfma_f32_16x16x32_bf16 v[4:7], v[84:87], v[68:71], v[4:7]
    ds_read_b128 v[100:103], v149 offset:32768
    s_add_u32 m0, s50, 65536
    s_nop 0
    buffer_load_dwordx4 v158, s[20:23], s47 offen lds
    v_mfma_f32_16x16x32_bf16 v[8:11], v[88:91], v[68:71], v[8:11]
    ds_read_b64_tr_b16 v[116:117], v154 offset:32768
    v_mfma_f32_16x16x32_bf16 v[12:15], v[84:87], v[72:75], v[12:15]
    ds_read_b64_tr_b16 v[118:119], v154 offset:33792
    v_mfma_f32_16x16x32_bf16 v[16:19], v[88:91], v[72:75], v[16:19]
    ds_read_b64_tr_b16 v[120:121], v155 offset:32768
    buffer_load_dwordx4 v159, s[20:23], s47 offen offset:1024 lds
    s_add_u32 s47, s47, 128
    v_mfma_f32_16x16x32_bf16 v[20:23], v[92:95], v[68:71], v[20:23]
    ds_read_b64_tr_b16 v[122:123], v155 offset:33792
    v_mfma_f32_16x16x32_bf16 v[28:31], v[92:95], v[72:75], v[28:31]
    ds_read_b128 v[104:107], v149 offset:36864
    v_mfma_f32_16x16x32_bf16 v[24:27], v[96:99], v[68:71], v[24:27]
    ds_read_b64_tr_b16 v[124:125], v156 offset:32768
    buffer_load_dwordx4 v160, s[24:27], s48 offen offset:2048 sc1 lds
    v_mfma_f32_16x16x32_bf16 v[32:35], v[96:99], v[72:75], v[32:35]
    ds_read_b64_tr_b16 v[126:127], v156 offset:33792
    v_mfma_f32_16x16x32_bf16 v[36:39], v[84:87], v[76:79], v[36:39]
    ds_read_b64_tr_b16 v[128:129], v157 offset:32768
    v_mfma_f32_16x16x32_bf16 v[40:43], v[88:91], v[76:79], v[40:43]
    ds_read_b64_tr_b16 v[130:131], v157 offset:33792
    buffer_load_dwordx4 v161, s[24:27], s48 offen offset:3072 sc1 lds
    s_add_u32 s48, s48, 114688
    v_mfma_f32_16x16x32_bf16 v[52:55], v[92:95], v[76:79], v[52:55]
    ds_read_b128 v[108:111], v149 offset:40960
    v_mfma_f32_16x16x32_bf16 v[56:59], v[96:99], v[76:79], v[56:59]
    ds_read_b128 v[112:115], v149 offset:45056
    v_mfma_f32_16x16x32_bf16 v[44:47], v[84:87], v[80:83], v[44:47]
    v_mfma_f32_16x16x32_bf16 v[48:51], v[88:91], v[80:83], v[48:51]
    v_mfma_f32_16x16x32_bf16 v[60:63], v[92:95], v[80:83], v[60:63]
    v_mfma_f32_16x16x32_bf16 v[64:67], v[96:99], v[80:83], v[64:67]
    s_waitcnt vmcnt(8) lgkmcnt(0)
    s_barrier
    v_mfma_f32_16x16x32_bf16 v[4:7], v[116:119], v[100:103], v[4:7]
    ds_read_b128 v[68:71], v148 offset:0
    s_add_u32 m0, s50, 98304
    s_nop 0
    buffer_load_dwordx4 v158, s[20:23], s47 offen lds
    v_mfma_f32_16x16x32_bf16 v[8:11], v[120:123], v[100:103], v[8:11]
    ds_read_b64_tr_b16 v[84:85], v150 offset:0
    v_mfma_f32_16x16x32_bf16 v[12:15], v[116:119], v[104:107], v[12:15]
    ds_read_b64_tr_b16 v[86:87], v150 offset:1024
    v_mfma_f32_16x16x32_bf16 v[16:19], v[120:123], v[104:107], v[16:19]
    ds_read_b64_tr_b16 v[88:89], v151 offset:0
    buffer_load_dwordx4 v159, s[20:23], s47 offen offset:1024 lds
    s_add_u32 s47, s47, 128
    v_mfma_f32_16x16x32_bf16 v[20:23], v[124:127], v[100:103], v[20:23]
    ds_read_b64_tr_b16 v[90:91], v151 offset:1024
    v_mfma_f32_16x16x32_bf16 v[28:31], v[124:127], v[104:107], v[28:31]
    ds_read_b128 v[72:75], v148 offset:4096
    v_mfma_f32_16x16x32_bf16 v[24:27], v[128:131], v[100:103], v[24:27]
    ds_read_b64_tr_b16 v[92:93], v152 offset:0
    buffer_load_dwordx4 v160, s[24:27], s48 offen offset:2048 sc1 lds
    v_mfma_f32_16x16x32_bf16 v[32:35], v[128:131], v[104:107], v[32:35]
    ds_read_b64_tr_b16 v[94:95], v152 offset:1024
    v_mfma_f32_16x16x32_bf16 v[36:39], v[116:119], v[108:111], v[36:39]
    ds_read_b64_tr_b16 v[96:97], v153 offset:0
    v_mfma_f32_16x16x32_bf16 v[40:43], v[120:123], v[108:111], v[40:43]
    ds_read_b64_tr_b16 v[98:99], v153 offset:1024
    buffer_load_dwordx4 v161, s[24:27], s48 offen offset:3072 sc1 lds
    s_add_u32 s48, s48, 114688
    v_mfma_f32_16x16x32_bf16 v[52:55], v[124:127], v[108:111], v[52:55]
    ds_read_b128 v[76:79], v148 offset:8192
    v_mfma_f32_16x16x32_bf16 v[56:59], v[128:131], v[108:111], v[56:59]
    ds_read_b128 v[80:83], v148 offset:12288
    v_mfma_f32_16x16x32_bf16 v[44:47], v[116:119], v[112:115], v[44:47]
    v_mfma_f32_16x16x32_bf16 v[48:51], v[120:123], v[112:115], v[48:51]
    v_mfma_f32_16x16x32_bf16 v[60:63], v[124:127], v[112:115], v[60:63]
    v_mfma_f32_16x16x32_bf16 v[64:67], v[128:131], v[112:115], v[64:67]
    s_add_u32 s51, s51, 1
    s_cmp_lt_u32 s51, 7
    s_cbranch_scc1 L_k3_S_loop
    buffer_load_dwordx4 v[132:135], v166, s[32:35], s46 offen offset:0 sc1
    buffer_load_dwordx4 v[136:139], v166, s[32:35], s46 offen offset:256 sc1
    buffer_load_dwordx4 v[140:143], v166, s[32:35], s46 offen offset:2048 sc1
    buffer_load_dwordx4 v[144:147], v166, s[32:35], s46 offen offset:2304 sc1
    buffer_load_ushort v164, v252, s[36:39], s57 offen
    buffer_load_ushort v165, v252, s[36:39], s57 offen offset:32
    s_waitcnt vmcnt(14) lgkmcnt(0)
    s_barrier
    v_mfma_f32_16x16x32_bf16 v[4:7], v[84:87], v[68:71], v[4:7]
    ds_read_b128 v[100:103], v148 offset:32768
    s_add_u32 m0, s50, 0
    s_add_u32 s56, s55, 0
    buffer_load_dwordx4 v176, s[96:99], s56 offen offset:0 lds
    v_mfma_f32_16x16x32_bf16 v[8:11], v[88:91], v[68:71], v[8:11]
    ds_read_b64_tr_b16 v[116:117], v150 offset:32768
    v_mfma_f32_16x16x32_bf16 v[12:15], v[84:87], v[72:75], v[12:15]
    ds_read_b64_tr_b16 v[118:119], v150 offset:33792
    v_mfma_f32_16x16x32_bf16 v[16:19], v[88:91], v[72:75], v[16:19]
    ds_read_b64_tr_b16 v[120:121], v151 offset:32768
    buffer_load_dwordx4 v177, s[96:99], s56 offen offset:1024 lds
    v_mfma_f32_16x16x32_bf16 v[20:23], v[92:95], v[68:71], v[20:23]
    ds_read_b64_tr_b16 v[122:123], v151 offset:33792
    v_mfma_f32_16x16x32_bf16 v[28:31], v[92:95], v[72:75], v[28:31]
    ds_read_b128 v[104:107], v148 offset:36864
    v_mfma_f32_16x16x32_bf16 v[24:27], v[96:99], v[68:71], v[24:27]
    ds_read_b64_tr_b16 v[124:125], v152 offset:32768
    buffer_load_dwordx4 v178, s[96:99], s56 offen offset:2048 lds
    v_mfma_f32_16x16x32_bf16 v[32:35], v[96:99], v[72:75], v[32:35]
    ds_read_b64_tr_b16 v[126:127], v152 offset:33792
    v_mfma_f32_16x16x32_bf16 v[36:39], v[84:87], v[76:79], v[36:39]
    ds_read_b64_tr_b16 v[128:129], v153 offset:32768
    v_mfma_f32_16x16x32_bf16 v[40:43], v[88:91], v[76:79], v[40:43]
    ds_read_b64_tr_b16 v[130:131], v153 offset:33792
    buffer_load_dwordx4 v179, s[96:99], s56 offen offset:3072 lds
    v_mfma_f32_16x16x32_bf16 v[52:55], v[92:95], v[76:79], v[52:55]
    ds_read_b128 v[108:111], v148 offset:40960
    v_mfma_f32_16x16x32_bf16 v[56:59], v[96:99], v[76:79], v[56:59]
    ds_read_b128 v[112:115], v148 offset:45056
    v_mfma_f32_16x16x32_bf16 v[44:47], v[84:87], v[80:83], v[44:47]
    v_mfma_f32_16x16x32_bf16 v[48:51], v[88:91], v[80:83], v[48:51]
    v_mfma_f32_16x16x32_bf16 v[60:63], v[92:95], v[80:83], v[60:63]
    v_mfma_f32_16x16x32_bf16 v[64:67], v[96:99], v[80:83], v[64:67]
    s_waitcnt vmcnt(14) lgkmcnt(0)
    s_barrier
    v_mfma_f32_16x16x32_bf16 v[4:7], v[116:119], v[100:103], v[4:7]
    ds_read_b128 v[68:71], v149 offset:0
    s_add_u32 m0, s50, 32768
    s_add_u32 s56, s55, 262144
    buffer_load_dwordx4 v176, s[96:99], s56 offen offset:0 lds
    v_mfma_f32_16x16x32_bf16 v[8:11], v[120:123], v[100:103], v[8:11]
    ds_read_b64_tr_b16 v[84:85], v154 offset:0
    v_mfma_f32_16x16x32_bf16 v[12:15], v[116:119], v[104:107], v[12:15]
    ds_read_b64_tr_b16 v[86:87], v154 offset:1024
    v_mfma_f32_16x16x32_bf16 v[16:19], v[120:123], v[104:107], v[16:19]
    ds_read_b64_tr_b16 v[88:89], v155 offset:0
    buffer_load_dwordx4 v177, s[96:99], s56 offen offset:1024 lds
    v_mfma_f32_16x16x32_bf16 v[20:23], v[124:127], v[100:103], v[20:23]
    ds_read_b64_tr_b16 v[90:91], v155 offset:1024
    v_mfma_f32_16x16x32_bf16 v[28:31], v[124:127], v[104:107], v[28:31]
    ds_read_b128 v[72:75], v149 offset:4096
    v_mfma_f32_16x16x32_bf16 v[24:27], v[128:131], v[100:103], v[24:27]
    ds_read_b64_tr_b16 v[92:93], v156 offset:0
    buffer_load_dwordx4 v178, s[96:99], s56 offen offset:2048 lds
    v_mfma_f32_16x16x32_bf16 v[32:35], v[128:131], v[104:107], v[32:35]
    ds_read_b64_tr_b16 v[94:95], v156 offset:1024
    v_mfma_f32_16x16x32_bf16 v[36:39], v[116:119], v[108:111], v[36:39]
    ds_read_b64_tr_b16 v[96:97], v157 offset:0
    v_mfma_f32_16x16x32_bf16 v[40:43], v[120:123], v[108:111], v[40:43]
    ds_read_b64_tr_b16 v[98:99], v157 offset:1024
    buffer_load_dwordx4 v179, s[96:99], s56 offen offset:3072 lds
    v_mfma_f32_16x16x32_bf16 v[52:55], v[124:127], v[108:111], v[52:55]
    ds_read_b128 v[76:79], v149 offset:8192
    v_mfma_f32_16x16x32_bf16 v[56:59], v[128:131], v[108:111], v[56:59]
    ds_read_b128 v[80:83], v149 offset:12288
    v_mfma_f32_16x16x32_bf16 v[44:47], v[116:119], v[112:115], v[44:47]
    v_mfma_f32_16x16x32_bf16 v[48:51], v[120:123], v[112:115], v[48:51]
    v_mfma_f32_16x16x32_bf16 v[60:63], v[124:127], v[112:115], v[60:63]
    v_mfma_f32_16x16x32_bf16 v[64:67], v[128:131], v[112:115], v[64:67]
    s_waitcnt vmcnt(14) lgkmcnt(0)
    s_barrier
    v_mfma_f32_16x16x32_bf16 v[4:7], v[84:87], v[68:71], v[4:7]
    ds_read_b128 v[100:103], v149 offset:32768
    s_add_u32 m0, s50, 65536
    s_add_u32 s56, s55, 524288
    buffer_load_dwordx4 v176, s[96:99], s56 offen offset:0 lds
    v_mfma_f32_16x16x32_bf16 v[8:11], v[88:91], v[68:71], v[8:11]
    ds_read_b64_tr_b16 v[116:117], v154 offset:32768
    v_mfma_f32_16x16x32_bf16 v[12:15], v[84:87], v[72:75], v[12:15]
    ds_read_b64_tr_b16 v[118:119], v154 offset:33792
    v_mfma_f32_16x16x32_bf16 v[16:19], v[88:91], v[72:75], v[16:19]
    ds_read_b64_tr_b16 v[120:121], v155 offset:32768
    buffer_load_dwordx4 v177, s[96:99], s56 offen offset:1024 lds
    v_mfma_f32_16x16x32_bf16 v[20:23], v[92:95], v[68:71], v[20:23]
    ds_read_b64_tr_b16 v[122:123], v155 offset:33792
    v_mfma_f32_16x16x32_bf16 v[28:31], v[92:95], v[72:75], v[28:31]
    ds_read_b128 v[104:107], v149 offset:36864
    v_mfma_f32_16x16x32_bf16 v[24:27], v[96:99], v[68:71], v[24:27]
    ds_read_b64_tr_b16 v[124:125], v156 offset:32768
    buffer_load_dwordx4 v178, s[96:99], s56 offen offset:2048 lds
    v_mfma_f32_16x16x32_bf16 v[32:35], v[96:99], v[72:75], v[32:35]
    ds_read_b64_tr_b16 v[126:127], v156 offset:33792
    v_mfma_f32_16x16x32_bf16 v[36:39], v[84:87], v[76:79], v[36:39]
    ds_read_b64_tr_b16 v[128:129], v157 offset:32768
    v_mfma_f32_16x16x32_bf16 v[40:43], v[88:91], v[76:79], v[40:43]
    ds_read_b64_tr_b16 v[130:131], v157 offset:33792
    buffer_load_dwordx4 v179, s[96:99], s56 offen offset:3072 lds
    v_mfma_f32_16x16x32_bf16 v[52:55], v[92:95], v[76:79], v[52:55]
    ds_read_b128 v[108:111], v149 offset:40960
    v_mfma_f32_16x16x32_bf16 v[56:59], v[96:99], v[76:79], v[56:59]
    ds_read_b128 v[112:115], v149 offset:45056
    v_mfma_f32_16x16x32_bf16 v[44:47], v[84:87], v[80:83], v[44:47]
    v_mfma_f32_16x16x32_bf16 v[48:51], v[88:91], v[80:83], v[48:51]
    v_mfma_f32_16x16x32_bf16 v[60:63], v[92:95], v[80:83], v[60:63]
    v_mfma_f32_16x16x32_bf16 v[64:67], v[96:99], v[80:83], v[64:67]
    s_waitcnt lgkmcnt(0)
    s_barrier
    v_mfma_f32_16x16x32_bf16 v[4:7], v[116:119], v[100:103], v[4:7]
    s_add_u32 m0, s50, 98304
    s_add_u32 s56, s55, 786432
    buffer_load_dwordx4 v176, s[96:99], s56 offen offset:0 lds
    v_mfma_f32_16x16x32_bf16 v[8:11], v[120:123], v[100:103], v[8:11]
    v_mfma_f32_16x16x32_bf16 v[12:15], v[116:119], v[104:107], v[12:15]
    v_mfma_f32_16x16x32_bf16 v[16:19], v[120:123], v[104:107], v[16:19]
    buffer_load_dwordx4 v177, s[96:99], s56 offen offset:1024 lds
    v_mfma_f32_16x16x32_bf16 v[20:23], v[124:127], v[100:103], v[20:23]
    v_mfma_f32_16x16x32_bf16 v[28:31], v[124:127], v[104:107], v[28:31]
    v_mfma_f32_16x16x32_bf16 v[24:27], v[128:131], v[100:103], v[24:27]
    buffer_load_dwordx4 v178, s[96:99], s56 offen offset:2048 lds
    v_mfma_f32_16x16x32_bf16 v[32:35], v[128:131], v[104:107], v[32:35]
    v_mfma_f32_16x16x32_bf16 v[36:39], v[116:119], v[108:111], v[36:39]
    v_mfma_f32_16x16x32_bf16 v[40:43], v[120:123], v[108:111], v[40:43]
    buffer_load_dwordx4 v179, s[96:99], s56 offen offset:3072 lds
    v_mfma_f32_16x16x32_bf16 v[52:55], v[124:127], v[108:111], v[52:55]
    v_mfma_f32_16x16x32_bf16 v[56:59], v[128:131], v[108:111], v[56:59]
    v_mfma_f32_16x16x32_bf16 v[44:47], v[116:119], v[112:115], v[44:47]
    v_mfma_f32_16x16x32_bf16 v[48:51], v[120:123], v[112:115], v[48:51]
    v_mfma_f32_16x16x32_bf16 v[60:63], v[124:127], v[112:115], v[60:63]
    v_mfma_f32_16x16x32_bf16 v[64:67], v[128:131], v[112:115], v[64:67]
    s_waitcnt vmcnt(16)
    v_add_u32 v168, s50, v162
    v_xor_b32 v169, 0x4000, v168
    v_add_u32 v168, 131072, v168
    v_add_u32 v169, 131072, v169
    s_nop 1
    s_cmp_eq_u32 s41, 0
    s_cbranch_scc0 L_k3_S_e1
    v_cvt_pk_bf16_f32 v68, v36, v37
    v_cvt_pk_bf16_f32 v69, v38, v39
    v_cvt_pk_bf16_f32 v70, v40, v41
    v_cvt_pk_bf16_f32 v71, v42, v43
    ds_write_b128 v168, v[68:71] offset:0
    v_cvt_pk_bf16_f32 v72, v44, v45
    v_cvt_pk_bf16_f32 v73, v46, v47
    v_cvt_pk_bf16_f32 v74, v48, v49
    v_cvt_pk_bf16_f32 v75, v50, v51
    ds_write_b128 v168, v[72:75] offset:1024
    v_cvt_pk_bf16_f32 v76, v52, v53
    v_cvt_pk_bf16_f32 v77, v54, v55
    v_cvt_pk_bf16_f32 v78, v56, v57
    v_cvt_pk_bf16_f32 v79, v58, v59
    ds_write_b128 v168, v[76:79] offset:2048
    v_cvt_pk_bf16_f32 v80, v60, v61
    v_cvt_pk_bf16_f32 v81, v62, v63
    v_cvt_pk_bf16_f32 v82, v64, v65
    v_cvt_pk_bf16_f32 v83, v66, v67
    ds_write_b128 v168, v[80:83] offset:3072
    s_waitcnt lgkmcnt(0)
    s_barrier
    ds_read_b128 v[68:71], v169 offset:0
    ds_read_b128 v[72:75], v169 offset:1024
    ds_read_b128 v[76:79], v169 offset:2048
    ds_read_b128 v[80:83], v169 offset:3072
    v_lshlrev_b32 v164, 16, v164
    v_lshlrev_b32 v165, 16, v165
    s_waitcnt lgkmcnt(3)
    v_lshlrev_b32 v170, 16, v68
    v_and_b32 v171, 0xffff0000, v68
    v_add_f32 v4, v4, v170
    v_add_f32 v5, v5, v171
    v_lshlrev_b32 v170, 16, v69
    v_and_b32 v171, 0xffff0000, v69
    v_add_f32 v6, v6, v170
    v_add_f32 v7, v7, v171
    v_lshlrev_b32 v170, 16, v70
    v_and_b32 v171, 0xffff0000, v70
    v_add_f32 v8, v8, v170
    v_add_f32 v9, v9, v171
    v_lshlrev_b32 v170, 16, v71
    v_and_b32 v171, 0xffff0000, v71
    v_add_f32 v10, v10, v170
    v_add_f32 v11, v11, v171
    v_add_f32 v4, v4, v164
    v_add_f32 v5, v5, v164
    v_add_f32 v6, v6, v164
    v_add_f32 v7, v7, v164
    v_add_f32 v8, v8, v164
    v_add_f32 v9, v9, v164
    v_add_f32 v10, v10, v164
    v_add_f32 v11, v11, v164
    v_lshlrev_b32 v170, 16, v132
    v_and_b32 v171, 0xffff0000, v132
    v_mul_f32 v170, v170, v4
    v_mul_f32 v171, v171, v5
    v_cvt_pk_bf16_f32 v132, v170, v171
    v_lshlrev_b32 v170, 16, v133
    v_and_b32 v171, 0xffff0000, v133
    v_mul_f32 v170, v170, v6
    v_mul_f32 v171, v171, v7
    v_cvt_pk_bf16_f32 v133, v170, v171
    v_lshlrev_b32 v170, 16, v134
    v_and_b32 v171, 0xffff0000, v134
    v_mul_f32 v170, v170, v8
    v_mul_f32 v171, v171, v9
    v_cvt_pk_bf16_f32 v134, v170, v171
    v_lshlrev_b32 v170, 16, v135
    v_and_b32 v171, 0xffff0000, v135
    v_mul_f32 v170, v170, v10
    v_mul_f32 v171, v171, v11
    v_cvt_pk_bf16_f32 v135, v170, v171
    buffer_store_dwordx4 v[132:135], v166, s[28:31], s58 offen offset:0 sc1
    s_waitcnt lgkmcnt(2)
    v_lshlrev_b32 v170, 16, v72
    v_and_b32 v171, 0xffff0000, v72
    v_add_f32 v12, v12, v170
    v_add_f32 v13, v13, v171
    v_lshlrev_b32 v170, 16, v73
    v_and_b32 v171, 0xffff0000, v73
    v_add_f32 v14, v14, v170
    v_add_f32 v15, v15, v171
    v_lshlrev_b32 v170, 16, v74
    v_and_b32 v171, 0xffff0000, v74
    v_add_f32 v16, v16, v170
    v_add_f32 v17, v17, v171
    v_lshlrev_b32 v170, 16, v75
    v_and_b32 v171, 0xffff0000, v75
    v_add_f32 v18, v18, v170
    v_add_f32 v19, v19, v171
    v_add_f32 v12, v12, v165
    v_add_f32 v13, v13, v165
    v_add_f32 v14, v14, v165
    v_add_f32 v15, v15, v165
    v_add_f32 v16, v16, v165
    v_add_f32 v17, v17, v165
    v_add_f32 v18, v18, v165
    v_add_f32 v19, v19, v165
    v_lshlrev_b32 v170, 16, v136
    v_and_b32 v171, 0xffff0000, v136
    v_mul_f32 v170, v170, v12
    v_mul_f32 v171, v171, v13
    v_cvt_pk_bf16_f32 v136, v170, v171
    v_lshlrev_b32 v170, 16, v137
    v_and_b32 v171, 0xffff0000, v137
    v_mul_f32 v170, v170, v14
    v_mul_f32 v171, v171, v15
    v_cvt_pk_bf16_f32 v137, v170, v171
    v_lshlrev_b32 v170, 16, v138
    v_and_b32 v171, 0xffff0000, v138
    v_mul_f32 v170, v170, v16
    v_mul_f32 v171, v171, v17
    v_cvt_pk_bf16_f32 v138, v170, v171
    v_lshlrev_b32 v170, 16, v139
    v_and_b32 v171, 0xffff0000, v139
    v_mul_f32 v170, v170, v18
    v_mul_f32 v171, v171, v19
    v_cvt_pk_bf16_f32 v139, v170, v171
    buffer_store_dwordx4 v[136:139], v166, s[28:31], s58 offen offset:256 sc1
    s_waitcnt lgkmcnt(1)
    v_lshlrev_b32 v170, 16, v76
    v_and_b32 v171, 0xffff0000, v76
    v_add_f32 v20, v20, v170
    v_add_f32 v21, v21, v171
    v_lshlrev_b32 v170, 16, v77
    v_and_b32 v171, 0xffff0000, v77
    v_add_f32 v22, v22, v170
    v_add_f32 v23, v23, v171
    v_lshlrev_b32 v170, 16, v78
    v_and_b32 v171, 0xffff0000, v78
    v_add_f32 v24, v24, v170
    v_add_f32 v25, v25, v171
    v_lshlrev_b32 v170, 16, v79
    v_and_b32 v171, 0xffff0000, v79
    v_add_f32 v26, v26, v170
    v_add_f32 v27, v27, v171
    v_add_f32 v20, v20, v164
    v_add_f32 v21, v21, v164
    v_add_f32 v22, v22, v164
    v_add_f32 v23, v23, v164
    v_add_f32 v24, v24, v164
    v_add_f32 v25, v25, v164
    v_add_f32 v26, v26, v164
    v_add_f32 v27, v27, v164
    v_lshlrev_b32 v170, 16, v140
    v_and_b32 v171, 0xffff0000, v140
    v_mul_f32 v170, v170, v20
    v_mul_f32 v171, v171, v21
    v_cvt_pk_bf16_f32 v140, v170, v171
    v_lshlrev_b32 v170, 16, v141
    v_and_b32 v171, 0xffff0000, v141
    v_mul_f32 v170, v170, v22
    v_mul_f32 v171, v171, v23
    v_cvt_pk_bf16_f32 v141, v170, v171
    v_lshlrev_b32 v170, 16, v142
    v_and_b32 v171, 0xffff0000, v142
    v_mul_f32 v170, v170, v24
    v_mul_f32 v171, v171, v25
    v_cvt_pk_bf16_f32 v142, v170, v171
    v_lshlrev_b32 v170, 16, v143
    v_and_b32 v171, 0xffff0000, v143
    v_mul_f32 v170, v170, v26
    v_mul_f32 v171, v171, v27
    v_cvt_pk_bf16_f32 v143, v170, v171
    buffer_store_dwordx4 v[140:143], v166, s[28:31], s58 offen offset:2048 sc1
    s_waitcnt lgkmcnt(0)
    v_lshlrev_b32 v170, 16, v80
    v_and_b32 v171, 0xffff0000, v80
    v_add_f32 v28, v28, v170
    v_add_f32 v29, v29, v171
    v_lshlrev_b32 v170, 16, v81
    v_and_b32 v171, 0xffff0000, v81
    v_add_f32 v30, v30, v170
    v_add_f32 v31, v31, v171
    v_lshlrev_b32 v170, 16, v82
    v_and_b32 v171, 0xffff0000, v82
    v_add_f32 v32, v32, v170
    v_add_f32 v33, v33, v171
    v_lshlrev_b32 v170, 16, v83
    v_and_b32 v171, 0xffff0000, v83
    v_add_f32 v34, v34, v170
    v_add_f32 v35, v35, v171
    v_add_f32 v28, v28, v165
    v_add_f32 v29, v29, v165
    v_add_f32 v30, v30, v165
    v_add_f32 v31, v31, v165
    v_add_f32 v32, v32, v165
    v_add_f32 v33, v33, v165
    v_add_f32 v34, v34, v165
    v_add_f32 v35, v35, v165
    v_lshlrev_b32 v170, 16, v144
    v_and_b32 v171, 0xffff0000, v144
    v_mul_f32 v170, v170, v28
    v_mul_f32 v171, v171, v29
    v_cvt_pk_bf16_f32 v144, v170, v171
    v_lshlrev_b32 v170, 16, v145
    v_and_b32 v171, 0xffff0000, v145
    v_mul_f32 v170, v170, v30
    v_mul_f32 v171, v171, v31
    v_cvt_pk_bf16_f32 v145, v170, v171
    v_lshlrev_b32 v170, 16, v146
    v_and_b32 v171, 0xffff0000, v146
    v_mul_f32 v170, v170, v32
    v_mul_f32 v171, v171, v33
    v_cvt_pk_bf16_f32 v146, v170, v171
    v_lshlrev_b32 v170, 16, v147
    v_and_b32 v171, 0xffff0000, v147
    v_mul_f32 v170, v170, v34
    v_mul_f32 v171, v171, v35
    v_cvt_pk_bf16_f32 v147, v170, v171
    buffer_store_dwordx4 v[144:147], v166, s[28:31], s58 offen offset:2304 sc1
    s_branch L_k3_p2
L_k3_S_e1:
    v_cvt_pk_bf16_f32 v68, v4, v5
    v_cvt_pk_bf16_f32 v69, v6, v7
    v_cvt_pk_bf16_f32 v70, v8, v9
    v_cvt_pk_bf16_f32 v71, v10, v11
    ds_write_b128 v168, v[68:71] offset:0
    v_cvt_pk_bf16_f32 v72, v12, v13
    v_cvt_pk_bf16_f32 v73, v14, v15
    v_cvt_pk_bf16_f32 v74, v16, v17
    v_cvt_pk_bf16_f32 v75, v18, v19
    ds_write_b128 v168, v[72:75] offset:1024
    v_cvt_pk_bf16_f32 v76, v20, v21
    v_cvt_pk_bf16_f32 v77, v22, v23
    v_cvt_pk_bf16_f32 v78, v24, v25
    v_cvt_pk_bf16_f32 v79, v26, v27
    ds_write_b128 v168, v[76:79] offset:2048
    v_cvt_pk_bf16_f32 v80, v28, v29
    v_cvt_pk_bf16_f32 v81, v30, v31
    v_cvt_pk_bf16_f32 v82, v32, v33
    v_cvt_pk_bf16_f32 v83, v34, v35
    ds_write_b128 v168, v[80:83] offset:3072
    s_waitcnt lgkmcnt(0)
    s_barrier
    ds_read_b128 v[68:71], v169 offset:0
    ds_read_b128 v[72:75], v169 offset:1024
    ds_read_b128 v[76:79], v169 offset:2048
    ds_read_b128 v[80:83], v169 offset:3072
    v_lshlrev_b32 v164, 16, v164
    v_lshlrev_b32 v165, 16, v165
    s_waitcnt lgkmcnt(3)
    v_lshlrev_b32 v170, 16, v68
    v_and_b32 v171, 0xffff0000, v68
    v_add_f32 v36, v36, v170
    v_add_f32 v37, v37, v171
    v_lshlrev_b32 v170, 16, v69
    v_and_b32 v171, 0xffff0000, v69
    v_add_f32 v38, v38, v170
    v_add_f32 v39, v39, v171
    v_lshlrev_b32 v170, 16, v70
    v_and_b32 v171, 0xffff0000, v70
    v_add_f32 v40, v40, v170
    v_add_f32 v41, v41, v171
    v_lshlrev_b32 v170, 16, v71
    v_and_b32 v171, 0xffff0000, v71
    v_add_f32 v42, v42, v170
    v_add_f32 v43, v43, v171
    v_add_f32 v36, v36, v164
    v_add_f32 v37, v37, v164
    v_add_f32 v38, v38, v164
    v_add_f32 v39, v39, v164
    v_add_f32 v40, v40, v164
    v_add_f32 v41, v41, v164
    v_add_f32 v42, v42, v164
    v_add_f32 v43, v43, v164
    v_lshlrev_b32 v170, 16, v132
    v_and_b32 v171, 0xffff0000, v132
    v_mul_f32 v170, v170, v36
    v_mul_f32 v171, v171, v37
    v_cvt_pk_bf16_f32 v132, v170, v171
    v_lshlrev_b32 v170, 16, v133
    v_and_b32 v171, 0xffff0000, v133
    v_mul_f32 v170, v170, v38
    v_mul_f32 v171, v171, v39
    v_cvt_pk_bf16_f32 v133, v170, v171
    v_lshlrev_b32 v170, 16, v134
    v_and_b32 v171, 0xffff0000, v134
    v_mul_f32 v170, v170, v40
    v_mul_f32 v171, v171, v41
    v_cvt_pk_bf16_f32 v134, v170, v171
    v_lshlrev_b32 v170, 16, v135
    v_and_b32 v171, 0xffff0000, v135
    v_mul_f32 v170, v170, v42
    v_mul_f32 v171, v171, v43
    v_cvt_pk_bf16_f32 v135, v170, v171
    buffer_store_dwordx4 v[132:135], v166, s[28:31], s58 offen offset:0 sc1
    s_waitcnt lgkmcnt(2)
    v_lshlrev_b32 v170, 16, v72
    v_and_b32 v171, 0xffff0000, v72
    v_add_f32 v44, v44, v170
    v_add_f32 v45, v45, v171
    v_lshlrev_b32 v170, 16, v73
    v_and_b32 v171, 0xffff0000, v73
    v_add_f32 v46, v46, v170
    v_add_f32 v47, v47, v171
    v_lshlrev_b32 v170, 16, v74
    v_and_b32 v171, 0xffff0000, v74
    v_add_f32 v48, v48, v170
    v_add_f32 v49, v49, v171
    v_lshlrev_b32 v170, 16, v75
    v_and_b32 v171, 0xffff0000, v75
    v_add_f32 v50, v50, v170
    v_add_f32 v51, v51, v171
    v_add_f32 v44, v44, v165
    v_add_f32 v45, v45, v165
    v_add_f32 v46, v46, v165
    v_add_f32 v47, v47, v165
    v_add_f32 v48, v48, v165
    v_add_f32 v49, v49, v165
    v_add_f32 v50, v50, v165
    v_add_f32 v51, v51, v165
    v_lshlrev_b32 v170, 16, v136
    v_and_b32 v171, 0xffff0000, v136
    v_mul_f32 v170, v170, v44
    v_mul_f32 v171, v171, v45
    v_cvt_pk_bf16_f32 v136, v170, v171
    v_lshlrev_b32 v170, 16, v137
    v_and_b32 v171, 0xffff0000, v137
    v_mul_f32 v170, v170, v46
    v_mul_f32 v171, v171, v47
    v_cvt_pk_bf16_f32 v137, v170, v171
    v_lshlrev_b32 v170, 16, v138
    v_and_b32 v171, 0xffff0000, v138
    v_mul_f32 v170, v170, v48
    v_mul_f32 v171, v171, v49
    v_cvt_pk_bf16_f32 v138, v170, v171
    v_lshlrev_b32 v170, 16, v139
    v_and_b32 v171, 0xffff0000, v139
    v_mul_f32 v170, v170, v50
    v_mul_f32 v171, v171, v51
    v_cvt_pk_bf16_f32 v139, v170, v171
    buffer_store_dwordx4 v[136:139], v166, s[28:31], s58 offen offset:256 sc1
    s_waitcnt lgkmcnt(1)
    v_lshlrev_b32 v170, 16, v76
    v_and_b32 v171, 0xffff0000, v76
    v_add_f32 v52, v52, v170
    v_add_f32 v53, v53, v171
    v_lshlrev_b32 v170, 16, v77
    v_and_b32 v171, 0xffff0000, v77
    v_add_f32 v54, v54, v170
    v_add_f32 v55, v55, v171
    v_lshlrev_b32 v170, 16, v78
    v_and_b32 v171, 0xffff0000, v78
    v_add_f32 v56, v56, v170
    v_add_f32 v57, v57, v171
    v_lshlrev_b32 v170, 16, v79
    v_and_b32 v171, 0xffff0000, v79
    v_add_f32 v58, v58, v170
    v_add_f32 v59, v59, v171
    v_add_f32 v52, v52, v164
    v_add_f32 v53, v53, v164
    v_add_f32 v54, v54, v164
    v_add_f32 v55, v55, v164
    v_add_f32 v56, v56, v164
    v_add_f32 v57, v57, v164
    v_add_f32 v58, v58, v164
    v_add_f32 v59, v59, v164
    v_lshlrev_b32 v170, 16, v140
    v_and_b32 v171, 0xffff0000, v140
    v_mul_f32 v170, v170, v52
    v_mul_f32 v171, v171, v53
    v_cvt_pk_bf16_f32 v140, v170, v171
    v_lshlrev_b32 v170, 16, v141
    v_and_b32 v171, 0xffff0000, v141
    v_mul_f32 v170, v170, v54
    v_mul_f32 v171, v171, v55
    v_cvt_pk_bf16_f32 v141, v170, v171
    v_lshlrev_b32 v170, 16, v142
    v_and_b32 v171, 0xffff0000, v142
    v_mul_f32 v170, v170, v56
    v_mul_f32 v171, v171, v57
    v_cvt_pk_bf16_f32 v142, v170, v171
    v_lshlrev_b32 v170, 16, v143
    v_and_b32 v171, 0xffff0000, v143
    v_mul_f32 v170, v170, v58
    v_mul_f32 v171, v171, v59
    v_cvt_pk_bf16_f32 v143, v170, v171
    buffer_store_dwordx4 v[140:143], v166, s[28:31], s58 offen offset:2048 sc1
    s_waitcnt lgkmcnt(0)
    v_lshlrev_b32 v170, 16, v80
    v_and_b32 v171, 0xffff0000, v80
    v_add_f32 v60, v60, v170
    v_add_f32 v61, v61, v171
    v_lshlrev_b32 v170, 16, v81
    v_and_b32 v171, 0xffff0000, v81
    v_add_f32 v62, v62, v170
    v_add_f32 v63, v63, v171
    v_lshlrev_b32 v170, 16, v82
    v_and_b32 v171, 0xffff0000, v82
    v_add_f32 v64, v64, v170
    v_add_f32 v65, v65, v171
    v_lshlrev_b32 v170, 16, v83
    v_and_b32 v171, 0xffff0000, v83
    v_add_f32 v66, v66, v170
    v_add_f32 v67, v67, v171
    v_add_f32 v60, v60, v165
    v_add_f32 v61, v61, v165
    v_add_f32 v62, v62, v165
    v_add_f32 v63, v63, v165
    v_add_f32 v64, v64, v165
    v_add_f32 v65, v65, v165
    v_add_f32 v66, v66, v165
    v_add_f32 v67, v67, v165
    v_lshlrev_b32 v170, 16, v144
    v_and_b32 v171, 0xffff0000, v144
    v_mul_f32 v170, v170, v60
    v_mul_f32 v171, v171, v61
    v_cvt_pk_bf16_f32 v144, v170, v171
    v_lshlrev_b32 v170, 16, v145
    v_and_b32 v171, 0xffff0000, v145
    v_mul_f32 v170, v170, v62
    v_mul_f32 v171, v171, v63
    v_cvt_pk_bf16_f32 v145, v170, v171
    v_lshlrev_b32 v170, 16, v146
    v_and_b32 v171, 0xffff0000, v146
    v_mul_f32 v170, v170, v64
    v_mul_f32 v171, v171, v65
    v_cvt_pk_bf16_f32 v146, v170, v171
    v_lshlrev_b32 v170, 16, v147
    v_and_b32 v171, 0xffff0000, v147
    v_mul_f32 v170, v170, v66
    v_mul_f32 v171, v171, v67
    v_cvt_pk_bf16_f32 v147, v170, v171
    buffer_store_dwordx4 v[144:147], v166, s[28:31], s58 offen offset:2304 sc1
    s_branch L_k3_p2
L_k3_O:
    s_lshr_b32 s49, s53, 2
    s_bfe_u32 s46, s53, 0x10001
    s_and_b32 s44, s53, 1
    s_lshr_b32 s53, s54, 2
    s_lshl_b32 s53, s53, 1
    s_add_u32 s44, s44, s53
    s_sub_u32 s44, 15, s44
    s_and_b32 s45, s54, 3
    s_and_b32 s3, s2, 7
    s_mov_b32 s59, 0
    s_and_b32 s53, s59, 1
    s_lshr_b32 s54, s59, 1
    s_lshl_b32 s54, s54, 2
    s_or_b32 s53, s53, s54
    s_xor_b32 s53, s53, s3
    s_lshl_b32 s47, s44, 20
    s_lshl_b32 s54, s53, 15
    s_add_u32 s47, s47, s54
    s_lshl_b32 s48, s45, 8
    s_lshl_b32 s54, s53, 19
    s_add_u32 s48, s48, s54
    s_add_u32 s59, s59, 1
    s_lshr_b32 s53, s40, 1
    s_lshl_b32 s53, s53, 18
    s_lshl_b32 s54, s42, 11
    s_add_u32 s53, s53, s54
    v_add_u32 v158, s53, v162
    v_mov_b32 v159, v158
    v_lshrrev_b32 v168, 4, v163
    v_lshlrev_b32 v169, 2, v168
    v_and_b32 v170, 15, v163
    v_xor_b32 v169, v169, v170
    s_lshl_b32 s53, s40, 3
    v_add_u32 v168, s53, v168
    v_mul_u32_u24 v168, 1024, v168
    v_lshl_add_u32 v160, v169, 4, v168
    v_xor_b32 v161, 16, v160
    v_add_u32 v161, 3072, v161
    s_waitcnt lgkmcnt(0)
    s_add_u32 s20, s4, 50331648
    s_addc_u32 s21, s5, 0
    s_mov_b32 s22, 16777216
    s_mov_b32 s23, 0x20000
    s_sub_u32 s24, s6, 2048
    s_subb_u32 s25, s7, 0
    s_mov_b32 s26, 4196352
    s_mov_b32 s27, 0x20000
    s_waitcnt vmcnt(0)
    s_cmp_lg_u32 s40, 7
    s_cbranch_scc1 L_k3_dep_okO
    s_add_u32 s32, s4, 92274688
    s_addc_u32 s33, s5, 0
    s_mov_b32 s34, 24576
    s_mov_b32 s35, 0x20000
    v_mov_b32 v174, 0
    s_lshl_b32 s101, s44, 10
    s_add_u32 s101, s101, 8192
    s_lshl_b32 s53, s3, 7
    s_add_u32 s53, s53, s101
    s_mov_b32 s51, 0x200000
L_k3_depO:
    buffer_load_dword v175, v174, s[32:35], s53 offen sc0 sc1
    s_waitcnt vmcnt(0)
    v_cmp_gt_u32 vcc, 16, v175
    s_cbranch_vccz L_k3_dep_okO
    s_sleep 1
    s_sub_u32 s51, s51, 1
    s_cmp_lg_u32 s51, 0
    s_cbranch_scc1 L_k3_depO
L_k3_dep_okO:
    s_barrier
    s_add_u32 m0, s50, 0
    s_nop 0
    buffer_load_dwordx4 v158, s[20:23], s47 offen sc1 lds
    buffer_load_dwordx4 v159, s[20:23], s47 offen offset:1024 sc1 lds
    s_add_u32 s47, s47, 4096
    buffer_load_dwordx4 v160, s[24:27], s48 offen offset:2048 lds
    buffer_load_dwordx4 v161, s[24:27], s48 offen offset:3072 lds
    s_add_u32 s48, s48, 65536
    s_lshl_b32 s53, s42, 14
    s_lshl_b32 s54, s41, 12
    s_add_u32 s53, s53, s54
    v_add_u32 v148, s53, v162
    s_add_u32 m0, s50, 32768
    s_nop 0
    buffer_load_dwordx4 v158, s[20:23], s47 offen sc1 lds
    buffer_load_dwordx4 v159, s[20:23], s47 offen offset:1024 sc1 lds
    s_add_u32 s47, s47, 4096
    buffer_load_dwordx4 v160, s[24:27], s48 offen offset:2048 lds
    buffer_load_dwordx4 v161, s[24:27], s48 offen offset:3072 lds
    s_add_u32 s48, s48, 65536
    v_bfe_u32 v168, v163, 2, 2
    v_lshlrev_b32 v169, 8, v168
    s_lshl_b32 s53, s43, 1
    v_xor_b32 v168, s53, v168
    v_lshl_add_u32 v169, v168, 6, v169
    v_bfe_u32 v168, v163, 1, 1
    v_lshl_add_u32 v169, v168, 5, v169
    v_and_b32 v168, 1, v163
    v_lshl_add_u32 v169, v168, 3, v169
    v_bfe_u32 v168, v163, 4, 1
    v_lshl_add_u32 v169, v168, 4, v169
    v_lshl_add_u32 v169, v168, 10, v169
    v_lshrrev_b32 v168, 5, v163
    v_lshl_add_u32 v169, v168, 13, v169
    s_lshl_b32 s53, s41, 14
    s_add_u32 s53, s53, 2048
    v_add_u32 v150, s53, v169
    v_xor_b32 v151, 16, v150
    v_xor_b32 v152, 64, v150
    v_xor_b32 v153, 80, v150
    v_add_u32 v149, 0x10000, v148
    v_add_u32 v154, 0x10000, v150
    v_add_u32 v155, 0x10000, v151
    v_add_u32 v156, 0x10000, v152
    v_add_u32 v157, 0x10000, v153
    s_add_u32 m0, s50, 65536
    s_nop 0
    buffer_load_dwordx4 v158, s[20:23], s47 offen sc1 lds
    buffer_load_dwordx4 v159, s[20:23], s47 offen offset:1024 sc1 lds
    s_add_u32 s47, s47, 4096
    buffer_load_dwordx4 v160, s[24:27], s48 offen offset:2048 lds
    buffer_load_dwordx4 v161, s[24:27], s48 offen offset:3072 lds
    s_add_u32 s48, s48, 65536
    v_and_b32 v168, 15, v163
    v_lshlrev_b32 v166, 4, v168
    v_lshrrev_b32 v169, 4, v163
    v_lshl_add_u32 v166, v169, 9, v166
    s_and_b32 s18, s2, 7
    s_lshl_b32 s18, s18, 2
    s_bfe_u32 s53, s2, 0x20003
    s_add_u32 s18, s18, s53
    s_lshr_b32 s19, s2, 5
    s_mov_b32 s96, s12
    s_mov_b32 s97, s13
    s_mov_b32 s98, 917504
    s_mov_b32 s99, 0x20000
    v_lshrrev_b32 v170, 3, v163
    v_lshlrev_b32 v170, 10, v170
    v_bfe_u32 v171, v163, 4, 1
    v_lshlrev_b32 v171, 2, v171
    v_and_b32 v172, 7, v163
    v_xor_b32 v171, v171, v172
    v_lshl_add_u32 v176, v171, 4, v170
    v_add_u32 v177, 7168, v176
    v_add_u32 v178, 14336, v176
    v_add_u32 v179, 21504, v176
    s_lshl_b32 s55, s40, 15
    s_lshl_b32 s53, s19, 7
    s_add_u32 s55, s55, s53
    s_lshl_b32 s57, s44, 2
    s_lshl_b32 s53, s42, 1
    s_add_u32 s57, s57, s53
    s_add_u32 s57, s57, s41
    s_add_u32 s28, s4, 83886080
    s_addc_u32 s29, s5, 0
    s_mov_b32 s30, 8388608
    s_mov_b32 s31, 0x20000
    s_lshl_b32 s58, s49, 1
    s_add_u32 s58, s58, s46
    s_lshl_b32 s58, s58, 21
    s_lshl_b32 s53, s57, 15
    s_add_u32 s58, s58, s53
    s_lshl_b32 s53, s45, 13
    s_add_u32 s58, s58, s53
    s_lshl_b32 s53, s43, 12
    s_add_u32 s58, s58, s53
    v_mov_b32 v4, 0
    v_mov_b32 v5, 0
    v_mov_b32 v6, 0
    v_mov_b32 v7, 0
    v_mov_b32 v8, 0
    v_mov_b32 v9, 0
    v_mov_b32 v10, 0
    v_mov_b32 v11, 0
    v_mov_b32 v12, 0
    v_mov_b32 v13, 0
    v_mov_b32 v14, 0
    v_mov_b32 v15, 0
    v_mov_b32 v16, 0
    v_mov_b32 v17, 0
    v_mov_b32 v18, 0
    v_mov_b32 v19, 0
    v_mov_b32 v20, 0
    v_mov_b32 v21, 0
    v_mov_b32 v22, 0
    v_mov_b32 v23, 0
    v_mov_b32 v24, 0
    v_mov_b32 v25, 0
    v_mov_b32 v26, 0
    v_mov_b32 v27, 0
    v_mov_b32 v28, 0
    v_mov_b32 v29, 0
    v_mov_b32 v30, 0
    v_mov_b32 v31, 0
    v_mov_b32 v32, 0
    v_mov_b32 v33, 0
    v_mov_b32 v34, 0
    v_mov_b32 v35, 0
    v_mov_b32 v36, 0
    v_mov_b32 v37, 0
    v_mov_b32 v38, 0
    v_mov_b32 v39, 0
    v_mov_b32 v40, 0
    v_mov_b32 v41, 0
    v_mov_b32 v42, 0
    v_mov_b32 v43, 0
    v_mov_b32 v44, 0
    v_mov_b32 v45, 0
    v_mov_b32 v46, 0
    v_mov_b32 v47, 0
    v_mov_b32 v48, 0
    v_mov_b32 v49, 0
    v_mov_b32 v50, 0
    v_mov_b32 v51, 0
    v_mov_b32 v52, 0
    v_mov_b32 v53, 0
    v_mov_b32 v54, 0
    v_mov_b32 v55, 0
    v_mov_b32 v56, 0
    v_mov_b32 v57, 0
    v_mov_b32 v58, 0
    v_mov_b32 v59, 0
    v_mov_b32 v60, 0
    v_mov_b32 v61, 0
    v_mov_b32 v62, 0
    v_mov_b32 v63, 0
    v_mov_b32 v64, 0
    v_mov_b32 v65, 0
    v_mov_b32 v66, 0
    v_mov_b32 v67, 0
    s_add_u32 m0, s50, 98304
    s_nop 0
    buffer_load_dwordx4 v158, s[20:23], s47 offen sc1 lds
    buffer_load_dwordx4 v159, s[20:23], s47 offen offset:1024 sc1 lds
    s_add_u32 s47, s47, 4096
    buffer_load_dwordx4 v160, s[24:27], s48 offen offset:2048 lds
    buffer_load_dwordx4 v161, s[24:27], s48 offen offset:3072 lds
    s_add_u32 s48, s48, 65536
    s_waitcnt vmcnt(12)
    s_barrier
    ds_read_b128 v[68:71], v148 offset:0
    ds_read_b64_tr_b16 v[84:85], v150 offset:0
    ds_read_b64_tr_b16 v[86:87], v150 offset:4096
    ds_read_b64_tr_b16 v[88:89], v151 offset:0
    ds_read_b64_tr_b16 v[90:91], v151 offset:4096
    ds_read_b128 v[72:75], v148 offset:1024
    ds_read_b64_tr_b16 v[92:93], v152 offset:0
    ds_read_b64_tr_b16 v[94:95], v152 offset:4096
    ds_read_b64_tr_b16 v[96:97], v153 offset:0
    ds_read_b64_tr_b16 v[98:99], v153 offset:4096
    ds_read_b128 v[76:79], v148 offset:8192
    ds_read_b128 v[80:83], v148 offset:9216
    s_mov_b32 s51, 0
    s_cmp_ge_u32 s44, 14
    s_cselect_b32 s51, 4, 0
    s_cselect_b32 s53, 1, 5
    v_and_b32 v164, s53, v163
    v_xor_b32 v164, s3, v164
    v_lshlrev_b32 v164, 7, v164
    s_add_u32 s32, s4, 92274688
    s_addc_u32 s33, s5, 0
    s_mov_b32 s34, 24576
    s_mov_b32 s35, 0x20000
    s_lshl_b32 s101, s44, 10
    s_add_u32 s101, s101, 8192
    s_cmp_eq_u32 s40, 7
    s_cselect_b32 s100, 1, 0
L_k3_O_loop:
    s_waitcnt vmcnt(8) lgkmcnt(0)
    s_barrier
    v_mfma_f32_16x16x32_bf16 v[4:7], v[84:87], v[68:71], v[4:7]
    ds_read_b128 v[100:103], v148 offset:32768
    s_add_u32 m0, s50, 0
    s_nop 0
    buffer_load_dwordx4 v158, s[20:23], s47 offen sc1 lds
    v_mfma_f32_16x16x32_bf16 v[8:11], v[88:91], v[68:71], v[8:11]
    ds_read_b64_tr_b16 v[116:117], v150 offset:32768
    v_mfma_f32_16x16x32_bf16 v[12:15], v[84:87], v[72:75], v[12:15]
    ds_read_b64_tr_b16 v[118:119], v150 offset:36864
    v_mfma_f32_16x16x32_bf16 v[16:19], v[88:91], v[72:75], v[16:19]
    ds_read_b64_tr_b16 v[120:121], v151 offset:32768
    buffer_load_dwordx4 v159, s[20:23], s47 offen offset:1024 sc1 lds
    s_add_u32 s47, s47, 4096
    v_mfma_f32_16x16x32_bf16 v[20:23], v[92:95], v[68:71], v[20:23]
    ds_read_b64_tr_b16 v[122:123], v151 offset:36864
    v_mfma_f32_16x16x32_bf16 v[28:31], v[92:95], v[72:75], v[28:31]
    ds_read_b128 v[104:107], v148 offset:33792
    v_mfma_f32_16x16x32_bf16 v[24:27], v[96:99], v[68:71], v[24:27]
    ds_read_b64_tr_b16 v[124:125], v152 offset:32768
    buffer_load_dwordx4 v160, s[24:27], s48 offen offset:2048 lds
    v_mfma_f32_16x16x32_bf16 v[32:35], v[96:99], v[72:75], v[32:35]
    ds_read_b64_tr_b16 v[126:127], v152 offset:36864
    v_mfma_f32_16x16x32_bf16 v[36:39], v[84:87], v[76:79], v[36:39]
    ds_read_b64_tr_b16 v[128:129], v153 offset:32768
    v_mfma_f32_16x16x32_bf16 v[40:43], v[88:91], v[76:79], v[40:43]
    ds_read_b64_tr_b16 v[130:131], v153 offset:36864
    buffer_load_dwordx4 v161, s[24:27], s48 offen offset:3072 lds
    s_add_u32 s48, s48, 65536
    v_mfma_f32_16x16x32_bf16 v[52:55], v[92:95], v[76:79], v[52:55]
    ds_read_b128 v[108:111], v148 offset:40960
    v_mfma_f32_16x16x32_bf16 v[56:59], v[96:99], v[76:79], v[56:59]
    ds_read_b128 v[112:115], v148 offset:41984
    v_mfma_f32_16x16x32_bf16 v[44:47], v[84:87], v[80:83], v[44:47]
    v_mfma_f32_16x16x32_bf16 v[48:51], v[88:91], v[80:83], v[48:51]
    v_mfma_f32_16x16x32_bf16 v[60:63], v[92:95], v[80:83], v[60:63]
    v_mfma_f32_16x16x32_bf16 v[64:67], v[96:99], v[80:83], v[64:67]
    s_cmp_eq_u32 s100, 1
    s_cbranch_scc1 L_k3_pl
L_k3_plret:
    s_waitcnt vmcnt(8) lgkmcnt(0)
    s_barrier
    v_mfma_f32_16x16x32_bf16 v[4:7], v[116:119], v[100:103], v[4:7]
    ds_read_b128 v[68:71], v149 offset:0
    s_add_u32 m0, s50, 32768
    s_nop 0
    buffer_load_dwordx4 v158, s[20:23], s47 offen sc1 lds
    v_mfma_f32_16x16x32_bf16 v[8:11], v[120:123], v[100:103], v[8:11]
    ds_read_b64_tr_b16 v[84:85], v154 offset:0
    v_mfma_f32_16x16x32_bf16 v[12:15], v[116:119], v[104:107], v[12:15]
    ds_read_b64_tr_b16 v[86:87], v154 offset:4096
    v_mfma_f32_16x16x32_bf16 v[16:19], v[120:123], v[104:107], v[16:19]
    ds_read_b64_tr_b16 v[88:89], v155 offset:0
    buffer_load_dwordx4 v159, s[20:23], s47 offen offset:1024 sc1 lds
    s_add_u32 s47, s47, 4096
    v_mfma_f32_16x16x32_bf16 v[20:23], v[124:127], v[100:103], v[20:23]
    ds_read_b64_tr_b16 v[90:91], v155 offset:4096
    v_mfma_f32_16x16x32_bf16 v[28:31], v[124:127], v[104:107], v[28:31]
    ds_read_b128 v[72:75], v149 offset:1024
    v_mfma_f32_16x16x32_bf16 v[24:27], v[128:131], v[100:103], v[24:27]
    ds_read_b64_tr_b16 v[92:93], v156 offset:0
    buffer_load_dwordx4 v160, s[24:27], s48 offen offset:2048 lds
    v_mfma_f32_16x16x32_bf16 v[32:35], v[128:131], v[104:107], v[32:35]
    ds_read_b64_tr_b16 v[94:95], v156 offset:4096
    v_mfma_f32_16x16x32_bf16 v[36:39], v[116:119], v[108:111], v[36:39]
    ds_read_b64_tr_b16 v[96:97], v157 offset:0
    v_mfma_f32_16x16x32_bf16 v[40:43], v[120:123], v[108:111], v[40:43]
    ds_read_b64_tr_b16 v[98:99], v157 offset:4096
    buffer_load_dwordx4 v161, s[24:27], s48 offen offset:3072 lds
    s_add_u32 s48, s48, 65536
    v_mfma_f32_16x16x32_bf16 v[52:55], v[124:127], v[108:111], v[52:55]
    ds_read_b128 v[76:79], v149 offset:8192
    v_mfma_f32_16x16x32_bf16 v[56:59], v[128:131], v[108:111], v[56:59]
    ds_read_b128 v[80:83], v149 offset:9216
    v_mfma_f32_16x16x32_bf16 v[44:47], v[116:119], v[112:115], v[44:47]
    v_mfma_f32_16x16x32_bf16 v[48:51], v[120:123], v[112:115], v[48:51]
    v_mfma_f32_16x16x32_bf16 v[60:63], v[124:127], v[112:115], v[60:63]
    v_mfma_f32_16x16x32_bf16 v[64:67], v[128:131], v[112:115], v[64:67]
    s_waitcnt vmcnt(8) lgkmcnt(0)
    s_barrier
    v_mfma_f32_16x16x32_bf16 v[4:7], v[84:87], v[68:71], v[4:7]
    ds_read_b128 v[100:103], v149 offset:32768
    s_add_u32 m0, s50, 65536
    s_nop 0
    buffer_load_dwordx4 v158, s[20:23], s47 offen sc1 lds
    v_mfma_f32_16x16x32_bf16 v[8:11], v[88:91], v[68:71], v[8:11]
    ds_read_b64_tr_b16 v[116:117], v154 offset:32768
    v_mfma_f32_16x16x32_bf16 v[12:15], v[84:87], v[72:75], v[12:15]
    ds_read_b64_tr_b16 v[118:119], v154 offset:36864
    v_mfma_f32_16x16x32_bf16 v[16:19], v[88:91], v[72:75], v[16:19]
    ds_read_b64_tr_b16 v[120:121], v155 offset:32768
    buffer_load_dwordx4 v159, s[20:23], s47 offen offset:1024 sc1 lds
    s_add_u32 s47, s47, 4096
    v_mfma_f32_16x16x32_bf16 v[20:23], v[92:95], v[68:71], v[20:23]
    ds_read_b64_tr_b16 v[122:123], v155 offset:36864
    v_mfma_f32_16x16x32_bf16 v[28:31], v[92:95], v[72:75], v[28:31]
    ds_read_b128 v[104:107], v149 offset:33792
    v_mfma_f32_16x16x32_bf16 v[24:27], v[96:99], v[68:71], v[24:27]
    ds_read_b64_tr_b16 v[124:125], v156 offset:32768
    buffer_load_dwordx4 v160, s[24:27], s48 offen offset:2048 lds
    v_mfma_f32_16x16x32_bf16 v[32:35], v[96:99], v[72:75], v[32:35]
    ds_read_b64_tr_b16 v[126:127], v156 offset:36864
    v_mfma_f32_16x16x32_bf16 v[36:39], v[84:87], v[76:79], v[36:39]
    ds_read_b64_tr_b16 v[128:129], v157 offset:32768
    v_mfma_f32_16x16x32_bf16 v[40:43], v[88:91], v[76:79], v[40:43]
    ds_read_b64_tr_b16 v[130:131], v157 offset:36864
    buffer_load_dwordx4 v161, s[24:27], s48 offen offset:3072 lds
    s_add_u32 s48, s48, 65536
    v_mfma_f32_16x16x32_bf16 v[52:55], v[92:95], v[76:79], v[52:55]
    ds_read_b128 v[108:111], v149 offset:40960
    v_mfma_f32_16x16x32_bf16 v[56:59], v[96:99], v[76:79], v[56:59]
    ds_read_b128 v[112:115], v149 offset:41984
    v_mfma_f32_16x16x32_bf16 v[44:47], v[84:87], v[80:83], v[44:47]
    v_mfma_f32_16x16x32_bf16 v[48:51], v[88:91], v[80:83], v[48:51]
    v_mfma_f32_16x16x32_bf16 v[60:63], v[92:95], v[80:83], v[60:63]
    v_mfma_f32_16x16x32_bf16 v[64:67], v[96:99], v[80:83], v[64:67]
    s_waitcnt vmcnt(8) lgkmcnt(0)
    s_barrier
    v_mfma_f32_16x16x32_bf16 v[4:7], v[116:119], v[100:103], v[4:7]
    ds_read_b128 v[68:71], v148 offset:0
    s_add_u32 m0, s50, 98304
    s_nop 0
    buffer_load_dwordx4 v158, s[20:23], s47 offen sc1 lds
    v_mfma_f32_16x16x32_bf16 v[8:11], v[120:123], v[100:103], v[8:11]
    ds_read_b64_tr_b16 v[84:85], v150 offset:0
    v_mfma_f32_16x16x32_bf16 v[12:15], v[116:119], v[104:107], v[12:15]
    ds_read_b64_tr_b16 v[86:87], v150 offset:4096
    v_mfma_f32_16x16x32_bf16 v[16:19], v[120:123], v[104:107], v[16:19]
    ds_read_b64_tr_b16 v[88:89], v151 offset:0
    buffer_load_dwordx4 v159, s[20:23], s47 offen offset:1024 sc1 lds
    s_add_u32 s47, s47, 4096
    v_mfma_f32_16x16x32_bf16 v[20:23], v[124:127], v[100:103], v[20:23]
    ds_read_b64_tr_b16 v[90:91], v151 offset:4096
    v_mfma_f32_16x16x32_bf16 v[28:31], v[124:127], v[104:107], v[28:31]
    ds_read_b128 v[72:75], v148 offset:1024
    v_mfma_f32_16x16x32_bf16 v[24:27], v[128:131], v[100:103], v[24:27]
    ds_read_b64_tr_b16 v[92:93], v152 offset:0
    buffer_load_dwordx4 v160, s[24:27], s48 offen offset:2048 lds
    v_mfma_f32_16x16x32_bf16 v[32:35], v[128:131], v[104:107], v[32:35]
    ds_read_b64_tr_b16 v[94:95], v152 offset:4096
    v_mfma_f32_16x16x32_bf16 v[36:39], v[116:119], v[108:111], v[36:39]
    ds_read_b64_tr_b16 v[96:97], v153 offset:0
    v_mfma_f32_16x16x32_bf16 v[40:43], v[120:123], v[108:111], v[40:43]
    ds_read_b64_tr_b16 v[98:99], v153 offset:4096
    buffer_load_dwordx4 v161, s[24:27], s48 offen offset:3072 lds
    s_add_u32 s48, s48, 65536
    v_mfma_f32_16x16x32_bf16 v[52:55], v[124:127], v[108:111], v[52:55]
    ds_read_b128 v[76:79], v148 offset:8192
    v_mfma_f32_16x16x32_bf16 v[56:59], v[128:131], v[108:111], v[56:59]
    ds_read_b128 v[80:83], v148 offset:9216
    v_mfma_f32_16x16x32_bf16 v[44:47], v[116:119], v[112:115], v[44:47]
    v_mfma_f32_16x16x32_bf16 v[48:51], v[120:123], v[112:115], v[48:51]
    v_mfma_f32_16x16x32_bf16 v[60:63], v[124:127], v[112:115], v[60:63]
    v_mfma_f32_16x16x32_bf16 v[64:67], v[128:131], v[112:115], v[64:67]
    s_bitcmp0_b32 s51, 0
    s_cbranch_scc1 L_k3_sw
L_k3_swret:
    s_add_u32 s51, s51, 1
    s_cmp_lt_u32 s51, 7
    s_cbranch_scc1 L_k3_O_loop
    s_waitcnt vmcnt(8) lgkmcnt(0)
    s_barrier
    v_mfma_f32_16x16x32_bf16 v[4:7], v[84:87], v[68:71], v[4:7]
    ds_read_b128 v[100:103], v148 offset:32768
    s_add_u32 m0, s50, 0
    s_add_u32 s56, s55, 0
    buffer_load_dwordx4 v176, s[96:99], s56 offen offset:0 lds
    v_mfma_f32_16x16x32_bf16 v[8:11], v[88:91], v[68:71], v[8:11]
    ds_read_b64_tr_b16 v[116:117], v150 offset:32768
    v_mfma_f32_16x16x32_bf16 v[12:15], v[84:87], v[72:75], v[12:15]
    ds_read_b64_tr_b16 v[118:119], v150 offset:36864
    v_mfma_f32_16x16x32_bf16 v[16:19], v[88:91], v[72:75], v[16:19]
    ds_read_b64_tr_b16 v[120:121], v151 offset:32768
    buffer_load_dwordx4 v177, s[96:99], s56 offen offset:1024 lds
    v_mfma_f32_16x16x32_bf16 v[20:23], v[92:95], v[68:71], v[20:23]
    ds_read_b64_tr_b16 v[122:123], v151 offset:36864
    v_mfma_f32_16x16x32_bf16 v[28:31], v[92:95], v[72:75], v[28:31]
    ds_read_b128 v[104:107], v148 offset:33792
    v_mfma_f32_16x16x32_bf16 v[24:27], v[96:99], v[68:71], v[24:27]
    ds_read_b64_tr_b16 v[124:125], v152 offset:32768
    buffer_load_dwordx4 v178, s[96:99], s56 offen offset:2048 lds
    v_mfma_f32_16x16x32_bf16 v[32:35], v[96:99], v[72:75], v[32:35]
    ds_read_b64_tr_b16 v[126:127], v152 offset:36864
    v_mfma_f32_16x16x32_bf16 v[36:39], v[84:87], v[76:79], v[36:39]
    ds_read_b64_tr_b16 v[128:129], v153 offset:32768
    v_mfma_f32_16x16x32_bf16 v[40:43], v[88:91], v[76:79], v[40:43]
    ds_read_b64_tr_b16 v[130:131], v153 offset:36864
    buffer_load_dwordx4 v179, s[96:99], s56 offen offset:3072 lds
    v_mfma_f32_16x16x32_bf16 v[52:55], v[92:95], v[76:79], v[52:55]
    ds_read_b128 v[108:111], v148 offset:40960
    v_mfma_f32_16x16x32_bf16 v[56:59], v[96:99], v[76:79], v[56:59]
    ds_read_b128 v[112:115], v148 offset:41984
    v_mfma_f32_16x16x32_bf16 v[44:47], v[84:87], v[80:83], v[44:47]
    v_mfma_f32_16x16x32_bf16 v[48:51], v[88:91], v[80:83], v[48:51]
    v_mfma_f32_16x16x32_bf16 v[60:63], v[92:95], v[80:83], v[60:63]
    v_mfma_f32_16x16x32_bf16 v[64:67], v[96:99], v[80:83], v[64:67]
    s_waitcnt vmcnt(8) lgkmcnt(0)
    s_barrier
    v_mfma_f32_16x16x32_bf16 v[4:7], v[116:119], v[100:103], v[4:7]
    ds_read_b128 v[68:71], v149 offset:0
    s_add_u32 m0, s50, 32768
    s_add_u32 s56, s55, 262144
    buffer_load_dwordx4 v176, s[96:99], s56 offen offset:0 lds
    v_mfma_f32_16x16x32_bf16 v[8:11], v[120:123], v[100:103], v[8:11]
    ds_read_b64_tr_b16 v[84:85], v154 offset:0
    v_mfma_f32_16x16x32_bf16 v[12:15], v[116:119], v[104:107], v[12:15]
    ds_read_b64_tr_b16 v[86:87], v154 offset:4096
    v_mfma_f32_16x16x32_bf16 v[16:19], v[120:123], v[104:107], v[16:19]
    ds_read_b64_tr_b16 v[88:89], v155 offset:0
    buffer_load_dwordx4 v177, s[96:99], s56 offen offset:1024 lds
    v_mfma_f32_16x16x32_bf16 v[20:23], v[124:127], v[100:103], v[20:23]
    ds_read_b64_tr_b16 v[90:91], v155 offset:4096
    v_mfma_f32_16x16x32_bf16 v[28:31], v[124:127], v[104:107], v[28:31]
    ds_read_b128 v[72:75], v149 offset:1024
    v_mfma_f32_16x16x32_bf16 v[24:27], v[128:131], v[100:103], v[24:27]
    ds_read_b64_tr_b16 v[92:93], v156 offset:0
    buffer_load_dwordx4 v178, s[96:99], s56 offen offset:2048 lds
    v_mfma_f32_16x16x32_bf16 v[32:35], v[128:131], v[104:107], v[32:35]
    ds_read_b64_tr_b16 v[94:95], v156 offset:4096
    v_mfma_f32_16x16x32_bf16 v[36:39], v[116:119], v[108:111], v[36:39]
    ds_read_b64_tr_b16 v[96:97], v157 offset:0
    v_mfma_f32_16x16x32_bf16 v[40:43], v[120:123], v[108:111], v[40:43]
    ds_read_b64_tr_b16 v[98:99], v157 offset:4096
    buffer_load_dwordx4 v179, s[96:99], s56 offen offset:3072 lds
    v_mfma_f32_16x16x32_bf16 v[52:55], v[124:127], v[108:111], v[52:55]
    ds_read_b128 v[76:79], v149 offset:8192
    v_mfma_f32_16x16x32_bf16 v[56:59], v[128:131], v[108:111], v[56:59]
    ds_read_b128 v[80:83], v149 offset:9216
    v_mfma_f32_16x16x32_bf16 v[44:47], v[116:119], v[112:115], v[44:47]
    v_mfma_f32_16x16x32_bf16 v[48:51], v[120:123], v[112:115], v[48:51]
    v_mfma_f32_16x16x32_bf16 v[60:63], v[124:127], v[112:115], v[60:63]
    v_mfma_f32_16x16x32_bf16 v[64:67], v[128:131], v[112:115], v[64:67]
    s_waitcnt vmcnt(8) lgkmcnt(0)
    s_barrier
    v_mfma_f32_16x16x32_bf16 v[4:7], v[84:87], v[68:71], v[4:7]
    ds_read_b128 v[100:103], v149 offset:32768
    s_add_u32 m0, s50, 65536
    s_add_u32 s56, s55, 524288
    buffer_load_dwordx4 v176, s[96:99], s56 offen offset:0 lds
    v_mfma_f32_16x16x32_bf16 v[8:11], v[88:91], v[68:71], v[8:11]
    ds_read_b64_tr_b16 v[116:117], v154 offset:32768
    v_mfma_f32_16x16x32_bf16 v[12:15], v[84:87], v[72:75], v[12:15]
    ds_read_b64_tr_b16 v[118:119], v154 offset:36864
    v_mfma_f32_16x16x32_bf16 v[16:19], v[88:91], v[72:75], v[16:19]
    ds_read_b64_tr_b16 v[120:121], v155 offset:32768
    buffer_load_dwordx4 v177, s[96:99], s56 offen offset:1024 lds
    v_mfma_f32_16x16x32_bf16 v[20:23], v[92:95], v[68:71], v[20:23]
    ds_read_b64_tr_b16 v[122:123], v155 offset:36864
    v_mfma_f32_16x16x32_bf16 v[28:31], v[92:95], v[72:75], v[28:31]
    ds_read_b128 v[104:107], v149 offset:33792
    v_mfma_f32_16x16x32_bf16 v[24:27], v[96:99], v[68:71], v[24:27]
    ds_read_b64_tr_b16 v[124:125], v156 offset:32768
    buffer_load_dwordx4 v178, s[96:99], s56 offen offset:2048 lds
    v_mfma_f32_16x16x32_bf16 v[32:35], v[96:99], v[72:75], v[32:35]
    ds_read_b64_tr_b16 v[126:127], v156 offset:36864
    v_mfma_f32_16x16x32_bf16 v[36:39], v[84:87], v[76:79], v[36:39]
    ds_read_b64_tr_b16 v[128:129], v157 offset:32768
    v_mfma_f32_16x16x32_bf16 v[40:43], v[88:91], v[76:79], v[40:43]
    ds_read_b64_tr_b16 v[130:131], v157 offset:36864
    buffer_load_dwordx4 v179, s[96:99], s56 offen offset:3072 lds
    v_mfma_f32_16x16x32_bf16 v[52:55], v[92:95], v[76:79], v[52:55]
    ds_read_b128 v[108:111], v149 offset:40960
    v_mfma_f32_16x16x32_bf16 v[56:59], v[96:99], v[76:79], v[56:59]
    ds_read_b128 v[112:115], v149 offset:41984
    v_mfma_f32_16x16x32_bf16 v[44:47], v[84:87], v[80:83], v[44:47]
    v_mfma_f32_16x16x32_bf16 v[48:51], v[88:91], v[80:83], v[48:51]
    v_mfma_f32_16x16x32_bf16 v[60:63], v[92:95], v[80:83], v[60:63]
    v_mfma_f32_16x16x32_bf16 v[64:67], v[96:99], v[80:83], v[64:67]
    s_waitcnt lgkmcnt(0)
    s_barrier
    v_mfma_f32_16x16x32_bf16 v[4:7], v[116:119], v[100:103], v[4:7]
    s_add_u32 m0, s50, 98304
    s_add_u32 s56, s55, 786432
    buffer_load_dwordx4 v176, s[96:99], s56 offen offset:0 lds
    v_mfma_f32_16x16x32_bf16 v[8:11], v[120:123], v[100:103], v[8:11]
    v_mfma_f32_16x16x32_bf16 v[12:15], v[116:119], v[104:107], v[12:15]
    v_mfma_f32_16x16x32_bf16 v[16:19], v[120:123], v[104:107], v[16:19]
    buffer_load_dwordx4 v177, s[96:99], s56 offen offset:1024 lds
    v_mfma_f32_16x16x32_bf16 v[20:23], v[124:127], v[100:103], v[20:23]
    v_mfma_f32_16x16x32_bf16 v[28:31], v[124:127], v[104:107], v[28:31]
    v_mfma_f32_16x16x32_bf16 v[24:27], v[128:131], v[100:103], v[24:27]
    buffer_load_dwordx4 v178, s[96:99], s56 offen offset:2048 lds
    v_mfma_f32_16x16x32_bf16 v[32:35], v[128:131], v[104:107], v[32:35]
    v_mfma_f32_16x16x32_bf16 v[36:39], v[116:119], v[108:111], v[36:39]
    v_mfma_f32_16x16x32_bf16 v[40:43], v[120:123], v[108:111], v[40:43]
    buffer_load_dwordx4 v179, s[96:99], s56 offen offset:3072 lds
    v_mfma_f32_16x16x32_bf16 v[52:55], v[124:127], v[108:111], v[52:55]
    v_mfma_f32_16x16x32_bf16 v[56:59], v[128:131], v[108:111], v[56:59]
    v_mfma_f32_16x16x32_bf16 v[44:47], v[116:119], v[112:115], v[44:47]
    v_mfma_f32_16x16x32_bf16 v[48:51], v[120:123], v[112:115], v[48:51]
    v_mfma_f32_16x16x32_bf16 v[60:63], v[124:127], v[112:115], v[60:63]
    v_mfma_f32_16x16x32_bf16 v[64:67], v[128:131], v[112:115], v[64:67]
    v_add_u32 v168, s50, v162
    v_xor_b32 v169, 0x4000, v168
    v_add_u32 v168, 131072, v168
    v_add_u32 v169, 131072, v169
    s_nop 1
    s_cmp_eq_u32 s41, 0
    s_cbranch_scc0 L_k3_O_e1
    v_cvt_pk_bf16_f32 v68, v36, v37
    v_cvt_pk_bf16_f32 v69, v38, v39
    v_cvt_pk_bf16_f32 v70, v40, v41
    v_cvt_pk_bf16_f32 v71, v42, v43
    ds_write_b128 v168, v[68:71] offset:0
    v_cvt_pk_bf16_f32 v72, v44, v45
    v_cvt_pk_bf16_f32 v73, v46, v47
    v_cvt_pk_bf16_f32 v74, v48, v49
    v_cvt_pk_bf16_f32 v75, v50, v51
    ds_write_b128 v168, v[72:75] offset:1024
    v_cvt_pk_bf16_f32 v76, v52, v53
    v_cvt_pk_bf16_f32 v77, v54, v55
    v_cvt_pk_bf16_f32 v78, v56, v57
    v_cvt_pk_bf16_f32 v79, v58, v59
    ds_write_b128 v168, v[76:79] offset:2048
    v_cvt_pk_bf16_f32 v80, v60, v61
    v_cvt_pk_bf16_f32 v81, v62, v63
    v_cvt_pk_bf16_f32 v82, v64, v65
    v_cvt_pk_bf16_f32 v83, v66, v67
    ds_write_b128 v168, v[80:83] offset:3072
    s_waitcnt lgkmcnt(0)
    s_barrier
    ds_read_b128 v[68:71], v169 offset:0
    ds_read_b128 v[72:75], v169 offset:1024
    ds_read_b128 v[76:79], v169 offset:2048
    ds_read_b128 v[80:83], v169 offset:3072
    s_waitcnt lgkmcnt(3)
    v_lshlrev_b32 v170, 16, v68
    v_and_b32 v171, 0xffff0000, v68
    v_add_f32 v4, v4, v170
    v_add_f32 v5, v5, v171
    v_lshlrev_b32 v170, 16, v69
    v_and_b32 v171, 0xffff0000, v69
    v_add_f32 v6, v6, v170
    v_add_f32 v7, v7, v171
    v_lshlrev_b32 v170, 16, v70
    v_and_b32 v171, 0xffff0000, v70
    v_add_f32 v8, v8, v170
    v_add_f32 v9, v9, v171
    v_lshlrev_b32 v170, 16, v71
    v_and_b32 v171, 0xffff0000, v71
    v_add_f32 v10, v10, v170
    v_add_f32 v11, v11, v171
    v_cvt_pk_bf16_f32 v132, v4, v5
    v_cvt_pk_bf16_f32 v133, v6, v7
    v_cvt_pk_bf16_f32 v134, v8, v9
    v_cvt_pk_bf16_f32 v135, v10, v11
    buffer_store_dwordx4 v[132:135], v166, s[28:31], s58 offen offset:0 sc1
    s_waitcnt lgkmcnt(2)
    v_lshlrev_b32 v170, 16, v72
    v_and_b32 v171, 0xffff0000, v72
    v_add_f32 v12, v12, v170
    v_add_f32 v13, v13, v171
    v_lshlrev_b32 v170, 16, v73
    v_and_b32 v171, 0xffff0000, v73
    v_add_f32 v14, v14, v170
    v_add_f32 v15, v15, v171
    v_lshlrev_b32 v170, 16, v74
    v_and_b32 v171, 0xffff0000, v74
    v_add_f32 v16, v16, v170
    v_add_f32 v17, v17, v171
    v_lshlrev_b32 v170, 16, v75
    v_and_b32 v171, 0xffff0000, v75
    v_add_f32 v18, v18, v170
    v_add_f32 v19, v19, v171
    v_cvt_pk_bf16_f32 v136, v12, v13
    v_cvt_pk_bf16_f32 v137, v14, v15
    v_cvt_pk_bf16_f32 v138, v16, v17
    v_cvt_pk_bf16_f32 v139, v18, v19
    buffer_store_dwordx4 v[136:139], v166, s[28:31], s58 offen offset:256 sc1
    s_waitcnt lgkmcnt(1)
    v_lshlrev_b32 v170, 16, v76
    v_and_b32 v171, 0xffff0000, v76
    v_add_f32 v20, v20, v170
    v_add_f32 v21, v21, v171
    v_lshlrev_b32 v170, 16, v77
    v_and_b32 v171, 0xffff0000, v77
    v_add_f32 v22, v22, v170
    v_add_f32 v23, v23, v171
    v_lshlrev_b32 v170, 16, v78
    v_and_b32 v171, 0xffff0000, v78
    v_add_f32 v24, v24, v170
    v_add_f32 v25, v25, v171
    v_lshlrev_b32 v170, 16, v79
    v_and_b32 v171, 0xffff0000, v79
    v_add_f32 v26, v26, v170
    v_add_f32 v27, v27, v171
    v_cvt_pk_bf16_f32 v140, v20, v21
    v_cvt_pk_bf16_f32 v141, v22, v23
    v_cvt_pk_bf16_f32 v142, v24, v25
    v_cvt_pk_bf16_f32 v143, v26, v27
    buffer_store_dwordx4 v[140:143], v166, s[28:31], s58 offen offset:2048 sc1
    s_waitcnt lgkmcnt(0)
    v_lshlrev_b32 v170, 16, v80
    v_and_b32 v171, 0xffff0000, v80
    v_add_f32 v28, v28, v170
    v_add_f32 v29, v29, v171
    v_lshlrev_b32 v170, 16, v81
    v_and_b32 v171, 0xffff0000, v81
    v_add_f32 v30, v30, v170
    v_add_f32 v31, v31, v171
    v_lshlrev_b32 v170, 16, v82
    v_and_b32 v171, 0xffff0000, v82
    v_add_f32 v32, v32, v170
    v_add_f32 v33, v33, v171
    v_lshlrev_b32 v170, 16, v83
    v_and_b32 v171, 0xffff0000, v83
    v_add_f32 v34, v34, v170
    v_add_f32 v35, v35, v171
    v_cvt_pk_bf16_f32 v144, v28, v29
    v_cvt_pk_bf16_f32 v145, v30, v31
    v_cvt_pk_bf16_f32 v146, v32, v33
    v_cvt_pk_bf16_f32 v147, v34, v35
    buffer_store_dwordx4 v[144:147], v166, s[28:31], s58 offen offset:2304 sc1
    s_branch L_k3_p2
L_k3_O_e1:
    v_cvt_pk_bf16_f32 v68, v4, v5
    v_cvt_pk_bf16_f32 v69, v6, v7
    v_cvt_pk_bf16_f32 v70, v8, v9
    v_cvt_pk_bf16_f32 v71, v10, v11
    ds_write_b128 v168, v[68:71] offset:0
    v_cvt_pk_bf16_f32 v72, v12, v13
    v_cvt_pk_bf16_f32 v73, v14, v15
    v_cvt_pk_bf16_f32 v74, v16, v17
    v_cvt_pk_bf16_f32 v75, v18, v19
    ds_write_b128 v168, v[72:75] offset:1024
    v_cvt_pk_bf16_f32 v76, v20, v21
    v_cvt_pk_bf16_f32 v77, v22, v23
    v_cvt_pk_bf16_f32 v78, v24, v25
    v_cvt_pk_bf16_f32 v79, v26, v27
    ds_write_b128 v168, v[76:79] offset:2048
    v_cvt_pk_bf16_f32 v80, v28, v29
    v_cvt_pk_bf16_f32 v81, v30, v31
    v_cvt_pk_bf16_f32 v82, v32, v33
    v_cvt_pk_bf16_f32 v83, v34, v35
    ds_write_b128 v168, v[80:83] offset:3072
    s_waitcnt lgkmcnt(0)
    s_barrier
    ds_read_b128 v[68:71], v169 offset:0
    ds_read_b128 v[72:75], v169 offset:1024
    ds_read_b128 v[76:79], v169 offset:2048
    ds_read_b128 v[80:83], v169 offset:3072
    s_waitcnt lgkmcnt(3)
    v_lshlrev_b32 v170, 16, v68
    v_and_b32 v171, 0xffff0000, v68
    v_add_f32 v36, v36, v170
    v_add_f32 v37, v37, v171
    v_lshlrev_b32 v170, 16, v69
    v_and_b32 v171, 0xffff0000, v69
    v_add_f32 v38, v38, v170
    v_add_f32 v39, v39, v171
    v_lshlrev_b32 v170, 16, v70
    v_and_b32 v171, 0xffff0000, v70
    v_add_f32 v40, v40, v170
    v_add_f32 v41, v41, v171
    v_lshlrev_b32 v170, 16, v71
    v_and_b32 v171, 0xffff0000, v71
    v_add_f32 v42, v42, v170
    v_add_f32 v43, v43, v171
    v_cvt_pk_bf16_f32 v132, v36, v37
    v_cvt_pk_bf16_f32 v133, v38, v39
    v_cvt_pk_bf16_f32 v134, v40, v41
    v_cvt_pk_bf16_f32 v135, v42, v43
    buffer_store_dwordx4 v[132:135], v166, s[28:31], s58 offen offset:0 sc1
    s_waitcnt lgkmcnt(2)
    v_lshlrev_b32 v170, 16, v72
    v_and_b32 v171, 0xffff0000, v72
    v_add_f32 v44, v44, v170
    v_add_f32 v45, v45, v171
    v_lshlrev_b32 v170, 16, v73
    v_and_b32 v171, 0xffff0000, v73
    v_add_f32 v46, v46, v170
    v_add_f32 v47, v47, v171
    v_lshlrev_b32 v170, 16, v74
    v_and_b32 v171, 0xffff0000, v74
    v_add_f32 v48, v48, v170
    v_add_f32 v49, v49, v171
    v_lshlrev_b32 v170, 16, v75
    v_and_b32 v171, 0xffff0000, v75
    v_add_f32 v50, v50, v170
    v_add_f32 v51, v51, v171
    v_cvt_pk_bf16_f32 v136, v44, v45
    v_cvt_pk_bf16_f32 v137, v46, v47
    v_cvt_pk_bf16_f32 v138, v48, v49
    v_cvt_pk_bf16_f32 v139, v50, v51
    buffer_store_dwordx4 v[136:139], v166, s[28:31], s58 offen offset:256 sc1
    s_waitcnt lgkmcnt(1)
    v_lshlrev_b32 v170, 16, v76
    v_and_b32 v171, 0xffff0000, v76
    v_add_f32 v52, v52, v170
    v_add_f32 v53, v53, v171
    v_lshlrev_b32 v170, 16, v77
    v_and_b32 v171, 0xffff0000, v77
    v_add_f32 v54, v54, v170
    v_add_f32 v55, v55, v171
    v_lshlrev_b32 v170, 16, v78
    v_and_b32 v171, 0xffff0000, v78
    v_add_f32 v56, v56, v170
    v_add_f32 v57, v57, v171
    v_lshlrev_b32 v170, 16, v79
    v_and_b32 v171, 0xffff0000, v79
    v_add_f32 v58, v58, v170
    v_add_f32 v59, v59, v171
    v_cvt_pk_bf16_f32 v140, v52, v53
    v_cvt_pk_bf16_f32 v141, v54, v55
    v_cvt_pk_bf16_f32 v142, v56, v57
    v_cvt_pk_bf16_f32 v143, v58, v59
    buffer_store_dwordx4 v[140:143], v166, s[28:31], s58 offen offset:2048 sc1
    s_waitcnt lgkmcnt(0)
    v_lshlrev_b32 v170, 16, v80
    v_and_b32 v171, 0xffff0000, v80
    v_add_f32 v60, v60, v170
    v_add_f32 v61, v61, v171
    v_lshlrev_b32 v170, 16, v81
    v_and_b32 v171, 0xffff0000, v81
    v_add_f32 v62, v62, v170
    v_add_f32 v63, v63, v171
    v_lshlrev_b32 v170, 16, v82
    v_and_b32 v171, 0xffff0000, v82
    v_add_f32 v64, v64, v170
    v_add_f32 v65, v65, v171
    v_lshlrev_b32 v170, 16, v83
    v_and_b32 v171, 0xffff0000, v83
    v_add_f32 v66, v66, v170
    v_add_f32 v67, v67, v171
    v_cvt_pk_bf16_f32 v144, v60, v61
    v_cvt_pk_bf16_f32 v145, v62, v63
    v_cvt_pk_bf16_f32 v146, v64, v65
    v_cvt_pk_bf16_f32 v147, v66, v67
    buffer_store_dwordx4 v[144:147], v166, s[28:31], s58 offen offset:2304 sc1
L_k3_p2:
    s_lshr_b32 s41, s40, 1
    s_mov_b32 s20, s16
    s_mov_b32 s21, s17
    s_mov_b32 s22, 2097152
    s_mov_b32 s23, 0x20000
    s_lshl_b32 s53, s19, 7
    v_lshrrev_b32 v168, 3, v0
    v_lshlrev_b32 v168, 10, v168
    v_and_b32 v169, 7, v0
    v_lshl_add_u32 v252, v169, 4, v168
    s_lshl_b32 s58, s18, 16
    s_add_u32 s58, s58, s53
    s_add_u32 s32, s4, 92274688
    s_addc_u32 s33, s5, 0
    s_mov_b32 s34, 24576
    s_mov_b32 s35, 0x20000
    s_add_u32 s36, s4, 104857600
    s_addc_u32 s37, s5, 0
    s_mov_b32 s38, 3670016
    s_mov_b32 s39, 0x20000
    v_bfe_u32 v168, v163, 2, 2
    v_lshlrev_b32 v169, 7, v168
    v_lshrrev_b32 v168, 1, v168
    v_lshl_add_u32 v169, v168, 6, v169
    v_bfe_u32 v168, v163, 4, 1
    v_lshl_add_u32 v169, v168, 5, v169
    v_and_b32 v168, 3, v163
    v_lshl_add_u32 v169, v168, 3, v169
    v_lshrrev_b32 v168, 5, v163
    v_lshl_add_u32 v169, v168, 9, v169
    s_mul_i32 s53, s41, 28672
    v_add_u32 v170, s53, v169
    v_xor_b32 v171, 64, v170
    v_mov_b32 v172, 0
    v_mov_b32 v173, 1
    s_lshl_b32 s53, s44, 7
    s_waitcnt vmcnt(0)
    s_barrier
    s_cmp_lg_u32 s40, 7
    s_cbranch_scc1 L_k3_nosig
    s_mov_b64 exec, 1
    buffer_atomic_add v173, v172, s[32:35], s53 offen sc1
    s_mov_b64 exec, -1
L_k3_nosig:
    buffer_load_dwordx4 v[208:211], v252, s[20:23], s58 offen
    ds_read_b64_tr_b16 v[36:37], v170 offset:0
    ds_read_b64_tr_b16 v[38:39], v170 offset:1024
    ds_read_b64_tr_b16 v[40:41], v171 offset:0
    ds_read_b64_tr_b16 v[42:43], v171 offset:1024
    ds_read_b64_tr_b16 v[44:45], v170 offset:2048
    ds_read_b64_tr_b16 v[46:47], v170 offset:3072
    ds_read_b64_tr_b16 v[48:49], v171 offset:2048
    ds_read_b64_tr_b16 v[50:51], v171 offset:3072
    ds_read_b64_tr_b16 v[52:53], v170 offset:4096
    ds_read_b64_tr_b16 v[54:55], v170 offset:5120
    ds_read_b64_tr_b16 v[56:57], v171 offset:4096
    ds_read_b64_tr_b16 v[58:59], v171 offset:5120
    s_waitcnt lgkmcnt(2)
    ds_read_b64_tr_b16 v[60:61], v170 offset:6144
    ds_read_b64_tr_b16 v[62:63], v170 offset:7168
    ds_read_b64_tr_b16 v[64:65], v171 offset:6144
    ds_read_b64_tr_b16 v[66:67], v171 offset:7168
    ds_read_b64_tr_b16 v[176:177], v170 offset:8192
    ds_read_b64_tr_b16 v[178:179], v170 offset:9216
    ds_read_b64_tr_b16 v[180:181], v171 offset:8192
    ds_read_b64_tr_b16 v[182:183], v171 offset:9216
    ds_read_b64_tr_b16 v[184:185], v170 offset:10240
    ds_read_b64_tr_b16 v[186:187], v170 offset:11264
    ds_read_b64_tr_b16 v[188:189], v171 offset:10240
    ds_read_b64_tr_b16 v[190:191], v171 offset:11264
    s_waitcnt lgkmcnt(2)
    ds_read_b64_tr_b16 v[192:193], v170 offset:12288
    ds_read_b64_tr_b16 v[194:195], v170 offset:13312
    ds_read_b64_tr_b16 v[196:197], v171 offset:12288
    ds_read_b64_tr_b16 v[198:199], v171 offset:13312
    ds_read_b64_tr_b16 v[200:201], v170 offset:14336
    ds_read_b64_tr_b16 v[202:203], v170 offset:15360
    ds_read_b64_tr_b16 v[204:205], v171 offset:14336
    ds_read_b64_tr_b16 v[206:207], v171 offset:15360
    ds_read_b64_tr_b16 v[124:125], v170 offset:16384
    ds_read_b64_tr_b16 v[126:127], v170 offset:17408
    ds_read_b64_tr_b16 v[128:129], v171 offset:16384
    ds_read_b64_tr_b16 v[130:131], v171 offset:17408
    s_waitcnt lgkmcnt(2)
    ds_read_b64_tr_b16 v[212:213], v170 offset:18432
    ds_read_b64_tr_b16 v[214:215], v170 offset:19456
    ds_read_b64_tr_b16 v[216:217], v171 offset:18432
    ds_read_b64_tr_b16 v[218:219], v171 offset:19456
    ds_read_b64_tr_b16 v[220:221], v170 offset:20480
    ds_read_b64_tr_b16 v[222:223], v170 offset:21504
    ds_read_b64_tr_b16 v[224:225], v171 offset:20480
    ds_read_b64_tr_b16 v[226:227], v171 offset:21504
    ds_read_b64_tr_b16 v[228:229], v170 offset:22528
    ds_read_b64_tr_b16 v[230:231], v170 offset:23552
    ds_read_b64_tr_b16 v[232:233], v171 offset:22528
    ds_read_b64_tr_b16 v[234:235], v171 offset:23552
    s_waitcnt lgkmcnt(2)
    ds_read_b64_tr_b16 v[236:237], v170 offset:24576
    ds_read_b64_tr_b16 v[238:239], v170 offset:25600
    ds_read_b64_tr_b16 v[240:241], v171 offset:24576
    ds_read_b64_tr_b16 v[242:243], v171 offset:25600
    ds_read_b64_tr_b16 v[244:245], v170 offset:26624
    ds_read_b64_tr_b16 v[246:247], v170 offset:27648
    ds_read_b64_tr_b16 v[248:249], v171 offset:26624
    ds_read_b64_tr_b16 v[250:251], v171 offset:27648
    s_add_u32 s20, s4, 83886080
    s_addc_u32 s21, s5, 0
    s_mov_b32 s22, 4194304
    s_mov_b32 s23, 0x20000
    s_cmp_ge_u32 s18, 28
    s_cselect_b32 s22, 8388608, s22
    s_cselect_b32 s52, 23, 15
    s_mov_b32 s28, s14
    s_mov_b32 s29, s15
    s_mov_b32 s30, 2097152
    s_mov_b32 s31, 0x20000
    s_lshl_b32 s57, s18, 1
    s_add_u32 s57, s57, s42
    s_mul_i32 s55, s57, 57344
    s_mul_i32 s53, s41, 14336
    s_add_u32 s55, s55, s53
    s_lshl_b32 s56, s41, 21
    s_lshl_b32 s53, s57, 15
    s_add_u32 s56, s56, s53
    s_lshl_b32 s53, s19, 12
    s_add_u32 s56, s56, s53
    v_and_b32 v168, 31, v163
    s_lshl_b32 s53, s42, 5
    v_add_u32 v168, s53, v168
    v_mul_u32_u24 v168, 272, v168
    v_lshrrev_b32 v169, 5, v163
    v_lshl_add_u32 v168, v169, 4, v168
    s_mul_i32 s53, s41, 17408
    v_add_u32 v168, s53, v168
    v_lshrrev_b32 v169, 3, v0
    v_mul_u32_u24 v169, 272, v169
    v_and_b32 v170, 7, v0
    v_lshl_add_u32 v169, v170, 5, v169
    s_cmp_lg_u32 s40, 7
    s_cbranch_scc1 L_k3_go
    s_lshr_b32 s53, s18, 1
    s_lshl_b32 s53, s53, 7
    s_mov_b32 s51, 0x200000
L_k3_poll:
    buffer_load_dword v173, v172, s[32:35], s53 offen sc0 sc1
    s_waitcnt vmcnt(0)
    v_cmp_gt_u32 vcc, s52, v173
    s_cbranch_vccz L_k3_go
    s_sleep 1
    s_sub_u32 s51, s51, 1
    s_cmp_lg_u32 s51, 0
    s_cbranch_scc1 L_k3_poll
L_k3_go:
    s_waitcnt lgkmcnt(0)
    s_barrier
    buffer_load_dwordx4 v[132:135], v162, s[20:23], s56 offen offset:0 sc1
    buffer_load_dwordx4 v[136:139], v162, s[20:23], s56 offen offset:1024 sc1
    buffer_load_dwordx4 v[140:143], v162, s[20:23], s56 offen offset:2048 sc1
    buffer_load_dwordx4 v[144:147], v162, s[20:23], s56 offen offset:3072 sc1
    buffer_load_dwordx4 v[68:71], v162, s[36:39], s55 offen offset:0 sc1
    buffer_load_dwordx4 v[72:75], v162, s[36:39], s55 offen offset:1024 sc1
    buffer_load_dwordx4 v[76:79], v162, s[36:39], s55 offen offset:2048 sc1
    buffer_load_dwordx4 v[80:83], v162, s[36:39], s55 offen offset:3072 sc1
    s_add_u32 s55, s55, 4096
    buffer_load_dwordx4 v[84:87], v162, s[36:39], s55 offen offset:0 sc1
    buffer_load_dwordx4 v[88:91], v162, s[36:39], s55 offen offset:1024 sc1
    buffer_load_dwordx4 v[92:95], v162, s[36:39], s55 offen offset:2048 sc1
    buffer_load_dwordx4 v[96:99], v162, s[36:39], s55 offen offset:3072 sc1
    s_add_u32 s55, s55, 4096
    buffer_load_dwordx4 v[100:103], v162, s[36:39], s55 offen offset:0 sc1
    buffer_load_dwordx4 v[104:107], v162, s[36:39], s55 offen offset:1024 sc1
    buffer_load_dwordx4 v[108:111], v162, s[36:39], s55 offen offset:2048 sc1
    buffer_load_dwordx4 v[112:115], v162, s[36:39], s55 offen offset:3072 sc1
    s_add_u32 s55, s55, 4096
    buffer_load_dwordx4 v[116:119], v162, s[36:39], s55 offen offset:0 sc1
    buffer_load_dwordx4 v[120:123], v162, s[36:39], s55 offen offset:1024 sc1
    s_waitcnt vmcnt(14)
    v_lshlrev_b32 v4, 16, v132
    v_and_b32 v5, 0xffff0000, v132
    v_lshlrev_b32 v6, 16, v133
    v_and_b32 v7, 0xffff0000, v133
    v_lshlrev_b32 v8, 16, v134
    v_and_b32 v9, 0xffff0000, v134
    v_lshlrev_b32 v10, 16, v135
    v_and_b32 v11, 0xffff0000, v135
    v_lshlrev_b32 v12, 16, v136
    v_and_b32 v13, 0xffff0000, v136
    v_lshlrev_b32 v14, 16, v137
    v_and_b32 v15, 0xffff0000, v137
    v_lshlrev_b32 v16, 16, v138
    v_and_b32 v17, 0xffff0000, v138
    v_lshlrev_b32 v18, 16, v139
    v_and_b32 v19, 0xffff0000, v139
    v_lshlrev_b32 v20, 16, v140
    v_and_b32 v21, 0xffff0000, v140
    v_lshlrev_b32 v22, 16, v141
    v_and_b32 v23, 0xffff0000, v141
    v_lshlrev_b32 v24, 16, v142
    v_and_b32 v25, 0xffff0000, v142
    v_lshlrev_b32 v26, 16, v143
    v_and_b32 v27, 0xffff0000, v143
    v_lshlrev_b32 v28, 16, v144
    v_and_b32 v29, 0xffff0000, v144
    v_lshlrev_b32 v30, 16, v145
    v_and_b32 v31, 0xffff0000, v145
    v_lshlrev_b32 v32, 16, v146
    v_and_b32 v33, 0xffff0000, v146
    v_lshlrev_b32 v34, 16, v147
    v_and_b32 v35, 0xffff0000, v147
    s_nop 0
    s_waitcnt vmcnt(13)
    v_mfma_f32_32x32x16_bf16 v[4:19], v[36:39], v[68:71], v[4:19]
    v_mfma_f32_32x32x16_bf16 v[20:35], v[40:43], v[68:71], v[20:35]
    s_waitcnt vmcnt(12)
    v_mfma_f32_32x32x16_bf16 v[4:19], v[44:47], v[72:75], v[4:19]
    v_mfma_f32_32x32x16_bf16 v[20:35], v[48:51], v[72:75], v[20:35]
    s_waitcnt vmcnt(11)
    v_mfma_f32_32x32x16_bf16 v[4:19], v[52:55], v[76:79], v[4:19]
    v_mfma_f32_32x32x16_bf16 v[20:35], v[56:59], v[76:79], v[20:35]
    s_waitcnt vmcnt(10)
    v_mfma_f32_32x32x16_bf16 v[4:19], v[60:63], v[80:83], v[4:19]
    v_mfma_f32_32x32x16_bf16 v[20:35], v[64:67], v[80:83], v[20:35]
    s_waitcnt vmcnt(9)
    v_mfma_f32_32x32x16_bf16 v[4:19], v[176:179], v[84:87], v[4:19]
    v_mfma_f32_32x32x16_bf16 v[20:35], v[180:183], v[84:87], v[20:35]
    s_waitcnt vmcnt(8)
    v_mfma_f32_32x32x16_bf16 v[4:19], v[184:187], v[88:91], v[4:19]
    v_mfma_f32_32x32x16_bf16 v[20:35], v[188:191], v[88:91], v[20:35]
    s_waitcnt vmcnt(7)
    v_mfma_f32_32x32x16_bf16 v[4:19], v[192:195], v[92:95], v[4:19]
    v_mfma_f32_32x32x16_bf16 v[20:35], v[196:199], v[92:95], v[20:35]
    s_waitcnt vmcnt(6)
    v_mfma_f32_32x32x16_bf16 v[4:19], v[200:203], v[96:99], v[4:19]
    v_mfma_f32_32x32x16_bf16 v[20:35], v[204:207], v[96:99], v[20:35]
    s_waitcnt vmcnt(5)
    v_mfma_f32_32x32x16_bf16 v[4:19], v[124:127], v[100:103], v[4:19]
    v_mfma_f32_32x32x16_bf16 v[20:35], v[128:131], v[100:103], v[20:35]
    s_waitcnt vmcnt(4)
    v_mfma_f32_32x32x16_bf16 v[4:19], v[212:215], v[104:107], v[4:19]
    v_mfma_f32_32x32x16_bf16 v[20:35], v[216:219], v[104:107], v[20:35]
    s_waitcnt vmcnt(3)
    v_mfma_f32_32x32x16_bf16 v[4:19], v[220:223], v[108:111], v[4:19]
    v_mfma_f32_32x32x16_bf16 v[20:35], v[224:227], v[108:111], v[20:35]
    s_waitcnt vmcnt(2)
    v_mfma_f32_32x32x16_bf16 v[4:19], v[228:231], v[112:115], v[4:19]
    v_mfma_f32_32x32x16_bf16 v[20:35], v[232:235], v[112:115], v[20:35]
    s_waitcnt vmcnt(1)
    v_mfma_f32_32x32x16_bf16 v[4:19], v[236:239], v[116:119], v[4:19]
    v_mfma_f32_32x32x16_bf16 v[20:35], v[240:243], v[116:119], v[20:35]
    s_waitcnt vmcnt(0)
    v_mfma_f32_32x32x16_bf16 v[4:19], v[244:247], v[120:123], v[4:19]
    v_mfma_f32_32x32x16_bf16 v[20:35], v[248:251], v[120:123], v[20:35]
    s_nop 10
    ds_write_b128 v168, v[4:7] offset:0
    ds_write_b128 v168, v[8:11] offset:32
    ds_write_b128 v168, v[12:15] offset:64
    ds_write_b128 v168, v[16:19] offset:96
    ds_write_b128 v168, v[20:23] offset:128
    ds_write_b128 v168, v[24:27] offset:160
    ds_write_b128 v168, v[28:31] offset:192
    ds_write_b128 v168, v[32:35] offset:224
    s_waitcnt lgkmcnt(0)
    s_barrier
    ds_read_b128 v[68:71], v169 offset:0
    ds_read_b128 v[72:75], v169 offset:16
    ds_read_b128 v[76:79], v169 offset:17408
    ds_read_b128 v[80:83], v169 offset:17424
    ds_read_b128 v[84:87], v169 offset:34816
    ds_read_b128 v[88:91], v169 offset:34832
    ds_read_b128 v[92:95], v169 offset:52224
    ds_read_b128 v[96:99], v169 offset:52240
    s_waitcnt lgkmcnt(4)
    v_add_f32 v68, v68, v76
    v_add_f32 v69, v69, v77
    v_add_f32 v70, v70, v78
    v_add_f32 v71, v71, v79
    v_add_f32 v72, v72, v80
    v_add_f32 v73, v73, v81
    v_add_f32 v74, v74, v82
    v_add_f32 v75, v75, v83
    s_waitcnt lgkmcnt(2)
    v_add_f32 v68, v68, v84
    v_add_f32 v69, v69, v85
    v_add_f32 v70, v70, v86
    v_add_f32 v71, v71, v87
    v_add_f32 v72, v72, v88
    v_add_f32 v73, v73, v89
    v_add_f32 v74, v74, v90
    v_add_f32 v75, v75, v91
    s_waitcnt lgkmcnt(0)
    v_add_f32 v68, v68, v92
    v_add_f32 v69, v69, v93
    v_add_f32 v70, v70, v94
    v_add_f32 v71, v71, v95
    v_add_f32 v72, v72, v96
    v_add_f32 v73, v73, v97
    v_add_f32 v74, v74, v98
    v_add_f32 v75, v75, v99
    v_lshlrev_b32 v170, 16, v208
    v_and_b32 v171, 0xffff0000, v208
    v_add_f32 v170, v170, v68
    v_add_f32 v171, v171, v69
    v_cvt_pk_bf16_f32 v208, v170, v171
    v_lshlrev_b32 v170, 16, v209
    v_and_b32 v171, 0xffff0000, v209
    v_add_f32 v170, v170, v70
    v_add_f32 v171, v171, v71
    v_cvt_pk_bf16_f32 v209, v170, v171
    v_lshlrev_b32 v170, 16, v210
    v_and_b32 v171, 0xffff0000, v210
    v_add_f32 v170, v170, v72
    v_add_f32 v171, v171, v73
    v_cvt_pk_bf16_f32 v210, v170, v171
    v_lshlrev_b32 v170, 16, v211
    v_and_b32 v171, 0xffff0000, v211
    v_add_f32 v170, v170, v74
    v_add_f32 v171, v171, v75
    v_cvt_pk_bf16_f32 v211, v170, v171
    buffer_store_dwordx4 v[208:211], v252, s[28:31], s58 offen sc1
L_k3_exit:
    s_endpgm
L_k3_pl:
    buffer_load_dword v165, v164, s[32:35], s101 offen sc0 sc1
    s_branch L_k3_plret
L_k3_sw:
    s_and_b32 s53, s59, 1
    s_lshr_b32 s54, s59, 1
    s_lshl_b32 s54, s54, 2
    s_or_b32 s53, s53, s54
    s_xor_b32 s53, s53, s3
    s_lshl_b32 s47, s44, 20
    s_lshl_b32 s54, s53, 15
    s_add_u32 s47, s47, s54
    s_lshl_b32 s48, s45, 8
    s_lshl_b32 s54, s53, 19
    s_add_u32 s48, s48, s54
    s_add_u32 s59, s59, 1
    s_cmp_lg_u32 s100, 1
    s_cbranch_scc1 L_k3_swret
    s_mov_b32 s100, 0
    s_mov_b32 s53, 0x200000
L_k3_sw2:
    v_cmp_gt_u32 vcc, 16, v165
    s_cbranch_vccz L_k3_swret
    buffer_load_dword v165, v164, s[32:35], s101 offen sc0 sc1
    s_waitcnt vmcnt(0)
    s_sub_u32 s53, s53, 1
    s_cmp_lg_u32 s53, 0
    s_cbranch_scc1 L_k3_sw2
    s_branch L_k3_swret
.section .rodata,"a"
.p2align 6
.amdhsa_kernel parallel_sum__compressed_kv_cla__mixer_gmlp__prompt_kernel
  .amdhsa_next_free_vgpr 256
  .amdhsa_next_free_sgpr 102
  .amdhsa_accum_offset 256
  .amdhsa_group_segment_fixed_size 0
  .amdhsa_kernarg_size 112
  .amdhsa_user_sgpr_count 2
  .amdhsa_user_sgpr_kernarg_segment_ptr 1
  .amdhsa_system_sgpr_workgroup_id_x 1
.end_amdhsa_kernel
```
